```python
import torch

def _softmax(x, axis=-1):
    return torch.softmax(x, dim=axis)

def _gelu(x):
    return torch.nn.functional.gelu(x, approximate='tanh')

def _silu(x):
    return torch.nn.functional.silu(x)

def _sigmoid(x):
    return torch.sigmoid(x)

def _layernorm(x, axis=-1, eps=1e-05):
    m = x.mean(dim=axis, keepdim=True)
    v = x.var(dim=axis, keepdim=True, unbiased=False)
    return (x - m) / torch.sqrt(v + eps)

def _scatter_add(tgt, idx, src, axis=0):
    return tgt.clone().index_add_(axis, idx, src)

def _segment_sum(src, seg, n):
    out = torch.zeros((n,) + src.shape[1:], dtype=src.dtype)
    return out.index_add_(0, seg, src)

def _pad(x, pw):
    flat = tuple((v for pair in reversed(pw) for v in pair))
    return torch.nn.functional.pad(x, flat)
kernel_name = 'parallel_sum__ssm_conv_h3__mixer_gmlp__prompt'

def setup_inputs():

    _w = lambda a: (lambda t: t.to(torch.bfloat16) if t.is_floating_point() else t)(torch.as_tensor(a))

    def _A_setup():
        B, S, D = (1, 2048, 576)
        ks = 4
        return {'q': _w((lambda *s: torch.randn(*s, dtype=torch.bfloat16) * 0.05)(B, S, D)), 'k': _w((lambda *s: torch.randn(*s, dtype=torch.bfloat16) * 1.6)(B, S, D)), 'v': _w((lambda *s: torch.randn(*s, dtype=torch.bfloat16) * 0.4)(B, S, D)), 'shift_k': _w((lambda *s: torch.randn(*s, dtype=torch.bfloat16) * 1.6)(D, ks) * 0.5), 'ssm_k': _w((lambda *s: torch.randn(*s, dtype=torch.bfloat16) * 3.2)(D, S) * (1.0 / S ** 0.5)), 'ssm_D': _w((lambda *s: torch.randn(*s, dtype=torch.bfloat16) * 0.8)(D))}
    _A_in = _A_setup()

    def _B_setup():
        B, S, D, F = (1, 2048, 576, 4608)
        Fh = F // 2
        return {'x': _w((lambda *s: torch.randn(*s, dtype=torch.bfloat16) * 0.05)(B, S, D)), 'w_in': _w((lambda *s: torch.randn(*s, dtype=torch.bfloat16) * 0.4)(D, 2 * Fh)), 'w_sp': _w(0.01 * (lambda *s: torch.randn(*s, dtype=torch.bfloat16) * 0.4)(S, S)), 'b_sp': _w(1.0 + 0.01 * (lambda *s: torch.randn(*s, dtype=torch.bfloat16) * 0.05)(S)), 'w_out': _w((lambda *s: torch.randn(*s, dtype=torch.bfloat16) * 0.05)(Fh, D))}
    _B_in = _B_setup()
    return {'A_q': _A_in['q'], 'A_k': _A_in['k'], 'A_v': _A_in['v'], 'A_shift_k': _A_in['shift_k'], 'A_ssm_k': _A_in['ssm_k'], 'A_ssm_D': _A_in['ssm_D'], 'B_x': _B_in['x'], 'B_w_in': _B_in['w_in'], 'B_w_sp': _B_in['w_sp'], 'B_b_sp': _B_in['b_sp'], 'B_w_out': _B_in['w_out']}

def reference(A_q, A_k, A_v, A_shift_k, A_ssm_k, A_ssm_D, B_x, B_w_in, B_w_sp, B_b_sp, B_w_out):

    def _A_ref(q, k, v, shift_k, ssm_k, ssm_D):
        B, S, D = q.shape
        ks = shift_k.shape[-1]
        k_pad = _pad(k, ((0, 0), (ks - 1, 0), (0, 0)))
        k_shift = torch.zeros_like(k)
        for t in range(ks):
            k_shift = k_shift + k_pad[:, t:t + S, :] * shift_k[:, ks - 1 - t][None, None, :]
        kv = k_shift * v
        L = 2 * S
        kv_pad = _pad(kv, ((0, 0), (0, S), (0, 0)))
        kf_pad = _pad(ssm_k, ((0, 0), (0, S)))
        kv_f = (lambda x, axes=(-2, -1): torch.fft.rfft2(x.float(), dim=axes))(kv_pad[:, None, :, :], axes=(1, 2))
        kf_f = (lambda x, axes=(-2, -1): torch.fft.rfft2(x.float(), dim=axes))(kf_pad[:, None, :], axes=(1, 2))
        kf_f = (lambda x, *d: x.permute(*d))(kf_f, 1, 2, 0)
        y_f = kv_f * kf_f[None, :, :, :]
        y = (lambda x, s, axes=(-2, -1): torch.fft.irfft2(x, s=s, dim=axes).to(torch.bfloat16))(y_f, (1, L), axes=(1, 2))[:, 0, :S, :]
        y = y + kv * ssm_D[None, None, :]
        return q * y

    def _B_ref(x, w_in, w_sp, b_sp, w_out):
        B, S, D = x.shape
        F = w_in.shape[-1]
        Fh = F // 2
        z = _gelu(torch.einsum('bsd,df->bsf', x, w_in))
        z1 = z[..., :Fh].clone()
        z2 = _layernorm(z[..., Fh:], axis=-1)
        g = torch.einsum('ts,bsf->btf', w_sp, z2) + b_sp[None, :, None]
        return torch.einsum('bsf,fd->bsd', z1 * g, w_out)
    x = A_q
    xn = _layernorm(x, axis=-1)
    return x + _A_ref(xn, A_k, A_v, A_shift_k, A_ssm_k, A_ssm_D) + _B_ref(xn, B_w_in, B_w_sp, B_b_sp, B_w_out)
```

```asm
; @launch grid=(256,1,1) block=(256,1,1) lds=163840
.amdgcn_target "amdgcn-amd-amdhsa--gfx950"
.text
.globl parallel_sum__ssm_conv_h3__mixer_gmlp__prompt_kernel
.p2align 8
.type parallel_sum__ssm_conv_h3__mixer_gmlp__prompt_kernel,@function
parallel_sum__ssm_conv_h3__mixer_gmlp__prompt_kernel:
    s_cmp_ge_u32 s2, 256
    s_cbranch_scc1 KM_end
    s_load_dwordx2 s[48:49], s[0:1], 104
    s_load_dwordx8 s[4:11], s[0:1], 0
    s_load_dwordx2 s[52:53], s[0:1], 56
    s_load_dwordx4 s[12:15], s[0:1], 32
    s_load_dwordx8 s[20:27], s[0:1], 64
    s_getpc_b64 s[16:17]
    s_lshr_b32 s18, s2, 3
    s_mul_i32 s18, s18, 2304
    v_min_u32 v4, 17, v0
    v_lshl_add_u32 v4, v4, 7, s18
    v_min_u32 v4, KM_end - parallel_sum__ssm_conv_h3__mixer_gmlp__prompt_kernel - 128, v4
    global_load_dword a178, v4, s[16:17]
    v_lshrrev_b32 v1, 6, v0
    v_and_b32 v0, 63, v0
    v_readfirstlane_b32 s3, v1
    v_lshlrev_b32 v1, 4, v0
    s_and_b32 s56, s2, 1
    s_lshl_b32 s56, s56, 3
    s_bfe_u32 s57, s2, 0x30003
    s_add_u32 s56, s56, s57
    s_bfe_u32 s58, s2, 0x20001
    s_lshl_b32 s58, s58, 2
    s_lshr_b32 s57, s2, 6
    s_add_u32 s58, s58, s57
    s_lshr_b32 s59, s58, 2
    s_lshl_b32 s60, s56, 2
    s_add_u32 s59, s59, s60
    s_add_u32 s60, s60, s3
    s_lshl_b32 s61, s59, 5
    s_and_b32 s57, s58, 1
    s_lshl_b32 s57, s57, 4
    s_add_u32 s61, s61, s57
    s_and_b32 s57, s58, 2
    s_lshl_b32 s57, s57, 1
    s_add_u32 s61, s61, s57
    s_and_b32 s57, s3, 2
    s_lshl_b32 s57, s57, 2
    s_add_u32 s61, s61, s57
    s_and_b32 s57, s3, 1
    s_lshl_b32 s57, s57, 1
    s_add_u32 s61, s61, s57
    s_mul_i32 s62, s61, 1152
    v_lshrrev_b32 v4, 5, v0
    v_and_b32 v5, 31, v0
    v_mul_u32_u24 v6, 1152, v4
    v_lshl_add_u32 v6, v5, 4, v6
    v_lshrrev_b32 v7, 3, v5
    v_lshlrev_b32 v7, 28, v7
    v_or_b32 v7, v7, v6
    s_mov_b32 s50, 0x3500000
    s_mov_b32 s51, 0x20000
    s_mov_b32 s38, 0x240000
    s_mov_b32 s39, 0x20000
    s_mov_b32 s54, 0x510000
    s_mov_b32 s55, 0x20000
    s_waitcnt lgkmcnt(0)
    s_mov_b32 s36, s4
    s_mov_b32 s37, s5
    buffer_load_dwordx4 v[64:67], v6, s[36:39], s62 offen
    buffer_load_dwordx4 v[68:71], v6, s[36:39], s62 offen offset:512
    buffer_load_dwordx4 v[72:75], v7, s[36:39], s62 offen offset:1024
    s_add_u32 s18, s48, 0x7f8000
    s_addc_u32 s19, s49, 0
    s_load_dword s95, s[18:19], 0
    s_cmp_ge_u32 s56, 9
    s_cselect_b32 s57, 9, 0
    s_cselect_b32 s62, 0x40000000, 0
    s_sub_u32 s63, s56, s57
    v_lshrrev_b32 v8, 1, v0
    v_mul_u32_u24 v8, 9216, v8
    v_and_b32 v9, 1, v0
    v_lshl_add_u32 v8, v9, 4, v8
    v_add_u32 v8, s62, v8
    v_add_u32 v60, s62, v1
    s_lshl_b32 s64, s63, 1
    s_and_b32 s57, s3, 1
    s_add_u32 s64, s64, s57
    s_lshr_b32 s62, s3, 1
    s_mul_i32 s65, s62, 18
    s_add_u32 s65, s65, s64
    s_lshl_b32 s65, s65, 10
    s_mul_i32 s66, s58, 36864
    s_add_u32 s66, s66, 0x800000
    s_add_u32 s65, s65, s66
    s_mul_i32 s64, s64, 294912
    s_mul_i32 s62, s62, 4608
    s_sub_u32 s64, s64, s62
    s_lshl_b32 s57, s58, 5
    s_add_u32 s64, s64, s57
    s_lshl_b32 s57, s3, 10
    s_add_u32 m0, s57, 135168
    s_add_u32 s64, s64, 8704
    buffer_load_dwordx4 v8, s[52:55], s64 offen lds
    v_lshrrev_b32 v8, 4, v0
    v_mul_u32_u24 v9, 73728, v8
    v_and_b32 v8, 1, v8
    v_lshlrev_b32 v8, 3, v8
    v_and_b32 v10, 15, v0
    v_xor_b32 v8, v8, v10
    v_lshl_add_u32 v56, v8, 4, v9
    v_add_u32 v57, 8160, v56
    v_add_u32 v58, 16320, v56
    v_add_u32 v59, 24480, v56
    s_lshr_b32 s57, s3, 1
    s_lshl_b32 s57, s57, 5
    s_and_b32 s62, s3, 1
    s_lshl_b32 s62, s62, 2
    s_add_u32 s57, s57, s62
    s_mul_i32 s67, s57, 9216
    s_lshl_b32 s57, s58, 8
    s_add_u32 s67, s67, s57
    s_mul_i32 s70, s3, 4224
    s_mul_i32 s71, s63, 589824
    s_add_u32 s71, s71, s67
    s_add_u32 s71, s71, 4608
    s_add_u32 s72, s67, 5308416
    s_add_u32 m0, s70, 101376
    s_nop 0
    buffer_load_dwordx4 v56, s[52:55], s71 offen offset:0 lds
    buffer_load_dwordx4 v57, s[52:55], s71 offen offset:1056 lds
    buffer_load_dwordx4 v58, s[52:55], s71 offen offset:2112 lds
    buffer_load_dwordx4 v59, s[52:55], s71 offen offset:3168 lds
    s_mov_b32 s28, s6
    s_mov_b32 s29, s7
    s_mov_b32 s30, 0x240000
    s_mov_b32 s31, 0x00020000
    s_mov_b32 s32, s8
    s_mov_b32 s33, s9
    s_mov_b32 s34, 0x240000
    s_mov_b32 s35, 0x00020000
    s_mov_b32 s40, s10
    s_mov_b32 s41, s11
    s_mov_b32 s42, 0x1200
    s_mov_b32 s43, 0x00020000
    s_cmp_lg_u32 s3, 3
    s_cbranch_scc1 KM_nx1
    v_add_u32 v3, 256, v0
    s_mul_i32 s68, s2, 9216
    v_lshlrev_b32 v40, 2, v3
    v_cmp_gt_u32 vcc, 288, v3
    v_mov_b32 v41, 0x7ffffff0
    v_lshlrev_b32 v45, 4, v3
    v_cndmask_b32 v40, v41, v40, vcc
    v_add_u32 v40, s68, v40
    v_add_u32 v41, 4608, v40
    v_subrev_u32 v42, 3456, v40
    v_subrev_u32 v43, 2304, v40
    v_subrev_u32 v44, 1152, v40
    buffer_load_dword v16, v42, s[28:31], 0 offen nt
    buffer_load_dword v17, v43, s[28:31], 0 offen nt
    buffer_load_dword v18, v44, s[28:31], 0 offen nt
    buffer_load_dword v19, v40, s[28:31], 0 offen offset:0 nt
    buffer_load_dword v20, v40, s[28:31], 0 offen offset:1152 nt
    buffer_load_dword v21, v40, s[28:31], 0 offen offset:2304 nt
    buffer_load_dword v22, v40, s[28:31], 0 offen offset:3456 nt
    buffer_load_dword v23, v41, s[28:31], 0 offen offset:0 nt
    buffer_load_dword v24, v41, s[28:31], 0 offen offset:1152 nt
    buffer_load_dword v25, v41, s[28:31], 0 offen offset:2304 nt
    buffer_load_dword v26, v41, s[28:31], 0 offen offset:3456 nt
    buffer_load_dword v28, v40, s[32:35], 0 offen offset:0 nt
    buffer_load_dword v29, v40, s[32:35], 0 offen offset:1152 nt
    buffer_load_dword v30, v40, s[32:35], 0 offen offset:2304 nt
    buffer_load_dword v31, v40, s[32:35], 0 offen offset:3456 nt
    buffer_load_dword v32, v41, s[32:35], 0 offen offset:0 nt
    buffer_load_dword v33, v41, s[32:35], 0 offen offset:1152 nt
    buffer_load_dword v34, v41, s[32:35], 0 offen offset:2304 nt
    buffer_load_dword v35, v41, s[32:35], 0 offen offset:3456 nt
    buffer_load_dwordx4 v[36:39], v45, s[40:43], 0 offen
KM_nx1:
    s_lshl_b32 s57, s3, 1
    v_add_u32 v8, s57, v4
    v_xor_b32 v8, v8, v5
    v_and_b32 v8, 7, v8
    v_lshlrev_b32 v8, 4, v8
    v_lshl_add_u32 v8, v5, 7, v8
    v_add_u32 v8, 153600, v8
    v_lshlrev_b32 v9, 11, v4
    v_bfe_u32 v10, v0, 3, 2
    v_lshl_add_u32 v9, v10, 8, v9
    v_and_b32 v10, 7, v0
    v_lshl_add_u32 v9, v10, 4, v9
    s_mul_i32 s73, s59, 36864
    s_and_b32 s57, s58, 2
    s_lshl_b32 s57, s57, 9
    s_add_u32 s73, s73, s57
    s_and_b32 s57, s58, 1
    s_lshl_b32 s57, s57, 7
    s_add_u32 s73, s73, s57
    s_lshl_b32 s74, s3, 12
    s_add_u32 s75, s73, 32768
    s_add_u32 s73, s73, s74
    s_lshl_b32 s57, s3, 10
    s_add_u32 s57, s57, 153600
    v_lshrrev_b32 v11, 3, v0
    v_lshlrev_b32 v11, 4, v11
    v_xor_b32 v11, v11, v1
    v_add_u32 v10, s57, v11
    v_add_u32 v11, 161792, v11
    v_cmp_gt_u32 s[16:17], 8, v5
    v_mov_b32 v12, 0x3ae38e39
    s_lshl_b32 s76, s60, 12
    s_add_u32 s76, s76, 0x780000
    s_lshl_b32 s77, s58, 8
    s_lshl_b32 s78, s58, 9
    s_add_u32 s78, s78, 0x1140000
    s_add_u32 s77, s77, s76
    v_lshrrev_b32 v55, 2, v1
    v_mov_b32 v13, -1
    s_cmp_lg_u32 s3, 3
    s_cbranch_scc1 KM_nx3
    s_waitcnt vmcnt(25)
    s_branch KM_nx4
KM_nx3:
    s_waitcnt vmcnt(5)
KM_nx4:
    v_lshlrev_b32 v80, 16, v64
    v_and_b32 v81, 0xffff0000, v64
    v_lshlrev_b32 v82, 16, v65
    v_and_b32 v83, 0xffff0000, v65
    v_lshlrev_b32 v84, 16, v66
    v_and_b32 v85, 0xffff0000, v66
    v_lshlrev_b32 v86, 16, v67
    v_and_b32 v87, 0xffff0000, v67
    v_lshlrev_b32 v88, 16, v68
    v_and_b32 v89, 0xffff0000, v68
    v_lshlrev_b32 v90, 16, v69
    v_and_b32 v91, 0xffff0000, v69
    v_lshlrev_b32 v92, 16, v70
    v_and_b32 v93, 0xffff0000, v70
    v_lshlrev_b32 v94, 16, v71
    v_and_b32 v95, 0xffff0000, v71
    v_lshlrev_b32 v96, 16, v72
    v_and_b32 v97, 0xffff0000, v72
    v_lshlrev_b32 v98, 16, v73
    v_and_b32 v99, 0xffff0000, v73
    v_lshlrev_b32 v100, 16, v74
    v_and_b32 v101, 0xffff0000, v74
    v_lshlrev_b32 v102, 16, v75
    v_and_b32 v103, 0xffff0000, v75
    v_pk_add_f32 v[128:129], v[80:81], v[92:93]
    v_pk_add_f32 v[130:131], v[82:83], v[94:95]
    v_pk_add_f32 v[132:133], v[84:85], v[96:97]
    v_pk_add_f32 v[134:135], v[86:87], v[98:99]
    v_pk_add_f32 v[136:137], v[88:89], v[100:101]
    v_pk_add_f32 v[138:139], v[90:91], v[102:103]
    v_pk_add_f32 v[128:129], v[128:129], v[134:135]
    v_pk_add_f32 v[130:131], v[130:131], v[136:137]
    v_pk_add_f32 v[132:133], v[132:133], v[138:139]
    v_pk_add_f32 v[128:129], v[128:129], v[130:131]
    v_pk_add_f32 v[128:129], v[128:129], v[132:133]
    v_add_f32 v128, v128, v129
    s_add_u32 m0, s70, 118272
    s_add_u32 s71, s71, 589824
    s_sub_u32 s64, s71, 5308416
    s_cmp_ge_u32 s71, s72
    s_cselect_b32 s71, s64, s71
    buffer_load_dwordx4 v56, s[52:55], s71 offen offset:0 lds
    buffer_load_dwordx4 v57, s[52:55], s71 offen offset:1056 lds
    buffer_load_dwordx4 v58, s[52:55], s71 offen offset:2112 lds
    buffer_load_dwordx4 v59, s[52:55], s71 offen offset:3168 lds
    s_nop 1
    v_add_f32 v128, v128, v128 row_ror:8
    s_nop 1
    v_add_f32 v128, v128, v128 row_ror:4
    s_nop 1
    v_add_f32 v128, v128, v128 row_ror:2
    s_nop 1
    v_add_f32 v128, v128, v128 row_ror:1
    v_mov_b32 v129, v128
    s_nop 1
    v_permlane16_swap_b32 v128, v129
    v_add_f32 v128, v128, v129
    v_mul_f32 v140, v128, v12
    v_mov_b32 v141, v140
    v_pk_add_f32 v[104:105], v[80:81], v[140:141] neg_lo:[0,1] neg_hi:[0,1]
    v_pk_add_f32 v[106:107], v[82:83], v[140:141] neg_lo:[0,1] neg_hi:[0,1]
    v_pk_add_f32 v[108:109], v[84:85], v[140:141] neg_lo:[0,1] neg_hi:[0,1]
    v_pk_add_f32 v[110:111], v[86:87], v[140:141] neg_lo:[0,1] neg_hi:[0,1]
    v_pk_add_f32 v[112:113], v[88:89], v[140:141] neg_lo:[0,1] neg_hi:[0,1]
    v_pk_add_f32 v[114:115], v[90:91], v[140:141] neg_lo:[0,1] neg_hi:[0,1]
    v_pk_add_f32 v[116:117], v[92:93], v[140:141] neg_lo:[0,1] neg_hi:[0,1]
    v_pk_add_f32 v[118:119], v[94:95], v[140:141] neg_lo:[0,1] neg_hi:[0,1]
    v_pk_add_f32 v[120:121], v[96:97], v[140:141] neg_lo:[0,1] neg_hi:[0,1]
    v_pk_add_f32 v[122:123], v[98:99], v[140:141] neg_lo:[0,1] neg_hi:[0,1]
    v_pk_add_f32 v[124:125], v[100:101], v[140:141] neg_lo:[0,1] neg_hi:[0,1]
    v_pk_add_f32 v[126:127], v[102:103], v[140:141] neg_lo:[0,1] neg_hi:[0,1]
    v_pk_mul_f32 v[128:129], v[104:105], v[104:105]
    v_pk_mul_f32 v[130:131], v[112:113], v[112:113]
    v_pk_mul_f32 v[132:133], v[120:121], v[120:121]
    v_pk_fma_f32 v[128:129], v[106:107], v[106:107], v[128:129]
    v_pk_fma_f32 v[130:131], v[114:115], v[114:115], v[130:131]
    v_pk_fma_f32 v[132:133], v[122:123], v[122:123], v[132:133]
    v_pk_fma_f32 v[128:129], v[108:109], v[108:109], v[128:129]
    v_pk_fma_f32 v[130:131], v[116:117], v[116:117], v[130:131]
    v_pk_fma_f32 v[132:133], v[124:125], v[124:125], v[132:133]
    v_pk_fma_f32 v[128:129], v[110:111], v[110:111], v[128:129]
    v_pk_fma_f32 v[130:131], v[118:119], v[118:119], v[130:131]
    v_pk_fma_f32 v[132:133], v[126:127], v[126:127], v[132:133]
    v_pk_add_f32 v[128:129], v[128:129], v[130:131]
    v_add_f32 v132, v132, v133
    v_add_f32 v128, v128, v129
    v_cndmask_b32 v132, 0, v132, s[16:17]
    v_add_f32 v128, v128, v132
    s_nop 1
    v_add_f32 v128, v128, v128 row_ror:8
    s_nop 1
    v_add_f32 v128, v128, v128 row_ror:4
    s_nop 1
    v_add_f32 v128, v128, v128 row_ror:2
    s_nop 1
    v_add_f32 v128, v128, v128 row_ror:1
    v_mov_b32 v129, v128
    s_nop 1
    v_permlane16_swap_b32 v128, v129
    v_add_f32 v128, v128, v129
    v_mul_f32 v142, v128, v12
    v_cvt_pk_bf16_f32 v140, v140, v140
    v_and_b32 v140, 0xffff0000, v140
    v_cvt_pk_bf16_f32 v142, v142, v142
    v_and_b32 v142, 0xffff0000, v142
    v_mov_b32 v141, v140
    v_add_f32 v142, 0x3727c5ac, v142
    v_cvt_pk_bf16_f32 v142, v142, v142
    v_and_b32 v142, 0xffff0000, v142
    v_sqrt_f32 v142, v142
    v_pk_add_f32 v[80:81], v[80:81], v[140:141] neg_lo:[0,1] neg_hi:[0,1]
    v_pk_add_f32 v[82:83], v[82:83], v[140:141] neg_lo:[0,1] neg_hi:[0,1]
    v_pk_add_f32 v[84:85], v[84:85], v[140:141] neg_lo:[0,1] neg_hi:[0,1]
    v_pk_add_f32 v[86:87], v[86:87], v[140:141] neg_lo:[0,1] neg_hi:[0,1]
    v_pk_add_f32 v[88:89], v[88:89], v[140:141] neg_lo:[0,1] neg_hi:[0,1]
    v_pk_add_f32 v[90:91], v[90:91], v[140:141] neg_lo:[0,1] neg_hi:[0,1]
    v_pk_add_f32 v[92:93], v[92:93], v[140:141] neg_lo:[0,1] neg_hi:[0,1]
    v_pk_add_f32 v[94:95], v[94:95], v[140:141] neg_lo:[0,1] neg_hi:[0,1]
    v_pk_add_f32 v[96:97], v[96:97], v[140:141] neg_lo:[0,1] neg_hi:[0,1]
    v_pk_add_f32 v[98:99], v[98:99], v[140:141] neg_lo:[0,1] neg_hi:[0,1]
    v_pk_add_f32 v[100:101], v[100:101], v[140:141] neg_lo:[0,1] neg_hi:[0,1]
    v_pk_add_f32 v[102:103], v[102:103], v[140:141] neg_lo:[0,1] neg_hi:[0,1]
    v_cvt_pk_bf16_f32 v142, v142, v142
    v_and_b32 v142, 0xffff0000, v142
    v_rcp_f32 v142, v142
    v_cvt_pk_bf16_f32 v64, v80, v81
    v_cvt_pk_bf16_f32 v65, v82, v83
    v_cvt_pk_bf16_f32 v66, v84, v85
    v_cvt_pk_bf16_f32 v67, v86, v87
    v_cvt_pk_bf16_f32 v68, v88, v89
    v_cvt_pk_bf16_f32 v69, v90, v91
    v_cvt_pk_bf16_f32 v70, v92, v93
    v_cvt_pk_bf16_f32 v71, v94, v95
    v_cvt_pk_bf16_f32 v72, v96, v97
    v_cvt_pk_bf16_f32 v73, v98, v99
    v_cvt_pk_bf16_f32 v74, v100, v101
    v_cvt_pk_bf16_f32 v75, v102, v103
    v_mov_b32 v143, v142
    v_mov_b32 v141, v142
    v_lshlrev_b32 v80, 16, v64
    v_and_b32 v81, 0xffff0000, v64
    v_lshlrev_b32 v82, 16, v65
    v_and_b32 v83, 0xffff0000, v65
    v_lshlrev_b32 v84, 16, v66
    v_and_b32 v85, 0xffff0000, v66
    v_lshlrev_b32 v86, 16, v67
    v_and_b32 v87, 0xffff0000, v67
    v_lshlrev_b32 v88, 16, v68
    v_and_b32 v89, 0xffff0000, v68
    v_lshlrev_b32 v90, 16, v69
    v_and_b32 v91, 0xffff0000, v69
    v_lshlrev_b32 v92, 16, v70
    v_and_b32 v93, 0xffff0000, v70
    v_lshlrev_b32 v94, 16, v71
    v_and_b32 v95, 0xffff0000, v71
    v_lshlrev_b32 v96, 16, v72
    v_and_b32 v97, 0xffff0000, v72
    v_lshlrev_b32 v98, 16, v73
    v_and_b32 v99, 0xffff0000, v73
    v_lshlrev_b32 v100, 16, v74
    v_and_b32 v101, 0xffff0000, v74
    v_lshlrev_b32 v102, 16, v75
    v_and_b32 v103, 0xffff0000, v75
    v_pk_mul_f32 v[80:81], v[80:81], v[142:143]
    v_pk_mul_f32 v[82:83], v[82:83], v[142:143]
    v_pk_mul_f32 v[84:85], v[84:85], v[142:143]
    v_pk_mul_f32 v[86:87], v[86:87], v[142:143]
    v_pk_mul_f32 v[88:89], v[88:89], v[142:143]
    v_pk_mul_f32 v[90:91], v[90:91], v[142:143]
    v_pk_mul_f32 v[92:93], v[92:93], v[142:143]
    v_pk_mul_f32 v[94:95], v[94:95], v[142:143]
    v_pk_mul_f32 v[96:97], v[96:97], v[142:143]
    v_pk_mul_f32 v[98:99], v[98:99], v[142:143]
    v_pk_mul_f32 v[100:101], v[100:101], v[142:143]
    v_pk_mul_f32 v[102:103], v[102:103], v[142:143]
    v_cvt_pk_bf16_f32 v64, v80, v81
    v_cvt_pk_bf16_f32 v65, v82, v83
    v_cvt_pk_bf16_f32 v66, v84, v85
    v_cvt_pk_bf16_f32 v67, v86, v87
    v_cvt_pk_bf16_f32 v68, v88, v89
    v_cvt_pk_bf16_f32 v69, v90, v91
    v_cvt_pk_bf16_f32 v70, v92, v93
    v_cvt_pk_bf16_f32 v71, v94, v95
    v_cvt_pk_bf16_f32 v72, v96, v97
    v_cvt_pk_bf16_f32 v73, v98, v99
    v_cvt_pk_bf16_f32 v74, v100, v101
    v_cvt_pk_bf16_f32 v75, v102, v103
    ds_write_b128 v8, v[64:67]
    ds_write_b128 v8, v[68:71] offset:4096
    s_mov_b64 exec, s[16:17]
    ds_write_b128 v8, v[72:75] offset:8192
    s_mov_b64 exec, -1
    v_lshrrev_b32 v12, 4, v0
    v_lshlrev_b32 v12, 8, v12
    v_and_b32 v14, 15, v0
    v_lshl_add_u32 v12, v14, 3, v12
    s_lshl_b32 s57, s3, 10
    s_add_u32 s57, s57, 135168
    v_add_u32 v12, s57, v12
    s_cmp_lg_u32 s3, 3
    s_cbranch_scc1 KM_nx6
    s_waitcnt vmcnt(28)
    s_branch KM_nx7
KM_nx6:
    s_waitcnt vmcnt(8)
KM_nx7:
    ds_read_b64_tr_b16 v[76:77], v12
    ds_read_b64_tr_b16 v[78:79], v12 offset:128
    buffer_store_dword v13, v55, s[48:51], s77 offen sc1
    s_lshl_b32 s57, s61, 3
    s_add_u32 s57, s57, 0x240000
    v_lshl_add_u32 v144, v4, 3, s57
    s_waitcnt lgkmcnt(0)
    s_barrier
    ds_read_b128 v[64:67], v10
    ds_read_b128 v[68:71], v10 offset:4096
    ds_read_b128 v[72:75], v11
    s_mul_i32 s95, s95, 1664525
    s_add_u32 s95, s95, 1013904223
    s_add_u32 s57, s73, 16384
    s_cmp_lg_u32 s3, 0
    s_waitcnt lgkmcnt(0)
    s_cbranch_scc1 KM_nx8
    buffer_store_dwordx4 v[72:75], v9, s[48:51], s75 offen sc1
KM_nx8:
    buffer_store_dwordx4 v[64:67], v9, s[48:51], s73 offen sc1
    buffer_store_dwordx4 v[68:71], v9, s[48:51], s57 offen sc1
    buffer_store_dwordx4 v[76:79], v60, s[48:51], s65 offen sc1
    s_add_u32 m0, s70, 0
    s_add_u32 s71, s71, 589824
    s_sub_u32 s64, s71, 5308416
    s_cmp_ge_u32 s71, s72
    s_cselect_b32 s71, s64, s71
    buffer_load_dwordx4 v56, s[52:55], s71 offen offset:0 lds
    buffer_load_dwordx4 v57, s[52:55], s71 offen offset:1056 lds
    buffer_load_dwordx4 v58, s[52:55], s71 offen offset:2112 lds
    buffer_load_dwordx4 v59, s[52:55], s71 offen offset:3168 lds
    s_lshl_b32 s73, s56, 9
    s_add_u32 s73, s73, 0x1100000
    s_lshl_b32 s57, s3, 7
    s_add_u32 s75, s73, s57
    s_mul_i32 s57, s58, 8448
    s_add_u32 s75, s75, s57
    s_lshr_b32 s57, s58, 2
    s_lshl_b32 s57, s57, 7
    s_and_b32 s62, s58, 3
    s_lshl_b32 s62, s62, 2
    s_add_u32 s73, s73, s57
    s_add_u32 s73, s73, s62
    s_lshl_b32 s57, s3, 8
    s_add_u32 s57, s57, s2
    s_lshl_b32 s57, s57, 13
    v_lshlrev_b32 v62, 7, v0
    v_add_u32 v62, s57, v62
    s_mov_b32 s44, s20
    s_mov_b32 s45, s21
    s_mov_b32 s46, 0x800000
    s_mov_b32 s47, 0x00020000
    s_mov_b32 exec_lo, 0xffffffff
    s_mov_b32 exec_hi, 0x0
    buffer_load_dword a176, v62, s[44:47], 0 offen
    v_mov_b32 v62, 0x40000000
    s_mov_b64 exec, -1
    s_mul_i32 s81, s60, 144
    s_mul_i32 s57, s58, 9
    s_add_u32 s81, s81, s57
    s_lshl_b32 s81, s81, 10
    s_add_u32 s81, s81, 0x1900000
    s_lshr_b32 s82, s56, 2
    s_lshl_b32 s82, s82, 7
    s_and_b32 s57, s56, 3
    s_lshl_b32 s57, s57, 2
    s_add_u32 s82, s82, s57
    s_add_u32 s82, s82, s78
    s_lshl_b32 s57, s3, 6
    s_add_u32 s78, s78, s57
    s_add_u32 s78, s78, s57
    s_mul_i32 s62, s56, 8448
    s_add_u32 s78, s78, s62
    v_add_u32 v3, s57, v0
    s_mov_b32 s36, s10
    s_mov_b32 s37, s11
    s_mov_b32 s38, 0x1200
    s_mov_b32 s39, 0x00020000
    s_mov_b32 s40, s20
    s_mov_b32 s41, s21
    s_mov_b32 s42, 0x800000
    s_mov_b32 s43, 0x00020000
    s_mov_b32 s44, s24
    s_mov_b32 s45, s25
    s_mov_b32 s46, 0x288000
    s_mov_b32 s47, 0x00020000
    s_mov_b32 s8, s22
    s_mov_b32 s9, s23
    s_mov_b32 s10, 0x1000
    s_mov_b32 s11, 0x00020000
    s_mov_b32 s16, 0x11111111
    s_mov_b32 s17, 0x11111111
    v_mov_b32 v4, 0xbdd2d3e8
    v_mov_b32 v6, 0xc0135761
    v_mov_b32 v12, 1.0
    v_mov_b32 v5, 0xbdd2d3e8
    v_mov_b32 v7, 0xc0135761
    v_mov_b32 v13, 1.0
    v_mov_b32 v11, 0x39e38e39
    s_mul_i32 s68, s2, 9216
    v_lshlrev_b32 v40, 2, v3
    v_lshlrev_b32 v45, 4, v3
    v_add_u32 v40, s68, v40
    v_add_u32 v41, 4608, v40
    v_subrev_u32 v42, 3456, v40
    v_subrev_u32 v43, 2304, v40
    v_subrev_u32 v44, 1152, v40
    v_lshrrev_b32 v10, 4, v0
    v_bfe_u32 v9, v0, 2, 2
    v_lshlrev_b32 v54, 8, v9
    v_lshl_add_u32 v54, v10, 6, v54
    v_and_b32 v8, 3, v0
    v_lshl_add_u32 v54, v8, 4, v54
    v_lshl_add_u32 v52, v9, 3, v8
    v_lshlrev_b32 v52, 1, v52
    s_lshl_b32 s83, s60, 6
    v_lshrrev_b32 v8, 3, v0
    v_mul_u32_u24 v53, 1152, v8
    v_lshrrev_b32 v9, 2, v8
    v_lshlrev_b32 v9, 3, v9
    v_and_b32 v8, 3, v8
    v_add_u32 v8, v8, v9
    v_lshlrev_b32 v8, 12, v8
    v_and_b32 v9, 7, v0
    v_lshl_add_u32 v53, v9, 4, v53
    v_xor_b32 v9, v9, v10
    v_lshl_add_u32 v46, v9, 4, v8
    v_xor_b32 v47, 64, v46
    v_add_u32 v47, 64512, v47
    v_add_u32 v48, 14336, v46
    v_add_u32 v49, 14336, v47
    s_lshl_b32 s57, s56, 19
    s_lshl_b32 s62, s3, 10
    s_add_u32 s57, s57, s62
    s_add_u32 s62, s3, 0
    s_and_b32 s62, s62, 3
    s_lshl_b32 s62, s62, 17
    s_add_u32 s84, s62, s57
    s_add_u32 s62, s3, 1
    s_and_b32 s62, s62, 3
    s_lshl_b32 s62, s62, 17
    s_add_u32 s85, s62, s57
    s_add_u32 s62, s3, 2
    s_and_b32 s62, s62, 3
    s_lshl_b32 s62, s62, 17
    s_add_u32 s86, s62, s57
    s_add_u32 s62, s3, 3
    s_and_b32 s62, s62, 3
    s_lshl_b32 s62, s62, 17
    s_add_u32 s87, s62, s57
    s_mul_i32 s88, s3, 2359296
    s_mul_i32 s62, s58, 9216
    s_add_u32 s88, s88, s62
    s_add_u32 s88, s88, 0x1900000
    s_add_u32 s57, s56, s58
    s_and_b32 s57, s57, 1
    s_mov_b32 s89, 0x67452301
    s_cmp_eq_u32 s57, 1
    s_cselect_b32 s89, 0x75634120, s89
    s_lshr_b32 s57, s58, 2
    s_mul_i32 s57, s57, 0x22222222
    s_add_u32 s89, s89, s57
    s_lshl_b32 s90, s3, 8
    s_add_u32 s90, s90, s2
    s_mul_hi_u32 s91, s90, 0x1C71C71D
    s_mul_i32 s92, s91, 9
    s_sub_u32 s92, s90, s92
    s_mul_hi_u32 s93, s91, 0x1C71C71D
    s_mul_i32 s57, s93, 9
    s_sub_u32 s57, s91, s57
    s_lshl_b32 s97, s93, 3
    s_add_u32 s97, s97, s57
    s_add_u32 s62, s93, 64
    s_cmp_eq_u32 s57, 8
    s_cselect_b32 s97, s62, s97
    s_mul_i32 s97, s97, 36864
    s_lshl_b32 s62, s92, 7
    s_add_u32 s97, s97, s62
    s_cmp_ge_u32 s90, 648
    s_cselect_b32 s46, 0, s46
    s_cselect_b32 s90, 0x40000000, 0
    s_lshr_b32 s59, s93, 1
    s_mul_i32 s57, s59, 18
    s_sub_u32 s57, s91, s57
    s_lshr_b32 s62, s57, 1
    s_mul_i32 s62, s62, 9
    s_mul_i32 s59, s59, 81
    s_add_u32 s59, s59, s62
    s_lshl_b32 s59, s59, 10
    s_add_u32 s59, s59, 0xe00000
    s_and_b32 s57, s57, 1
    s_lshl_b32 s62, s57, 12
    s_lshl_b32 s57, s57, 7
    s_add_u32 s57, s57, 8192
    s_lshl_b32 s92, s92, 4
    s_mov_b32 s91, 331776
    v_and_b32 v96, 15, v0
    v_add_u32 v96, s92, v96
    v_mul_u32_u24 v97, 57, v96
    v_lshrrev_b32 v97, 10, v97
    v_mul_u32_u24 v98, 18, v97
    v_sub_u32 v98, v96, v98
    v_mul_lo_u32 v97, v97, s91
    v_lshrrev_b32 v96, 3, v98
    v_lshlrev_b32 v96, 11, v96
    v_and_b32 v99, 1, v98
    v_lshl_add_u32 v96, v99, 10, v96
    v_lshl_add_u32 v99, v99, 6, s57
    v_cmp_le_u32 vcc, 16, v98
    v_bfe_u32 v98, v98, 1, 2
    v_lshl_add_u32 v96, v98, 6, v96
    v_add_u32 v96, s62, v96
    v_cndmask_b32 v96, v96, v99, vcc
    v_add3_u32 v96, v96, v97, s90
    v_accvgpr_write_b32 a179, v96
    s_waitcnt vmcnt(5)
    s_barrier
    s_cmp_lg_u32 s3, 0
    s_cbranch_scc1 KM_nx5
    v_mov_b32 v8, s95
    v_mul_u32_u24 v9, 8448, v0
    s_mov_b64 exec, 0xffff
    buffer_store_dword v8, v9, s[48:51], s73 offen sc1
    s_mov_b64 exec, 1
    s_lshl_b32 s57, s58, 8
    s_lshl_b32 s62, s56, 2
    s_add_u32 s57, s57, s62
    s_add_u32 s57, s57, 0x11e0000
    buffer_store_dword v8, v60, s[48:51], s57 offen sc1
    s_mov_b64 exec, -1
KM_nx5:
    s_mov_b32 s94, 1000000
    s_mul_i32 s79, s60, 36864
    s_lshl_b32 s80, s63, 12
    s_add_u32 s80, s80, s79
    s_add_u32 s79, s79, 36864
    v_bfe_u32 v8, v0, 2, 2
    v_mul_u32_u24 v2, 1056, v8
    v_lshrrev_b32 v8, 4, v0
    v_lshl_add_u32 v2, v8, 8, v2
    v_and_b32 v9, 3, v0
    v_lshl_add_u32 v2, v9, 3, v2
    v_add_u32 v2, 101376, v2
    v_and_b32 v8, 1, v8
    v_lshlrev_b32 v8, 7, v8
    v_sub_u32 v61, v2, v8
    v_add_u32 v2, v2, v8
    v_add_u32 v60, 135168, v1
    v_min_u32 v63, 32, v55
    s_add_u32 m0, s70, 16896
    s_add_u32 s71, s71, 589824
    s_sub_u32 s64, s71, 5308416
    s_cmp_ge_u32 s71, s72
    s_cselect_b32 s71, s64, s71
    buffer_load_dwordx4 v56, s[52:55], s71 offen offset:0 lds
    buffer_load_dwordx4 v57, s[52:55], s71 offen offset:1056 lds
    buffer_load_dwordx4 v58, s[52:55], s71 offen offset:2112 lds
    buffer_load_dwordx4 v59, s[52:55], s71 offen offset:3168 lds
    s_add_u32 m0, s70, 33792
    s_add_u32 s71, s71, 589824
    s_sub_u32 s64, s71, 5308416
    s_cmp_ge_u32 s71, s72
    s_cselect_b32 s71, s64, s71
    buffer_load_dwordx4 v56, s[52:55], s71 offen offset:0 lds
    buffer_load_dwordx4 v57, s[52:55], s71 offen offset:1056 lds
    buffer_load_dwordx4 v58, s[52:55], s71 offen offset:2112 lds
    buffer_load_dwordx4 v59, s[52:55], s71 offen offset:3168 lds
    s_cmp_lg_u32 s3, 3
    s_cbranch_scc1 KM_nx2
    v_add_u32 v184, 256, v0
    v_lshlrev_b32 v192, 16, v36
    v_and_b32 v193, 0xffff0000, v36
    v_lshlrev_b32 v194, 16, v37
    v_and_b32 v195, 0xffff0000, v37
    v_lshlrev_b32 v196, 16, v16
    v_lshlrev_b32 v197, 16, v17
    v_lshlrev_b32 v198, 16, v18
    v_lshlrev_b32 v199, 16, v19
    v_lshlrev_b32 v200, 16, v20
    v_lshlrev_b32 v201, 16, v21
    v_lshlrev_b32 v202, 16, v22
    v_lshlrev_b32 v203, 16, v23
    v_lshlrev_b32 v204, 16, v24
    v_lshlrev_b32 v205, 16, v25
    v_lshlrev_b32 v206, 16, v26
    v_mul_f32 v208, v196, v195
    v_mul_f32 v209, v197, v195
    v_mul_f32 v210, v198, v195
    v_mul_f32 v211, v199, v195
    v_mul_f32 v212, v200, v195
    v_mul_f32 v213, v201, v195
    v_mul_f32 v214, v202, v195
    v_mul_f32 v215, v203, v195
    v_fmac_f32 v208, v197, v194
    v_fmac_f32 v209, v198, v194
    v_fmac_f32 v210, v199, v194
    v_fmac_f32 v211, v200, v194
    v_fmac_f32 v212, v201, v194
    v_fmac_f32 v213, v202, v194
    v_fmac_f32 v214, v203, v194
    v_fmac_f32 v215, v204, v194
    v_fmac_f32 v208, v198, v193
    v_fmac_f32 v209, v199, v193
    v_fmac_f32 v210, v200, v193
    v_fmac_f32 v211, v201, v193
    v_fmac_f32 v212, v202, v193
    v_fmac_f32 v213, v203, v193
    v_fmac_f32 v214, v204, v193
    v_fmac_f32 v215, v205, v193
    v_fmac_f32 v208, v199, v192
    v_fmac_f32 v209, v200, v192
    v_fmac_f32 v210, v201, v192
    v_fmac_f32 v211, v202, v192
    v_fmac_f32 v212, v203, v192
    v_fmac_f32 v213, v204, v192
    v_fmac_f32 v214, v205, v192
    v_fmac_f32 v215, v206, v192
    v_lshlrev_b32 v196, 16, v28
    v_lshlrev_b32 v197, 16, v29
    v_lshlrev_b32 v198, 16, v30
    v_lshlrev_b32 v199, 16, v31
    v_lshlrev_b32 v200, 16, v32
    v_lshlrev_b32 v201, 16, v33
    v_lshlrev_b32 v202, 16, v34
    v_lshlrev_b32 v203, 16, v35
    v_pk_mul_f32 v[208:209], v[208:209], v[196:197]
    v_pk_mul_f32 v[210:211], v[210:211], v[198:199]
    v_pk_mul_f32 v[212:213], v[212:213], v[200:201]
    v_pk_mul_f32 v[214:215], v[214:215], v[202:203]
    v_cvt_pk_bf16_f32 v216, v215, v214
    v_cvt_pk_bf16_f32 v217, v213, v212
    v_cvt_pk_bf16_f32 v218, v211, v210
    v_cvt_pk_bf16_f32 v219, v209, v208
    v_lshlrev_b32 v192, 16, v38
    v_and_b32 v193, 0xffff0000, v38
    v_lshlrev_b32 v194, 16, v39
    v_and_b32 v195, 0xffff0000, v39
    v_and_b32 v196, 0xffff0000, v16
    v_and_b32 v197, 0xffff0000, v17
    v_and_b32 v198, 0xffff0000, v18
    v_and_b32 v199, 0xffff0000, v19
    v_and_b32 v200, 0xffff0000, v20
    v_and_b32 v201, 0xffff0000, v21
    v_and_b32 v202, 0xffff0000, v22
    v_and_b32 v203, 0xffff0000, v23
    v_and_b32 v204, 0xffff0000, v24
    v_and_b32 v205, 0xffff0000, v25
    v_and_b32 v206, 0xffff0000, v26
    v_mul_f32 v208, v196, v195
    v_mul_f32 v209, v197, v195
    v_mul_f32 v210, v198, v195
    v_mul_f32 v211, v199, v195
    v_mul_f32 v212, v200, v195
    v_mul_f32 v213, v201, v195
    v_mul_f32 v214, v202, v195
    v_mul_f32 v215, v203, v195
    v_fmac_f32 v208, v197, v194
    v_fmac_f32 v209, v198, v194
    v_fmac_f32 v210, v199, v194
    v_fmac_f32 v211, v200, v194
    v_fmac_f32 v212, v201, v194
    v_fmac_f32 v213, v202, v194
    v_fmac_f32 v214, v203, v194
    v_fmac_f32 v215, v204, v194
    v_fmac_f32 v208, v198, v193
    v_fmac_f32 v209, v199, v193
    v_fmac_f32 v210, v200, v193
    v_fmac_f32 v211, v201, v193
    v_fmac_f32 v212, v202, v193
    v_fmac_f32 v213, v203, v193
    v_fmac_f32 v214, v204, v193
    v_fmac_f32 v215, v205, v193
    v_fmac_f32 v208, v199, v192
    v_fmac_f32 v209, v200, v192
    v_fmac_f32 v210, v201, v192
    v_fmac_f32 v211, v202, v192
    v_fmac_f32 v212, v203, v192
    v_fmac_f32 v213, v204, v192
    v_fmac_f32 v214, v205, v192
    v_fmac_f32 v215, v206, v192
    v_and_b32 v196, 0xffff0000, v28
    v_and_b32 v197, 0xffff0000, v29
    v_and_b32 v198, 0xffff0000, v30
    v_and_b32 v199, 0xffff0000, v31
    v_and_b32 v200, 0xffff0000, v32
    v_and_b32 v201, 0xffff0000, v33
    v_and_b32 v202, 0xffff0000, v34
    v_and_b32 v203, 0xffff0000, v35
    v_pk_mul_f32 v[208:209], v[208:209], v[196:197]
    v_pk_mul_f32 v[210:211], v[210:211], v[198:199]
    v_pk_mul_f32 v[212:213], v[212:213], v[200:201]
    v_pk_mul_f32 v[214:215], v[214:215], v[202:203]
    v_cvt_pk_bf16_f32 v220, v215, v214
    v_cvt_pk_bf16_f32 v221, v213, v212
    v_cvt_pk_bf16_f32 v222, v211, v210
    v_cvt_pk_bf16_f32 v223, v209, v208
    v_lshrrev_b32 v186, 2, v184
    v_lshlrev_b32 v186, 14, v186
    v_and_b32 v187, 3, v184
    v_lshl_add_u32 v186, v187, 4, v186
    s_lshl_b32 s68, s2, 6
    s_add_u32 s68, s68, 0x280000
    s_add_u32 s69, s68, 1179648
    v_cmp_gt_u32 vcc, 288, v184
    v_mov_b32 v187, 0x7ffffff0
    s_nop 0
    v_cndmask_b32 v186, v187, v186, vcc
    buffer_store_dwordx4 v[216:219], v186, s[48:51], s68 offen sc1
    buffer_store_dwordx4 v[220:223], v186, s[48:51], s69 offen sc1
KM_nx2:
KM_xf_poll:
    s_load_dwordx4 s[16:19], s[48:49], s75 glc
    s_sub_u32 s94, s94, 1
    s_cmp_lt_i32 s94, 1
    s_waitcnt lgkmcnt(0)
    s_cbranch_scc1 KM_xf_done
    s_cmp_lg_u32 s16, s95
    s_cbranch_scc1 KM_xf_poll
    s_cmp_lg_u32 s17, s95
    s_cbranch_scc1 KM_xf_poll
    s_cmp_lg_u32 s18, s95
    s_cbranch_scc1 KM_xf_poll
    s_cmp_lg_u32 s19, s95
    s_cbranch_scc1 KM_xf_poll
KM_xf_done:
    s_mov_b32 s16, 0x11111111
    s_mov_b32 s17, 0x11111111
    buffer_load_dwordx4 a[0:3], v1, s[48:51], s80 offen offset:0 sc1
    buffer_load_dwordx4 a[4:7], v1, s[48:51], s80 offen offset:1024 sc1
    buffer_load_dwordx4 a[8:11], v1, s[48:51], s80 offen offset:2048 sc1
    buffer_load_dwordx4 a[12:15], v1, s[48:51], s80 offen offset:3072 sc1
    s_add_u32 s80, s80, 4096
    s_sub_u32 s64, s80, 36864
    s_cmp_ge_u32 s80, s79
    s_cselect_b32 s80, s64, s80
    buffer_load_dwordx4 a[16:19], v1, s[48:51], s80 offen offset:0 sc1
    buffer_load_dwordx4 a[20:23], v1, s[48:51], s80 offen offset:1024 sc1
    buffer_load_dwordx4 a[24:27], v1, s[48:51], s80 offen offset:2048 sc1
    buffer_load_dwordx4 a[28:31], v1, s[48:51], s80 offen offset:3072 sc1
    s_barrier
    ds_read_b64_tr_b16 v[64:65], v2 offset:0
    ds_read_b64_tr_b16 v[66:67], v2 offset:4224
    ds_read_b64_tr_b16 v[68:69], v2 offset:8448
    ds_read_b64_tr_b16 v[70:71], v2 offset:12672
    ds_read_b64_tr_b16 v[72:73], v2 offset:32
    ds_read_b64_tr_b16 v[74:75], v2 offset:4256
    ds_read_b64_tr_b16 v[76:77], v2 offset:8480
    ds_read_b64_tr_b16 v[78:79], v2 offset:12704
    ds_read_b64_tr_b16 v[80:81], v2 offset:64
    ds_read_b64_tr_b16 v[82:83], v2 offset:4288
    ds_read_b64_tr_b16 v[84:85], v2 offset:8512
    ds_read_b64_tr_b16 v[86:87], v2 offset:12736
    s_waitcnt vmcnt(4)
    s_waitcnt lgkmcnt(8)
    v_mfma_f32_16x16x32_bf16 v[184:187], a[0:3], v[64:67], 0
    ds_read_b64_tr_b16 v[88:89], v2 offset:96
    s_add_u32 s80, s80, 4096
    v_mfma_f32_16x16x32_bf16 v[184:187], a[8:11], v[68:71], v[184:187]
    ds_read_b64_tr_b16 v[90:91], v2 offset:4320
    s_sub_u32 s64, s80, 36864
    s_cmp_ge_u32 s80, s79
    s_cselect_b32 s80, s64, s80
    v_mfma_f32_16x16x32_bf16 v[188:191], a[4:7], v[64:67], 0
    ds_read_b64_tr_b16 v[92:93], v2 offset:8544
    buffer_load_dwordx4 a[32:35], v1, s[48:51], s80 offen offset:0 sc1
    v_mfma_f32_16x16x32_bf16 v[188:191], a[12:15], v[68:71], v[188:191]
    ds_read_b64_tr_b16 v[94:95], v2 offset:12768
    s_waitcnt lgkmcnt(8)
    v_mfma_f32_16x16x32_bf16 v[192:195], a[0:3], v[72:75], 0
    ds_read_b64_tr_b16 v[64:65], v61 offset:128
    buffer_load_dwordx4 a[36:39], v1, s[48:51], s80 offen offset:1024 sc1
    v_mfma_f32_16x16x32_bf16 v[192:195], a[8:11], v[76:79], v[192:195]
    ds_read_b64_tr_b16 v[66:67], v61 offset:4352
    buffer_load_dwordx4 a[40:43], v1, s[48:51], s80 offen offset:2048 sc1
    v_mfma_f32_16x16x32_bf16 v[196:199], a[4:7], v[72:75], 0
    ds_read_b64_tr_b16 v[68:69], v61 offset:8576
    v_mfma_f32_16x16x32_bf16 v[196:199], a[12:15], v[76:79], v[196:199]
    ds_read_b64_tr_b16 v[70:71], v61 offset:12800
    s_waitcnt lgkmcnt(8)
    v_mfma_f32_16x16x32_bf16 v[200:203], a[0:3], v[80:83], 0
    ds_read_b64_tr_b16 v[72:73], v61 offset:160
    buffer_load_dwordx4 a[44:47], v1, s[48:51], s80 offen offset:3072 sc1
    v_mfma_f32_16x16x32_bf16 v[200:203], a[8:11], v[84:87], v[200:203]
    ds_read_b64_tr_b16 v[74:75], v61 offset:4384
    s_add_u32 s80, s80, 4096
    v_mfma_f32_16x16x32_bf16 v[204:207], a[4:7], v[80:83], 0
    ds_read_b64_tr_b16 v[76:77], v61 offset:8608
    s_sub_u32 s64, s80, 36864
    s_cmp_ge_u32 s80, s79
    s_cselect_b32 s80, s64, s80
    v_mfma_f32_16x16x32_bf16 v[204:207], a[12:15], v[84:87], v[204:207]
    ds_read_b64_tr_b16 v[78:79], v61 offset:12832
    s_waitcnt lgkmcnt(8)
    v_mfma_f32_16x16x32_bf16 v[208:211], a[0:3], v[88:91], 0
    ds_read_b64_tr_b16 v[80:81], v61 offset:192
    buffer_load_dwordx4 a[48:51], v1, s[48:51], s80 offen offset:0 sc1
    v_mfma_f32_16x16x32_bf16 v[208:211], a[8:11], v[92:95], v[208:211]
    ds_read_b64_tr_b16 v[82:83], v61 offset:4416
    v_mfma_f32_16x16x32_bf16 v[212:215], a[4:7], v[88:91], 0
    ds_read_b64_tr_b16 v[84:85], v61 offset:8640
    buffer_load_dwordx4 a[52:55], v1, s[48:51], s80 offen offset:1024 sc1
    v_mfma_f32_16x16x32_bf16 v[212:215], a[12:15], v[92:95], v[212:215]
    ds_read_b64_tr_b16 v[86:87], v61 offset:12864
    s_waitcnt lgkmcnt(8)
    v_mfma_f32_16x16x32_bf16 v[216:219], a[0:3], v[64:67], 0
    ds_read_b64_tr_b16 v[88:89], v61 offset:224
    v_mfma_f32_16x16x32_bf16 v[216:219], a[8:11], v[68:71], v[216:219]
    ds_read_b64_tr_b16 v[90:91], v61 offset:4448
    buffer_load_dwordx4 a[56:59], v1, s[48:51], s80 offen offset:2048 sc1
    v_mfma_f32_16x16x32_bf16 v[220:223], a[4:7], v[64:67], 0
    ds_read_b64_tr_b16 v[92:93], v61 offset:8672
    v_mfma_f32_16x16x32_bf16 v[220:223], a[12:15], v[68:71], v[220:223]
    ds_read_b64_tr_b16 v[94:95], v61 offset:12896
    s_waitcnt lgkmcnt(8)
    v_mfma_f32_16x16x32_bf16 v[224:227], a[0:3], v[72:75], 0
    s_barrier
    ds_read_b64_tr_b16 v[64:65], v2 offset:16896
    v_mfma_f32_16x16x32_bf16 v[224:227], a[8:11], v[76:79], v[224:227]
    ds_read_b64_tr_b16 v[66:67], v2 offset:21120
    buffer_load_dwordx4 a[60:63], v1, s[48:51], s80 offen offset:3072 sc1
    v_mfma_f32_16x16x32_bf16 v[228:231], a[4:7], v[72:75], 0
    ds_read_b64_tr_b16 v[68:69], v2 offset:25344
    s_add_u32 m0, s70, 50688
    v_mfma_f32_16x16x32_bf16 v[228:231], a[12:15], v[76:79], v[228:231]
    ds_read_b64_tr_b16 v[70:71], v2 offset:29568
    s_waitcnt lgkmcnt(8)
    v_mfma_f32_16x16x32_bf16 v[232:235], a[0:3], v[80:83], 0
    ds_read_b64_tr_b16 v[72:73], v2 offset:16928
    s_add_u32 s71, s71, 589824
    v_mfma_f32_16x16x32_bf16 v[232:235], a[8:11], v[84:87], v[232:235]
    ds_read_b64_tr_b16 v[74:75], v2 offset:21152
    s_sub_u32 s64, s71, 5308416
    s_cmp_ge_u32 s71, s72
    s_cselect_b32 s71, s64, s71
    v_mfma_f32_16x16x32_bf16 v[236:239], a[4:7], v[80:83], 0
    ds_read_b64_tr_b16 v[76:77], v2 offset:25376
    buffer_load_dwordx4 v56, s[52:55], s71 offen offset:0 lds
    v_mfma_f32_16x16x32_bf16 v[236:239], a[12:15], v[84:87], v[236:239]
    ds_read_b64_tr_b16 v[78:79], v2 offset:29600
    s_waitcnt lgkmcnt(8)
    v_mfma_f32_16x16x32_bf16 v[240:243], a[0:3], v[88:91], 0
    ds_read_b64_tr_b16 v[80:81], v2 offset:16960
    buffer_load_dwordx4 v57, s[52:55], s71 offen offset:1056 lds
    v_mfma_f32_16x16x32_bf16 v[240:243], a[8:11], v[92:95], v[240:243]
    ds_read_b64_tr_b16 v[82:83], v2 offset:21184
    s_lshl_b32 s65, s58, 8
    s_add_u32 s65, s65, 0x11e0000
    buffer_load_dword v96, v63, s[48:51], s65 offen sc1
    v_mfma_f32_16x16x32_bf16 v[244:247], a[4:7], v[88:91], 0
    ds_read_b64_tr_b16 v[84:85], v2 offset:25408
    v_mfma_f32_16x16x32_bf16 v[244:247], a[12:15], v[92:95], v[244:247]
    ds_read_b64_tr_b16 v[86:87], v2 offset:29632
    s_waitcnt lgkmcnt(8)
    s_waitcnt vmcnt(11)
    v_mfma_f32_16x16x32_bf16 v[184:187], a[16:19], v[64:67], v[184:187]
    ds_read_b64_tr_b16 v[88:89], v2 offset:16992
    buffer_load_dwordx4 v58, s[52:55], s71 offen offset:2112 lds
    v_mfma_f32_16x16x32_bf16 v[184:187], a[24:27], v[68:71], v[184:187]
    ds_read_b64_tr_b16 v[90:91], v2 offset:21216
    v_mfma_f32_16x16x32_bf16 v[188:191], a[28:31], v[68:71], v[188:191]
    ds_read_b64_tr_b16 v[92:93], v2 offset:25440
    v_mfma_f32_16x16x32_bf16 v[188:191], a[20:23], v[64:67], v[188:191]
    ds_read_b64_tr_b16 v[94:95], v2 offset:29664
    s_waitcnt lgkmcnt(8)
    v_mfma_f32_16x16x32_bf16 v[192:195], a[16:19], v[72:75], v[192:195]
    ds_read_b64_tr_b16 v[64:65], v61 offset:17024
    v_mfma_f32_16x16x32_bf16 v[192:195], a[24:27], v[76:79], v[192:195]
    ds_read_b64_tr_b16 v[66:67], v61 offset:21248
    buffer_load_dwordx4 v59, s[52:55], s71 offen offset:3168 lds
    v_mfma_f32_16x16x32_bf16 v[196:199], a[28:31], v[76:79], v[196:199]
    ds_read_b64_tr_b16 v[68:69], v61 offset:25472
    v_mfma_f32_16x16x32_bf16 v[196:199], a[20:23], v[72:75], v[196:199]
    ds_read_b64_tr_b16 v[70:71], v61 offset:29696
    s_waitcnt lgkmcnt(8)
    v_mfma_f32_16x16x32_bf16 v[200:203], a[16:19], v[80:83], v[200:203]
    ds_read_b64_tr_b16 v[72:73], v61 offset:17056
    s_add_u32 s80, s80, 4096
    v_mfma_f32_16x16x32_bf16 v[200:203], a[24:27], v[84:87], v[200:203]
    ds_read_b64_tr_b16 v[74:75], v61 offset:21280
    s_sub_u32 s64, s80, 36864
    s_cmp_ge_u32 s80, s79
    s_cselect_b32 s80, s64, s80
    v_mfma_f32_16x16x32_bf16 v[204:207], a[28:31], v[84:87], v[204:207]
    ds_read_b64_tr_b16 v[76:77], v61 offset:25504
    buffer_load_dwordx4 a[64:67], v1, s[48:51], s80 offen offset:0 sc1
    v_mfma_f32_16x16x32_bf16 v[204:207], a[20:23], v[80:83], v[204:207]
    ds_read_b64_tr_b16 v[78:79], v61 offset:29728
    s_waitcnt lgkmcnt(8)
    v_mfma_f32_16x16x32_bf16 v[208:211], a[16:19], v[88:91], v[208:211]
    ds_read_b64_tr_b16 v[80:81], v61 offset:17088
    v_mfma_f32_16x16x32_bf16 v[208:211], a[24:27], v[92:95], v[208:211]
    ds_read_b64_tr_b16 v[82:83], v61 offset:21312
    buffer_load_dwordx4 a[68:71], v1, s[48:51], s80 offen offset:1024 sc1
    v_mfma_f32_16x16x32_bf16 v[212:215], a[28:31], v[92:95], v[212:215]
    ds_read_b64_tr_b16 v[84:85], v61 offset:25536
    v_mfma_f32_16x16x32_bf16 v[212:215], a[20:23], v[88:91], v[212:215]
    ds_read_b64_tr_b16 v[86:87], v61 offset:29760
    s_waitcnt lgkmcnt(8)
    v_mfma_f32_16x16x32_bf16 v[216:219], a[16:19], v[64:67], v[216:219]
    ds_read_b64_tr_b16 v[88:89], v61 offset:17120
    buffer_load_dwordx4 a[72:75], v1, s[48:51], s80 offen offset:2048 sc1
    v_mfma_f32_16x16x32_bf16 v[216:219], a[24:27], v[68:71], v[216:219]
    ds_read_b64_tr_b16 v[90:91], v61 offset:21344
    v_mfma_f32_16x16x32_bf16 v[220:223], a[28:31], v[68:71], v[220:223]
    ds_read_b64_tr_b16 v[92:93], v61 offset:25568
    v_mfma_f32_16x16x32_bf16 v[220:223], a[20:23], v[64:67], v[220:223]
    ds_read_b64_tr_b16 v[94:95], v61 offset:29792
    s_waitcnt lgkmcnt(8)
    v_add_u32 v2, 0xfffe7400, v2
    v_add_u32 v61, 0xfffe7400, v61
    v_mfma_f32_16x16x32_bf16 v[224:227], a[16:19], v[72:75], v[224:227]
    s_barrier
    ds_read_b64_tr_b16 v[64:65], v2 offset:0
    v_mfma_f32_16x16x32_bf16 v[224:227], a[24:27], v[76:79], v[224:227]
    ds_read_b64_tr_b16 v[66:67], v2 offset:4224
    buffer_load_dwordx4 a[76:79], v1, s[48:51], s80 offen offset:3072 sc1
    v_mfma_f32_16x16x32_bf16 v[228:231], a[28:31], v[76:79], v[228:231]
    ds_read_b64_tr_b16 v[68:69], v2 offset:8448
    s_add_u32 m0, s70, 67584
    v_mfma_f32_16x16x32_bf16 v[228:231], a[20:23], v[72:75], v[228:231]
    ds_read_b64_tr_b16 v[70:71], v2 offset:12672
    s_waitcnt lgkmcnt(8)
    v_mfma_f32_16x16x32_bf16 v[232:235], a[16:19], v[80:83], v[232:235]
    ds_read_b64_tr_b16 v[72:73], v2 offset:32
    s_add_u32 s71, s71, 589824
    v_mfma_f32_16x16x32_bf16 v[232:235], a[24:27], v[84:87], v[232:235]
    ds_read_b64_tr_b16 v[74:75], v2 offset:4256
    s_sub_u32 s64, s71, 5308416
    s_cmp_ge_u32 s71, s72
    s_cselect_b32 s71, s64, s71
    v_mfma_f32_16x16x32_bf16 v[236:239], a[28:31], v[84:87], v[236:239]
    ds_read_b64_tr_b16 v[76:77], v2 offset:8480
    buffer_load_dwordx4 v56, s[52:55], s71 offen offset:0 lds
    v_mfma_f32_16x16x32_bf16 v[236:239], a[20:23], v[80:83], v[236:239]
    ds_read_b64_tr_b16 v[78:79], v2 offset:12704
    s_waitcnt lgkmcnt(8)
    v_mfma_f32_16x16x32_bf16 v[240:243], a[16:19], v[88:91], v[240:243]
    ds_read_b64_tr_b16 v[80:81], v2 offset:64
    buffer_load_dwordx4 v57, s[52:55], s71 offen offset:1056 lds
    v_mfma_f32_16x16x32_bf16 v[240:243], a[24:27], v[92:95], v[240:243]
    ds_read_b64_tr_b16 v[82:83], v2 offset:4288
    v_mfma_f32_16x16x32_bf16 v[244:247], a[28:31], v[92:95], v[244:247]
    ds_read_b64_tr_b16 v[84:85], v2 offset:8512
    v_mfma_f32_16x16x32_bf16 v[244:247], a[20:23], v[88:91], v[244:247]
    ds_read_b64_tr_b16 v[86:87], v2 offset:12736
    s_waitcnt lgkmcnt(8)
    s_waitcnt vmcnt(15)
    v_mfma_f32_16x16x32_bf16 v[184:187], a[32:35], v[64:67], v[184:187]
    ds_read_b64_tr_b16 v[88:89], v2 offset:96
    buffer_load_dwordx4 v58, s[52:55], s71 offen offset:2112 lds
    v_mfma_f32_16x16x32_bf16 v[184:187], a[40:43], v[68:71], v[184:187]
    ds_read_b64_tr_b16 v[90:91], v2 offset:4320
    v_mfma_f32_16x16x32_bf16 v[188:191], a[44:47], v[68:71], v[188:191]
    ds_read_b64_tr_b16 v[92:93], v2 offset:8544
    v_mfma_f32_16x16x32_bf16 v[188:191], a[36:39], v[64:67], v[188:191]
    ds_read_b64_tr_b16 v[94:95], v2 offset:12768
    s_waitcnt lgkmcnt(8)
    v_mfma_f32_16x16x32_bf16 v[192:195], a[32:35], v[72:75], v[192:195]
    ds_read_b64_tr_b16 v[64:65], v61 offset:128
    buffer_load_dwordx4 v59, s[52:55], s71 offen offset:3168 lds
    v_mfma_f32_16x16x32_bf16 v[192:195], a[40:43], v[76:79], v[192:195]
    ds_read_b64_tr_b16 v[66:67], v61 offset:4352
    v_mfma_f32_16x16x32_bf16 v[196:199], a[44:47], v[76:79], v[196:199]
    ds_read_b64_tr_b16 v[68:69], v61 offset:8576
    v_mfma_f32_16x16x32_bf16 v[196:199], a[36:39], v[72:75], v[196:199]
    ds_read_b64_tr_b16 v[70:71], v61 offset:12800
    s_waitcnt lgkmcnt(8)
    v_mfma_f32_16x16x32_bf16 v[200:203], a[32:35], v[80:83], v[200:203]
    ds_read_b64_tr_b16 v[72:73], v61 offset:160
    s_add_u32 s80, s80, 4096
    v_mfma_f32_16x16x32_bf16 v[200:203], a[40:43], v[84:87], v[200:203]
    ds_read_b64_tr_b16 v[74:75], v61 offset:4384
    s_sub_u32 s64, s80, 36864
    s_cmp_ge_u32 s80, s79
    s_cselect_b32 s80, s64, s80
    v_mfma_f32_16x16x32_bf16 v[204:207], a[44:47], v[84:87], v[204:207]
    ds_read_b64_tr_b16 v[76:77], v61 offset:8608
    buffer_load_dwordx4 a[80:83], v1, s[48:51], s80 offen offset:0 sc1
    v_mfma_f32_16x16x32_bf16 v[204:207], a[36:39], v[80:83], v[204:207]
    ds_read_b64_tr_b16 v[78:79], v61 offset:12832
    s_waitcnt lgkmcnt(8)
    v_mfma_f32_16x16x32_bf16 v[208:211], a[32:35], v[88:91], v[208:211]
    ds_read_b64_tr_b16 v[80:81], v61 offset:192
    buffer_load_dwordx4 a[84:87], v1, s[48:51], s80 offen offset:1024 sc1
    v_mfma_f32_16x16x32_bf16 v[208:211], a[40:43], v[92:95], v[208:211]
    ds_read_b64_tr_b16 v[82:83], v61 offset:4416
    v_mfma_f32_16x16x32_bf16 v[212:215], a[44:47], v[92:95], v[212:215]
    ds_read_b64_tr_b16 v[84:85], v61 offset:8640
    buffer_load_dwordx4 a[88:91], v1, s[48:51], s80 offen offset:2048 sc1
    v_mfma_f32_16x16x32_bf16 v[212:215], a[36:39], v[88:91], v[212:215]
    ds_read_b64_tr_b16 v[86:87], v61 offset:12864
    s_waitcnt lgkmcnt(8)
    v_mfma_f32_16x16x32_bf16 v[216:219], a[32:35], v[64:67], v[216:219]
    ds_read_b64_tr_b16 v[88:89], v61 offset:224
    v_mfma_f32_16x16x32_bf16 v[216:219], a[40:43], v[68:71], v[216:219]
    ds_read_b64_tr_b16 v[90:91], v61 offset:4448
    buffer_load_dwordx4 a[92:95], v1, s[48:51], s80 offen offset:3072 sc1
    v_mfma_f32_16x16x32_bf16 v[220:223], a[44:47], v[68:71], v[220:223]
    ds_read_b64_tr_b16 v[92:93], v61 offset:8672
    s_add_u32 m0, s70, 84480
    v_mfma_f32_16x16x32_bf16 v[220:223], a[36:39], v[64:67], v[220:223]
    ds_read_b64_tr_b16 v[94:95], v61 offset:12896
    s_waitcnt lgkmcnt(8)
    v_mfma_f32_16x16x32_bf16 v[224:227], a[32:35], v[72:75], v[224:227]
    s_barrier
    ds_read_b64_tr_b16 v[64:65], v2 offset:16896
    v_mfma_f32_16x16x32_bf16 v[224:227], a[40:43], v[76:79], v[224:227]
    ds_read_b64_tr_b16 v[66:67], v2 offset:21120
    s_add_u32 s71, s71, 589824
    v_mfma_f32_16x16x32_bf16 v[228:231], a[44:47], v[76:79], v[228:231]
    ds_read_b64_tr_b16 v[68:69], v2 offset:25344
    s_sub_u32 s64, s71, 5308416
    s_cmp_ge_u32 s71, s72
    s_cselect_b32 s71, s64, s71
    v_mfma_f32_16x16x32_bf16 v[228:231], a[36:39], v[72:75], v[228:231]
    ds_read_b64_tr_b16 v[70:71], v2 offset:29568
    s_waitcnt lgkmcnt(8)
    v_mfma_f32_16x16x32_bf16 v[232:235], a[32:35], v[80:83], v[232:235]
    ds_read_b64_tr_b16 v[72:73], v2 offset:16928
    buffer_load_dwordx4 v56, s[52:55], s71 offen offset:0 lds
    v_mfma_f32_16x16x32_bf16 v[232:235], a[40:43], v[84:87], v[232:235]
    ds_read_b64_tr_b16 v[74:75], v2 offset:21152
    buffer_load_dwordx4 v57, s[52:55], s71 offen offset:1056 lds
    v_mfma_f32_16x16x32_bf16 v[236:239], a[44:47], v[84:87], v[236:239]
    ds_read_b64_tr_b16 v[76:77], v2 offset:25376
    v_mfma_f32_16x16x32_bf16 v[236:239], a[36:39], v[80:83], v[236:239]
    ds_read_b64_tr_b16 v[78:79], v2 offset:29600
    s_waitcnt lgkmcnt(8)
    v_mfma_f32_16x16x32_bf16 v[240:243], a[32:35], v[88:91], v[240:243]
    ds_read_b64_tr_b16 v[80:81], v2 offset:16960
    v_mfma_f32_16x16x32_bf16 v[240:243], a[40:43], v[92:95], v[240:243]
    ds_read_b64_tr_b16 v[82:83], v2 offset:21184
    v_mfma_f32_16x16x32_bf16 v[244:247], a[44:47], v[92:95], v[244:247]
    ds_read_b64_tr_b16 v[84:85], v2 offset:25408
    buffer_load_dwordx4 v58, s[52:55], s71 offen offset:2112 lds
    v_mfma_f32_16x16x32_bf16 v[244:247], a[36:39], v[88:91], v[244:247]
    ds_read_b64_tr_b16 v[86:87], v2 offset:29632
    s_waitcnt lgkmcnt(8)
    s_waitcnt vmcnt(20)
    v_mfma_f32_16x16x32_bf16 v[184:187], a[48:51], v[64:67], v[184:187]
    ds_read_b64_tr_b16 v[88:89], v2 offset:16992
    v_mfma_f32_16x16x32_bf16 v[184:187], a[56:59], v[68:71], v[184:187]
    ds_read_b64_tr_b16 v[90:91], v2 offset:21216
    v_mfma_f32_16x16x32_bf16 v[188:191], a[60:63], v[68:71], v[188:191]
    ds_read_b64_tr_b16 v[92:93], v2 offset:25440
    buffer_load_dwordx4 v59, s[52:55], s71 offen offset:3168 lds
    v_mfma_f32_16x16x32_bf16 v[188:191], a[52:55], v[64:67], v[188:191]
    ds_read_b64_tr_b16 v[94:95], v2 offset:29664
    s_waitcnt lgkmcnt(8)
    v_mfma_f32_16x16x32_bf16 v[192:195], a[48:51], v[72:75], v[192:195]
    ds_read_b64_tr_b16 v[64:65], v61 offset:17024
    s_waitcnt vmcnt(18)
    s_branch KM_of_chk
KM_of_poll:
    buffer_load_dword v96, v63, s[48:51], s65 offen sc1
    s_waitcnt vmcnt(0)
KM_of_chk:
    v_cmp_ne_u32 vcc, s95, v96
    s_sub_u32 s94, s94, 1
    s_cmp_lt_i32 s94, 1
    s_cbranch_scc1 KM_of_done
    s_cbranch_vccnz KM_of_poll
KM_of_done:
    v_mfma_f32_16x16x32_bf16 v[192:195], a[56:59], v[76:79], v[192:195]
    ds_read_b64_tr_b16 v[66:67], v61 offset:21248
    s_add_u32 s80, s80, 4096
    v_mfma_f32_16x16x32_bf16 v[196:199], a[60:63], v[76:79], v[196:199]
    ds_read_b64_tr_b16 v[68:69], v61 offset:25472
    s_sub_u32 s64, s80, 36864
    s_cmp_ge_u32 s80, s79
    s_cselect_b32 s80, s64, s80
    v_mfma_f32_16x16x32_bf16 v[196:199], a[52:55], v[72:75], v[196:199]
    ds_read_b64_tr_b16 v[70:71], v61 offset:29696
    s_waitcnt lgkmcnt(8)
    v_mfma_f32_16x16x32_bf16 v[200:203], a[48:51], v[80:83], v[200:203]
    ds_read_b64_tr_b16 v[72:73], v61 offset:17056
    buffer_load_dwordx4 a[96:99], v1, s[48:51], s80 offen offset:0 sc1
    v_mfma_f32_16x16x32_bf16 v[200:203], a[56:59], v[84:87], v[200:203]
    ds_read_b64_tr_b16 v[74:75], v61 offset:21280
    v_mfma_f32_16x16x32_bf16 v[204:207], a[60:63], v[84:87], v[204:207]
    ds_read_b64_tr_b16 v[76:77], v61 offset:25504
    buffer_load_dwordx4 a[100:103], v1, s[48:51], s80 offen offset:1024 sc1
    v_mfma_f32_16x16x32_bf16 v[204:207], a[52:55], v[80:83], v[204:207]
    ds_read_b64_tr_b16 v[78:79], v61 offset:29728
    s_waitcnt lgkmcnt(8)
    v_mfma_f32_16x16x32_bf16 v[208:211], a[48:51], v[88:91], v[208:211]
    ds_read_b64_tr_b16 v[80:81], v61 offset:17088
    v_mfma_f32_16x16x32_bf16 v[208:211], a[56:59], v[92:95], v[208:211]
    ds_read_b64_tr_b16 v[82:83], v61 offset:21312
    buffer_load_dwordx4 a[104:107], v1, s[48:51], s80 offen offset:2048 sc1
    v_mfma_f32_16x16x32_bf16 v[212:215], a[60:63], v[92:95], v[212:215]
    ds_read_b64_tr_b16 v[84:85], v61 offset:25536
    v_mfma_f32_16x16x32_bf16 v[212:215], a[52:55], v[88:91], v[212:215]
    ds_read_b64_tr_b16 v[86:87], v61 offset:29760
    s_waitcnt lgkmcnt(8)
    v_mfma_f32_16x16x32_bf16 v[216:219], a[48:51], v[64:67], v[216:219]
    ds_read_b64_tr_b16 v[88:89], v61 offset:17120
    buffer_load_dwordx4 a[108:111], v1, s[48:51], s80 offen offset:3072 sc1
    v_mfma_f32_16x16x32_bf16 v[216:219], a[56:59], v[68:71], v[216:219]
    ds_read_b64_tr_b16 v[90:91], v61 offset:21344
    s_add_u32 m0, s70, 101376
    v_mfma_f32_16x16x32_bf16 v[220:223], a[60:63], v[68:71], v[220:223]
    ds_read_b64_tr_b16 v[92:93], v61 offset:25568
    s_add_u32 s71, s71, 589824
    v_mfma_f32_16x16x32_bf16 v[220:223], a[52:55], v[64:67], v[220:223]
    ds_read_b64_tr_b16 v[94:95], v61 offset:29792
    s_waitcnt lgkmcnt(8)
    v_mfma_f32_16x16x32_bf16 v[224:227], a[48:51], v[72:75], v[224:227]
    s_barrier
    ds_read_b64_tr_b16 v[64:65], v2 offset:33792
    v_mfma_f32_16x16x32_bf16 v[224:227], a[56:59], v[76:79], v[224:227]
    ds_read_b64_tr_b16 v[66:67], v2 offset:38016
    s_sub_u32 s64, s71, 5308416
    s_cmp_ge_u32 s71, s72
    s_cselect_b32 s71, s64, s71
    v_mfma_f32_16x16x32_bf16 v[228:231], a[60:63], v[76:79], v[228:231]
    ds_read_b64_tr_b16 v[68:69], v2 offset:42240
    buffer_load_dwordx4 v56, s[52:55], s71 offen offset:0 lds
    v_mfma_f32_16x16x32_bf16 v[228:231], a[52:55], v[72:75], v[228:231]
    ds_read_b64_tr_b16 v[70:71], v2 offset:46464
    s_waitcnt lgkmcnt(8)
    v_mfma_f32_16x16x32_bf16 v[232:235], a[48:51], v[80:83], v[232:235]
    ds_read_b64_tr_b16 v[72:73], v2 offset:33824
    buffer_load_dwordx4 v57, s[52:55], s71 offen offset:1056 lds
    v_mfma_f32_16x16x32_bf16 v[232:235], a[56:59], v[84:87], v[232:235]
    ds_read_b64_tr_b16 v[74:75], v2 offset:38048
    v_mfma_f32_16x16x32_bf16 v[236:239], a[60:63], v[84:87], v[236:239]
    ds_read_b64_tr_b16 v[76:77], v2 offset:42272
    v_mfma_f32_16x16x32_bf16 v[236:239], a[52:55], v[80:83], v[236:239]
    ds_read_b64_tr_b16 v[78:79], v2 offset:46496
    s_waitcnt lgkmcnt(8)
    v_mfma_f32_16x16x32_bf16 v[240:243], a[48:51], v[88:91], v[240:243]
    ds_read_b64_tr_b16 v[80:81], v2 offset:33856
    buffer_load_dwordx4 v58, s[52:55], s71 offen offset:2112 lds
    v_mfma_f32_16x16x32_bf16 v[240:243], a[56:59], v[92:95], v[240:243]
    ds_read_b64_tr_b16 v[82:83], v2 offset:38080
    v_mfma_f32_16x16x32_bf16 v[244:247], a[60:63], v[92:95], v[244:247]
    ds_read_b64_tr_b16 v[84:85], v2 offset:42304
    v_mfma_f32_16x16x32_bf16 v[244:247], a[52:55], v[88:91], v[244:247]
    ds_read_b64_tr_b16 v[86:87], v2 offset:46528
    s_waitcnt lgkmcnt(8)
    s_waitcnt vmcnt(19)
    v_mfma_f32_16x16x32_bf16 v[184:187], a[64:67], v[64:67], v[184:187]
    ds_read_b64_tr_b16 v[88:89], v2 offset:33888
    v_mfma_f32_16x16x32_bf16 v[184:187], a[72:75], v[68:71], v[184:187]
    ds_read_b64_tr_b16 v[90:91], v2 offset:38112
    buffer_load_dwordx4 v59, s[52:55], s71 offen offset:3168 lds
    v_mfma_f32_16x16x32_bf16 v[188:191], a[76:79], v[68:71], v[188:191]
    ds_read_b64_tr_b16 v[92:93], v2 offset:42336
    v_mfma_f32_16x16x32_bf16 v[188:191], a[68:71], v[64:67], v[188:191]
    ds_read_b64_tr_b16 v[94:95], v2 offset:46560
    s_waitcnt lgkmcnt(8)
    v_mfma_f32_16x16x32_bf16 v[192:195], a[64:67], v[72:75], v[192:195]
    ds_read_b64_tr_b16 v[64:65], v61 offset:33920
    s_add_u32 s80, s80, 4096
    v_mfma_f32_16x16x32_bf16 v[192:195], a[72:75], v[76:79], v[192:195]
    ds_read_b64_tr_b16 v[66:67], v61 offset:38144
    s_sub_u32 s64, s80, 36864
    s_cmp_ge_u32 s80, s79
    s_cselect_b32 s80, s64, s80
    v_mfma_f32_16x16x32_bf16 v[196:199], a[76:79], v[76:79], v[196:199]
    ds_read_b64_tr_b16 v[68:69], v61 offset:42368
    buffer_load_dwordx4 a[112:115], v1, s[48:51], s80 offen offset:0 sc1
    v_mfma_f32_16x16x32_bf16 v[196:199], a[68:71], v[72:75], v[196:199]
    ds_read_b64_tr_b16 v[70:71], v61 offset:46592
    s_waitcnt lgkmcnt(8)
    v_mfma_f32_16x16x32_bf16 v[200:203], a[64:67], v[80:83], v[200:203]
    ds_read_b64_tr_b16 v[72:73], v61 offset:33952
    v_mfma_f32_16x16x32_bf16 v[200:203], a[72:75], v[84:87], v[200:203]
    ds_read_b64_tr_b16 v[74:75], v61 offset:38176
    buffer_load_dwordx4 a[116:119], v1, s[48:51], s80 offen offset:1024 sc1
    v_mfma_f32_16x16x32_bf16 v[204:207], a[76:79], v[84:87], v[204:207]
    ds_read_b64_tr_b16 v[76:77], v61 offset:42400
    v_mfma_f32_16x16x32_bf16 v[204:207], a[68:71], v[80:83], v[204:207]
    ds_read_b64_tr_b16 v[78:79], v61 offset:46624
    s_waitcnt lgkmcnt(8)
    v_mfma_f32_16x16x32_bf16 v[208:211], a[64:67], v[88:91], v[208:211]
    ds_read_b64_tr_b16 v[80:81], v61 offset:33984
    buffer_load_dwordx4 a[120:123], v1, s[48:51], s80 offen offset:2048 sc1
    v_mfma_f32_16x16x32_bf16 v[208:211], a[72:75], v[92:95], v[208:211]
    ds_read_b64_tr_b16 v[82:83], v61 offset:38208
    v_mfma_f32_16x16x32_bf16 v[212:215], a[76:79], v[92:95], v[212:215]
    ds_read_b64_tr_b16 v[84:85], v61 offset:42432
    buffer_load_dwordx4 a[124:127], v1, s[48:51], s80 offen offset:3072 sc1
    v_mfma_f32_16x16x32_bf16 v[212:215], a[68:71], v[88:91], v[212:215]
    ds_read_b64_tr_b16 v[86:87], v61 offset:46656
    s_waitcnt lgkmcnt(8)
    v_mfma_f32_16x16x32_bf16 v[216:219], a[64:67], v[64:67], v[216:219]
    ds_read_b64_tr_b16 v[88:89], v61 offset:34016
    s_add_u32 s80, s80, 4096
    v_mfma_f32_16x16x32_bf16 v[216:219], a[72:75], v[68:71], v[216:219]
    ds_read_b64_tr_b16 v[90:91], v61 offset:38240
    s_sub_u32 s64, s80, 36864
    s_cmp_ge_u32 s80, s79
    s_cselect_b32 s80, s64, s80
    v_mfma_f32_16x16x32_bf16 v[220:223], a[76:79], v[68:71], v[220:223]
    ds_read_b64_tr_b16 v[92:93], v61 offset:42464
    buffer_load_dwordx4 a[128:131], v1, s[48:51], s80 offen offset:0 sc1
    v_mfma_f32_16x16x32_bf16 v[220:223], a[68:71], v[64:67], v[220:223]
    ds_read_b64_tr_b16 v[94:95], v61 offset:46688
    s_waitcnt lgkmcnt(8)
    v_add_u32 v2, 0xc600, v2
    v_add_u32 v61, 0xc600, v61
    v_mfma_f32_16x16x32_bf16 v[224:227], a[64:67], v[72:75], v[224:227]
    s_barrier
    ds_read_b64_tr_b16 v[64:65], v2 offset:0
    v_mfma_f32_16x16x32_bf16 v[224:227], a[72:75], v[76:79], v[224:227]
    ds_read_b64_tr_b16 v[66:67], v2 offset:4224
    buffer_load_dwordx4 a[132:135], v1, s[48:51], s80 offen offset:1024 sc1
    v_mfma_f32_16x16x32_bf16 v[228:231], a[76:79], v[76:79], v[228:231]
    ds_read_b64_tr_b16 v[68:69], v2 offset:8448
    v_mfma_f32_16x16x32_bf16 v[228:231], a[68:71], v[72:75], v[228:231]
    ds_read_b64_tr_b16 v[70:71], v2 offset:12672
    s_waitcnt lgkmcnt(8)
    v_mfma_f32_16x16x32_bf16 v[232:235], a[64:67], v[80:83], v[232:235]
    ds_read_b64_tr_b16 v[72:73], v2 offset:32
    buffer_load_dwordx4 a[136:139], v1, s[48:51], s80 offen offset:2048 sc1
    v_mfma_f32_16x16x32_bf16 v[232:235], a[72:75], v[84:87], v[232:235]
    ds_read_b64_tr_b16 v[74:75], v2 offset:4256
    v_mfma_f32_16x16x32_bf16 v[236:239], a[76:79], v[84:87], v[236:239]
    ds_read_b64_tr_b16 v[76:77], v2 offset:8480
    buffer_load_dwordx4 a[140:143], v1, s[48:51], s80 offen offset:3072 sc1
    v_mfma_f32_16x16x32_bf16 v[236:239], a[68:71], v[80:83], v[236:239]
    ds_read_b64_tr_b16 v[78:79], v2 offset:12704
    s_waitcnt lgkmcnt(8)
    v_mfma_f32_16x16x32_bf16 v[240:243], a[64:67], v[88:91], v[240:243]
    ds_read_b64_tr_b16 v[80:81], v2 offset:64
    s_lshl_b32 s61, s3, 11
    v_mfma_f32_16x16x32_bf16 v[240:243], a[72:75], v[92:95], v[240:243]
    ds_read_b64_tr_b16 v[82:83], v2 offset:4288
    s_add_u32 m0, s61, 135168
    v_mfma_f32_16x16x32_bf16 v[244:247], a[76:79], v[92:95], v[244:247]
    ds_read_b64_tr_b16 v[84:85], v2 offset:8512
    s_mov_b32 s61, 0
    v_mfma_f32_16x16x32_bf16 v[244:247], a[68:71], v[88:91], v[244:247]
    ds_read_b64_tr_b16 v[86:87], v2 offset:12736
    s_waitcnt lgkmcnt(8)
    s_waitcnt vmcnt(20)
    v_mfma_f32_16x16x32_bf16 v[184:187], a[80:83], v[64:67], v[184:187]
    ds_read_b64_tr_b16 v[88:89], v2 offset:96
    s_add_u32 s64, s63, s3
    v_mfma_f32_16x16x32_bf16 v[184:187], a[88:91], v[68:71], v[184:187]
    ds_read_b64_tr_b16 v[90:91], v2 offset:4320
    s_cmp_ge_u32 s64, 9
    s_cselect_b32 s65, 9, 0
    s_sub_u32 s64, s64, s65
    v_mfma_f32_16x16x32_bf16 v[188:191], a[92:95], v[68:71], v[188:191]
    ds_read_b64_tr_b16 v[92:93], v2 offset:8544
    s_lshl_b32 s64, s64, 11
    v_mfma_f32_16x16x32_bf16 v[188:191], a[84:87], v[64:67], v[188:191]
    ds_read_b64_tr_b16 v[94:95], v2 offset:12768
    s_waitcnt lgkmcnt(8)
    v_mfma_f32_16x16x32_bf16 v[192:195], a[80:83], v[72:75], v[192:195]
    ds_read_b64_tr_b16 v[64:65], v61 offset:128
    s_add_u32 s64, s64, s61
    v_mfma_f32_16x16x32_bf16 v[192:195], a[88:91], v[76:79], v[192:195]
    ds_read_b64_tr_b16 v[66:67], v61 offset:4352
    s_add_u32 s64, s64, s66
    v_mfma_f32_16x16x32_bf16 v[196:199], a[92:95], v[76:79], v[196:199]
    ds_read_b64_tr_b16 v[68:69], v61 offset:8576
    buffer_load_dwordx4 v1, s[48:51], s64 offen offset:0 sc1 lds
    v_mfma_f32_16x16x32_bf16 v[196:199], a[84:87], v[72:75], v[196:199]
    ds_read_b64_tr_b16 v[70:71], v61 offset:12800
    s_waitcnt lgkmcnt(8)
    v_mfma_f32_16x16x32_bf16 v[200:203], a[80:83], v[80:83], v[200:203]
    ds_read_b64_tr_b16 v[72:73], v61 offset:160
    buffer_load_dwordx4 v1, s[48:51], s64 offen offset:1024 sc1 lds
    v_mfma_f32_16x16x32_bf16 v[200:203], a[88:91], v[84:87], v[200:203]
    ds_read_b64_tr_b16 v[74:75], v61 offset:4384
    s_lshl_b32 s61, s3, 11
    v_mfma_f32_16x16x32_bf16 v[204:207], a[92:95], v[84:87], v[204:207]
    ds_read_b64_tr_b16 v[76:77], v61 offset:8608
    s_add_u32 m0, s61, 143360
    v_mfma_f32_16x16x32_bf16 v[204:207], a[84:87], v[80:83], v[204:207]
    ds_read_b64_tr_b16 v[78:79], v61 offset:12832
    s_waitcnt lgkmcnt(8)
    v_mfma_f32_16x16x32_bf16 v[208:211], a[80:83], v[88:91], v[208:211]
    ds_read_b64_tr_b16 v[80:81], v61 offset:192
    s_mov_b32 s61, 0
    v_mfma_f32_16x16x32_bf16 v[208:211], a[88:91], v[92:95], v[208:211]
    ds_read_b64_tr_b16 v[82:83], v61 offset:4416
    s_add_u32 s64, s63, s3
    v_mfma_f32_16x16x32_bf16 v[212:215], a[92:95], v[92:95], v[212:215]
    ds_read_b64_tr_b16 v[84:85], v61 offset:8640
    s_add_u32 s64, s64, 4
    v_mfma_f32_16x16x32_bf16 v[212:215], a[84:87], v[88:91], v[212:215]
    ds_read_b64_tr_b16 v[86:87], v61 offset:12864
    s_waitcnt lgkmcnt(8)
    v_mfma_f32_16x16x32_bf16 v[216:219], a[80:83], v[64:67], v[216:219]
    ds_read_b64_tr_b16 v[88:89], v61 offset:224
    s_cmp_ge_u32 s64, 9
    s_cselect_b32 s65, 9, 0
    s_sub_u32 s64, s64, s65
    v_mfma_f32_16x16x32_bf16 v[216:219], a[88:91], v[68:71], v[216:219]
    ds_read_b64_tr_b16 v[90:91], v61 offset:4448
    s_lshl_b32 s64, s64, 11
    v_mfma_f32_16x16x32_bf16 v[220:223], a[92:95], v[68:71], v[220:223]
    ds_read_b64_tr_b16 v[92:93], v61 offset:8672
    s_add_u32 s64, s64, s61
    v_mfma_f32_16x16x32_bf16 v[220:223], a[84:87], v[64:67], v[220:223]
    ds_read_b64_tr_b16 v[94:95], v61 offset:12896
    s_waitcnt lgkmcnt(8)
    v_mfma_f32_16x16x32_bf16 v[224:227], a[80:83], v[72:75], v[224:227]
    s_barrier
    ds_read_b64_tr_b16 v[64:65], v2 offset:16896
    v_mfma_f32_16x16x32_bf16 v[224:227], a[88:91], v[76:79], v[224:227]
    ds_read_b64_tr_b16 v[66:67], v2 offset:21120
    s_add_u32 s64, s64, s66
    v_mfma_f32_16x16x32_bf16 v[228:231], a[92:95], v[76:79], v[228:231]
    ds_read_b64_tr_b16 v[68:69], v2 offset:25344
    buffer_load_dwordx4 v1, s[48:51], s64 offen offset:0 sc1 lds
    v_mfma_f32_16x16x32_bf16 v[228:231], a[84:87], v[72:75], v[228:231]
    ds_read_b64_tr_b16 v[70:71], v2 offset:29568
    s_waitcnt lgkmcnt(8)
    v_mfma_f32_16x16x32_bf16 v[232:235], a[80:83], v[80:83], v[232:235]
    ds_read_b64_tr_b16 v[72:73], v2 offset:16928
    buffer_load_dwordx4 v1, s[48:51], s64 offen offset:1024 sc1 lds
    v_mfma_f32_16x16x32_bf16 v[232:235], a[88:91], v[84:87], v[232:235]
    ds_read_b64_tr_b16 v[74:75], v2 offset:21152
    s_and_b32 s61, s3, 1
    v_mfma_f32_16x16x32_bf16 v[236:239], a[92:95], v[84:87], v[236:239]
    ds_read_b64_tr_b16 v[76:77], v2 offset:25376
    s_lshl_b32 s61, s61, 10
    v_mfma_f32_16x16x32_bf16 v[236:239], a[84:87], v[80:83], v[236:239]
    ds_read_b64_tr_b16 v[78:79], v2 offset:29600
    s_waitcnt lgkmcnt(8)
    v_mfma_f32_16x16x32_bf16 v[240:243], a[80:83], v[88:91], v[240:243]
    ds_read_b64_tr_b16 v[80:81], v2 offset:16960
    s_add_u32 m0, s61, 151552
    v_mfma_f32_16x16x32_bf16 v[240:243], a[88:91], v[92:95], v[240:243]
    ds_read_b64_tr_b16 v[82:83], v2 offset:21184
    s_add_u32 s64, s63, 8
    v_mfma_f32_16x16x32_bf16 v[244:247], a[92:95], v[92:95], v[244:247]
    ds_read_b64_tr_b16 v[84:85], v2 offset:25408
    s_cmp_ge_u32 s64, 9
    s_cselect_b32 s65, 9, 0
    s_sub_u32 s64, s64, s65
    v_mfma_f32_16x16x32_bf16 v[244:247], a[84:87], v[88:91], v[244:247]
    ds_read_b64_tr_b16 v[86:87], v2 offset:29632
    s_waitcnt lgkmcnt(8)
    s_waitcnt vmcnt(16)
    v_mfma_f32_16x16x32_bf16 v[184:187], a[96:99], v[64:67], v[184:187]
    ds_read_b64_tr_b16 v[88:89], v2 offset:16992
    s_lshl_b32 s64, s64, 11
    v_mfma_f32_16x16x32_bf16 v[184:187], a[104:107], v[68:71], v[184:187]
    ds_read_b64_tr_b16 v[90:91], v2 offset:21216
    s_add_u32 s64, s64, s61
    v_mfma_f32_16x16x32_bf16 v[188:191], a[108:111], v[68:71], v[188:191]
    ds_read_b64_tr_b16 v[92:93], v2 offset:25440
    s_add_u32 s64, s64, s66
    v_mfma_f32_16x16x32_bf16 v[188:191], a[100:103], v[64:67], v[188:191]
    ds_read_b64_tr_b16 v[94:95], v2 offset:29664
    s_waitcnt lgkmcnt(8)
    v_mfma_f32_16x16x32_bf16 v[192:195], a[96:99], v[72:75], v[192:195]
    ds_read_b64_tr_b16 v[64:65], v61 offset:17024
    buffer_load_dwordx4 v1, s[48:51], s64 offen offset:0 sc1 lds
    v_mfma_f32_16x16x32_bf16 v[192:195], a[104:107], v[76:79], v[192:195]
    ds_read_b64_tr_b16 v[66:67], v61 offset:21248
    buffer_load_ushort v50, v52, s[8:11], s83 offen
    v_mfma_f32_16x16x32_bf16 v[196:199], a[108:111], v[76:79], v[196:199]
    ds_read_b64_tr_b16 v[68:69], v61 offset:25472
    buffer_load_ushort v51, v52, s[8:11], s83 offen offset:8
    v_mfma_f32_16x16x32_bf16 v[196:199], a[100:103], v[72:75], v[196:199]
    ds_read_b64_tr_b16 v[70:71], v61 offset:29696
    s_waitcnt lgkmcnt(8)
    v_mfma_f32_16x16x32_bf16 v[200:203], a[96:99], v[80:83], v[200:203]
    ds_read_b64_tr_b16 v[72:73], v61 offset:17056
    buffer_load_dword v16, v42, s[28:31], 0 offen nt
    v_mfma_f32_16x16x32_bf16 v[200:203], a[104:107], v[84:87], v[200:203]
    ds_read_b64_tr_b16 v[74:75], v61 offset:21280
    buffer_load_dword v17, v43, s[28:31], 0 offen nt
    v_mfma_f32_16x16x32_bf16 v[204:207], a[108:111], v[84:87], v[204:207]
    ds_read_b64_tr_b16 v[76:77], v61 offset:25504
    buffer_load_dword v18, v44, s[28:31], 0 offen nt
    v_mfma_f32_16x16x32_bf16 v[204:207], a[100:103], v[80:83], v[204:207]
    ds_read_b64_tr_b16 v[78:79], v61 offset:29728
    s_waitcnt lgkmcnt(8)
    v_mfma_f32_16x16x32_bf16 v[208:211], a[96:99], v[88:91], v[208:211]
    ds_read_b64_tr_b16 v[80:81], v61 offset:17088
    buffer_load_dword v19, v40, s[28:31], 0 offen offset:0 nt
    v_mfma_f32_16x16x32_bf16 v[208:211], a[104:107], v[92:95], v[208:211]
    ds_read_b64_tr_b16 v[82:83], v61 offset:21312
    buffer_load_dword v20, v40, s[28:31], 0 offen offset:1152 nt
    v_mfma_f32_16x16x32_bf16 v[212:215], a[108:111], v[92:95], v[212:215]
    ds_read_b64_tr_b16 v[84:85], v61 offset:25536
    buffer_load_dword v21, v40, s[28:31], 0 offen offset:2304 nt
    v_mfma_f32_16x16x32_bf16 v[212:215], a[100:103], v[88:91], v[212:215]
    ds_read_b64_tr_b16 v[86:87], v61 offset:29760
    s_waitcnt lgkmcnt(8)
    v_mfma_f32_16x16x32_bf16 v[216:219], a[96:99], v[64:67], v[216:219]
    ds_read_b64_tr_b16 v[88:89], v61 offset:17120
    buffer_load_dword v22, v40, s[28:31], 0 offen offset:3456 nt
    v_mfma_f32_16x16x32_bf16 v[216:219], a[104:107], v[68:71], v[216:219]
    ds_read_b64_tr_b16 v[90:91], v61 offset:21344
    v_mfma_f32_16x16x32_bf16 v[220:223], a[108:111], v[68:71], v[220:223]
    ds_read_b64_tr_b16 v[92:93], v61 offset:25568
    buffer_load_dword v23, v41, s[28:31], 0 offen offset:0 nt
    v_mfma_f32_16x16x32_bf16 v[220:223], a[100:103], v[64:67], v[220:223]
    ds_read_b64_tr_b16 v[94:95], v61 offset:29792
    s_waitcnt lgkmcnt(8)
    v_mfma_f32_16x16x32_bf16 v[224:227], a[96:99], v[72:75], v[224:227]
    s_barrier
    ds_read_b64_tr_b16 v[64:65], v2 offset:33792
    v_mfma_f32_16x16x32_bf16 v[224:227], a[104:107], v[76:79], v[224:227]
    ds_read_b64_tr_b16 v[66:67], v2 offset:38016
    buffer_load_dword v24, v41, s[28:31], 0 offen offset:1152 nt
    v_mfma_f32_16x16x32_bf16 v[228:231], a[108:111], v[76:79], v[228:231]
    ds_read_b64_tr_b16 v[68:69], v2 offset:42240
    buffer_load_dword v25, v41, s[28:31], 0 offen offset:2304 nt
    v_mfma_f32_16x16x32_bf16 v[228:231], a[100:103], v[72:75], v[228:231]
    ds_read_b64_tr_b16 v[70:71], v2 offset:46464
    s_waitcnt lgkmcnt(8)
    v_mfma_f32_16x16x32_bf16 v[232:235], a[96:99], v[80:83], v[232:235]
    ds_read_b64_tr_b16 v[72:73], v2 offset:33824
    buffer_load_dword v26, v41, s[28:31], 0 offen offset:3456 nt
    v_mfma_f32_16x16x32_bf16 v[232:235], a[104:107], v[84:87], v[232:235]
    ds_read_b64_tr_b16 v[74:75], v2 offset:38048
    buffer_load_dword v28, v40, s[32:35], 0 offen offset:0 nt
    v_mfma_f32_16x16x32_bf16 v[236:239], a[108:111], v[84:87], v[236:239]
    ds_read_b64_tr_b16 v[76:77], v2 offset:42272
    v_mfma_f32_16x16x32_bf16 v[236:239], a[100:103], v[80:83], v[236:239]
    ds_read_b64_tr_b16 v[78:79], v2 offset:46496
    s_waitcnt lgkmcnt(8)
    v_mfma_f32_16x16x32_bf16 v[240:243], a[96:99], v[88:91], v[240:243]
    ds_read_b64_tr_b16 v[80:81], v2 offset:33856
    buffer_load_dword v29, v40, s[32:35], 0 offen offset:1152 nt
    v_mfma_f32_16x16x32_bf16 v[240:243], a[104:107], v[92:95], v[240:243]
    ds_read_b64_tr_b16 v[82:83], v2 offset:38080
    buffer_load_dword v30, v40, s[32:35], 0 offen offset:2304 nt
    v_mfma_f32_16x16x32_bf16 v[244:247], a[108:111], v[92:95], v[244:247]
    ds_read_b64_tr_b16 v[84:85], v2 offset:42304
    buffer_load_dword v31, v40, s[32:35], 0 offen offset:3456 nt
    v_mfma_f32_16x16x32_bf16 v[244:247], a[100:103], v[88:91], v[244:247]
    ds_read_b64_tr_b16 v[86:87], v2 offset:46528
    s_waitcnt lgkmcnt(8)
    s_waitcnt vmcnt(26)
    v_mfma_f32_16x16x32_bf16 v[184:187], a[112:115], v[64:67], v[184:187]
    ds_read_b64_tr_b16 v[88:89], v2 offset:33888
    buffer_load_dword v32, v41, s[32:35], 0 offen offset:0 nt
    v_mfma_f32_16x16x32_bf16 v[184:187], a[120:123], v[68:71], v[184:187]
    ds_read_b64_tr_b16 v[90:91], v2 offset:38112
    v_mfma_f32_16x16x32_bf16 v[188:191], a[124:127], v[68:71], v[188:191]
    ds_read_b64_tr_b16 v[92:93], v2 offset:42336
    buffer_load_dword v33, v41, s[32:35], 0 offen offset:1152 nt
    v_mfma_f32_16x16x32_bf16 v[188:191], a[116:119], v[64:67], v[188:191]
    ds_read_b64_tr_b16 v[94:95], v2 offset:46560
    s_waitcnt lgkmcnt(8)
    v_mfma_f32_16x16x32_bf16 v[192:195], a[112:115], v[72:75], v[192:195]
    ds_read_b64_tr_b16 v[64:65], v61 offset:33920
    buffer_load_dword v34, v41, s[32:35], 0 offen offset:2304 nt
    v_mfma_f32_16x16x32_bf16 v[192:195], a[120:123], v[76:79], v[192:195]
    ds_read_b64_tr_b16 v[66:67], v61 offset:38144
    buffer_load_dword v35, v41, s[32:35], 0 offen offset:3456 nt
    v_mfma_f32_16x16x32_bf16 v[196:199], a[124:127], v[76:79], v[196:199]
    ds_read_b64_tr_b16 v[68:69], v61 offset:42368
    v_mfma_f32_16x16x32_bf16 v[196:199], a[116:119], v[72:75], v[196:199]
    ds_read_b64_tr_b16 v[70:71], v61 offset:46592
    s_waitcnt lgkmcnt(8)
    v_mfma_f32_16x16x32_bf16 v[200:203], a[112:115], v[80:83], v[200:203]
    ds_read_b64_tr_b16 v[72:73], v61 offset:33952
    buffer_load_dwordx4 v[36:39], v45, s[36:39], 0 offen
    v_mfma_f32_16x16x32_bf16 v[200:203], a[120:123], v[84:87], v[200:203]
    ds_read_b64_tr_b16 v[74:75], v61 offset:38176
    s_add_u32 s64, s97, 0
    v_mfma_f32_16x16x32_bf16 v[204:207], a[124:127], v[84:87], v[204:207]
    ds_read_b64_tr_b16 v[76:77], v61 offset:42400
    buffer_load_dwordx4 a[144:147], v53, s[44:47], s64 offen nt
    v_mfma_f32_16x16x32_bf16 v[204:207], a[116:119], v[80:83], v[204:207]
    ds_read_b64_tr_b16 v[78:79], v61 offset:46624
    s_waitcnt lgkmcnt(8)
    v_mfma_f32_16x16x32_bf16 v[208:211], a[112:115], v[88:91], v[208:211]
    ds_read_b64_tr_b16 v[80:81], v61 offset:33984
    s_add_u32 s64, s97, 9216
    v_mfma_f32_16x16x32_bf16 v[208:211], a[120:123], v[92:95], v[208:211]
    ds_read_b64_tr_b16 v[82:83], v61 offset:38208
    buffer_load_dwordx4 a[148:151], v53, s[44:47], s64 offen nt
    v_mfma_f32_16x16x32_bf16 v[212:215], a[124:127], v[92:95], v[212:215]
    ds_read_b64_tr_b16 v[84:85], v61 offset:42432
    s_add_u32 s64, s97, 18432
    v_mfma_f32_16x16x32_bf16 v[212:215], a[116:119], v[88:91], v[212:215]
    ds_read_b64_tr_b16 v[86:87], v61 offset:46656
    s_waitcnt lgkmcnt(8)
    v_mfma_f32_16x16x32_bf16 v[216:219], a[112:115], v[64:67], v[216:219]
    ds_read_b64_tr_b16 v[88:89], v61 offset:34016
    buffer_load_dwordx4 a[152:155], v53, s[44:47], s64 offen nt
    v_mfma_f32_16x16x32_bf16 v[216:219], a[120:123], v[68:71], v[216:219]
    ds_read_b64_tr_b16 v[90:91], v61 offset:38240
    v_mfma_f32_16x16x32_bf16 v[220:223], a[124:127], v[68:71], v[220:223]
    ds_read_b64_tr_b16 v[92:93], v61 offset:42464
    s_add_u32 s64, s97, 27648
    v_mfma_f32_16x16x32_bf16 v[220:223], a[116:119], v[64:67], v[220:223]
    ds_read_b64_tr_b16 v[94:95], v61 offset:46688
    s_waitcnt lgkmcnt(8)
    v_add_u32 v2, 0xc600, v2
    v_add_u32 v61, 0xc600, v61
    v_mfma_f32_16x16x32_bf16 v[224:227], a[112:115], v[72:75], v[224:227]
    s_barrier
    ds_read_b64_tr_b16 v[64:65], v2 offset:0
    v_mfma_f32_16x16x32_bf16 v[224:227], a[120:123], v[76:79], v[224:227]
    ds_read_b64_tr_b16 v[66:67], v2 offset:4224
    buffer_load_dwordx4 a[156:159], v53, s[44:47], s64 offen nt
    v_mfma_f32_16x16x32_bf16 v[228:231], a[124:127], v[76:79], v[228:231]
    ds_read_b64_tr_b16 v[68:69], v2 offset:8448
    v_mfma_f32_16x16x32_bf16 v[228:231], a[116:119], v[72:75], v[228:231]
    ds_read_b64_tr_b16 v[70:71], v2 offset:12672
    s_waitcnt lgkmcnt(8)
    v_mfma_f32_16x16x32_bf16 v[232:235], a[112:115], v[80:83], v[232:235]
    ds_read_b64_tr_b16 v[72:73], v2 offset:32
    v_mfma_f32_16x16x32_bf16 v[232:235], a[120:123], v[84:87], v[232:235]
    ds_read_b64_tr_b16 v[74:75], v2 offset:4256
    v_mfma_f32_16x16x32_bf16 v[236:239], a[124:127], v[84:87], v[236:239]
    ds_read_b64_tr_b16 v[76:77], v2 offset:8480
    v_mfma_f32_16x16x32_bf16 v[236:239], a[116:119], v[80:83], v[236:239]
    ds_read_b64_tr_b16 v[78:79], v2 offset:12704
    s_waitcnt lgkmcnt(8)
    v_mfma_f32_16x16x32_bf16 v[240:243], a[112:115], v[88:91], v[240:243]
    ds_read_b64_tr_b16 v[80:81], v2 offset:64
    v_mfma_f32_16x16x32_bf16 v[240:243], a[120:123], v[92:95], v[240:243]
    ds_read_b64_tr_b16 v[82:83], v2 offset:4288
    v_mfma_f32_16x16x32_bf16 v[244:247], a[124:127], v[92:95], v[244:247]
    ds_read_b64_tr_b16 v[84:85], v2 offset:8512
    v_mfma_f32_16x16x32_bf16 v[244:247], a[116:119], v[88:91], v[244:247]
    ds_read_b64_tr_b16 v[86:87], v2 offset:12736
    s_waitcnt lgkmcnt(8)
    s_waitcnt vmcnt(31)
    v_mfma_f32_16x16x32_bf16 v[184:187], a[128:131], v[64:67], v[184:187]
    ds_read_b64_tr_b16 v[88:89], v2 offset:96
    v_mfma_f32_16x16x32_bf16 v[184:187], a[136:139], v[68:71], v[184:187]
    ds_read_b64_tr_b16 v[90:91], v2 offset:4320
    v_mfma_f32_16x16x32_bf16 v[188:191], a[140:143], v[68:71], v[188:191]
    ds_read_b64_tr_b16 v[92:93], v2 offset:8544
    v_mfma_f32_16x16x32_bf16 v[188:191], a[132:135], v[64:67], v[188:191]
    ds_read_b64_tr_b16 v[94:95], v2 offset:12768
    s_waitcnt lgkmcnt(8)
    v_mfma_f32_16x16x32_bf16 v[192:195], a[128:131], v[72:75], v[192:195]
    ds_read_b64_tr_b16 v[64:65], v61 offset:128
    v_mfma_f32_16x16x32_bf16 v[192:195], a[136:139], v[76:79], v[192:195]
    ds_read_b64_tr_b16 v[66:67], v61 offset:4352
    v_mfma_f32_16x16x32_bf16 v[196:199], a[140:143], v[76:79], v[196:199]
    ds_read_b64_tr_b16 v[68:69], v61 offset:8576
    v_mfma_f32_16x16x32_bf16 v[196:199], a[132:135], v[72:75], v[196:199]
    ds_read_b64_tr_b16 v[70:71], v61 offset:12800
    s_waitcnt lgkmcnt(8)
    v_mfma_f32_16x16x32_bf16 v[200:203], a[128:131], v[80:83], v[200:203]
    ds_read_b64_tr_b16 v[72:73], v61 offset:160
    v_mfma_f32_16x16x32_bf16 v[200:203], a[136:139], v[84:87], v[200:203]
    ds_read_b64_tr_b16 v[74:75], v61 offset:4384
    v_mfma_f32_16x16x32_bf16 v[204:207], a[140:143], v[84:87], v[204:207]
    ds_read_b64_tr_b16 v[76:77], v61 offset:8608
    v_mfma_f32_16x16x32_bf16 v[204:207], a[132:135], v[80:83], v[204:207]
    ds_read_b64_tr_b16 v[78:79], v61 offset:12832
    s_waitcnt lgkmcnt(8)
    v_mfma_f32_16x16x32_bf16 v[208:211], a[128:131], v[88:91], v[208:211]
    ds_read_b64_tr_b16 v[80:81], v61 offset:192
    v_mfma_f32_16x16x32_bf16 v[208:211], a[136:139], v[92:95], v[208:211]
    ds_read_b64_tr_b16 v[82:83], v61 offset:4416
    v_mfma_f32_16x16x32_bf16 v[212:215], a[140:143], v[92:95], v[212:215]
    ds_read_b64_tr_b16 v[84:85], v61 offset:8640
    v_mfma_f32_16x16x32_bf16 v[212:215], a[132:135], v[88:91], v[212:215]
    ds_read_b64_tr_b16 v[86:87], v61 offset:12864
    s_waitcnt lgkmcnt(8)
    v_mfma_f32_16x16x32_bf16 v[216:219], a[128:131], v[64:67], v[216:219]
    ds_read_b64_tr_b16 v[88:89], v61 offset:224
    v_mfma_f32_16x16x32_bf16 v[216:219], a[136:139], v[68:71], v[216:219]
    ds_read_b64_tr_b16 v[90:91], v61 offset:4448
    v_mfma_f32_16x16x32_bf16 v[220:223], a[140:143], v[68:71], v[220:223]
    ds_read_b64_tr_b16 v[92:93], v61 offset:8672
    v_mfma_f32_16x16x32_bf16 v[220:223], a[132:135], v[64:67], v[220:223]
    ds_read_b64_tr_b16 v[94:95], v61 offset:12896
    s_waitcnt lgkmcnt(8)
    v_mfma_f32_16x16x32_bf16 v[224:227], a[128:131], v[72:75], v[224:227]
    s_waitcnt vmcnt(26)
    s_barrier
    ds_read_b128 v[64:67], v60 offset:0
    v_mfma_f32_16x16x32_bf16 v[224:227], a[136:139], v[76:79], v[224:227]
    v_mfma_f32_16x16x32_bf16 v[228:231], a[140:143], v[76:79], v[228:231]
    ds_read_b128 v[68:71], v60 offset:1024
    v_mfma_f32_16x16x32_bf16 v[228:231], a[132:135], v[72:75], v[228:231]
    s_waitcnt lgkmcnt(6)
    v_mfma_f32_16x16x32_bf16 v[232:235], a[128:131], v[80:83], v[232:235]
    ds_read_b128 v[72:75], v60 offset:2048
    v_mfma_f32_16x16x32_bf16 v[232:235], a[136:139], v[84:87], v[232:235]
    v_mfma_f32_16x16x32_bf16 v[236:239], a[140:143], v[84:87], v[236:239]
    ds_read_b128 v[76:79], v60 offset:3072
    v_mfma_f32_16x16x32_bf16 v[236:239], a[132:135], v[80:83], v[236:239]
    s_waitcnt lgkmcnt(4)
    v_mfma_f32_16x16x32_bf16 v[240:243], a[128:131], v[88:91], v[240:243]
    ds_read_b128 v[80:83], v60 offset:4096
    v_mfma_f32_16x16x32_bf16 v[240:243], a[136:139], v[92:95], v[240:243]
    v_mfma_f32_16x16x32_bf16 v[244:247], a[140:143], v[92:95], v[244:247]
    ds_read_b128 v[84:87], v60 offset:5120
    v_mfma_f32_16x16x32_bf16 v[244:247], a[132:135], v[88:91], v[244:247]
    s_waitcnt lgkmcnt(4)
    v_mfma_f32_16x16x32_bf16 v[248:251], a[0:3], v[64:67], 0
    ds_read_b128 v[88:91], v60 offset:6144
    v_mfma_f32_16x16x32_bf16 v[248:251], a[8:11], v[68:71], v[248:251]
    s_mov_b32 exec_lo, 1
    s_mov_b32 exec_hi, 1
    buffer_store_dwordx2 v[140:141], v144, s[48:51], 0 offen sc1
    s_mov_b64 exec, -1
    v_mfma_f32_16x16x32_bf16 v[252:255], a[4:7], v[64:67], 0
    ds_read_b128 v[92:95], v60 offset:7168
    v_mfma_f32_16x16x32_bf16 v[252:255], a[12:15], v[68:71], v[252:255]
    s_waitcnt lgkmcnt(4)
    v_mfma_f32_16x16x32_bf16 v[248:251], a[16:19], v[72:75], v[248:251]
    ds_read_b128 v[64:67], v60 offset:8192
    v_mfma_f32_16x16x32_bf16 v[248:251], a[24:27], v[76:79], v[248:251]
    v_mfma_f32_16x16x32_bf16 v[252:255], a[28:31], v[76:79], v[252:255]
    ds_read_b128 v[68:71], v60 offset:9216
    v_mfma_f32_16x16x32_bf16 v[252:255], a[20:23], v[72:75], v[252:255]
    s_waitcnt lgkmcnt(4)
    v_mfma_f32_16x16x32_bf16 v[248:251], a[32:35], v[80:83], v[248:251]
    ds_read_b128 v[72:75], v60 offset:10240
    v_mfma_f32_16x16x32_bf16 v[248:251], a[40:43], v[84:87], v[248:251]
    v_mfma_f32_16x16x32_bf16 v[252:255], a[44:47], v[84:87], v[252:255]
    ds_read_b128 v[76:79], v60 offset:11264
    v_mfma_f32_16x16x32_bf16 v[252:255], a[36:39], v[80:83], v[252:255]
    s_waitcnt lgkmcnt(4)
    v_mfma_f32_16x16x32_bf16 v[248:251], a[48:51], v[88:91], v[248:251]
    ds_read_b128 v[80:83], v60 offset:12288
    v_mfma_f32_16x16x32_bf16 v[248:251], a[56:59], v[92:95], v[248:251]
    v_mfma_f32_16x16x32_bf16 v[252:255], a[60:63], v[92:95], v[252:255]
    ds_read_b128 v[84:87], v60 offset:13312
    v_mfma_f32_16x16x32_bf16 v[252:255], a[52:55], v[88:91], v[252:255]
    s_waitcnt lgkmcnt(4)
    v_mfma_f32_16x16x32_bf16 v[248:251], a[64:67], v[64:67], v[248:251]
    ds_read_b128 v[88:91], v60 offset:14336
    v_mfma_f32_16x16x32_bf16 v[248:251], a[72:75], v[68:71], v[248:251]
    v_mfma_f32_16x16x32_bf16 v[252:255], a[76:79], v[68:71], v[252:255]
    ds_read_b128 v[92:95], v60 offset:15360
    v_mfma_f32_16x16x32_bf16 v[252:255], a[68:71], v[64:67], v[252:255]
    s_waitcnt lgkmcnt(4)
    v_mfma_f32_16x16x32_bf16 v[248:251], a[80:83], v[72:75], v[248:251]
    ds_read_b128 v[64:67], v60 offset:16384
    v_mfma_f32_16x16x32_bf16 v[248:251], a[88:91], v[76:79], v[248:251]
    v_mfma_f32_16x16x32_bf16 v[252:255], a[92:95], v[76:79], v[252:255]
    ds_read_b128 v[68:71], v60 offset:17408
    v_mfma_f32_16x16x32_bf16 v[252:255], a[84:87], v[72:75], v[252:255]
    s_waitcnt lgkmcnt(4)
    v_mfma_f32_16x16x32_bf16 v[248:251], a[96:99], v[80:83], v[248:251]
    s_add_u32 m0, s70, 118272
    s_add_u32 s71, s71, 585216
    s_sub_u32 s64, s71, 5308416
    s_cmp_ge_u32 s71, s72
    s_cselect_b32 s71, s64, s71
    v_mfma_f32_16x16x32_bf16 v[248:251], a[104:107], v[84:87], v[248:251]
    v_mfma_f32_16x16x32_bf16 v[252:255], a[108:111], v[84:87], v[252:255]
    buffer_load_dwordx4 v56, s[52:55], s71 offen offset:0 lds
    v_mfma_f32_16x16x32_bf16 v[252:255], a[100:103], v[80:83], v[252:255]
    s_waitcnt lgkmcnt(2)
    v_mfma_f32_16x16x32_bf16 v[248:251], a[112:115], v[88:91], v[248:251]
    v_mfma_f32_16x16x32_bf16 v[248:251], a[120:123], v[92:95], v[248:251]
    v_mfma_f32_16x16x32_bf16 v[252:255], a[124:127], v[92:95], v[252:255]
    v_mfma_f32_16x16x32_bf16 v[252:255], a[116:119], v[88:91], v[252:255]
    s_waitcnt lgkmcnt(0)
    buffer_load_dwordx4 v57, s[52:55], s71 offen offset:1056 lds
    v_mfma_f32_16x16x32_bf16 v[248:251], a[128:131], v[64:67], v[248:251]
    v_mfma_f32_16x16x32_bf16 v[248:251], a[136:139], v[68:71], v[248:251]
    v_mfma_f32_16x16x32_bf16 v[252:255], a[140:143], v[68:71], v[252:255]
    v_mfma_f32_16x16x32_bf16 v[252:255], a[132:135], v[64:67], v[252:255]
    s_waitcnt lgkmcnt(0)
    s_barrier
    v_pk_mul_f32 v[112:113], v[184:185], v[184:185]
    buffer_load_dwordx4 v58, s[52:55], s71 offen offset:2112 lds
    v_pk_mul_f32 v[114:115], v[186:187], v[186:187]
    v_pk_mul_f32 v[116:117], v[188:189], v[188:189]
    v_pk_mul_f32 v[118:119], v[190:191], v[190:191]
    v_pk_mul_f32 v[120:121], v[192:193], v[192:193]
    v_pk_mul_f32 v[122:123], v[194:195], v[194:195]
    v_pk_mul_f32 v[124:125], v[196:197], v[196:197]
    v_pk_mul_f32 v[126:127], v[198:199], v[198:199]
    v_pk_mul_f32 v[128:129], v[200:201], v[200:201]
    v_pk_mul_f32 v[130:131], v[202:203], v[202:203]
    v_pk_mul_f32 v[132:133], v[204:205], v[204:205]
    v_pk_mul_f32 v[134:135], v[206:207], v[206:207]
    v_pk_mul_f32 v[136:137], v[208:209], v[208:209]
    v_pk_mul_f32 v[138:139], v[210:211], v[210:211]
    v_pk_mul_f32 v[140:141], v[212:213], v[212:213]
    v_pk_mul_f32 v[142:143], v[214:215], v[214:215]
    v_pk_mul_f32 v[144:145], v[216:217], v[216:217]
    v_pk_mul_f32 v[146:147], v[218:219], v[218:219]
    v_pk_mul_f32 v[148:149], v[220:221], v[220:221]
    buffer_load_dwordx4 v59, s[52:55], s71 offen offset:3168 lds
    v_pk_mul_f32 v[150:151], v[222:223], v[222:223]
    v_pk_mul_f32 v[152:153], v[224:225], v[224:225]
    v_pk_mul_f32 v[154:155], v[226:227], v[226:227]
    v_pk_mul_f32 v[156:157], v[228:229], v[228:229]
    v_pk_mul_f32 v[158:159], v[230:231], v[230:231]
    v_pk_mul_f32 v[160:161], v[232:233], v[232:233]
    v_pk_mul_f32 v[162:163], v[234:235], v[234:235]
    v_pk_mul_f32 v[164:165], v[236:237], v[236:237]
    v_pk_mul_f32 v[166:167], v[238:239], v[238:239]
    v_pk_mul_f32 v[168:169], v[240:241], v[240:241]
    v_pk_mul_f32 v[170:171], v[242:243], v[242:243]
    v_pk_mul_f32 v[172:173], v[244:245], v[244:245]
    v_pk_mul_f32 v[174:175], v[246:247], v[246:247]
    v_pk_mul_f32 v[176:177], v[248:249], v[248:249]
    v_pk_mul_f32 v[178:179], v[250:251], v[250:251]
    v_pk_mul_f32 v[180:181], v[252:253], v[252:253]
    v_pk_mul_f32 v[182:183], v[254:255], v[254:255]
    v_pk_fma_f32 v[112:113], v[112:113], v[4:5], v[6:7]
    s_add_u32 m0, s70, 0
    s_add_u32 s71, s71, 589824
    s_sub_u32 s64, s71, 5308416
    s_cmp_ge_u32 s71, s72
    s_cselect_b32 s71, s64, s71
    buffer_load_dwordx4 v56, s[52:55], s71 offen offset:0 lds
    v_pk_fma_f32 v[114:115], v[114:115], v[4:5], v[6:7]
    v_pk_fma_f32 v[116:117], v[116:117], v[4:5], v[6:7]
    v_pk_fma_f32 v[118:119], v[118:119], v[4:5], v[6:7]
    v_pk_fma_f32 v[120:121], v[120:121], v[4:5], v[6:7]
    v_pk_fma_f32 v[122:123], v[122:123], v[4:5], v[6:7]
    v_pk_fma_f32 v[124:125], v[124:125], v[4:5], v[6:7]
    v_pk_fma_f32 v[126:127], v[126:127], v[4:5], v[6:7]
    v_pk_fma_f32 v[128:129], v[128:129], v[4:5], v[6:7]
    v_pk_fma_f32 v[130:131], v[130:131], v[4:5], v[6:7]
    v_pk_fma_f32 v[132:133], v[132:133], v[4:5], v[6:7]
    v_pk_fma_f32 v[134:135], v[134:135], v[4:5], v[6:7]
    v_pk_fma_f32 v[136:137], v[136:137], v[4:5], v[6:7]
    v_pk_fma_f32 v[138:139], v[138:139], v[4:5], v[6:7]
    v_pk_fma_f32 v[140:141], v[140:141], v[4:5], v[6:7]
    v_pk_fma_f32 v[142:143], v[142:143], v[4:5], v[6:7]
    v_pk_fma_f32 v[144:145], v[144:145], v[4:5], v[6:7]
    v_pk_fma_f32 v[146:147], v[146:147], v[4:5], v[6:7]
    v_pk_fma_f32 v[148:149], v[148:149], v[4:5], v[6:7]
    buffer_load_dwordx4 v57, s[52:55], s71 offen offset:1056 lds
    v_pk_fma_f32 v[150:151], v[150:151], v[4:5], v[6:7]
    v_pk_fma_f32 v[152:153], v[152:153], v[4:5], v[6:7]
    v_pk_fma_f32 v[154:155], v[154:155], v[4:5], v[6:7]
    v_pk_fma_f32 v[156:157], v[156:157], v[4:5], v[6:7]
    v_pk_fma_f32 v[158:159], v[158:159], v[4:5], v[6:7]
    v_pk_fma_f32 v[160:161], v[160:161], v[4:5], v[6:7]
    v_pk_fma_f32 v[162:163], v[162:163], v[4:5], v[6:7]
    v_pk_fma_f32 v[164:165], v[164:165], v[4:5], v[6:7]
    v_pk_fma_f32 v[166:167], v[166:167], v[4:5], v[6:7]
    v_pk_fma_f32 v[168:169], v[168:169], v[4:5], v[6:7]
    v_pk_fma_f32 v[170:171], v[170:171], v[4:5], v[6:7]
    v_pk_fma_f32 v[172:173], v[172:173], v[4:5], v[6:7]
    v_pk_fma_f32 v[174:175], v[174:175], v[4:5], v[6:7]
    v_pk_fma_f32 v[176:177], v[176:177], v[4:5], v[6:7]
    v_pk_fma_f32 v[178:179], v[178:179], v[4:5], v[6:7]
    v_pk_fma_f32 v[180:181], v[180:181], v[4:5], v[6:7]
    v_pk_fma_f32 v[182:183], v[182:183], v[4:5], v[6:7]
    v_pk_mul_f32 v[112:113], v[184:185], v[112:113]
    buffer_load_dwordx4 v58, s[52:55], s71 offen offset:2112 lds
    v_pk_mul_f32 v[114:115], v[186:187], v[114:115]
    v_pk_mul_f32 v[116:117], v[188:189], v[116:117]
    v_pk_mul_f32 v[118:119], v[190:191], v[118:119]
    v_pk_mul_f32 v[120:121], v[192:193], v[120:121]
    v_pk_mul_f32 v[122:123], v[194:195], v[122:123]
    v_pk_mul_f32 v[124:125], v[196:197], v[124:125]
    v_pk_mul_f32 v[126:127], v[198:199], v[126:127]
    v_pk_mul_f32 v[128:129], v[200:201], v[128:129]
    v_pk_mul_f32 v[130:131], v[202:203], v[130:131]
    v_pk_mul_f32 v[132:133], v[204:205], v[132:133]
    v_pk_mul_f32 v[134:135], v[206:207], v[134:135]
    v_pk_mul_f32 v[136:137], v[208:209], v[136:137]
    v_pk_mul_f32 v[138:139], v[210:211], v[138:139]
    v_pk_mul_f32 v[140:141], v[212:213], v[140:141]
    v_pk_mul_f32 v[142:143], v[214:215], v[142:143]
    v_pk_mul_f32 v[144:145], v[216:217], v[144:145]
    v_pk_mul_f32 v[146:147], v[218:219], v[146:147]
    v_pk_mul_f32 v[148:149], v[220:221], v[148:149]
    v_pk_mul_f32 v[150:151], v[222:223], v[150:151]
    buffer_load_dwordx4 v59, s[52:55], s71 offen offset:3168 lds
    v_pk_mul_f32 v[152:153], v[224:225], v[152:153]
    v_pk_mul_f32 v[154:155], v[226:227], v[154:155]
    v_pk_mul_f32 v[156:157], v[228:229], v[156:157]
    v_pk_mul_f32 v[158:159], v[230:231], v[158:159]
    v_pk_mul_f32 v[160:161], v[232:233], v[160:161]
    v_pk_mul_f32 v[162:163], v[234:235], v[162:163]
    v_pk_mul_f32 v[164:165], v[236:237], v[164:165]
    v_pk_mul_f32 v[166:167], v[238:239], v[166:167]
    v_pk_mul_f32 v[168:169], v[240:241], v[168:169]
    v_pk_mul_f32 v[170:171], v[242:243], v[170:171]
    v_pk_mul_f32 v[172:173], v[244:245], v[172:173]
    v_pk_mul_f32 v[174:175], v[246:247], v[174:175]
    v_pk_mul_f32 v[176:177], v[248:249], v[176:177]
    v_pk_mul_f32 v[178:179], v[250:251], v[178:179]
    v_pk_mul_f32 v[180:181], v[252:253], v[180:181]
    v_pk_mul_f32 v[182:183], v[254:255], v[182:183]
    v_exp_f32 v112, v112
    s_add_u32 m0, s70, 16896
    s_add_u32 s71, s71, 589824
    s_sub_u32 s64, s71, 5308416
    s_cmp_ge_u32 s71, s72
    s_cselect_b32 s71, s64, s71
    buffer_load_dwordx4 v56, s[52:55], s71 offen offset:0 lds
    v_exp_f32 v113, v113
    v_exp_f32 v114, v114
    v_exp_f32 v115, v115
    v_exp_f32 v116, v116
    v_exp_f32 v117, v117
    v_exp_f32 v118, v118
    v_exp_f32 v119, v119
    v_exp_f32 v120, v120
    v_exp_f32 v121, v121
    buffer_load_dwordx4 v57, s[52:55], s71 offen offset:1056 lds
    v_exp_f32 v122, v122
    v_exp_f32 v123, v123
    v_exp_f32 v124, v124
    v_exp_f32 v125, v125
    v_exp_f32 v126, v126
    v_exp_f32 v127, v127
    v_exp_f32 v128, v128
    v_exp_f32 v129, v129
    v_exp_f32 v130, v130
    buffer_load_dwordx4 v58, s[52:55], s71 offen offset:2112 lds
    v_exp_f32 v131, v131
    v_exp_f32 v132, v132
    v_exp_f32 v133, v133
    v_exp_f32 v134, v134
    v_exp_f32 v135, v135
    v_exp_f32 v136, v136
    v_exp_f32 v137, v137
    v_exp_f32 v138, v138
    v_exp_f32 v139, v139
    buffer_load_dwordx4 v59, s[52:55], s71 offen offset:3168 lds
    v_exp_f32 v140, v140
    v_exp_f32 v141, v141
    v_exp_f32 v142, v142
    v_exp_f32 v143, v143
    v_exp_f32 v144, v144
    v_exp_f32 v145, v145
    v_exp_f32 v146, v146
    v_exp_f32 v147, v147
    v_exp_f32 v148, v148
    v_exp_f32 v149, v149
    buffer_load_dword a177, v62, s[40:43], 0 offen
    v_exp_f32 v150, v150
    v_exp_f32 v151, v151
    v_exp_f32 v152, v152
    v_exp_f32 v153, v153
    v_exp_f32 v154, v154
    v_exp_f32 v155, v155
    v_exp_f32 v156, v156
    v_exp_f32 v157, v157
    v_exp_f32 v158, v158
    v_exp_f32 v159, v159
    v_exp_f32 v160, v160
    v_exp_f32 v161, v161
    v_exp_f32 v162, v162
    v_exp_f32 v163, v163
    v_exp_f32 v164, v164
    v_exp_f32 v165, v165
    v_exp_f32 v166, v166
    v_exp_f32 v167, v167
    v_exp_f32 v168, v168
    v_exp_f32 v169, v169
    v_exp_f32 v170, v170
    v_exp_f32 v171, v171
    v_exp_f32 v172, v172
    v_exp_f32 v173, v173
    v_exp_f32 v174, v174
    v_exp_f32 v175, v175
    v_exp_f32 v176, v176
    v_exp_f32 v177, v177
    v_exp_f32 v178, v178
    v_exp_f32 v179, v179
    v_exp_f32 v180, v180
    v_exp_f32 v181, v181
    v_exp_f32 v182, v182
    v_exp_f32 v183, v183
    v_pk_add_f32 v[112:113], v[112:113], v[12:13]
    v_pk_add_f32 v[114:115], v[114:115], v[12:13]
    v_pk_add_f32 v[116:117], v[116:117], v[12:13]
    v_pk_add_f32 v[118:119], v[118:119], v[12:13]
    v_pk_add_f32 v[120:121], v[120:121], v[12:13]
    v_pk_add_f32 v[122:123], v[122:123], v[12:13]
    v_pk_add_f32 v[124:125], v[124:125], v[12:13]
    v_pk_add_f32 v[126:127], v[126:127], v[12:13]
    v_pk_add_f32 v[128:129], v[128:129], v[12:13]
    v_pk_add_f32 v[130:131], v[130:131], v[12:13]
    v_pk_add_f32 v[132:133], v[132:133], v[12:13]
    v_pk_add_f32 v[134:135], v[134:135], v[12:13]
    v_pk_add_f32 v[136:137], v[136:137], v[12:13]
    v_pk_add_f32 v[138:139], v[138:139], v[12:13]
    v_pk_add_f32 v[140:141], v[140:141], v[12:13]
    v_pk_add_f32 v[142:143], v[142:143], v[12:13]
    v_pk_add_f32 v[144:145], v[144:145], v[12:13]
    v_pk_add_f32 v[146:147], v[146:147], v[12:13]
    v_pk_add_f32 v[148:149], v[148:149], v[12:13]
    v_pk_add_f32 v[150:151], v[150:151], v[12:13]
    v_pk_add_f32 v[152:153], v[152:153], v[12:13]
    v_pk_add_f32 v[154:155], v[154:155], v[12:13]
    v_pk_add_f32 v[156:157], v[156:157], v[12:13]
    v_pk_add_f32 v[158:159], v[158:159], v[12:13]
    v_pk_add_f32 v[160:161], v[160:161], v[12:13]
    v_pk_add_f32 v[162:163], v[162:163], v[12:13]
    v_pk_add_f32 v[164:165], v[164:165], v[12:13]
    v_pk_add_f32 v[166:167], v[166:167], v[12:13]
    v_pk_add_f32 v[168:169], v[168:169], v[12:13]
    v_pk_add_f32 v[170:171], v[170:171], v[12:13]
    v_pk_add_f32 v[172:173], v[172:173], v[12:13]
    v_pk_add_f32 v[174:175], v[174:175], v[12:13]
    v_pk_add_f32 v[176:177], v[176:177], v[12:13]
    v_pk_add_f32 v[178:179], v[178:179], v[12:13]
    v_pk_add_f32 v[180:181], v[180:181], v[12:13]
    v_pk_add_f32 v[182:183], v[182:183], v[12:13]
    v_rcp_f32 v112, v112
    v_rcp_f32 v113, v113
    v_rcp_f32 v114, v114
    v_rcp_f32 v115, v115
    v_rcp_f32 v116, v116
    v_rcp_f32 v117, v117
    v_rcp_f32 v118, v118
    v_rcp_f32 v119, v119
    v_rcp_f32 v120, v120
    v_rcp_f32 v121, v121
    v_rcp_f32 v122, v122
    v_rcp_f32 v123, v123
    v_rcp_f32 v124, v124
    v_rcp_f32 v125, v125
    v_rcp_f32 v126, v126
    v_rcp_f32 v127, v127
    v_rcp_f32 v128, v128
    v_rcp_f32 v129, v129
    v_rcp_f32 v130, v130
    v_rcp_f32 v131, v131
    v_rcp_f32 v132, v132
    v_rcp_f32 v133, v133
    v_rcp_f32 v134, v134
    v_rcp_f32 v135, v135
    v_rcp_f32 v136, v136
    v_rcp_f32 v137, v137
    v_rcp_f32 v138, v138
    v_rcp_f32 v139, v139
    v_rcp_f32 v140, v140
    v_rcp_f32 v141, v141
    v_rcp_f32 v142, v142
    v_rcp_f32 v143, v143
    v_rcp_f32 v144, v144
    v_rcp_f32 v145, v145
    v_rcp_f32 v146, v146
    v_rcp_f32 v147, v147
    v_rcp_f32 v148, v148
    v_rcp_f32 v149, v149
    v_rcp_f32 v150, v150
    v_rcp_f32 v151, v151
    v_rcp_f32 v152, v152
    v_rcp_f32 v153, v153
    v_rcp_f32 v154, v154
    v_rcp_f32 v155, v155
    v_rcp_f32 v156, v156
    v_rcp_f32 v157, v157
    v_rcp_f32 v158, v158
    v_rcp_f32 v159, v159
    v_rcp_f32 v160, v160
    v_rcp_f32 v161, v161
    v_rcp_f32 v162, v162
    v_rcp_f32 v163, v163
    v_rcp_f32 v164, v164
    v_rcp_f32 v165, v165
    v_rcp_f32 v166, v166
    v_rcp_f32 v167, v167
    v_rcp_f32 v168, v168
    v_rcp_f32 v169, v169
    v_rcp_f32 v170, v170
    v_rcp_f32 v171, v171
    v_rcp_f32 v172, v172
    v_rcp_f32 v173, v173
    v_rcp_f32 v174, v174
    v_rcp_f32 v175, v175
    v_rcp_f32 v176, v176
    v_rcp_f32 v177, v177
    v_rcp_f32 v178, v178
    v_rcp_f32 v179, v179
    v_rcp_f32 v180, v180
    v_rcp_f32 v181, v181
    v_rcp_f32 v182, v182
    v_rcp_f32 v183, v183
    v_pk_mul_f32 v[184:185], v[184:185], v[112:113]
    v_pk_mul_f32 v[186:187], v[186:187], v[114:115]
    v_pk_mul_f32 v[188:189], v[188:189], v[116:117]
    v_pk_mul_f32 v[190:191], v[190:191], v[118:119]
    v_pk_mul_f32 v[192:193], v[192:193], v[120:121]
    v_pk_mul_f32 v[194:195], v[194:195], v[122:123]
    v_pk_mul_f32 v[196:197], v[196:197], v[124:125]
    v_pk_mul_f32 v[198:199], v[198:199], v[126:127]
    v_pk_mul_f32 v[200:201], v[200:201], v[128:129]
    v_pk_mul_f32 v[202:203], v[202:203], v[130:131]
    v_pk_mul_f32 v[204:205], v[204:205], v[132:133]
    v_pk_mul_f32 v[206:207], v[206:207], v[134:135]
    v_pk_mul_f32 v[208:209], v[208:209], v[136:137]
    v_pk_mul_f32 v[210:211], v[210:211], v[138:139]
    v_pk_mul_f32 v[212:213], v[212:213], v[140:141]
    v_pk_mul_f32 v[214:215], v[214:215], v[142:143]
    v_pk_mul_f32 v[216:217], v[216:217], v[144:145]
    v_pk_mul_f32 v[218:219], v[218:219], v[146:147]
    v_pk_mul_f32 v[220:221], v[220:221], v[148:149]
    v_pk_mul_f32 v[222:223], v[222:223], v[150:151]
    v_pk_mul_f32 v[224:225], v[224:225], v[152:153]
    v_pk_mul_f32 v[226:227], v[226:227], v[154:155]
    v_pk_mul_f32 v[228:229], v[228:229], v[156:157]
    v_pk_mul_f32 v[230:231], v[230:231], v[158:159]
    v_pk_mul_f32 v[232:233], v[232:233], v[160:161]
    v_pk_mul_f32 v[234:235], v[234:235], v[162:163]
    v_pk_mul_f32 v[236:237], v[236:237], v[164:165]
    v_pk_mul_f32 v[238:239], v[238:239], v[166:167]
    v_pk_mul_f32 v[240:241], v[240:241], v[168:169]
    v_pk_mul_f32 v[242:243], v[242:243], v[170:171]
    v_pk_mul_f32 v[244:245], v[244:245], v[172:173]
    v_pk_mul_f32 v[246:247], v[246:247], v[174:175]
    v_pk_mul_f32 v[248:249], v[248:249], v[176:177]
    v_pk_mul_f32 v[250:251], v[250:251], v[178:179]
    v_pk_mul_f32 v[252:253], v[252:253], v[180:181]
    v_pk_mul_f32 v[254:255], v[254:255], v[182:183]
    v_pk_mul_f32 v[104:105], v[184:185], v[184:185]
    v_pk_mul_f32 v[106:107], v[186:187], v[186:187]
    v_pk_mul_f32 v[108:109], v[188:189], v[188:189]
    v_pk_mul_f32 v[110:111], v[190:191], v[190:191]
    v_pk_add_f32 v[96:97], v[184:185], v[192:193]
    v_pk_fma_f32 v[104:105], v[192:193], v[192:193], v[104:105]
    v_pk_add_f32 v[98:99], v[186:187], v[194:195]
    v_pk_fma_f32 v[106:107], v[194:195], v[194:195], v[106:107]
    v_pk_add_f32 v[100:101], v[188:189], v[196:197]
    v_pk_fma_f32 v[108:109], v[196:197], v[196:197], v[108:109]
    v_pk_add_f32 v[102:103], v[190:191], v[198:199]
    v_pk_fma_f32 v[110:111], v[198:199], v[198:199], v[110:111]
    v_pk_add_f32 v[96:97], v[96:97], v[200:201]
    v_pk_fma_f32 v[104:105], v[200:201], v[200:201], v[104:105]
    v_pk_add_f32 v[98:99], v[98:99], v[202:203]
    v_pk_fma_f32 v[106:107], v[202:203], v[202:203], v[106:107]
    v_pk_add_f32 v[100:101], v[100:101], v[204:205]
    v_pk_fma_f32 v[108:109], v[204:205], v[204:205], v[108:109]
    v_pk_add_f32 v[102:103], v[102:103], v[206:207]
    v_pk_fma_f32 v[110:111], v[206:207], v[206:207], v[110:111]
    v_pk_add_f32 v[96:97], v[96:97], v[208:209]
    v_pk_fma_f32 v[104:105], v[208:209], v[208:209], v[104:105]
    v_pk_add_f32 v[98:99], v[98:99], v[210:211]
    v_pk_fma_f32 v[106:107], v[210:211], v[210:211], v[106:107]
    v_pk_add_f32 v[100:101], v[100:101], v[212:213]
    v_pk_fma_f32 v[108:109], v[212:213], v[212:213], v[108:109]
    v_pk_add_f32 v[102:103], v[102:103], v[214:215]
    v_pk_fma_f32 v[110:111], v[214:215], v[214:215], v[110:111]
    v_pk_add_f32 v[96:97], v[96:97], v[216:217]
    v_pk_fma_f32 v[104:105], v[216:217], v[216:217], v[104:105]
    v_pk_add_f32 v[98:99], v[98:99], v[218:219]
    v_pk_fma_f32 v[106:107], v[218:219], v[218:219], v[106:107]
    v_pk_add_f32 v[100:101], v[100:101], v[220:221]
    v_pk_fma_f32 v[108:109], v[220:221], v[220:221], v[108:109]
    v_pk_add_f32 v[102:103], v[102:103], v[222:223]
    v_pk_fma_f32 v[110:111], v[222:223], v[222:223], v[110:111]
    v_pk_add_f32 v[96:97], v[96:97], v[224:225]
    v_pk_fma_f32 v[104:105], v[224:225], v[224:225], v[104:105]
    v_pk_add_f32 v[98:99], v[98:99], v[226:227]
    v_pk_fma_f32 v[106:107], v[226:227], v[226:227], v[106:107]
    v_pk_add_f32 v[100:101], v[100:101], v[228:229]
    v_pk_fma_f32 v[108:109], v[228:229], v[228:229], v[108:109]
    v_pk_add_f32 v[102:103], v[102:103], v[230:231]
    v_pk_fma_f32 v[110:111], v[230:231], v[230:231], v[110:111]
    v_pk_add_f32 v[96:97], v[96:97], v[232:233]
    v_pk_fma_f32 v[104:105], v[232:233], v[232:233], v[104:105]
    v_pk_add_f32 v[98:99], v[98:99], v[234:235]
    v_pk_fma_f32 v[106:107], v[234:235], v[234:235], v[106:107]
    v_pk_add_f32 v[100:101], v[100:101], v[236:237]
    v_pk_fma_f32 v[108:109], v[236:237], v[236:237], v[108:109]
    v_pk_add_f32 v[102:103], v[102:103], v[238:239]
    v_pk_fma_f32 v[110:111], v[238:239], v[238:239], v[110:111]
    v_pk_add_f32 v[96:97], v[96:97], v[240:241]
    v_pk_fma_f32 v[104:105], v[240:241], v[240:241], v[104:105]
    v_pk_add_f32 v[98:99], v[98:99], v[242:243]
    v_pk_fma_f32 v[106:107], v[242:243], v[242:243], v[106:107]
    v_pk_add_f32 v[100:101], v[100:101], v[244:245]
    v_pk_fma_f32 v[108:109], v[244:245], v[244:245], v[108:109]
    v_pk_add_f32 v[102:103], v[102:103], v[246:247]
    v_pk_fma_f32 v[110:111], v[246:247], v[246:247], v[110:111]
    v_pk_add_f32 v[96:97], v[96:97], v[248:249]
    v_pk_fma_f32 v[104:105], v[248:249], v[248:249], v[104:105]
    v_pk_add_f32 v[98:99], v[98:99], v[250:251]
    v_pk_fma_f32 v[106:107], v[250:251], v[250:251], v[106:107]
    v_pk_add_f32 v[100:101], v[100:101], v[252:253]
    v_pk_fma_f32 v[108:109], v[252:253], v[252:253], v[108:109]
    v_pk_add_f32 v[102:103], v[102:103], v[254:255]
    v_pk_fma_f32 v[110:111], v[254:255], v[254:255], v[110:111]
    s_nop 0
    v_add_f32 v112, v96, v96 row_ror:8 bank_mask:0x3
    v_add_f32 v113, v97, v97 row_ror:8 bank_mask:0x3
    v_add_f32 v114, v98, v98 row_ror:8 bank_mask:0x3
    v_add_f32 v115, v99, v99 row_ror:8 bank_mask:0x3
    v_add_f32 v116, v100, v100 row_ror:8 bank_mask:0x3
    v_add_f32 v117, v101, v101 row_ror:8 bank_mask:0x3
    v_add_f32 v118, v102, v102 row_ror:8 bank_mask:0x3
    v_add_f32 v119, v103, v103 row_ror:8 bank_mask:0x3
    v_add_f32 v112, v104, v104 row_ror:8 bank_mask:0xc
    v_add_f32 v113, v105, v105 row_ror:8 bank_mask:0xc
    v_add_f32 v114, v106, v106 row_ror:8 bank_mask:0xc
    v_add_f32 v115, v107, v107 row_ror:8 bank_mask:0xc
    v_add_f32 v116, v108, v108 row_ror:8 bank_mask:0xc
    v_add_f32 v117, v109, v109 row_ror:8 bank_mask:0xc
    v_add_f32 v118, v110, v110 row_ror:8 bank_mask:0xc
    v_add_f32 v119, v111, v111 row_ror:8 bank_mask:0xc
    v_add_f32 v120, v112, v112 row_half_mirror bank_mask:0x5
    v_add_f32 v121, v114, v114 row_half_mirror bank_mask:0x5
    v_add_f32 v122, v116, v116 row_half_mirror bank_mask:0x5
    v_add_f32 v123, v118, v118 row_half_mirror bank_mask:0x5
    v_add_f32 v120, v113, v113 row_half_mirror bank_mask:0xa
    v_add_f32 v121, v115, v115 row_half_mirror bank_mask:0xa
    v_add_f32 v122, v117, v117 row_half_mirror bank_mask:0xa
    v_add_f32 v123, v119, v119 row_half_mirror bank_mask:0xa
    v_add_f32 v120, v120, v120 quad_perm:[1,0,3,2]
    v_add_f32 v121, v121, v121 quad_perm:[1,0,3,2]
    v_add_f32 v122, v122, v122 quad_perm:[1,0,3,2]
    v_add_f32 v123, v123, v123 quad_perm:[1,0,3,2]
    v_add_f32 v120, v120, v120 quad_perm:[2,3,0,1]
    v_add_f32 v121, v121, v121 quad_perm:[2,3,0,1]
    v_add_f32 v122, v122, v122 quad_perm:[2,3,0,1]
    v_add_f32 v123, v123, v123 quad_perm:[2,3,0,1]
    s_mov_b64 exec, s[16:17]
    buffer_store_dwordx4 v[120:123], v55, s[48:51], s77 offen sc1
    s_mov_b64 exec, -1
    s_waitcnt vmcnt(10)
    s_barrier
    ds_read_b64_tr_b16 v[72:73], v2 offset:16896
    ds_read_b64_tr_b16 v[74:75], v2 offset:21120
    ds_read_b64_tr_b16 v[76:77], v2 offset:25344
    ds_read_b64_tr_b16 v[78:79], v2 offset:29568
    ds_read_b64_tr_b16 v[80:81], v2 offset:16928
    ds_read_b64_tr_b16 v[82:83], v2 offset:21152
    ds_read_b64_tr_b16 v[84:85], v2 offset:25376
    ds_read_b64_tr_b16 v[86:87], v2 offset:29600
    ds_read_b64_tr_b16 v[88:89], v2 offset:16960
    ds_read_b64_tr_b16 v[90:91], v2 offset:21184
    ds_read_b64_tr_b16 v[92:93], v2 offset:25408
    ds_read_b64_tr_b16 v[94:95], v2 offset:29632
    s_waitcnt lgkmcnt(8)
    v_mfma_f32_16x16x32_bf16 v[112:115], v[72:75], a[0:3], 0
    ds_read_b64_tr_b16 v[64:65], v2 offset:16992
    v_mfma_f32_16x16x32_bf16 v[112:115], v[76:79], a[8:11], v[112:115]
    ds_read_b64_tr_b16 v[66:67], v2 offset:21216
    v_mfma_f32_16x16x32_bf16 v[116:119], v[72:75], a[4:7], 0
    ds_read_b64_tr_b16 v[68:69], v2 offset:25440
    v_mfma_f32_16x16x32_bf16 v[116:119], v[76:79], a[12:15], v[116:119]
    ds_read_b64_tr_b16 v[70:71], v2 offset:29664
    s_waitcnt lgkmcnt(8)
    v_mfma_f32_16x16x32_bf16 v[120:123], v[80:83], a[0:3], 0
    ds_read_b64_tr_b16 v[72:73], v61 offset:17024
    v_mfma_f32_16x16x32_bf16 v[120:123], v[84:87], a[8:11], v[120:123]
    ds_read_b64_tr_b16 v[74:75], v61 offset:21248
    v_mfma_f32_16x16x32_bf16 v[124:127], v[80:83], a[4:7], 0
    ds_read_b64_tr_b16 v[76:77], v61 offset:25472
    v_mfma_f32_16x16x32_bf16 v[124:127], v[84:87], a[12:15], v[124:127]
    ds_read_b64_tr_b16 v[78:79], v61 offset:29696
    s_waitcnt lgkmcnt(8)
    v_mfma_f32_16x16x32_bf16 v[128:131], v[88:91], a[0:3], 0
    ds_read_b64_tr_b16 v[80:81], v61 offset:17056
    v_mfma_f32_16x16x32_bf16 v[128:131], v[92:95], a[8:11], v[128:131]
    ds_read_b64_tr_b16 v[82:83], v61 offset:21280
    v_mfma_f32_16x16x32_bf16 v[132:135], v[88:91], a[4:7], 0
    ds_read_b64_tr_b16 v[84:85], v61 offset:25504
    v_mfma_f32_16x16x32_bf16 v[132:135], v[92:95], a[12:15], v[132:135]
    ds_read_b64_tr_b16 v[86:87], v61 offset:29728
    s_waitcnt lgkmcnt(8)
    v_mfma_f32_16x16x32_bf16 v[136:139], v[64:67], a[0:3], 0
    ds_read_b64_tr_b16 v[88:89], v61 offset:17088
    v_mfma_f32_16x16x32_bf16 v[136:139], v[68:71], a[8:11], v[136:139]
    ds_read_b64_tr_b16 v[90:91], v61 offset:21312
    v_mfma_f32_16x16x32_bf16 v[140:143], v[64:67], a[4:7], 0
    ds_read_b64_tr_b16 v[92:93], v61 offset:25536
    v_mfma_f32_16x16x32_bf16 v[140:143], v[68:71], a[12:15], v[140:143]
    ds_read_b64_tr_b16 v[94:95], v61 offset:29760
    s_waitcnt lgkmcnt(8)
    v_mfma_f32_16x16x32_bf16 v[144:147], v[72:75], a[0:3], 0
    ds_read_b64_tr_b16 v[64:65], v61 offset:17120
    v_mfma_f32_16x16x32_bf16 v[144:147], v[76:79], a[8:11], v[144:147]
    ds_read_b64_tr_b16 v[66:67], v61 offset:21344
    v_mfma_f32_16x16x32_bf16 v[148:151], v[72:75], a[4:7], 0
    ds_read_b64_tr_b16 v[68:69], v61 offset:25568
    v_mfma_f32_16x16x32_bf16 v[148:151], v[76:79], a[12:15], v[148:151]
    ds_read_b64_tr_b16 v[70:71], v61 offset:29792
    s_waitcnt lgkmcnt(8)
    v_add_u32 v2, 0xfffe7400, v2
    v_add_u32 v61, 0xfffe7400, v61
    v_mfma_f32_16x16x32_bf16 v[152:155], v[80:83], a[0:3], 0
    s_waitcnt vmcnt(6)
    s_barrier
    ds_read_b64_tr_b16 v[72:73], v2 offset:0
    v_mfma_f32_16x16x32_bf16 v[152:155], v[84:87], a[8:11], v[152:155]
    ds_read_b64_tr_b16 v[74:75], v2 offset:4224
    v_mfma_f32_16x16x32_bf16 v[156:159], v[80:83], a[4:7], 0
    ds_read_b64_tr_b16 v[76:77], v2 offset:8448
    v_mfma_f32_16x16x32_bf16 v[156:159], v[84:87], a[12:15], v[156:159]
    ds_read_b64_tr_b16 v[78:79], v2 offset:12672
    s_waitcnt lgkmcnt(8)
    v_mfma_f32_16x16x32_bf16 v[160:163], v[88:91], a[0:3], 0
    ds_read_b64_tr_b16 v[80:81], v2 offset:32
    v_mfma_f32_16x16x32_bf16 v[160:163], v[92:95], a[8:11], v[160:163]
    ds_read_b64_tr_b16 v[82:83], v2 offset:4256
    v_mfma_f32_16x16x32_bf16 v[164:167], v[88:91], a[4:7], 0
    ds_read_b64_tr_b16 v[84:85], v2 offset:8480
    v_mfma_f32_16x16x32_bf16 v[164:167], v[92:95], a[12:15], v[164:167]
    ds_read_b64_tr_b16 v[86:87], v2 offset:12704
    s_waitcnt lgkmcnt(8)
    v_mfma_f32_16x16x32_bf16 v[168:171], v[64:67], a[0:3], 0
    ds_read_b64_tr_b16 v[88:89], v2 offset:64
    v_mfma_f32_16x16x32_bf16 v[168:171], v[68:71], a[8:11], v[168:171]
    ds_read_b64_tr_b16 v[90:91], v2 offset:4288
    buffer_load_dwordx4 v[96:99], v54, s[48:51], s76 offen offset:0 sc1
    buffer_load_dwordx4 v[100:103], v54, s[48:51], s76 offen offset:1024 sc1
    buffer_load_dwordx4 v[104:107], v54, s[48:51], s76 offen offset:2048 sc1
    buffer_load_dwordx4 v[108:111], v54, s[48:51], s76 offen offset:3072 sc1
    v_mfma_f32_16x16x32_bf16 v[172:175], v[64:67], a[4:7], 0
    ds_read_b64_tr_b16 v[92:93], v2 offset:8512
    v_mfma_f32_16x16x32_bf16 v[172:175], v[68:71], a[12:15], v[172:175]
    ds_read_b64_tr_b16 v[94:95], v2 offset:12736
    s_waitcnt lgkmcnt(8)
    v_mfma_f32_16x16x32_bf16 v[112:115], v[72:75], a[16:19], v[112:115]
    ds_read_b64_tr_b16 v[64:65], v2 offset:96
    v_mfma_f32_16x16x32_bf16 v[112:115], v[76:79], a[24:27], v[112:115]
    ds_read_b64_tr_b16 v[66:67], v2 offset:4320
    s_lshl_b32 s57, s3, 11
    s_add_u32 s57, s57, 153600
    v_bfe_u32 v42, v0, 2, 2
    v_lshlrev_b32 v43, 9, v10
    v_lshl_add_u32 v43, v42, 7, v43
    v_and_b32 v44, 3, v0
    v_lshl_add_u32 v43, v44, 3, v43
    v_add_u32 v43, s57, v43
    v_add_u32 v45, s57, v1
    v_lshlrev_b32 v42, 2, v42
    v_lshlrev_b32 v44, 4, v44
    v_lshl_add_u32 v44, v10, 8, v44
    v_accvgpr_read_b32 v52, a179
    ds_write_b128 v45, a[144:147] offset:0
    ds_write_b128 v45, a[148:151] offset:1024
    ds_read_b64_tr_b16 a[160:161], v43 offset:0
    ds_read_b64_tr_b16 a[164:165], v43 offset:32
    ds_read_b64_tr_b16 a[168:169], v43 offset:64
    ds_read_b64_tr_b16 a[172:173], v43 offset:96
    ds_bpermute_b32 v53, v42, v52 offset:0
    ds_bpermute_b32 v14, v42, v52 offset:16
    ds_bpermute_b32 v62, v42, v52 offset:32
    ds_bpermute_b32 v63, v42, v52 offset:48
    ds_write_b128 v45, a[152:155] offset:0
    ds_write_b128 v45, a[156:159] offset:1024
    ds_read_b64_tr_b16 a[162:163], v43 offset:0
    ds_read_b64_tr_b16 a[166:167], v43 offset:32
    ds_read_b64_tr_b16 a[170:171], v43 offset:64
    ds_read_b64_tr_b16 a[174:175], v43 offset:96
    s_waitcnt lgkmcnt(0)
    v_add_u32 v53, v53, v44
    v_add_u32 v14, v14, v44
    v_add_u32 v62, v62, v44
    v_add_u32 v63, v63, v44
    v_mfma_f32_16x16x32_bf16 v[116:119], v[76:79], a[28:31], v[116:119]
    ds_read_b64_tr_b16 v[68:69], v2 offset:8544
    v_mfma_f32_16x16x32_bf16 v[116:119], v[72:75], a[20:23], v[116:119]
    ds_read_b64_tr_b16 v[70:71], v2 offset:12768
    s_waitcnt lgkmcnt(8)
    v_mfma_f32_16x16x32_bf16 v[120:123], v[80:83], a[16:19], v[120:123]
    ds_read_b64_tr_b16 v[72:73], v61 offset:128
    buffer_store_dwordx4 a[160:163], v53, s[48:51], s59 offen sc1
    v_mfma_f32_16x16x32_bf16 v[120:123], v[84:87], a[24:27], v[120:123]
    ds_read_b64_tr_b16 v[74:75], v61 offset:4352
    v_mfma_f32_16x16x32_bf16 v[124:127], v[84:87], a[28:31], v[124:127]
    ds_read_b64_tr_b16 v[76:77], v61 offset:8576
    v_mfma_f32_16x16x32_bf16 v[124:127], v[80:83], a[20:23], v[124:127]
    ds_read_b64_tr_b16 v[78:79], v61 offset:12800
    s_waitcnt lgkmcnt(8)
    v_mfma_f32_16x16x32_bf16 v[128:131], v[88:91], a[16:19], v[128:131]
    ds_read_b64_tr_b16 v[80:81], v61 offset:160
    v_mfma_f32_16x16x32_bf16 v[128:131], v[92:95], a[24:27], v[128:131]
    ds_read_b64_tr_b16 v[82:83], v61 offset:4384
    v_mfma_f32_16x16x32_bf16 v[132:135], v[92:95], a[28:31], v[132:135]
    ds_read_b64_tr_b16 v[84:85], v61 offset:8608
    v_mfma_f32_16x16x32_bf16 v[132:135], v[88:91], a[20:23], v[132:135]
    ds_read_b64_tr_b16 v[86:87], v61 offset:12832
    s_waitcnt lgkmcnt(8)
    v_mfma_f32_16x16x32_bf16 v[136:139], v[64:67], a[16:19], v[136:139]
    ds_read_b64_tr_b16 v[88:89], v61 offset:192
    buffer_store_dwordx4 a[164:167], v14, s[48:51], s59 offen sc1
    v_mfma_f32_16x16x32_bf16 v[136:139], v[68:71], a[24:27], v[136:139]
    ds_read_b64_tr_b16 v[90:91], v61 offset:4416
    v_mfma_f32_16x16x32_bf16 v[140:143], v[68:71], a[28:31], v[140:143]
    ds_read_b64_tr_b16 v[92:93], v61 offset:8640
    v_mfma_f32_16x16x32_bf16 v[140:143], v[64:67], a[20:23], v[140:143]
    ds_read_b64_tr_b16 v[94:95], v61 offset:12864
    s_waitcnt lgkmcnt(8)
    v_mfma_f32_16x16x32_bf16 v[144:147], v[72:75], a[16:19], v[144:147]
    ds_read_b64_tr_b16 v[64:65], v61 offset:224
    s_add_u32 m0, s70, 33792
    v_mfma_f32_16x16x32_bf16 v[144:147], v[76:79], a[24:27], v[144:147]
    ds_read_b64_tr_b16 v[66:67], v61 offset:4448
    s_add_u32 s71, s71, 589824
    v_mfma_f32_16x16x32_bf16 v[148:151], v[76:79], a[28:31], v[148:151]
    ds_read_b64_tr_b16 v[68:69], v61 offset:8672
    s_sub_u32 s64, s71, 5308416
    s_cmp_ge_u32 s71, s72
    s_cselect_b32 s71, s64, s71
    v_mfma_f32_16x16x32_bf16 v[148:151], v[72:75], a[20:23], v[148:151]
    ds_read_b64_tr_b16 v[70:71], v61 offset:12896
    s_waitcnt lgkmcnt(8)
    v_mfma_f32_16x16x32_bf16 v[152:155], v[80:83], a[16:19], v[152:155]
    s_waitcnt vmcnt(8)
    s_barrier
    ds_read_b64_tr_b16 v[72:73], v2 offset:16896
    v_mfma_f32_16x16x32_bf16 v[152:155], v[84:87], a[24:27], v[152:155]
    ds_read_b64_tr_b16 v[74:75], v2 offset:21120
    buffer_load_dwordx4 v56, s[52:55], s71 offen offset:0 lds
    v_mfma_f32_16x16x32_bf16 v[156:159], v[84:87], a[28:31], v[156:159]
    ds_read_b64_tr_b16 v[76:77], v2 offset:25344
    buffer_load_dwordx4 v57, s[52:55], s71 offen offset:1056 lds
    v_mfma_f32_16x16x32_bf16 v[156:159], v[80:83], a[20:23], v[156:159]
    ds_read_b64_tr_b16 v[78:79], v2 offset:29568
    s_waitcnt lgkmcnt(8)
    v_mfma_f32_16x16x32_bf16 v[160:163], v[88:91], a[16:19], v[160:163]
    ds_read_b64_tr_b16 v[80:81], v2 offset:16928
    buffer_store_dwordx4 a[168:171], v62, s[48:51], s59 offen sc1
    v_mfma_f32_16x16x32_bf16 v[160:163], v[92:95], a[24:27], v[160:163]
    ds_read_b64_tr_b16 v[82:83], v2 offset:21152
    v_mfma_f32_16x16x32_bf16 v[164:167], v[92:95], a[28:31], v[164:167]
    ds_read_b64_tr_b16 v[84:85], v2 offset:25376
    buffer_load_dwordx4 v58, s[52:55], s71 offen offset:2112 lds
    v_mfma_f32_16x16x32_bf16 v[164:167], v[88:91], a[20:23], v[164:167]
    ds_read_b64_tr_b16 v[86:87], v2 offset:29600
    s_waitcnt lgkmcnt(8)
    v_mfma_f32_16x16x32_bf16 v[168:171], v[64:67], a[16:19], v[168:171]
    ds_read_b64_tr_b16 v[88:89], v2 offset:16960
    buffer_store_dwordx4 a[172:175], v63, s[48:51], s59 offen sc1
    v_mfma_f32_16x16x32_bf16 v[168:171], v[68:71], a[24:27], v[168:171]
    ds_read_b64_tr_b16 v[90:91], v2 offset:21184
    v_mfma_f32_16x16x32_bf16 v[172:175], v[68:71], a[28:31], v[172:175]
    ds_read_b64_tr_b16 v[92:93], v2 offset:25408
    v_mfma_f32_16x16x32_bf16 v[172:175], v[64:67], a[20:23], v[172:175]
    ds_read_b64_tr_b16 v[94:95], v2 offset:29632
    s_waitcnt lgkmcnt(8)
    v_mfma_f32_16x16x32_bf16 v[112:115], v[72:75], a[32:35], v[112:115]
    ds_read_b64_tr_b16 v[64:65], v2 offset:16992
    buffer_load_dwordx4 v59, s[52:55], s71 offen offset:3168 lds
    v_mfma_f32_16x16x32_bf16 v[112:115], v[76:79], a[40:43], v[112:115]
    ds_read_b64_tr_b16 v[66:67], v2 offset:21216
    v_mfma_f32_16x16x32_bf16 v[116:119], v[76:79], a[44:47], v[116:119]
    ds_read_b64_tr_b16 v[68:69], v2 offset:25440
    s_add_u32 m0, s70, 50688
    v_mfma_f32_16x16x32_bf16 v[116:119], v[72:75], a[36:39], v[116:119]
    ds_read_b64_tr_b16 v[70:71], v2 offset:29664
    s_waitcnt lgkmcnt(8)
    v_mfma_f32_16x16x32_bf16 v[120:123], v[80:83], a[32:35], v[120:123]
    ds_read_b64_tr_b16 v[72:73], v61 offset:17024
    s_add_u32 s71, s71, 589824
    v_mfma_f32_16x16x32_bf16 v[120:123], v[84:87], a[40:43], v[120:123]
    ds_read_b64_tr_b16 v[74:75], v61 offset:21248
    s_sub_u32 s64, s71, 5308416
    s_cmp_ge_u32 s71, s72
    s_cselect_b32 s71, s64, s71
    v_mfma_f32_16x16x32_bf16 v[124:127], v[84:87], a[44:47], v[124:127]
    ds_read_b64_tr_b16 v[76:77], v61 offset:25472
    buffer_load_dwordx4 v56, s[52:55], s71 offen offset:0 lds
    v_mfma_f32_16x16x32_bf16 v[124:127], v[80:83], a[36:39], v[124:127]
    ds_read_b64_tr_b16 v[78:79], v61 offset:29696
    s_waitcnt lgkmcnt(8)
    v_mfma_f32_16x16x32_bf16 v[128:131], v[88:91], a[32:35], v[128:131]
    ds_read_b64_tr_b16 v[80:81], v61 offset:17056
    v_mfma_f32_16x16x32_bf16 v[128:131], v[92:95], a[40:43], v[128:131]
    ds_read_b64_tr_b16 v[82:83], v61 offset:21280
    buffer_load_dwordx4 v57, s[52:55], s71 offen offset:1056 lds
    v_mfma_f32_16x16x32_bf16 v[132:135], v[92:95], a[44:47], v[132:135]
    ds_read_b64_tr_b16 v[84:85], v61 offset:25504
    s_waitcnt vmcnt(10)
    v_mfma_f32_16x16x32_bf16 v[132:135], v[88:91], a[36:39], v[132:135]
    ds_read_b64_tr_b16 v[86:87], v61 offset:29728
    s_waitcnt lgkmcnt(8)
    v_mfma_f32_16x16x32_bf16 v[136:139], v[64:67], a[32:35], v[136:139]
    ds_read_b64_tr_b16 v[88:89], v61 offset:17088
    s_branch KM_st_chk
KM_st_poll:
    buffer_load_dwordx4 v[96:99], v54, s[48:51], s76 offen offset:0 sc1
    buffer_load_dwordx4 v[100:103], v54, s[48:51], s76 offen offset:1024 sc1
    buffer_load_dwordx4 v[104:107], v54, s[48:51], s76 offen offset:2048 sc1
    buffer_load_dwordx4 v[108:111], v54, s[48:51], s76 offen offset:3072 sc1
    s_waitcnt vmcnt(0)
KM_st_chk:
    v_max3_u32 v8, v96, v97, v98
    v_max3_u32 v9, v99, v100, v101
    v_max3_u32 v8, v8, v102, v103
    v_max3_u32 v9, v9, v104, v105
    v_max3_u32 v8, v8, v106, v107
    v_max3_u32 v9, v9, v108, v109
    v_max3_u32 v8, v8, v110, v111
    v_max_u32 v8, v8, v9
    v_cmp_eq_u32 vcc, -1, v8
    s_sub_u32 s94, s94, 1
    s_cmp_lt_i32 s94, 1
    s_cbranch_scc1 KM_st_done
    s_cbranch_vccnz KM_st_poll
KM_st_done:
    v_mfma_f32_16x16x32_bf16 v[136:139], v[68:71], a[40:43], v[136:139]
    ds_read_b64_tr_b16 v[90:91], v61 offset:21312
    buffer_load_dwordx4 v58, s[52:55], s71 offen offset:2112 lds
    v_mfma_f32_16x16x32_bf16 v[140:143], v[68:71], a[44:47], v[140:143]
    ds_read_b64_tr_b16 v[92:93], v61 offset:25536
    v_add_f32 v96, v96, v100
    v_add_f32 v97, v97, v101
    v_add_f32 v98, v98, v102
    v_add_f32 v99, v99, v103
    v_add_f32 v104, v104, v108
    v_add_f32 v105, v105, v109
    v_add_f32 v106, v106, v110
    v_add_f32 v107, v107, v111
    v_add_f32 v96, v96, v104
    v_add_f32 v97, v97, v105
    v_add_f32 v98, v98, v106
    v_add_f32 v99, v99, v107
    v_add_f32 v96, v96, v96 row_ror:4
    v_add_f32 v97, v97, v97 row_ror:4
    v_add_f32 v98, v98, v98 row_ror:4
    v_add_f32 v99, v99, v99 row_ror:4
    v_add_f32 v96, v96, v96 row_ror:8
    v_add_f32 v97, v97, v97 row_ror:8
    v_add_f32 v98, v98, v98 row_ror:8
    v_add_f32 v99, v99, v99 row_ror:8
    v_mul_f32 v4, v96, v11 quad_perm:[0,1,0,1]
    v_mul_f32 v5, v97, v11 quad_perm:[0,1,0,1]
    v_mul_f32 v6, v98, v11 quad_perm:[0,1,0,1]
    v_mul_f32 v7, v99, v11 quad_perm:[0,1,0,1]
    v_mul_f32 v104, v96, v11 quad_perm:[2,3,2,3]
    v_mul_f32 v105, v97, v11 quad_perm:[2,3,2,3]
    v_mul_f32 v106, v98, v11 quad_perm:[2,3,2,3]
    v_mul_f32 v107, v99, v11 quad_perm:[2,3,2,3]
    v_fma_f32 v104, -v4, v4, v104
    v_fma_f32 v105, -v5, v5, v105
    v_fma_f32 v106, -v6, v6, v106
    v_fma_f32 v107, -v7, v7, v107
    v_max_f32 v104, 0, v104
    v_max_f32 v105, 0, v105
    v_max_f32 v106, 0, v106
    v_max_f32 v107, 0, v107
    v_cvt_pk_bf16_f32 v105, v104, v105
    v_lshlrev_b32 v104, 16, v105
    v_and_b32 v105, 0xffff0000, v105
    v_cvt_pk_bf16_f32 v107, v106, v107
    v_lshlrev_b32 v106, 16, v107
    v_and_b32 v107, 0xffff0000, v107
    v_add_f32 v104, 0x3727c5ac, v104
    v_add_f32 v105, 0x3727c5ac, v105
    v_add_f32 v106, 0x3727c5ac, v106
    v_add_f32 v107, 0x3727c5ac, v107
    v_cvt_pk_bf16_f32 v105, v104, v105
    v_lshlrev_b32 v104, 16, v105
    v_and_b32 v105, 0xffff0000, v105
    v_cvt_pk_bf16_f32 v107, v106, v107
    v_lshlrev_b32 v106, 16, v107
    v_and_b32 v107, 0xffff0000, v107
    v_sqrt_f32 v104, v104
    v_sqrt_f32 v105, v105
    v_sqrt_f32 v106, v106
    v_sqrt_f32 v107, v107
    v_cvt_pk_bf16_f32 v5, v4, v5
    v_lshlrev_b32 v4, 16, v5
    v_and_b32 v5, 0xffff0000, v5
    v_cvt_pk_bf16_f32 v7, v6, v7
    v_lshlrev_b32 v6, 16, v7
    v_and_b32 v7, 0xffff0000, v7
    v_cvt_pk_bf16_f32 v105, v104, v105
    v_lshlrev_b32 v104, 16, v105
    v_and_b32 v105, 0xffff0000, v105
    v_cvt_pk_bf16_f32 v107, v106, v107
    v_lshlrev_b32 v106, 16, v107
    v_and_b32 v107, 0xffff0000, v107
    v_rcp_f32 v104, v104
    v_rcp_f32 v105, v105
    v_rcp_f32 v106, v106
    v_rcp_f32 v107, v107
    s_nop 0
    v_mul_f32 v4, -v4, v104
    v_mul_f32 v5, -v5, v105
    v_mul_f32 v6, -v6, v106
    v_mul_f32 v7, -v7, v107
    v_mov_b32 v96, v104 quad_perm:[0,0,0,0]
    v_mov_b32 v97, v104 quad_perm:[1,1,1,1]
    v_mov_b32 v98, v105 quad_perm:[0,0,0,0]
    v_mov_b32 v99, v105 quad_perm:[1,1,1,1]
    v_mov_b32 v100, v106 quad_perm:[0,0,0,0]
    v_mov_b32 v101, v106 quad_perm:[1,1,1,1]
    v_mov_b32 v102, v107 quad_perm:[0,0,0,0]
    v_mov_b32 v103, v107 quad_perm:[1,1,1,1]
    v_mov_b32 v104, v4 quad_perm:[0,0,0,0]
    v_mov_b32 v105, v4 quad_perm:[1,1,1,1]
    v_mov_b32 v106, v5 quad_perm:[0,0,0,0]
    v_mov_b32 v107, v5 quad_perm:[1,1,1,1]
    v_mov_b32 v108, v6 quad_perm:[0,0,0,0]
    v_mov_b32 v109, v6 quad_perm:[1,1,1,1]
    v_mov_b32 v110, v7 quad_perm:[0,0,0,0]
    v_mov_b32 v111, v7 quad_perm:[1,1,1,1]
    v_pk_fma_f32 v[184:185], v[184:185], v[96:97], v[104:105]
    v_pk_fma_f32 v[186:187], v[186:187], v[98:99], v[106:107]
    v_pk_fma_f32 v[188:189], v[188:189], v[100:101], v[108:109]
    v_pk_fma_f32 v[190:191], v[190:191], v[102:103], v[110:111]
    v_cvt_pk_bf16_f32 v184, v184, v185
    v_cvt_pk_bf16_f32 v185, v186, v187
    v_cvt_pk_bf16_f32 v186, v188, v189
    v_cvt_pk_bf16_f32 v187, v190, v191
    buffer_store_dwordx4 v[184:187], v1, s[48:51], s81 offen offset:0 sc1
    v_mfma_f32_16x16x32_bf16 v[140:143], v[64:67], a[36:39], v[140:143]
    ds_read_b64_tr_b16 v[94:95], v61 offset:29760
    s_waitcnt lgkmcnt(8)
    v_mfma_f32_16x16x32_bf16 v[144:147], v[72:75], a[32:35], v[144:147]
    ds_read_b64_tr_b16 v[64:65], v61 offset:17120
    v_mfma_f32_16x16x32_bf16 v[144:147], v[76:79], a[40:43], v[144:147]
    ds_read_b64_tr_b16 v[66:67], v61 offset:21344
    v_mfma_f32_16x16x32_bf16 v[148:151], v[76:79], a[44:47], v[148:151]
    ds_read_b64_tr_b16 v[68:69], v61 offset:25568
    buffer_load_dwordx4 v59, s[52:55], s71 offen offset:3168 lds
    v_mfma_f32_16x16x32_bf16 v[148:151], v[72:75], a[36:39], v[148:151]
    ds_read_b64_tr_b16 v[70:71], v61 offset:29792
    s_waitcnt lgkmcnt(8)
    v_mfma_f32_16x16x32_bf16 v[152:155], v[80:83], a[32:35], v[152:155]
    s_waitcnt vmcnt(5)
    s_barrier
    ds_read_b64_tr_b16 v[72:73], v2 offset:33792
    v_mfma_f32_16x16x32_bf16 v[152:155], v[84:87], a[40:43], v[152:155]
    ds_read_b64_tr_b16 v[74:75], v2 offset:38016
    s_add_u32 m0, s70, 67584
    v_mfma_f32_16x16x32_bf16 v[156:159], v[84:87], a[44:47], v[156:159]
    ds_read_b64_tr_b16 v[76:77], v2 offset:42240
    s_add_u32 s71, s71, 589824
    v_mfma_f32_16x16x32_bf16 v[156:159], v[80:83], a[36:39], v[156:159]
    ds_read_b64_tr_b16 v[78:79], v2 offset:46464
    s_waitcnt lgkmcnt(8)
    v_mfma_f32_16x16x32_bf16 v[160:163], v[88:91], a[32:35], v[160:163]
    ds_read_b64_tr_b16 v[80:81], v2 offset:33824
    s_sub_u32 s64, s71, 5308416
    s_cmp_ge_u32 s71, s72
    s_cselect_b32 s71, s64, s71
    v_mfma_f32_16x16x32_bf16 v[160:163], v[92:95], a[40:43], v[160:163]
    ds_read_b64_tr_b16 v[82:83], v2 offset:38048
    buffer_load_dwordx4 v56, s[52:55], s71 offen offset:0 lds
    v_mfma_f32_16x16x32_bf16 v[164:167], v[92:95], a[44:47], v[164:167]
    ds_read_b64_tr_b16 v[84:85], v2 offset:42272
    v_pk_fma_f32 v[192:193], v[192:193], v[96:97], v[104:105]
    v_pk_fma_f32 v[194:195], v[194:195], v[98:99], v[106:107]
    v_pk_fma_f32 v[196:197], v[196:197], v[100:101], v[108:109]
    v_pk_fma_f32 v[198:199], v[198:199], v[102:103], v[110:111]
    v_cvt_pk_bf16_f32 v192, v192, v193
    v_cvt_pk_bf16_f32 v193, v194, v195
    v_cvt_pk_bf16_f32 v194, v196, v197
    v_cvt_pk_bf16_f32 v195, v198, v199
    buffer_store_dwordx4 v[192:195], v1, s[48:51], s81 offen offset:1024 sc1
    v_mfma_f32_16x16x32_bf16 v[164:167], v[88:91], a[36:39], v[164:167]
    ds_read_b64_tr_b16 v[86:87], v2 offset:46496
    s_waitcnt lgkmcnt(8)
    v_mfma_f32_16x16x32_bf16 v[168:171], v[64:67], a[32:35], v[168:171]
    ds_read_b64_tr_b16 v[88:89], v2 offset:33856
    buffer_load_dwordx4 v57, s[52:55], s71 offen offset:1056 lds
    v_mfma_f32_16x16x32_bf16 v[168:171], v[68:71], a[40:43], v[168:171]
    ds_read_b64_tr_b16 v[90:91], v2 offset:38080
    v_mfma_f32_16x16x32_bf16 v[172:175], v[68:71], a[44:47], v[172:175]
    ds_read_b64_tr_b16 v[92:93], v2 offset:42304
    v_pk_fma_f32 v[200:201], v[200:201], v[96:97], v[104:105]
    v_pk_fma_f32 v[202:203], v[202:203], v[98:99], v[106:107]
    v_pk_fma_f32 v[204:205], v[204:205], v[100:101], v[108:109]
    v_pk_fma_f32 v[206:207], v[206:207], v[102:103], v[110:111]
    v_cvt_pk_bf16_f32 v200, v200, v201
    v_cvt_pk_bf16_f32 v201, v202, v203
    v_cvt_pk_bf16_f32 v202, v204, v205
    v_cvt_pk_bf16_f32 v203, v206, v207
    buffer_store_dwordx4 v[200:203], v1, s[48:51], s81 offen offset:2048 sc1
    v_mfma_f32_16x16x32_bf16 v[172:175], v[64:67], a[36:39], v[172:175]
    ds_read_b64_tr_b16 v[94:95], v2 offset:46528
    s_waitcnt lgkmcnt(8)
    v_mfma_f32_16x16x32_bf16 v[112:115], v[72:75], a[48:51], v[112:115]
    ds_read_b64_tr_b16 v[64:65], v2 offset:33888
    buffer_load_dwordx4 v58, s[52:55], s71 offen offset:2112 lds
    v_mfma_f32_16x16x32_bf16 v[112:115], v[76:79], a[56:59], v[112:115]
    ds_read_b64_tr_b16 v[66:67], v2 offset:38112
    v_mfma_f32_16x16x32_bf16 v[116:119], v[76:79], a[60:63], v[116:119]
    ds_read_b64_tr_b16 v[68:69], v2 offset:42336
    v_mfma_f32_16x16x32_bf16 v[116:119], v[72:75], a[52:55], v[116:119]
    ds_read_b64_tr_b16 v[70:71], v2 offset:46560
    s_waitcnt lgkmcnt(8)
    v_mfma_f32_16x16x32_bf16 v[120:123], v[80:83], a[48:51], v[120:123]
    ds_read_b64_tr_b16 v[72:73], v61 offset:33920
    v_mfma_f32_16x16x32_bf16 v[120:123], v[84:87], a[56:59], v[120:123]
    ds_read_b64_tr_b16 v[74:75], v61 offset:38144
    buffer_load_dwordx4 v59, s[52:55], s71 offen offset:3168 lds
    v_mfma_f32_16x16x32_bf16 v[124:127], v[84:87], a[60:63], v[124:127]
    ds_read_b64_tr_b16 v[76:77], v61 offset:42368
    v_mfma_f32_16x16x32_bf16 v[124:127], v[80:83], a[52:55], v[124:127]
    ds_read_b64_tr_b16 v[78:79], v61 offset:46592
    s_waitcnt lgkmcnt(8)
    v_mfma_f32_16x16x32_bf16 v[128:131], v[88:91], a[48:51], v[128:131]
    ds_read_b64_tr_b16 v[80:81], v61 offset:33952
    s_add_u32 m0, s70, 84480
    v_mfma_f32_16x16x32_bf16 v[128:131], v[92:95], a[56:59], v[128:131]
    ds_read_b64_tr_b16 v[82:83], v61 offset:38176
    s_add_u32 s71, s71, 589824
    v_mfma_f32_16x16x32_bf16 v[132:135], v[92:95], a[60:63], v[132:135]
    ds_read_b64_tr_b16 v[84:85], v61 offset:42400
    s_sub_u32 s64, s71, 5308416
    s_cmp_ge_u32 s71, s72
    s_cselect_b32 s71, s64, s71
    v_mfma_f32_16x16x32_bf16 v[132:135], v[88:91], a[52:55], v[132:135]
    ds_read_b64_tr_b16 v[86:87], v61 offset:46624
    s_waitcnt lgkmcnt(8)
    v_mfma_f32_16x16x32_bf16 v[136:139], v[64:67], a[48:51], v[136:139]
    ds_read_b64_tr_b16 v[88:89], v61 offset:33984
    buffer_load_dwordx4 v56, s[52:55], s71 offen offset:0 lds
    v_mfma_f32_16x16x32_bf16 v[136:139], v[68:71], a[56:59], v[136:139]
    ds_read_b64_tr_b16 v[90:91], v61 offset:38208
    v_pk_fma_f32 v[208:209], v[208:209], v[96:97], v[104:105]
    v_pk_fma_f32 v[210:211], v[210:211], v[98:99], v[106:107]
    v_pk_fma_f32 v[212:213], v[212:213], v[100:101], v[108:109]
    v_pk_fma_f32 v[214:215], v[214:215], v[102:103], v[110:111]
    v_cvt_pk_bf16_f32 v208, v208, v209
    v_cvt_pk_bf16_f32 v209, v210, v211
    v_cvt_pk_bf16_f32 v210, v212, v213
    v_cvt_pk_bf16_f32 v211, v214, v215
    buffer_store_dwordx4 v[208:211], v1, s[48:51], s81 offen offset:3072 sc1
    v_mfma_f32_16x16x32_bf16 v[140:143], v[68:71], a[60:63], v[140:143]
    ds_read_b64_tr_b16 v[92:93], v61 offset:42432
    buffer_load_dwordx4 v57, s[52:55], s71 offen offset:1056 lds
    v_mfma_f32_16x16x32_bf16 v[140:143], v[64:67], a[52:55], v[140:143]
    ds_read_b64_tr_b16 v[94:95], v61 offset:46656
    s_waitcnt lgkmcnt(8)
    v_mfma_f32_16x16x32_bf16 v[144:147], v[72:75], a[48:51], v[144:147]
    ds_read_b64_tr_b16 v[64:65], v61 offset:34016
    v_mfma_f32_16x16x32_bf16 v[144:147], v[76:79], a[56:59], v[144:147]
    ds_read_b64_tr_b16 v[66:67], v61 offset:38240
    v_mfma_f32_16x16x32_bf16 v[148:151], v[76:79], a[60:63], v[148:151]
    ds_read_b64_tr_b16 v[68:69], v61 offset:42464
    v_pk_fma_f32 v[216:217], v[216:217], v[96:97], v[104:105]
    v_pk_fma_f32 v[218:219], v[218:219], v[98:99], v[106:107]
    v_pk_fma_f32 v[220:221], v[220:221], v[100:101], v[108:109]
    v_pk_fma_f32 v[222:223], v[222:223], v[102:103], v[110:111]
    v_cvt_pk_bf16_f32 v216, v216, v217
    v_cvt_pk_bf16_f32 v217, v218, v219
    v_cvt_pk_bf16_f32 v218, v220, v221
    v_cvt_pk_bf16_f32 v219, v222, v223
    s_add_u32 s81, s81, 4096
    buffer_store_dwordx4 v[216:219], v1, s[48:51], s81 offen offset:0 sc1
    v_mfma_f32_16x16x32_bf16 v[148:151], v[72:75], a[52:55], v[148:151]
    ds_read_b64_tr_b16 v[70:71], v61 offset:46688
    s_waitcnt lgkmcnt(8)
    v_add_u32 v2, 0xc600, v2
    v_add_u32 v61, 0xc600, v61
    v_mfma_f32_16x16x32_bf16 v[152:155], v[80:83], a[48:51], v[152:155]
    s_waitcnt vmcnt(10)
    s_barrier
    ds_read_b64_tr_b16 v[72:73], v2 offset:0
    v_mfma_f32_16x16x32_bf16 v[152:155], v[84:87], a[56:59], v[152:155]
    ds_read_b64_tr_b16 v[74:75], v2 offset:4224
    buffer_load_dwordx4 v58, s[52:55], s71 offen offset:2112 lds
    v_mfma_f32_16x16x32_bf16 v[156:159], v[84:87], a[60:63], v[156:159]
    ds_read_b64_tr_b16 v[76:77], v2 offset:8448
    v_lshlrev_b32 v184, 16, v36
    v_mfma_f32_16x16x32_bf16 v[156:159], v[80:83], a[52:55], v[156:159]
    ds_read_b64_tr_b16 v[78:79], v2 offset:12672
    s_waitcnt lgkmcnt(8)
    v_mfma_f32_16x16x32_bf16 v[160:163], v[88:91], a[48:51], v[160:163]
    ds_read_b64_tr_b16 v[80:81], v2 offset:32
    buffer_load_dwordx4 v59, s[52:55], s71 offen offset:3168 lds
    v_mfma_f32_16x16x32_bf16 v[160:163], v[92:95], a[56:59], v[160:163]
    ds_read_b64_tr_b16 v[82:83], v2 offset:4256
    v_and_b32 v185, 0xffff0000, v36
    v_mfma_f32_16x16x32_bf16 v[164:167], v[92:95], a[60:63], v[164:167]
    ds_read_b64_tr_b16 v[84:85], v2 offset:8480
    s_add_u32 m0, s70, 101376
    v_mfma_f32_16x16x32_bf16 v[164:167], v[88:91], a[52:55], v[164:167]
    ds_read_b64_tr_b16 v[86:87], v2 offset:12704
    s_waitcnt lgkmcnt(8)
    v_mfma_f32_16x16x32_bf16 v[168:171], v[64:67], a[48:51], v[168:171]
    ds_read_b64_tr_b16 v[88:89], v2 offset:64
    s_add_u32 s71, s71, 589824
    v_mfma_f32_16x16x32_bf16 v[168:171], v[68:71], a[56:59], v[168:171]
    ds_read_b64_tr_b16 v[90:91], v2 offset:4288
    s_sub_u32 s64, s71, 5308416
    s_cmp_ge_u32 s71, s72
    s_cselect_b32 s71, s64, s71
    v_mfma_f32_16x16x32_bf16 v[172:175], v[68:71], a[60:63], v[172:175]
    ds_read_b64_tr_b16 v[92:93], v2 offset:8512
    buffer_load_dwordx4 v56, s[52:55], s71 offen offset:0 lds
    v_mfma_f32_16x16x32_bf16 v[172:175], v[64:67], a[52:55], v[172:175]
    ds_read_b64_tr_b16 v[94:95], v2 offset:12736
    s_waitcnt lgkmcnt(8)
    v_mfma_f32_16x16x32_bf16 v[112:115], v[72:75], a[64:67], v[112:115]
    ds_read_b64_tr_b16 v[64:65], v2 offset:96
    v_pk_fma_f32 v[224:225], v[224:225], v[96:97], v[104:105]
    v_pk_fma_f32 v[226:227], v[226:227], v[98:99], v[106:107]
    v_pk_fma_f32 v[228:229], v[228:229], v[100:101], v[108:109]
    v_pk_fma_f32 v[230:231], v[230:231], v[102:103], v[110:111]
    v_cvt_pk_bf16_f32 v224, v224, v225
    v_cvt_pk_bf16_f32 v225, v226, v227
    v_cvt_pk_bf16_f32 v226, v228, v229
    v_cvt_pk_bf16_f32 v227, v230, v231
    buffer_store_dwordx4 v[224:227], v1, s[48:51], s81 offen offset:1024 sc1
    v_mfma_f32_16x16x32_bf16 v[112:115], v[76:79], a[72:75], v[112:115]
    ds_read_b64_tr_b16 v[66:67], v2 offset:4320
    buffer_load_dwordx4 v57, s[52:55], s71 offen offset:1056 lds
    v_mfma_f32_16x16x32_bf16 v[116:119], v[76:79], a[76:79], v[116:119]
    ds_read_b64_tr_b16 v[68:69], v2 offset:8544
    v_lshlrev_b32 v186, 16, v37
    v_mfma_f32_16x16x32_bf16 v[116:119], v[72:75], a[68:71], v[116:119]
    ds_read_b64_tr_b16 v[70:71], v2 offset:12768
    s_waitcnt lgkmcnt(8)
    v_mfma_f32_16x16x32_bf16 v[120:123], v[80:83], a[64:67], v[120:123]
    ds_read_b64_tr_b16 v[72:73], v61 offset:128
    v_and_b32 v187, 0xffff0000, v37
    v_mfma_f32_16x16x32_bf16 v[120:123], v[84:87], a[72:75], v[120:123]
    ds_read_b64_tr_b16 v[74:75], v61 offset:4352
    v_lshlrev_b32 v188, 16, v16
    v_mfma_f32_16x16x32_bf16 v[124:127], v[84:87], a[76:79], v[124:127]
    ds_read_b64_tr_b16 v[76:77], v61 offset:8576
    buffer_load_dwordx4 v58, s[52:55], s71 offen offset:2112 lds
    v_mfma_f32_16x16x32_bf16 v[124:127], v[80:83], a[68:71], v[124:127]
    ds_read_b64_tr_b16 v[78:79], v61 offset:12800
    s_waitcnt lgkmcnt(8)
    v_mfma_f32_16x16x32_bf16 v[128:131], v[88:91], a[64:67], v[128:131]
    ds_read_b64_tr_b16 v[80:81], v61 offset:160
    v_pk_fma_f32 v[232:233], v[232:233], v[96:97], v[104:105]
    v_pk_fma_f32 v[234:235], v[234:235], v[98:99], v[106:107]
    v_pk_fma_f32 v[236:237], v[236:237], v[100:101], v[108:109]
    v_pk_fma_f32 v[238:239], v[238:239], v[102:103], v[110:111]
    v_cvt_pk_bf16_f32 v232, v232, v233
    v_cvt_pk_bf16_f32 v233, v234, v235
    v_cvt_pk_bf16_f32 v234, v236, v237
    v_cvt_pk_bf16_f32 v235, v238, v239
    buffer_store_dwordx4 v[232:235], v1, s[48:51], s81 offen offset:2048 sc1
    v_mfma_f32_16x16x32_bf16 v[128:131], v[92:95], a[72:75], v[128:131]
    ds_read_b64_tr_b16 v[82:83], v61 offset:4384
    v_lshlrev_b32 v189, 16, v17
    v_mfma_f32_16x16x32_bf16 v[132:135], v[92:95], a[76:79], v[132:135]
    ds_read_b64_tr_b16 v[84:85], v61 offset:8608
    buffer_load_dwordx4 v59, s[52:55], s71 offen offset:3168 lds
    v_mfma_f32_16x16x32_bf16 v[132:135], v[88:91], a[68:71], v[132:135]
    ds_read_b64_tr_b16 v[86:87], v61 offset:12832
    s_waitcnt lgkmcnt(8)
    v_mfma_f32_16x16x32_bf16 v[136:139], v[64:67], a[64:67], v[136:139]
    ds_read_b64_tr_b16 v[88:89], v61 offset:192
    v_lshlrev_b32 v190, 16, v18
    v_mfma_f32_16x16x32_bf16 v[136:139], v[68:71], a[72:75], v[136:139]
    ds_read_b64_tr_b16 v[90:91], v61 offset:4416
    s_add_u32 m0, s70, 118272
    v_mfma_f32_16x16x32_bf16 v[140:143], v[68:71], a[76:79], v[140:143]
    ds_read_b64_tr_b16 v[92:93], v61 offset:8640
    s_add_u32 s71, s71, 589824
    v_mfma_f32_16x16x32_bf16 v[140:143], v[64:67], a[68:71], v[140:143]
    ds_read_b64_tr_b16 v[94:95], v61 offset:12864
    s_waitcnt lgkmcnt(8)
    v_mfma_f32_16x16x32_bf16 v[144:147], v[72:75], a[64:67], v[144:147]
    ds_read_b64_tr_b16 v[64:65], v61 offset:224
    s_sub_u32 s64, s71, 5308416
    s_cmp_ge_u32 s71, s72
    s_cselect_b32 s71, s64, s71
    v_mfma_f32_16x16x32_bf16 v[144:147], v[76:79], a[72:75], v[144:147]
    ds_read_b64_tr_b16 v[66:67], v61 offset:4448
    buffer_load_dwordx4 v56, s[52:55], s71 offen offset:0 lds
    v_mfma_f32_16x16x32_bf16 v[148:151], v[76:79], a[76:79], v[148:151]
    ds_read_b64_tr_b16 v[68:69], v61 offset:8672
    v_pk_fma_f32 v[240:241], v[240:241], v[96:97], v[104:105]
    v_pk_fma_f32 v[242:243], v[242:243], v[98:99], v[106:107]
    v_pk_fma_f32 v[244:245], v[244:245], v[100:101], v[108:109]
    v_pk_fma_f32 v[246:247], v[246:247], v[102:103], v[110:111]
    v_cvt_pk_bf16_f32 v240, v240, v241
    v_cvt_pk_bf16_f32 v241, v242, v243
    v_cvt_pk_bf16_f32 v242, v244, v245
    v_cvt_pk_bf16_f32 v243, v246, v247
    buffer_store_dwordx4 v[240:243], v1, s[48:51], s81 offen offset:3072 sc1
    v_mfma_f32_16x16x32_bf16 v[148:151], v[72:75], a[68:71], v[148:151]
    ds_read_b64_tr_b16 v[70:71], v61 offset:12896
    s_waitcnt lgkmcnt(8)
    v_mfma_f32_16x16x32_bf16 v[152:155], v[80:83], a[64:67], v[152:155]
    s_waitcnt vmcnt(14)
    s_barrier
    ds_read_b64_tr_b16 v[72:73], v2 offset:16896
    v_mfma_f32_16x16x32_bf16 v[152:155], v[84:87], a[72:75], v[152:155]
    ds_read_b64_tr_b16 v[74:75], v2 offset:21120
    buffer_load_dwordx4 v57, s[52:55], s71 offen offset:1056 lds
    v_mfma_f32_16x16x32_bf16 v[156:159], v[84:87], a[76:79], v[156:159]
    ds_read_b64_tr_b16 v[76:77], v2 offset:25344
    v_lshlrev_b32 v191, 16, v19
    v_mfma_f32_16x16x32_bf16 v[156:159], v[80:83], a[68:71], v[156:159]
    ds_read_b64_tr_b16 v[78:79], v2 offset:29568
    s_waitcnt lgkmcnt(8)
    v_mfma_f32_16x16x32_bf16 v[160:163], v[88:91], a[64:67], v[160:163]
    ds_read_b64_tr_b16 v[80:81], v2 offset:16928
    v_lshlrev_b32 v192, 16, v20
    v_mfma_f32_16x16x32_bf16 v[160:163], v[92:95], a[72:75], v[160:163]
    ds_read_b64_tr_b16 v[82:83], v2 offset:21152
    buffer_load_dwordx4 v58, s[52:55], s71 offen offset:2112 lds
    v_mfma_f32_16x16x32_bf16 v[164:167], v[92:95], a[76:79], v[164:167]
    ds_read_b64_tr_b16 v[84:85], v2 offset:25376
    v_pk_fma_f32 v[248:249], v[248:249], v[96:97], v[104:105]
    v_pk_fma_f32 v[250:251], v[250:251], v[98:99], v[106:107]
    v_pk_fma_f32 v[252:253], v[252:253], v[100:101], v[108:109]
    v_pk_fma_f32 v[254:255], v[254:255], v[102:103], v[110:111]
    v_cvt_pk_bf16_f32 v248, v248, v249
    v_cvt_pk_bf16_f32 v249, v250, v251
    v_cvt_pk_bf16_f32 v250, v252, v253
    v_cvt_pk_bf16_f32 v251, v254, v255
    s_add_u32 s81, s81, 4096
    buffer_store_dwordx4 v[248:251], v1, s[48:51], s81 offen offset:0 sc1
    v_mfma_f32_16x16x32_bf16 v[164:167], v[88:91], a[68:71], v[164:167]
    ds_read_b64_tr_b16 v[86:87], v2 offset:29600
    s_waitcnt lgkmcnt(8)
    v_mfma_f32_16x16x32_bf16 v[168:171], v[64:67], a[64:67], v[168:171]
    ds_read_b64_tr_b16 v[88:89], v2 offset:16960
    v_lshlrev_b32 v193, 16, v21
    v_mfma_f32_16x16x32_bf16 v[168:171], v[68:71], a[72:75], v[168:171]
    ds_read_b64_tr_b16 v[90:91], v2 offset:21184
    buffer_load_dwordx4 v59, s[52:55], s71 offen offset:3168 lds
    v_mfma_f32_16x16x32_bf16 v[172:175], v[68:71], a[76:79], v[172:175]
    ds_read_b64_tr_b16 v[92:93], v2 offset:25408
    v_lshlrev_b32 v194, 16, v22
    v_mfma_f32_16x16x32_bf16 v[172:175], v[64:67], a[68:71], v[172:175]
    ds_read_b64_tr_b16 v[94:95], v2 offset:29632
    s_waitcnt lgkmcnt(8)
    v_mfma_f32_16x16x32_bf16 v[112:115], v[72:75], a[80:83], v[112:115]
    ds_read_b64_tr_b16 v[64:65], v2 offset:16992
    s_lshl_b32 s61, s3, 11
    v_mfma_f32_16x16x32_bf16 v[112:115], v[76:79], a[88:91], v[112:115]
    ds_read_b64_tr_b16 v[66:67], v2 offset:21216
    s_add_u32 m0, s61, 135168
    v_mfma_f32_16x16x32_bf16 v[116:119], v[76:79], a[92:95], v[116:119]
    ds_read_b64_tr_b16 v[68:69], v2 offset:25440
    s_mov_b32 s61, 0
    v_mfma_f32_16x16x32_bf16 v[116:119], v[72:75], a[84:87], v[116:119]
    ds_read_b64_tr_b16 v[70:71], v2 offset:29664
    s_waitcnt lgkmcnt(8)
    v_mfma_f32_16x16x32_bf16 v[120:123], v[80:83], a[80:83], v[120:123]
    ds_read_b64_tr_b16 v[72:73], v61 offset:17024
    s_add_u32 s64, s63, s3
    v_mfma_f32_16x16x32_bf16 v[120:123], v[84:87], a[88:91], v[120:123]
    ds_read_b64_tr_b16 v[74:75], v61 offset:21248
    s_cmp_ge_u32 s64, 9
    s_cselect_b32 s65, 9, 0
    s_sub_u32 s64, s64, s65
    v_mfma_f32_16x16x32_bf16 v[124:127], v[84:87], a[92:95], v[124:127]
    ds_read_b64_tr_b16 v[76:77], v61 offset:25472
    s_lshl_b32 s64, s64, 11
    v_mfma_f32_16x16x32_bf16 v[124:127], v[80:83], a[84:87], v[124:127]
    ds_read_b64_tr_b16 v[78:79], v61 offset:29696
    s_waitcnt lgkmcnt(8)
    v_mfma_f32_16x16x32_bf16 v[128:131], v[88:91], a[80:83], v[128:131]
    ds_read_b64_tr_b16 v[80:81], v61 offset:17056
    s_add_u32 s64, s64, s61
    v_mfma_f32_16x16x32_bf16 v[128:131], v[92:95], a[88:91], v[128:131]
    ds_read_b64_tr_b16 v[82:83], v61 offset:21280
    s_add_u32 s64, s64, s66
    v_mfma_f32_16x16x32_bf16 v[132:135], v[92:95], a[92:95], v[132:135]
    ds_read_b64_tr_b16 v[84:85], v61 offset:25504
    s_add_u32 s64, s64, 18432
    v_mfma_f32_16x16x32_bf16 v[132:135], v[88:91], a[84:87], v[132:135]
    ds_read_b64_tr_b16 v[86:87], v61 offset:29728
    s_waitcnt lgkmcnt(8)
    v_mfma_f32_16x16x32_bf16 v[136:139], v[64:67], a[80:83], v[136:139]
    ds_read_b64_tr_b16 v[88:89], v61 offset:17088
    buffer_load_dwordx4 v1, s[48:51], s64 offen offset:0 sc1 lds
    v_mfma_f32_16x16x32_bf16 v[136:139], v[68:71], a[88:91], v[136:139]
    ds_read_b64_tr_b16 v[90:91], v61 offset:21312
    buffer_load_dwordx4 v1, s[48:51], s64 offen offset:1024 sc1 lds
    v_mfma_f32_16x16x32_bf16 v[140:143], v[68:71], a[92:95], v[140:143]
    ds_read_b64_tr_b16 v[92:93], v61 offset:25536
    s_lshl_b32 s61, s3, 11
    v_mfma_f32_16x16x32_bf16 v[140:143], v[64:67], a[84:87], v[140:143]
    ds_read_b64_tr_b16 v[94:95], v61 offset:29760
    s_waitcnt lgkmcnt(8)
    v_mfma_f32_16x16x32_bf16 v[144:147], v[72:75], a[80:83], v[144:147]
    ds_read_b64_tr_b16 v[64:65], v61 offset:17120
    s_add_u32 m0, s61, 143360
    v_mfma_f32_16x16x32_bf16 v[144:147], v[76:79], a[88:91], v[144:147]
    ds_read_b64_tr_b16 v[66:67], v61 offset:21344
    s_mov_b32 s61, 0
    v_mfma_f32_16x16x32_bf16 v[148:151], v[76:79], a[92:95], v[148:151]
    ds_read_b64_tr_b16 v[68:69], v61 offset:25568
    s_add_u32 s64, s63, s3
    v_mfma_f32_16x16x32_bf16 v[148:151], v[72:75], a[84:87], v[148:151]
    ds_read_b64_tr_b16 v[70:71], v61 offset:29792
    s_waitcnt lgkmcnt(8)
    v_mfma_f32_16x16x32_bf16 v[152:155], v[80:83], a[80:83], v[152:155]
    s_waitcnt vmcnt(14)
    s_barrier
    ds_read_b64_tr_b16 v[72:73], v2 offset:33792
    v_mfma_f32_16x16x32_bf16 v[152:155], v[84:87], a[88:91], v[152:155]
    ds_read_b64_tr_b16 v[74:75], v2 offset:38016
    s_add_u32 s64, s64, 4
    v_mfma_f32_16x16x32_bf16 v[156:159], v[84:87], a[92:95], v[156:159]
    ds_read_b64_tr_b16 v[76:77], v2 offset:42240
    s_cmp_ge_u32 s64, 9
    s_cselect_b32 s65, 9, 0
    s_sub_u32 s64, s64, s65
    v_mfma_f32_16x16x32_bf16 v[156:159], v[80:83], a[84:87], v[156:159]
    ds_read_b64_tr_b16 v[78:79], v2 offset:46464
    s_waitcnt lgkmcnt(8)
    v_mfma_f32_16x16x32_bf16 v[160:163], v[88:91], a[80:83], v[160:163]
    ds_read_b64_tr_b16 v[80:81], v2 offset:33824
    s_lshl_b32 s64, s64, 11
    v_mfma_f32_16x16x32_bf16 v[160:163], v[92:95], a[88:91], v[160:163]
    ds_read_b64_tr_b16 v[82:83], v2 offset:38048
    s_add_u32 s64, s64, s61
    v_mfma_f32_16x16x32_bf16 v[164:167], v[92:95], a[92:95], v[164:167]
    ds_read_b64_tr_b16 v[84:85], v2 offset:42272
    s_add_u32 s64, s64, s66
    v_mfma_f32_16x16x32_bf16 v[164:167], v[88:91], a[84:87], v[164:167]
    ds_read_b64_tr_b16 v[86:87], v2 offset:46496
    s_waitcnt lgkmcnt(8)
    v_mfma_f32_16x16x32_bf16 v[168:171], v[64:67], a[80:83], v[168:171]
    ds_read_b64_tr_b16 v[88:89], v2 offset:33856
    s_add_u32 s64, s64, 18432
    v_mfma_f32_16x16x32_bf16 v[168:171], v[68:71], a[88:91], v[168:171]
    ds_read_b64_tr_b16 v[90:91], v2 offset:38080
    buffer_load_dwordx4 v1, s[48:51], s64 offen offset:0 sc1 lds
    v_mfma_f32_16x16x32_bf16 v[172:175], v[68:71], a[92:95], v[172:175]
    ds_read_b64_tr_b16 v[92:93], v2 offset:42304
    buffer_load_dwordx4 v1, s[48:51], s64 offen offset:1024 sc1 lds
    v_mfma_f32_16x16x32_bf16 v[172:175], v[64:67], a[84:87], v[172:175]
    ds_read_b64_tr_b16 v[94:95], v2 offset:46528
    s_waitcnt lgkmcnt(8)
    v_mfma_f32_16x16x32_bf16 v[112:115], v[72:75], a[96:99], v[112:115]
    ds_read_b64_tr_b16 v[64:65], v2 offset:33888
    s_and_b32 s61, s3, 1
    v_mfma_f32_16x16x32_bf16 v[112:115], v[76:79], a[104:107], v[112:115]
    ds_read_b64_tr_b16 v[66:67], v2 offset:38112
    s_lshl_b32 s61, s61, 10
    v_mfma_f32_16x16x32_bf16 v[116:119], v[76:79], a[108:111], v[116:119]
    ds_read_b64_tr_b16 v[68:69], v2 offset:42336
    s_add_u32 m0, s61, 151552
    v_mfma_f32_16x16x32_bf16 v[116:119], v[72:75], a[100:103], v[116:119]
    ds_read_b64_tr_b16 v[70:71], v2 offset:46560
    s_waitcnt lgkmcnt(8)
    v_mfma_f32_16x16x32_bf16 v[120:123], v[80:83], a[96:99], v[120:123]
    ds_read_b64_tr_b16 v[72:73], v61 offset:33920
    s_add_u32 s64, s63, 8
    v_mfma_f32_16x16x32_bf16 v[120:123], v[84:87], a[104:107], v[120:123]
    ds_read_b64_tr_b16 v[74:75], v61 offset:38144
    s_cmp_ge_u32 s64, 9
    s_cselect_b32 s65, 9, 0
    s_sub_u32 s64, s64, s65
    v_mfma_f32_16x16x32_bf16 v[124:127], v[84:87], a[108:111], v[124:127]
    ds_read_b64_tr_b16 v[76:77], v61 offset:42368
    s_lshl_b32 s64, s64, 11
    v_mfma_f32_16x16x32_bf16 v[124:127], v[80:83], a[100:103], v[124:127]
    ds_read_b64_tr_b16 v[78:79], v61 offset:46592
    s_waitcnt lgkmcnt(8)
    v_mfma_f32_16x16x32_bf16 v[128:131], v[88:91], a[96:99], v[128:131]
    ds_read_b64_tr_b16 v[80:81], v61 offset:33952
    s_add_u32 s64, s64, s61
    v_mfma_f32_16x16x32_bf16 v[128:131], v[92:95], a[104:107], v[128:131]
    ds_read_b64_tr_b16 v[82:83], v61 offset:38176
    s_add_u32 s64, s64, s66
    v_mfma_f32_16x16x32_bf16 v[132:135], v[92:95], a[108:111], v[132:135]
    ds_read_b64_tr_b16 v[84:85], v61 offset:42400
    s_add_u32 s64, s64, 18432
    v_mfma_f32_16x16x32_bf16 v[132:135], v[88:91], a[100:103], v[132:135]
    ds_read_b64_tr_b16 v[86:87], v61 offset:46624
    s_waitcnt lgkmcnt(8)
    v_mfma_f32_16x16x32_bf16 v[136:139], v[64:67], a[96:99], v[136:139]
    ds_read_b64_tr_b16 v[88:89], v61 offset:33984
    buffer_load_dwordx4 v1, s[48:51], s64 offen offset:0 sc1 lds
    v_mfma_f32_16x16x32_bf16 v[136:139], v[68:71], a[104:107], v[136:139]
    ds_read_b64_tr_b16 v[90:91], v61 offset:38208
    s_bfe_u32 s67, s89, 0x30008
    v_mfma_f32_16x16x32_bf16 v[140:143], v[68:71], a[108:111], v[140:143]
    ds_read_b64_tr_b16 v[92:93], v61 offset:42432
    s_lshl_b32 s67, s67, 7
    v_mfma_f32_16x16x32_bf16 v[140:143], v[64:67], a[100:103], v[140:143]
    ds_read_b64_tr_b16 v[94:95], v61 offset:46656
    s_waitcnt lgkmcnt(8)
    v_mfma_f32_16x16x32_bf16 v[144:147], v[72:75], a[96:99], v[144:147]
    ds_read_b64_tr_b16 v[64:65], v61 offset:34016
    s_add_u32 m0, s74, 0
    v_mfma_f32_16x16x32_bf16 v[144:147], v[76:79], a[104:107], v[144:147]
    ds_read_b64_tr_b16 v[66:67], v61 offset:38240
    s_add_u32 s67, s67, s85
    v_mfma_f32_16x16x32_bf16 v[148:151], v[76:79], a[108:111], v[148:151]
    ds_read_b64_tr_b16 v[68:69], v61 offset:42464
    buffer_load_dwordx4 v46, s[40:43], s67 offen offset:0 lds
    v_mfma_f32_16x16x32_bf16 v[148:151], v[72:75], a[100:103], v[148:151]
    ds_read_b64_tr_b16 v[70:71], v61 offset:46688
    s_waitcnt lgkmcnt(8)
    v_add_u32 v2, 0xc600, v2
    v_add_u32 v61, 0xc600, v61
    v_mfma_f32_16x16x32_bf16 v[152:155], v[80:83], a[96:99], v[152:155]
    s_waitcnt vmcnt(12)
    s_barrier
    ds_read_b64_tr_b16 v[72:73], v2 offset:0
    v_mfma_f32_16x16x32_bf16 v[152:155], v[84:87], a[104:107], v[152:155]
    ds_read_b64_tr_b16 v[74:75], v2 offset:4224
    buffer_load_dwordx4 v47, s[40:43], s67 offen offset:1024 lds
    v_mfma_f32_16x16x32_bf16 v[156:159], v[84:87], a[108:111], v[156:159]
    ds_read_b64_tr_b16 v[76:77], v2 offset:8448
    v_lshlrev_b32 v195, 16, v23
    v_mfma_f32_16x16x32_bf16 v[156:159], v[80:83], a[100:103], v[156:159]
    ds_read_b64_tr_b16 v[78:79], v2 offset:12672
    s_waitcnt lgkmcnt(8)
    v_mfma_f32_16x16x32_bf16 v[160:163], v[88:91], a[96:99], v[160:163]
    ds_read_b64_tr_b16 v[80:81], v2 offset:32
    buffer_load_dwordx4 v48, s[40:43], s67 offen offset:2048 lds
    v_mfma_f32_16x16x32_bf16 v[160:163], v[92:95], a[104:107], v[160:163]
    ds_read_b64_tr_b16 v[82:83], v2 offset:4256
    v_lshlrev_b32 v196, 16, v24
    v_mfma_f32_16x16x32_bf16 v[164:167], v[92:95], a[108:111], v[164:167]
    ds_read_b64_tr_b16 v[84:85], v2 offset:8480
    v_lshlrev_b32 v197, 16, v25
    v_mfma_f32_16x16x32_bf16 v[164:167], v[88:91], a[100:103], v[164:167]
    ds_read_b64_tr_b16 v[86:87], v2 offset:12704
    s_waitcnt lgkmcnt(8)
    v_mfma_f32_16x16x32_bf16 v[168:171], v[64:67], a[96:99], v[168:171]
    ds_read_b64_tr_b16 v[88:89], v2 offset:64
    buffer_load_dwordx4 v49, s[40:43], s67 offen offset:3072 lds
    v_mfma_f32_16x16x32_bf16 v[168:171], v[68:71], a[104:107], v[168:171]
    ds_read_b64_tr_b16 v[90:91], v2 offset:4288
    v_lshlrev_b32 v198, 16, v26
    v_mfma_f32_16x16x32_bf16 v[172:175], v[68:71], a[108:111], v[172:175]
    ds_read_b64_tr_b16 v[92:93], v2 offset:8512
    v_mul_f32 v200, v188, v187
    v_mfma_f32_16x16x32_bf16 v[172:175], v[64:67], a[100:103], v[172:175]
    ds_read_b64_tr_b16 v[94:95], v2 offset:12736
    s_waitcnt lgkmcnt(8)
    v_mfma_f32_16x16x32_bf16 v[112:115], v[72:75], a[112:115], v[112:115]
    ds_read_b64_tr_b16 v[64:65], v2 offset:96
    s_bfe_u32 s67, s89, 0x30000
    v_mfma_f32_16x16x32_bf16 v[112:115], v[76:79], a[120:123], v[112:115]
    ds_read_b64_tr_b16 v[66:67], v2 offset:4320
    s_lshl_b32 s67, s67, 7
    v_mfma_f32_16x16x32_bf16 v[116:119], v[76:79], a[124:127], v[116:119]
    ds_read_b64_tr_b16 v[68:69], v2 offset:8544
    s_add_u32 m0, s74, 16384
    v_mfma_f32_16x16x32_bf16 v[116:119], v[72:75], a[116:119], v[116:119]
    ds_read_b64_tr_b16 v[70:71], v2 offset:12768
    s_waitcnt lgkmcnt(8)
    v_mfma_f32_16x16x32_bf16 v[120:123], v[80:83], a[112:115], v[120:123]
    ds_read_b64_tr_b16 v[72:73], v61 offset:128
    s_add_u32 s67, s67, s84
    v_mfma_f32_16x16x32_bf16 v[120:123], v[84:87], a[120:123], v[120:123]
    ds_read_b64_tr_b16 v[74:75], v61 offset:4352
    buffer_load_dwordx4 v46, s[40:43], s67 offen offset:0 lds
    v_mfma_f32_16x16x32_bf16 v[124:127], v[84:87], a[124:127], v[124:127]
    ds_read_b64_tr_b16 v[76:77], v61 offset:8576
    v_mul_f32 v201, v189, v187
    v_mfma_f32_16x16x32_bf16 v[124:127], v[80:83], a[116:119], v[124:127]
    ds_read_b64_tr_b16 v[78:79], v61 offset:12800
    s_waitcnt lgkmcnt(8)
    v_mfma_f32_16x16x32_bf16 v[128:131], v[88:91], a[112:115], v[128:131]
    ds_read_b64_tr_b16 v[80:81], v61 offset:160
    buffer_load_dwordx4 v47, s[40:43], s67 offen offset:1024 lds
    v_mfma_f32_16x16x32_bf16 v[128:131], v[92:95], a[120:123], v[128:131]
    ds_read_b64_tr_b16 v[82:83], v61 offset:4384
    v_mul_f32 v202, v190, v187
    v_mfma_f32_16x16x32_bf16 v[132:135], v[92:95], a[124:127], v[132:135]
    ds_read_b64_tr_b16 v[84:85], v61 offset:8608
    v_mul_f32 v203, v191, v187
    v_mfma_f32_16x16x32_bf16 v[132:135], v[88:91], a[116:119], v[132:135]
    ds_read_b64_tr_b16 v[86:87], v61 offset:12832
    s_waitcnt lgkmcnt(8)
    v_mfma_f32_16x16x32_bf16 v[136:139], v[64:67], a[112:115], v[136:139]
    ds_read_b64_tr_b16 v[88:89], v61 offset:192
    buffer_load_dwordx4 v48, s[40:43], s67 offen offset:2048 lds
    v_mfma_f32_16x16x32_bf16 v[136:139], v[68:71], a[120:123], v[136:139]
    ds_read_b64_tr_b16 v[90:91], v61 offset:4416
    v_mul_f32 v204, v192, v187
    v_mfma_f32_16x16x32_bf16 v[140:143], v[68:71], a[124:127], v[140:143]
    ds_read_b64_tr_b16 v[92:93], v61 offset:8640
    v_mul_f32 v205, v193, v187
    v_mfma_f32_16x16x32_bf16 v[140:143], v[64:67], a[116:119], v[140:143]
    ds_read_b64_tr_b16 v[94:95], v61 offset:12864
    s_waitcnt lgkmcnt(8)
    v_mfma_f32_16x16x32_bf16 v[144:147], v[72:75], a[112:115], v[144:147]
    ds_read_b64_tr_b16 v[64:65], v61 offset:224
    v_mul_f32 v206, v194, v187
    v_mfma_f32_16x16x32_bf16 v[144:147], v[76:79], a[120:123], v[144:147]
    ds_read_b64_tr_b16 v[66:67], v61 offset:4448
    v_mul_f32 v207, v195, v187
    v_mfma_f32_16x16x32_bf16 v[148:151], v[76:79], a[124:127], v[148:151]
    ds_read_b64_tr_b16 v[68:69], v61 offset:8672
    buffer_load_dwordx4 v49, s[40:43], s67 offen offset:3072 lds
    v_mfma_f32_16x16x32_bf16 v[148:151], v[72:75], a[116:119], v[148:151]
    ds_read_b64_tr_b16 v[70:71], v61 offset:12896
    s_waitcnt lgkmcnt(8)
    v_mfma_f32_16x16x32_bf16 v[152:155], v[80:83], a[112:115], v[152:155]
    s_waitcnt vmcnt(13)
    s_barrier
    ds_read_b64_tr_b16 v[72:73], v2 offset:16896
    v_mfma_f32_16x16x32_bf16 v[152:155], v[84:87], a[120:123], v[152:155]
    ds_read_b64_tr_b16 v[74:75], v2 offset:21120
    s_bfe_u32 s67, s89, 0x30000
    v_mfma_f32_16x16x32_bf16 v[156:159], v[84:87], a[124:127], v[156:159]
    ds_read_b64_tr_b16 v[76:77], v2 offset:25344
    s_lshl_b32 s67, s67, 7
    v_mfma_f32_16x16x32_bf16 v[156:159], v[80:83], a[116:119], v[156:159]
    ds_read_b64_tr_b16 v[78:79], v2 offset:29568
    s_waitcnt lgkmcnt(8)
    v_mfma_f32_16x16x32_bf16 v[160:163], v[88:91], a[112:115], v[160:163]
    ds_read_b64_tr_b16 v[80:81], v2 offset:16928
    s_add_u32 m0, s74, 32768
    v_mfma_f32_16x16x32_bf16 v[160:163], v[92:95], a[120:123], v[160:163]
    ds_read_b64_tr_b16 v[82:83], v2 offset:21152
    s_add_u32 s67, s67, s85
    v_mfma_f32_16x16x32_bf16 v[164:167], v[92:95], a[124:127], v[164:167]
    ds_read_b64_tr_b16 v[84:85], v2 offset:25376
    buffer_load_dwordx4 v46, s[40:43], s67 offen offset:0 lds
    v_mfma_f32_16x16x32_bf16 v[164:167], v[88:91], a[116:119], v[164:167]
    ds_read_b64_tr_b16 v[86:87], v2 offset:29600
    s_waitcnt lgkmcnt(8)
    v_mfma_f32_16x16x32_bf16 v[168:171], v[64:67], a[112:115], v[168:171]
    ds_read_b64_tr_b16 v[88:89], v2 offset:16960
    buffer_load_dwordx4 v47, s[40:43], s67 offen offset:1024 lds
    v_mfma_f32_16x16x32_bf16 v[168:171], v[68:71], a[120:123], v[168:171]
    ds_read_b64_tr_b16 v[90:91], v2 offset:21184
    v_fmac_f32 v200, v189, v186
    v_mfma_f32_16x16x32_bf16 v[172:175], v[68:71], a[124:127], v[172:175]
    ds_read_b64_tr_b16 v[92:93], v2 offset:25408
    v_fmac_f32 v201, v190, v186
    v_mfma_f32_16x16x32_bf16 v[172:175], v[64:67], a[116:119], v[172:175]
    ds_read_b64_tr_b16 v[94:95], v2 offset:29632
    s_waitcnt lgkmcnt(8)
    v_mfma_f32_16x16x32_bf16 v[112:115], v[72:75], a[128:131], v[112:115]
    ds_read_b64_tr_b16 v[64:65], v2 offset:16992
    v_fmac_f32 v202, v191, v186
    v_mfma_f32_16x16x32_bf16 v[112:115], v[76:79], a[136:139], v[112:115]
    ds_read_b64_tr_b16 v[66:67], v2 offset:21216
    v_fmac_f32 v203, v192, v186
    v_mfma_f32_16x16x32_bf16 v[116:119], v[76:79], a[140:143], v[116:119]
    ds_read_b64_tr_b16 v[68:69], v2 offset:25440
    buffer_load_dwordx4 v48, s[40:43], s67 offen offset:2048 lds
    v_mfma_f32_16x16x32_bf16 v[116:119], v[72:75], a[132:135], v[116:119]
    ds_read_b64_tr_b16 v[70:71], v2 offset:29664
    s_waitcnt lgkmcnt(8)
    v_mfma_f32_16x16x32_bf16 v[120:123], v[80:83], a[128:131], v[120:123]
    ds_read_b64_tr_b16 v[72:73], v61 offset:17024
    v_fmac_f32 v204, v193, v186
    v_mfma_f32_16x16x32_bf16 v[120:123], v[84:87], a[136:139], v[120:123]
    ds_read_b64_tr_b16 v[74:75], v61 offset:21248
    v_fmac_f32 v205, v194, v186
    v_mfma_f32_16x16x32_bf16 v[124:127], v[84:87], a[140:143], v[124:127]
    ds_read_b64_tr_b16 v[76:77], v61 offset:25472
    v_fmac_f32 v206, v195, v186
    v_mfma_f32_16x16x32_bf16 v[124:127], v[80:83], a[132:135], v[124:127]
    ds_read_b64_tr_b16 v[78:79], v61 offset:29696
    s_waitcnt lgkmcnt(8)
    v_mfma_f32_16x16x32_bf16 v[128:131], v[88:91], a[128:131], v[128:131]
    ds_read_b64_tr_b16 v[80:81], v61 offset:17056
    buffer_load_dwordx4 v49, s[40:43], s67 offen offset:3072 lds
    v_mfma_f32_16x16x32_bf16 v[128:131], v[92:95], a[136:139], v[128:131]
    ds_read_b64_tr_b16 v[82:83], v61 offset:21280
    s_barrier
    s_cmp_lg_u32 s3, 0
    s_cbranch_scc1 KM_nz
    v_mov_b32 v8, s95
    v_mul_u32_u24 v9, 8448, v0
    s_mov_b64 exec, 0xffff
    buffer_store_dword v8, v9, s[48:51], s82 offen sc1
    s_mov_b64 exec, -1
KM_nz:
    v_mfma_f32_16x16x32_bf16 v[132:135], v[92:95], a[140:143], v[132:135]
    ds_read_b64_tr_b16 v[84:85], v61 offset:25504
    s_bfe_u32 s67, s89, 0x30000
    v_mfma_f32_16x16x32_bf16 v[132:135], v[88:91], a[132:135], v[132:135]
    ds_read_b64_tr_b16 v[86:87], v61 offset:29728
    s_waitcnt lgkmcnt(8)
    v_mfma_f32_16x16x32_bf16 v[136:139], v[64:67], a[128:131], v[136:139]
    ds_read_b64_tr_b16 v[88:89], v61 offset:17088
    s_lshl_b32 s67, s67, 7
    v_mfma_f32_16x16x32_bf16 v[136:139], v[68:71], a[136:139], v[136:139]
    ds_read_b64_tr_b16 v[90:91], v61 offset:21312
    s_add_u32 m0, s74, 49152
    v_mfma_f32_16x16x32_bf16 v[140:143], v[68:71], a[140:143], v[140:143]
    ds_read_b64_tr_b16 v[92:93], v61 offset:25536
    s_add_u32 s67, s67, s86
    v_mfma_f32_16x16x32_bf16 v[140:143], v[64:67], a[132:135], v[140:143]
    ds_read_b64_tr_b16 v[94:95], v61 offset:29760
    s_waitcnt lgkmcnt(8)
    v_mfma_f32_16x16x32_bf16 v[144:147], v[72:75], a[128:131], v[144:147]
    ds_read_b64_tr_b16 v[64:65], v61 offset:17120
    buffer_load_dwordx4 v46, s[40:43], s67 offen offset:0 lds
    v_mfma_f32_16x16x32_bf16 v[144:147], v[76:79], a[136:139], v[144:147]
    ds_read_b64_tr_b16 v[66:67], v61 offset:21344
    buffer_load_dwordx4 v47, s[40:43], s67 offen offset:1024 lds
    v_mfma_f32_16x16x32_bf16 v[148:151], v[76:79], a[140:143], v[148:151]
    ds_read_b64_tr_b16 v[68:69], v61 offset:25568
    v_fmac_f32 v207, v196, v186
    v_mfma_f32_16x16x32_bf16 v[148:151], v[72:75], a[132:135], v[148:151]
    ds_read_b64_tr_b16 v[70:71], v61 offset:29792
    s_waitcnt lgkmcnt(8)
    v_mfma_f32_16x16x32_bf16 v[152:155], v[80:83], a[128:131], v[152:155]
    s_waitcnt vmcnt(14)
    s_barrier
    ds_read_b128 v[72:75], v60 offset:0
    v_mfma_f32_16x16x32_bf16 v[152:155], v[84:87], a[136:139], v[152:155]
    v_fmac_f32 v200, v190, v185
    v_fmac_f32 v201, v191, v185
    v_mfma_f32_16x16x32_bf16 v[156:159], v[84:87], a[140:143], v[156:159]
    ds_read_b128 v[76:79], v60 offset:1024
    v_fmac_f32 v202, v192, v185
    v_mfma_f32_16x16x32_bf16 v[156:159], v[80:83], a[132:135], v[156:159]
    s_waitcnt lgkmcnt(6)
    buffer_load_dwordx4 v48, s[40:43], s67 offen offset:2048 lds
    v_mfma_f32_16x16x32_bf16 v[160:163], v[88:91], a[128:131], v[160:163]
    ds_read_b128 v[80:83], v60 offset:2048
    v_fmac_f32 v203, v193, v185
    v_mfma_f32_16x16x32_bf16 v[160:163], v[92:95], a[136:139], v[160:163]
    v_fmac_f32 v204, v194, v185
    v_fmac_f32 v205, v195, v185
    v_mfma_f32_16x16x32_bf16 v[164:167], v[92:95], a[140:143], v[164:167]
    ds_read_b128 v[84:87], v60 offset:3072
    v_fmac_f32 v206, v196, v185
    v_mfma_f32_16x16x32_bf16 v[164:167], v[88:91], a[132:135], v[164:167]
    s_waitcnt lgkmcnt(4)
    v_fmac_f32 v207, v197, v185
    v_fmac_f32 v200, v191, v184
    v_mfma_f32_16x16x32_bf16 v[168:171], v[64:67], a[128:131], v[168:171]
    ds_read_b128 v[88:91], v60 offset:4096
    buffer_load_dwordx4 v49, s[40:43], s67 offen offset:3072 lds
    v_mfma_f32_16x16x32_bf16 v[168:171], v[68:71], a[136:139], v[168:171]
    v_fmac_f32 v201, v192, v184
    v_fmac_f32 v202, v193, v184
    v_mfma_f32_16x16x32_bf16 v[172:175], v[68:71], a[140:143], v[172:175]
    ds_read_b128 v[92:95], v60 offset:5120
    v_fmac_f32 v203, v194, v184
    v_mfma_f32_16x16x32_bf16 v[172:175], v[64:67], a[132:135], v[172:175]
    s_waitcnt lgkmcnt(4)
    s_bfe_u32 s67, s89, 0x30000
    s_lshl_b32 s67, s67, 7
    v_mfma_f32_16x16x32_bf16 v[176:179], v[72:75], a[0:3], 0
    ds_read_b128 v[64:67], v60 offset:6144
    s_add_u32 m0, s74, 65536
    v_mfma_f32_16x16x32_bf16 v[176:179], v[76:79], a[8:11], v[176:179]
    s_add_u32 s67, s67, s87
    v_fmac_f32 v204, v195, v184
    v_fmac_f32 v205, v196, v184
    v_mfma_f32_16x16x32_bf16 v[180:183], v[72:75], a[4:7], 0
    ds_read_b128 v[68:71], v60 offset:7168
    buffer_load_dwordx4 v46, s[40:43], s67 offen offset:0 lds
    v_mfma_f32_16x16x32_bf16 v[180:183], v[76:79], a[12:15], v[180:183]
    s_waitcnt lgkmcnt(4)
    v_fmac_f32 v206, v197, v184
    v_fmac_f32 v207, v198, v184
    v_mfma_f32_16x16x32_bf16 v[176:179], v[80:83], a[16:19], v[176:179]
    ds_read_b128 v[72:75], v60 offset:8192
    v_lshlrev_b32 v188, 16, v28
    v_mfma_f32_16x16x32_bf16 v[176:179], v[84:87], a[24:27], v[176:179]
    v_lshlrev_b32 v189, 16, v29
    v_lshlrev_b32 v190, 16, v30
    v_mfma_f32_16x16x32_bf16 v[180:183], v[84:87], a[28:31], v[180:183]
    ds_read_b128 v[76:79], v60 offset:9216
    v_lshlrev_b32 v191, 16, v31
    v_mfma_f32_16x16x32_bf16 v[180:183], v[80:83], a[20:23], v[180:183]
    s_waitcnt lgkmcnt(4)
    buffer_load_dwordx4 v47, s[40:43], s67 offen offset:1024 lds
    v_mfma_f32_16x16x32_bf16 v[176:179], v[88:91], a[32:35], v[176:179]
    ds_read_b128 v[80:83], v60 offset:10240
    v_lshlrev_b32 v192, 16, v32
    v_mfma_f32_16x16x32_bf16 v[176:179], v[92:95], a[40:43], v[176:179]
    v_lshlrev_b32 v193, 16, v33
    v_lshlrev_b32 v194, 16, v34
    v_mfma_f32_16x16x32_bf16 v[180:183], v[92:95], a[44:47], v[180:183]
    ds_read_b128 v[84:87], v60 offset:11264
    v_lshlrev_b32 v195, 16, v35
    v_mfma_f32_16x16x32_bf16 v[180:183], v[88:91], a[36:39], v[180:183]
    s_waitcnt lgkmcnt(4)
    v_mul_f32 v200, v200, v188
    v_mul_f32 v201, v201, v189
    v_mfma_f32_16x16x32_bf16 v[176:179], v[64:67], a[48:51], v[176:179]
    ds_read_b128 v[88:91], v60 offset:12288
    buffer_load_dwordx4 v48, s[40:43], s67 offen offset:2048 lds
    v_mfma_f32_16x16x32_bf16 v[176:179], v[68:71], a[56:59], v[176:179]
    v_mul_f32 v202, v202, v190
    v_mul_f32 v203, v203, v191
    v_mfma_f32_16x16x32_bf16 v[180:183], v[68:71], a[60:63], v[180:183]
    ds_read_b128 v[92:95], v60 offset:13312
    v_mul_f32 v204, v204, v192
    v_mfma_f32_16x16x32_bf16 v[180:183], v[64:67], a[52:55], v[180:183]
    s_waitcnt lgkmcnt(4)
    v_mul_f32 v205, v205, v193
    v_mul_f32 v206, v206, v194
    v_mfma_f32_16x16x32_bf16 v[176:179], v[72:75], a[64:67], v[176:179]
    ds_read_b128 v[64:67], v60 offset:14336
    v_mul_f32 v207, v207, v195
    v_mfma_f32_16x16x32_bf16 v[176:179], v[76:79], a[72:75], v[176:179]
    buffer_load_dwordx4 v49, s[40:43], s67 offen offset:3072 lds
    v_cvt_pk_bf16_f32 v208, v207, v206
    v_mfma_f32_16x16x32_bf16 v[180:183], v[76:79], a[76:79], v[180:183]
    ds_read_b128 v[68:71], v60 offset:15360
    v_cvt_pk_bf16_f32 v209, v205, v204
    v_mfma_f32_16x16x32_bf16 v[180:183], v[72:75], a[68:71], v[180:183]
    s_waitcnt lgkmcnt(4)
    v_cvt_pk_bf16_f32 v210, v203, v202
    v_cvt_pk_bf16_f32 v211, v201, v200
    v_mfma_f32_16x16x32_bf16 v[176:179], v[80:83], a[80:83], v[176:179]
    ds_read_b128 v[72:75], v60 offset:16384
    v_lshlrev_b32 v184, 16, v38
    v_mfma_f32_16x16x32_bf16 v[176:179], v[84:87], a[88:91], v[176:179]
    s_bfe_u32 s67, s89, 0x30004
    s_lshl_b32 s67, s67, 7
    s_add_u32 m0, s74, 81920
    v_mfma_f32_16x16x32_bf16 v[180:183], v[84:87], a[92:95], v[180:183]
    ds_read_b128 v[76:79], v60 offset:17408
    s_add_u32 s67, s67, s84
    v_mfma_f32_16x16x32_bf16 v[180:183], v[80:83], a[84:87], v[180:183]
    s_waitcnt lgkmcnt(4)
    buffer_load_dwordx4 v46, s[40:43], s67 offen offset:0 lds
    v_mfma_f32_16x16x32_bf16 v[176:179], v[88:91], a[96:99], v[176:179]
    v_and_b32 v185, 0xffff0000, v38
    v_lshlrev_b32 v186, 16, v39
    v_mfma_f32_16x16x32_bf16 v[176:179], v[92:95], a[104:107], v[176:179]
    v_and_b32 v187, 0xffff0000, v39
    v_and_b32 v188, 0xffff0000, v16
    v_mfma_f32_16x16x32_bf16 v[180:183], v[92:95], a[108:111], v[180:183]
    v_and_b32 v189, 0xffff0000, v17
    v_and_b32 v190, 0xffff0000, v18
    v_mfma_f32_16x16x32_bf16 v[180:183], v[88:91], a[100:103], v[180:183]
    s_waitcnt lgkmcnt(2)
    v_and_b32 v191, 0xffff0000, v19
    v_and_b32 v192, 0xffff0000, v20
    v_mfma_f32_16x16x32_bf16 v[176:179], v[64:67], a[112:115], v[176:179]
    buffer_load_dwordx4 v47, s[40:43], s67 offen offset:1024 lds
    v_and_b32 v193, 0xffff0000, v21
    v_mfma_f32_16x16x32_bf16 v[176:179], v[68:71], a[120:123], v[176:179]
    v_and_b32 v194, 0xffff0000, v22
    v_and_b32 v195, 0xffff0000, v23
    v_mfma_f32_16x16x32_bf16 v[180:183], v[68:71], a[124:127], v[180:183]
    v_and_b32 v196, 0xffff0000, v24
    v_and_b32 v197, 0xffff0000, v25
    v_mfma_f32_16x16x32_bf16 v[180:183], v[64:67], a[116:119], v[180:183]
    s_waitcnt lgkmcnt(0)
    v_and_b32 v198, 0xffff0000, v26
    v_mul_f32 v200, v188, v187
    v_mfma_f32_16x16x32_bf16 v[176:179], v[72:75], a[128:131], v[176:179]
    v_mul_f32 v201, v189, v187
    v_mul_f32 v202, v190, v187
    v_mfma_f32_16x16x32_bf16 v[176:179], v[76:79], a[136:139], v[176:179]
    buffer_load_dwordx4 v48, s[40:43], s67 offen offset:2048 lds
    v_mul_f32 v203, v191, v187
    v_mfma_f32_16x16x32_bf16 v[180:183], v[76:79], a[140:143], v[180:183]
    v_mul_f32 v204, v192, v187
    v_mul_f32 v205, v193, v187
    v_mfma_f32_16x16x32_bf16 v[180:183], v[72:75], a[132:135], v[180:183]
    v_mul_f32 v206, v194, v187
    v_mul_f32 v207, v195, v187
    s_barrier
    v_add_u32 v62, 4096, v1
    v_add_u32 v63, 8192, v1
    s_load_dwordx4 s[16:19], s[48:49], s78 glc
    v_fmac_f32 v200, v189, v186
    v_fmac_f32 v201, v190, v186
    v_fmac_f32 v202, v191, v186
    v_fmac_f32 v203, v192, v186
    v_fmac_f32 v204, v193, v186
    v_fmac_f32 v205, v194, v186
    v_fmac_f32 v206, v195, v186
    v_fmac_f32 v207, v196, v186
    v_fmac_f32 v200, v190, v185
    v_fmac_f32 v201, v191, v185
    v_fmac_f32 v202, v192, v185
    v_fmac_f32 v203, v193, v185
    buffer_load_dwordx4 v49, s[40:43], s67 offen offset:3072 lds
    v_fmac_f32 v204, v194, v185
    v_fmac_f32 v205, v195, v185
    v_fmac_f32 v206, v196, v185
    v_fmac_f32 v207, v197, v185
    v_fmac_f32 v200, v191, v184
    v_fmac_f32 v201, v192, v184
    v_fmac_f32 v202, v193, v184
    v_fmac_f32 v203, v194, v184
    v_fmac_f32 v204, v195, v184
    v_fmac_f32 v205, v196, v184
    v_fmac_f32 v206, v197, v184
    v_fmac_f32 v207, v198, v184
    v_and_b32 v188, 0xffff0000, v28
    v_and_b32 v189, 0xffff0000, v29
    v_and_b32 v190, 0xffff0000, v30
    v_and_b32 v191, 0xffff0000, v31
    v_and_b32 v192, 0xffff0000, v32
    v_and_b32 v193, 0xffff0000, v33
    v_and_b32 v194, 0xffff0000, v34
    v_and_b32 v195, 0xffff0000, v35
    s_bfe_u32 s67, s89, 0x30004
    s_lshl_b32 s67, s67, 7
    s_add_u32 m0, s74, 98304
    s_add_u32 s67, s67, s85
    buffer_load_dwordx4 v46, s[40:43], s67 offen offset:0 lds
    v_mul_f32 v200, v200, v188
    v_mul_f32 v201, v201, v189
    v_mul_f32 v202, v202, v190
    v_mul_f32 v203, v203, v191
    v_mul_f32 v204, v204, v192
    v_mul_f32 v205, v205, v193
    v_mul_f32 v206, v206, v194
    v_mul_f32 v207, v207, v195
    v_cvt_pk_bf16_f32 v212, v207, v206
    v_cvt_pk_bf16_f32 v213, v205, v204
    v_cvt_pk_bf16_f32 v214, v203, v202
    v_cvt_pk_bf16_f32 v215, v201, v200
    v_lshrrev_b32 v40, 2, v3
    v_lshlrev_b32 v40, 14, v40
    v_and_b32 v41, 3, v3
    v_lshl_add_u32 v40, v41, 4, v40
    s_lshl_b32 s68, s2, 6
    s_add_u32 s68, s68, 0x280000
    s_add_u32 s69, s68, 1179648
    buffer_store_dwordx4 v[208:211], v40, s[48:51], s68 offen sc1
    buffer_store_dwordx4 v[212:215], v40, s[48:51], s69 offen sc1
    v_mov_b32 v4, 0xbdd2d3e8
    v_mov_b32 v6, 0xc0135761
    v_mov_b32 v5, 0xbdd2d3e8
    v_mov_b32 v7, 0xc0135761
    s_branch KM_zf_chk
KM_zf_poll:
    s_load_dwordx4 s[16:19], s[48:49], s78 glc
KM_zf_chk:
    s_sub_u32 s94, s94, 1
    s_cmp_lt_i32 s94, 1
    s_waitcnt lgkmcnt(0)
    s_cbranch_scc1 KM_zf_done
    s_cmp_lg_u32 s16, s95
    s_cbranch_scc1 KM_zf_poll
    s_cmp_lg_u32 s17, s95
    s_cbranch_scc1 KM_zf_poll
    s_cmp_lg_u32 s18, s95
    s_cbranch_scc1 KM_zf_poll
    s_cmp_lg_u32 s19, s95
    s_cbranch_scc1 KM_zf_poll
KM_zf_done:
    v_pk_mul_f32 v[184:185], v[112:113], v[112:113]
    v_pk_mul_f32 v[186:187], v[114:115], v[114:115]
    v_pk_mul_f32 v[188:189], v[116:117], v[116:117]
    s_bfe_u32 s73, s89, 0x30000
    s_mul_i32 s73, s73, 294912
    s_add_u32 s73, s73, s88
    buffer_load_dwordx4 a[108:111], v1, s[48:51], s73 offen offset:0 sc1
    v_pk_mul_f32 v[190:191], v[118:119], v[118:119]
    v_pk_mul_f32 v[192:193], v[120:121], v[120:121]
    v_pk_mul_f32 v[194:195], v[122:123], v[122:123]
    v_pk_mul_f32 v[196:197], v[124:125], v[124:125]
    v_pk_mul_f32 v[198:199], v[126:127], v[126:127]
    v_pk_mul_f32 v[200:201], v[128:129], v[128:129]
    v_pk_mul_f32 v[202:203], v[130:131], v[130:131]
    v_pk_mul_f32 v[204:205], v[132:133], v[132:133]
    v_pk_mul_f32 v[206:207], v[134:135], v[134:135]
    v_pk_fma_f32 v[184:185], v[184:185], v[4:5], v[6:7]
    v_pk_fma_f32 v[186:187], v[186:187], v[4:5], v[6:7]
    v_pk_fma_f32 v[188:189], v[188:189], v[4:5], v[6:7]
    v_pk_fma_f32 v[190:191], v[190:191], v[4:5], v[6:7]
    v_pk_fma_f32 v[192:193], v[192:193], v[4:5], v[6:7]
    v_pk_fma_f32 v[194:195], v[194:195], v[4:5], v[6:7]
    v_pk_fma_f32 v[196:197], v[196:197], v[4:5], v[6:7]
    v_pk_fma_f32 v[198:199], v[198:199], v[4:5], v[6:7]
    v_pk_fma_f32 v[200:201], v[200:201], v[4:5], v[6:7]
    v_pk_fma_f32 v[202:203], v[202:203], v[4:5], v[6:7]
    buffer_load_dwordx4 a[112:115], v1, s[48:51], s73 offen offset:1024 sc1
    v_pk_fma_f32 v[204:205], v[204:205], v[4:5], v[6:7]
    v_pk_fma_f32 v[206:207], v[206:207], v[4:5], v[6:7]
    v_pk_mul_f32 v[184:185], v[112:113], v[184:185]
    v_pk_mul_f32 v[186:187], v[114:115], v[186:187]
    v_pk_mul_f32 v[188:189], v[116:117], v[188:189]
    v_pk_mul_f32 v[190:191], v[118:119], v[190:191]
    v_pk_mul_f32 v[192:193], v[120:121], v[192:193]
    v_pk_mul_f32 v[194:195], v[122:123], v[194:195]
    v_pk_mul_f32 v[196:197], v[124:125], v[196:197]
    v_pk_mul_f32 v[198:199], v[126:127], v[198:199]
    v_pk_mul_f32 v[200:201], v[128:129], v[200:201]
    v_pk_mul_f32 v[202:203], v[130:131], v[202:203]
    v_pk_mul_f32 v[204:205], v[132:133], v[204:205]
    v_pk_mul_f32 v[206:207], v[134:135], v[206:207]
    v_exp_f32 v184, v184
    v_exp_f32 v185, v185
    v_exp_f32 v186, v186
    buffer_load_dwordx4 a[116:119], v1, s[48:51], s73 offen offset:2048 sc1
    v_exp_f32 v187, v187
    v_exp_f32 v188, v188
    v_exp_f32 v189, v189
    v_exp_f32 v190, v190
    v_exp_f32 v191, v191
    v_exp_f32 v192, v192
    v_exp_f32 v193, v193
    v_exp_f32 v194, v194
    v_exp_f32 v195, v195
    v_exp_f32 v196, v196
    buffer_load_dwordx4 a[120:123], v1, s[48:51], s73 offen offset:3072 sc1
    v_exp_f32 v197, v197
    v_exp_f32 v198, v198
    v_exp_f32 v199, v199
    v_exp_f32 v200, v200
    v_exp_f32 v201, v201
    v_exp_f32 v202, v202
    v_exp_f32 v203, v203
    v_exp_f32 v204, v204
    v_exp_f32 v205, v205
    buffer_load_dwordx4 a[124:127], v62, s[48:51], s73 offen offset:0 sc1
    v_exp_f32 v206, v206
    v_exp_f32 v207, v207
    v_pk_add_f32 v[184:185], v[184:185], v[12:13]
    v_pk_add_f32 v[186:187], v[186:187], v[12:13]
    v_pk_add_f32 v[188:189], v[188:189], v[12:13]
    v_pk_add_f32 v[190:191], v[190:191], v[12:13]
    v_pk_add_f32 v[192:193], v[192:193], v[12:13]
    v_pk_add_f32 v[194:195], v[194:195], v[12:13]
    v_pk_add_f32 v[196:197], v[196:197], v[12:13]
    v_pk_add_f32 v[198:199], v[198:199], v[12:13]
    v_pk_add_f32 v[200:201], v[200:201], v[12:13]
    v_pk_add_f32 v[202:203], v[202:203], v[12:13]
    v_pk_add_f32 v[204:205], v[204:205], v[12:13]
    v_pk_add_f32 v[206:207], v[206:207], v[12:13]
    v_rcp_f32 v184, v184
    v_rcp_f32 v185, v185
    buffer_load_dwordx4 a[128:131], v62, s[48:51], s73 offen offset:1024 sc1
    v_rcp_f32 v186, v186
    v_rcp_f32 v187, v187
    v_rcp_f32 v188, v188
    v_rcp_f32 v189, v189
    v_rcp_f32 v190, v190
    v_rcp_f32 v191, v191
    v_rcp_f32 v192, v192
    v_rcp_f32 v193, v193
    v_rcp_f32 v194, v194
    v_rcp_f32 v195, v195
    buffer_load_dwordx4 a[132:135], v62, s[48:51], s73 offen offset:2048 sc1
    v_rcp_f32 v196, v196
    v_rcp_f32 v197, v197
    v_rcp_f32 v198, v198
    v_rcp_f32 v199, v199
    v_rcp_f32 v200, v200
    v_rcp_f32 v201, v201
    v_rcp_f32 v202, v202
    v_rcp_f32 v203, v203
    v_rcp_f32 v204, v204
    buffer_load_dwordx4 a[136:139], v62, s[48:51], s73 offen offset:3072 sc1
    v_rcp_f32 v205, v205
    v_rcp_f32 v206, v206
    v_rcp_f32 v207, v207
    v_pk_mul_f32 v[112:113], v[112:113], v[184:185]
    v_pk_mul_f32 v[114:115], v[114:115], v[186:187]
    v_pk_mul_f32 v[116:117], v[116:117], v[188:189]
    v_pk_mul_f32 v[118:119], v[118:119], v[190:191]
    v_pk_mul_f32 v[120:121], v[120:121], v[192:193]
    v_pk_mul_f32 v[122:123], v[122:123], v[194:195]
    v_pk_mul_f32 v[124:125], v[124:125], v[196:197]
    v_pk_mul_f32 v[126:127], v[126:127], v[198:199]
    v_pk_mul_f32 v[128:129], v[128:129], v[200:201]
    v_pk_mul_f32 v[130:131], v[130:131], v[202:203]
    v_pk_mul_f32 v[132:133], v[132:133], v[204:205]
    v_pk_mul_f32 v[134:135], v[134:135], v[206:207]
    v_cvt_pk_bf16_f32 v136, v136, v137
    v_cvt_pk_bf16_f32 v138, v138, v139
    buffer_load_dwordx4 a[140:143], v63, s[48:51], s73 offen offset:0 sc1
    v_cvt_pk_bf16_f32 v140, v140, v141
    v_cvt_pk_bf16_f32 v142, v142, v143
    v_cvt_pk_bf16_f32 v144, v144, v145
    v_cvt_pk_bf16_f32 v146, v146, v147
    v_cvt_pk_bf16_f32 v148, v148, v149
    v_cvt_pk_bf16_f32 v150, v150, v151
    v_cvt_pk_bf16_f32 v152, v152, v153
    v_cvt_pk_bf16_f32 v154, v154, v155
    v_cvt_pk_bf16_f32 v156, v156, v157
    v_cvt_pk_bf16_f32 v158, v158, v159
    v_cvt_pk_bf16_f32 v160, v160, v161
    v_cvt_pk_bf16_f32 v162, v162, v163
    v_cvt_pk_bf16_f32 v164, v164, v165
    v_cvt_pk_bf16_f32 v166, v166, v167
    v_cvt_pk_bf16_f32 v168, v168, v169
    v_cvt_pk_bf16_f32 v170, v170, v171
    v_cvt_pk_bf16_f32 v172, v172, v173
    v_cvt_pk_bf16_f32 v174, v174, v175
    v_cvt_pk_bf16_f32 v176, v176, v177
    s_bfe_u32 s73, s89, 0x30000
    s_mul_i32 s73, s73, 294912
    s_add_u32 s73, s73, s88
    s_add_u32 s73, s73, 147456
    buffer_load_dwordx4 a[144:147], v1, s[48:51], s73 offen offset:0 sc1
    v_cvt_pk_bf16_f32 v178, v178, v179
    v_cvt_pk_bf16_f32 v180, v180, v181
    v_cvt_pk_bf16_f32 v182, v182, v183
    v_cvt_pk_bf16_f32 v112, v112, v113
    v_cvt_pk_bf16_f32 v114, v114, v115
    v_cvt_pk_bf16_f32 v116, v116, v117
    v_cvt_pk_bf16_f32 v118, v118, v119
    v_cvt_pk_bf16_f32 v120, v120, v121
    v_cvt_pk_bf16_f32 v122, v122, v123
    v_cvt_pk_bf16_f32 v124, v124, v125
    v_cvt_pk_bf16_f32 v126, v126, v127
    v_cvt_pk_bf16_f32 v128, v128, v129
    v_cvt_pk_bf16_f32 v130, v130, v131
    v_cvt_pk_bf16_f32 v132, v132, v133
    v_cvt_pk_bf16_f32 v134, v134, v135
    v_accvgpr_write_b32 a72, v112
    v_accvgpr_write_b32 a73, v114
    v_accvgpr_write_b32 a74, v116
    v_accvgpr_write_b32 a75, v118
    buffer_load_dwordx4 a[148:151], v1, s[48:51], s73 offen offset:1024 sc1
    v_accvgpr_write_b32 a76, v120
    v_accvgpr_write_b32 a77, v122
    v_accvgpr_write_b32 a78, v124
    v_accvgpr_write_b32 a79, v126
    v_accvgpr_write_b32 a80, v128
    v_accvgpr_write_b32 a81, v130
    v_accvgpr_write_b32 a82, v132
    v_accvgpr_write_b32 a83, v134
    v_accvgpr_write_b32 a84, v136
    v_accvgpr_write_b32 a85, v138
    v_accvgpr_write_b32 a86, v140
    v_accvgpr_write_b32 a87, v142
    v_accvgpr_write_b32 a88, v144
    v_accvgpr_write_b32 a89, v146
    v_accvgpr_write_b32 a90, v148
    v_accvgpr_write_b32 a91, v150
    v_accvgpr_write_b32 a92, v152
    v_accvgpr_write_b32 a93, v154
    v_accvgpr_write_b32 a94, v156
    v_accvgpr_write_b32 a95, v158
    buffer_load_dwordx4 a[152:155], v1, s[48:51], s73 offen offset:2048 sc1
    v_accvgpr_write_b32 a96, v160
    v_accvgpr_write_b32 a97, v162
    v_accvgpr_write_b32 a98, v164
    v_accvgpr_write_b32 a99, v166
    v_accvgpr_write_b32 a100, v168
    v_accvgpr_write_b32 a101, v170
    v_accvgpr_write_b32 a102, v172
    v_accvgpr_write_b32 a103, v174
    v_accvgpr_write_b32 a104, v176
    v_accvgpr_write_b32 a105, v178
    v_accvgpr_write_b32 a106, v180
    v_accvgpr_write_b32 a107, v182
    v_mov_b32 v9, 0xbdd2d3e8
    v_lshlrev_b32 v50, 16, v50
    v_lshlrev_b32 v51, 16, v51
    v_accvgpr_write_b32 a252, v50
    v_accvgpr_write_b32 a253, v50
    v_accvgpr_write_b32 a254, v50
    v_accvgpr_write_b32 a255, v50
    v_accvgpr_write_b32 a68, v51
    v_accvgpr_write_b32 a69, v51
    v_accvgpr_write_b32 a70, v51
    v_accvgpr_write_b32 a71, v51
    v_mov_b32 v4, v46
    v_mov_b32 v5, v47
    v_mov_b32 v6, v48
    v_mov_b32 v7, v49
    v_add_u32 v2, 4096, v1
    v_add_u32 v3, 8192, v1
    v_and_b32 v8, 15, v0
    v_lshrrev_b32 v11, 1, v8
    v_xor_b32 v11, v11, v10
    v_lshlrev_b32 v8, 7, v8
    v_lshl_add_u32 v8, v11, 4, v8
    v_add_u32 v12, s74, v8
    s_mov_b32 s75, 65536
    s_mov_b32 s63, 131072
    v_add_u32 v13, 0, v12
    s_waitcnt vmcnt(31)
    ds_read_b128 v[16:19], v13 offset:16384
    v_xad_u32 v14, v12, 64, 0
    ds_read_b128 v[20:23], v14 offset:16384
    s_waitcnt vmcnt(3)
    buffer_load_dwordx4 a[156:159], v1, s[48:51], s73 offen offset:3072 sc1
    buffer_load_dwordx4 a[160:163], v2, s[48:51], s73 offen offset:0 sc1
    buffer_load_dwordx4 a[164:167], v2, s[48:51], s73 offen offset:1024 sc1
    buffer_load_dwordx4 a[168:171], v2, s[48:51], s73 offen offset:2048 sc1
    buffer_load_dwordx4 a[172:175], v2, s[48:51], s73 offen offset:3072 sc1
    buffer_load_dwordx4 a[176:179], v3, s[48:51], s73 offen offset:0 sc1
    s_waitcnt vmcnt(0)
    s_waitcnt lgkmcnt(0)
    v_mfma_f32_16x16x32_bf16 a[0:3], a[108:111], v[16:19], a[252:255]
    s_bfe_u32 s73, s89, 0x30004
    s_mul_i32 s73, s73, 294912
    s_add_u32 s73, s73, s88
    v_mfma_f32_16x16x32_bf16 a[0:3], a[144:147], v[20:23], a[0:3]
    ds_read_b128 v[24:27], v13 offset:18432
    v_mfma_f32_16x16x32_bf16 a[4:7], a[112:115], v[16:19], a[252:255]
    buffer_load_dwordx4 a[180:183], v1, s[48:51], s73 offen offset:0 sc1
    v_mfma_f32_16x16x32_bf16 a[4:7], a[148:151], v[20:23], a[4:7]
    ds_read_b128 v[28:31], v14 offset:18432
    v_mfma_f32_16x16x32_bf16 a[8:11], a[116:119], v[16:19], a[252:255]
    buffer_load_dwordx4 a[184:187], v1, s[48:51], s73 offen offset:1024 sc1
    v_mfma_f32_16x16x32_bf16 a[8:11], a[152:155], v[20:23], a[8:11]
    v_mfma_f32_16x16x32_bf16 a[12:15], a[120:123], v[16:19], a[252:255]
    v_mfma_f32_16x16x32_bf16 a[12:15], a[156:159], v[20:23], a[12:15]
    v_mfma_f32_16x16x32_bf16 a[16:19], a[124:127], v[16:19], a[252:255]
    buffer_load_dwordx4 a[188:191], v1, s[48:51], s73 offen offset:2048 sc1
    v_mfma_f32_16x16x32_bf16 a[16:19], a[160:163], v[20:23], a[16:19]
    v_mfma_f32_16x16x32_bf16 a[20:23], a[128:131], v[16:19], a[252:255]
    v_mfma_f32_16x16x32_bf16 a[20:23], a[164:167], v[20:23], a[20:23]
    v_mfma_f32_16x16x32_bf16 a[24:27], a[132:135], v[16:19], a[252:255]
    v_mfma_f32_16x16x32_bf16 a[24:27], a[168:171], v[20:23], a[24:27]
    buffer_load_dwordx4 a[192:195], v1, s[48:51], s73 offen offset:3072 sc1
    v_mfma_f32_16x16x32_bf16 a[28:31], a[136:139], v[16:19], a[252:255]
    v_mfma_f32_16x16x32_bf16 a[28:31], a[172:175], v[20:23], a[28:31]
    v_mfma_f32_16x16x32_bf16 a[32:35], a[140:143], v[16:19], a[252:255]
    v_mfma_f32_16x16x32_bf16 a[32:35], a[176:179], v[20:23], a[32:35]
    s_waitcnt lgkmcnt(0)
    buffer_load_dwordx4 a[196:199], v2, s[48:51], s73 offen offset:0 sc1
    v_mfma_f32_16x16x32_bf16 a[36:39], a[108:111], v[24:27], a[68:71]
    v_mfma_f32_16x16x32_bf16 a[36:39], a[144:147], v[28:31], a[36:39]
    ds_read_b128 v[16:19], v13 offset:32768
    s_lshr_b32 s72, s60, 1
    v_mfma_f32_16x16x32_bf16 a[40:43], a[112:115], v[24:27], a[68:71]
    s_mul_i32 s72, s72, 72
    s_lshr_b32 s57, s58, 1
    s_mul_i32 s57, s57, 9
    v_mfma_f32_16x16x32_bf16 a[40:43], a[148:151], v[28:31], a[40:43]
    ds_read_b128 v[20:23], v14 offset:32768
    s_add_u32 s72, s72, s57
    v_mfma_f32_16x16x32_bf16 a[44:47], a[116:119], v[24:27], a[68:71]
    buffer_load_dwordx4 a[200:203], v2, s[48:51], s73 offen offset:1024 sc1
    s_lshl_b32 s72, s72, 12
    v_mfma_f32_16x16x32_bf16 a[44:47], a[152:155], v[28:31], a[44:47]
    s_and_b32 s57, s60, 1
    s_lshl_b32 s57, s57, 11
    s_add_u32 s72, s72, s57
    v_mfma_f32_16x16x32_bf16 a[48:51], a[120:123], v[24:27], a[68:71]
    s_add_u32 s72, s72, 0x2b00000
    s_and_b32 s57, s58, 1
    s_lshl_b32 s64, s57, 10
    v_mfma_f32_16x16x32_bf16 a[48:51], a[156:159], v[28:31], a[48:51]
    s_add_u32 s64, s64, s72
    s_add_u32 s64, s64, 32768
    s_lshl_b32 s57, s57, 14
    v_mfma_f32_16x16x32_bf16 a[52:55], a[124:127], v[24:27], a[68:71]
    buffer_load_dwordx4 a[204:207], v2, s[48:51], s73 offen offset:2048 sc1
    s_add_u32 s72, s72, s57
    v_mfma_f32_16x16x32_bf16 a[52:55], a[160:163], v[28:31], a[52:55]
    s_lshr_b32 s79, s60, 1
    s_lshl_b32 s79, s79, 9
    s_lshr_b32 s57, s58, 2
    v_mfma_f32_16x16x32_bf16 a[56:59], a[128:131], v[24:27], a[68:71]
    s_lshl_b32 s57, s57, 7
    s_add_u32 s79, s79, s57
    s_and_b32 s57, s58, 3
    v_mfma_f32_16x16x32_bf16 a[56:59], a[164:167], v[28:31], a[56:59]
    s_lshl_b32 s57, s57, 3
    s_add_u32 s79, s79, s57
    s_and_b32 s57, s60, 1
    v_mfma_f32_16x16x32_bf16 a[60:63], a[132:135], v[24:27], a[68:71]
    buffer_load_dwordx4 a[208:211], v2, s[48:51], s73 offen offset:3072 sc1
    s_lshl_b32 s57, s57, 2
    v_mfma_f32_16x16x32_bf16 a[60:63], a[168:171], v[28:31], a[60:63]
    s_add_u32 s79, s79, s57
    s_add_u32 s79, s79, 0x1180000
    s_bfe_u32 s70, s2, 0x20001
    v_mfma_f32_16x16x32_bf16 a[64:67], a[136:139], v[24:27], a[68:71]
    s_lshl_b32 s70, s70, 3
    s_bfe_u32 s57, s2, 0x30003
    s_add_u32 s70, s70, s57
    v_mfma_f32_16x16x32_bf16 a[64:67], a[172:175], v[28:31], a[64:67]
    s_and_b32 s71, s2, 1
    s_lshl_b32 s71, s71, 2
    s_lshr_b32 s57, s2, 6
    v_mfma_f32_16x16x32_bf16 a[68:71], a[140:143], v[24:27], a[68:71]
    buffer_load_dwordx4 a[212:215], v3, s[48:51], s73 offen offset:0 sc1
    s_add_u32 s71, s71, s57
    v_mfma_f32_16x16x32_bf16 a[68:71], a[176:179], v[28:31], a[68:71]
    s_waitcnt lgkmcnt(0)
    s_mul_i32 s80, s70, 72
    s_mul_i32 s57, s3, 18
    v_mfma_f32_16x16x32_bf16 v[40:43], a[108:111], v[16:19], 0
    s_add_u32 s80, s80, s57
    s_lshl_b32 s80, s80, 12
    s_add_u32 s80, s80, 0x2b00000
    v_mfma_f32_16x16x32_bf16 v[40:43], a[144:147], v[20:23], v[40:43]
    ds_read_b128 v[24:27], v13 offset:34816
    s_bfe_u32 s73, s89, 0x30004
    v_mfma_f32_16x16x32_bf16 v[44:47], a[112:115], v[16:19], 0
    s_mul_i32 s73, s73, 294912
    s_add_u32 s73, s73, s88
    s_add_u32 s73, s73, 147456
    v_mfma_f32_16x16x32_bf16 v[44:47], a[148:151], v[20:23], v[44:47]
    ds_read_b128 v[28:31], v14 offset:34816
    s_lshl_b32 s81, s71, 2
    v_mfma_f32_16x16x32_bf16 v[48:51], a[116:119], v[16:19], 0
    buffer_load_dwordx4 a[216:219], v1, s[48:51], s73 offen offset:0 sc1
    s_add_u32 s81, s81, s3
    v_mfma_f32_16x16x32_bf16 v[48:51], a[152:155], v[20:23], v[48:51]
    s_mul_i32 s81, s81, 82944
    s_add_u32 s81, s81, 0xe00000
    s_add_u32 s76, s70, s71
    v_mfma_f32_16x16x32_bf16 v[52:55], a[120:123], v[16:19], 0
    s_and_b32 s76, s76, 0
    s_mul_i32 s77, s76, 9216
    s_lshl_b32 s78, s76, 13
    v_mfma_f32_16x16x32_bf16 v[52:55], a[156:159], v[20:23], v[52:55]
    buffer_load_dwordx4 a[220:223], v1, s[48:51], s73 offen offset:1024 sc1
    s_lshl_b32 s82, s70, 9
    v_mfma_f32_16x16x32_bf16 v[56:59], a[124:127], v[16:19], 0
    s_lshl_b32 s57, s3, 7
    s_add_u32 s82, s82, s57
    s_mul_i32 s57, s71, 16640
    v_mfma_f32_16x16x32_bf16 v[56:59], a[160:163], v[20:23], v[56:59]
    s_add_u32 s82, s82, s57
    s_add_u32 s82, s82, 0x1180000
    s_lshl_b32 s83, s3, 10
    v_mfma_f32_16x16x32_bf16 v[60:63], a[128:131], v[16:19], 0
    s_add_u32 s83, s83, 0x11d0000
    s_lshr_b32 s90, s2, 3
    s_lshl_b32 s90, s90, 7
    v_mfma_f32_16x16x32_bf16 v[60:63], a[164:167], v[20:23], v[60:63]
    s_and_b32 s57, s2, 7
    s_lshl_b32 s57, s57, 2
    s_add_u32 s90, s90, s57
    v_mfma_f32_16x16x32_bf16 v[64:67], a[132:135], v[16:19], 0
    buffer_load_dwordx4 a[224:227], v1, s[48:51], s73 offen offset:2048 sc1
    s_add_u32 s90, s90, 0x11d0000
    v_mfma_f32_16x16x32_bf16 v[64:67], a[168:171], v[20:23], v[64:67]
    s_mov_b32 s28, s12
    s_mov_b32 s29, s13
    s_mov_b32 s30, 0x240000
    v_mfma_f32_16x16x32_bf16 v[68:71], a[136:139], v[16:19], 0
    s_mov_b32 s31, 0x00020000
    s_mov_b32 s32, s14
    s_mov_b32 s33, s15
    v_mfma_f32_16x16x32_bf16 v[68:71], a[172:175], v[20:23], v[68:71]
    s_mov_b32 s34, 0x480
    s_mov_b32 s35, 0x00020000
    s_mov_b32 s36, s4
    v_mfma_f32_16x16x32_bf16 v[72:75], a[140:143], v[16:19], 0
    buffer_load_dwordx4 a[228:231], v1, s[48:51], s73 offen offset:3072 sc1
    s_mov_b32 s37, s5
    v_mfma_f32_16x16x32_bf16 v[72:75], a[176:179], v[20:23], v[72:75]
    s_waitcnt lgkmcnt(0)
    s_mov_b32 s38, 0x240000
    s_mov_b32 s39, 0x00020000
    v_mfma_f32_16x16x32_bf16 v[76:79], a[108:111], v[24:27], 0
    s_mov_b32 s44, s26
    s_mov_b32 s45, s27
    s_mov_b32 s46, 0x240000
    v_mfma_f32_16x16x32_bf16 v[76:79], a[144:147], v[28:31], v[76:79]
    ds_read_b128 v[16:19], v13 offset:49152
    s_mov_b32 s47, 0x00020000
    v_mfma_f32_16x16x32_bf16 v[80:83], a[112:115], v[24:27], 0
    buffer_load_dwordx4 a[232:235], v2, s[48:51], s73 offen offset:0 sc1
    s_mul_i32 s91, s3, 16640
    v_mfma_f32_16x16x32_bf16 v[80:83], a[148:151], v[28:31], v[80:83]
    ds_read_b128 v[20:23], v14 offset:49152
    s_add_u32 s91, s91, 65536
    v_mfma_f32_16x16x32_bf16 v[84:87], a[116:119], v[24:27], 0
    v_accvgpr_read_b32 v33, a84
    v_accvgpr_read_b32 v35, a85
    v_mfma_f32_16x16x32_bf16 v[84:87], a[152:155], v[28:31], v[84:87]
    v_lshlrev_b32 v32, 16, v33
    v_and_b32 v33, 0xffff0000, v33
    v_mfma_f32_16x16x32_bf16 v[88:91], a[120:123], v[24:27], 0
    v_lshlrev_b32 v34, 16, v35
    v_and_b32 v35, 0xffff0000, v35
    v_mfma_f32_16x16x32_bf16 v[88:91], a[156:159], v[28:31], v[88:91]
    buffer_load_dwordx4 a[236:239], v2, s[48:51], s73 offen offset:1024 sc1
    v_mul_f32 v36, v32, v32
    v_mfma_f32_16x16x32_bf16 v[92:95], a[124:127], v[24:27], 0
    v_mul_f32 v37, v33, v33
    v_mul_f32 v38, v34, v34
    v_mfma_f32_16x16x32_bf16 v[92:95], a[160:163], v[28:31], v[92:95]
    v_mul_f32 v39, v35, v35
    v_fmaak_f32 v36, v9, v36, 0xc0135761
    v_mfma_f32_16x16x32_bf16 v[96:99], a[128:131], v[24:27], 0
    v_fmaak_f32 v37, v9, v37, 0xc0135761
    v_fmaak_f32 v38, v9, v38, 0xc0135761
    v_mfma_f32_16x16x32_bf16 v[96:99], a[164:167], v[28:31], v[96:99]
    buffer_load_dwordx4 a[240:243], v2, s[48:51], s73 offen offset:2048 sc1
    v_fmaak_f32 v39, v9, v39, 0xc0135761
    v_mfma_f32_16x16x32_bf16 v[100:103], a[132:135], v[24:27], 0
    v_mul_f32 v36, v32, v36
    v_mul_f32 v37, v33, v37
    v_mfma_f32_16x16x32_bf16 v[100:103], a[168:171], v[28:31], v[100:103]
    v_mul_f32 v38, v34, v38
    v_mul_f32 v39, v35, v39
    v_mfma_f32_16x16x32_bf16 v[104:107], a[136:139], v[24:27], 0
    v_exp_f32 v36, v36
    v_mfma_f32_16x16x32_bf16 v[104:107], a[172:175], v[28:31], v[104:107]
    buffer_load_dwordx4 a[244:247], v2, s[48:51], s73 offen offset:3072 sc1
    v_mfma_f32_16x16x32_bf16 v[108:111], a[140:143], v[24:27], 0
    v_exp_f32 v37, v37
    v_mfma_f32_16x16x32_bf16 v[108:111], a[176:179], v[28:31], v[108:111]
    s_waitcnt lgkmcnt(0)
    v_exp_f32 v38, v38
    v_mfma_f32_16x16x32_bf16 v[112:115], a[108:111], v[16:19], 0
    v_exp_f32 v39, v39
    v_mfma_f32_16x16x32_bf16 v[112:115], a[144:147], v[20:23], v[112:115]
    ds_read_b128 v[24:27], v13 offset:51200
    v_add_f32 v36, 1.0, v36
    v_mfma_f32_16x16x32_bf16 v[116:119], a[112:115], v[16:19], 0
    buffer_load_dwordx4 a[248:251], v3, s[48:51], s73 offen offset:0 sc1
    v_add_f32 v37, 1.0, v37
    v_mfma_f32_16x16x32_bf16 v[116:119], a[148:151], v[20:23], v[116:119]
    ds_read_b128 v[28:31], v14 offset:51200
    v_add_f32 v38, 1.0, v38
    v_mfma_f32_16x16x32_bf16 v[120:123], a[116:119], v[16:19], 0
    v_add_f32 v39, 1.0, v39
    v_mfma_f32_16x16x32_bf16 v[120:123], a[152:155], v[20:23], v[120:123]
    v_rcp_f32 v36, v36
    v_mfma_f32_16x16x32_bf16 v[124:127], a[120:123], v[16:19], 0
    buffer_load_dwordx4 v5, s[40:43], s67 offen offset:1024 lds
    v_mfma_f32_16x16x32_bf16 v[124:127], a[156:159], v[20:23], v[124:127]
    v_rcp_f32 v37, v37
    v_mfma_f32_16x16x32_bf16 v[128:131], a[124:127], v[16:19], 0
    v_rcp_f32 v38, v38
    v_mfma_f32_16x16x32_bf16 v[128:131], a[160:163], v[20:23], v[128:131]
    v_rcp_f32 v39, v39
    v_mfma_f32_16x16x32_bf16 v[132:135], a[128:131], v[16:19], 0
    v_mul_f32 v32, v32, v36
    v_mul_f32 v33, v33, v37
    v_mfma_f32_16x16x32_bf16 v[132:135], a[164:167], v[20:23], v[132:135]
    buffer_load_dwordx4 v6, s[40:43], s67 offen offset:2048 lds
    v_mul_f32 v34, v34, v38
    v_mfma_f32_16x16x32_bf16 v[136:139], a[132:135], v[16:19], 0
    v_mul_f32 v35, v35, v39
    v_cvt_pk_bf16_f32 v36, v32, v33
    v_mfma_f32_16x16x32_bf16 v[136:139], a[168:171], v[20:23], v[136:139]
    v_cvt_pk_bf16_f32 v37, v34, v35
    v_accvgpr_write_b32 a84, v36
    v_mfma_f32_16x16x32_bf16 v[140:143], a[136:139], v[16:19], 0
    v_accvgpr_write_b32 a85, v37
    v_accvgpr_read_b32 v33, a86
    v_mfma_f32_16x16x32_bf16 v[140:143], a[172:175], v[20:23], v[140:143]
    buffer_load_dwordx4 v7, s[40:43], s67 offen offset:3072 lds
    v_accvgpr_read_b32 v35, a87
    v_mfma_f32_16x16x32_bf16 v[144:147], a[140:143], v[16:19], 0
    v_lshlrev_b32 v32, 16, v33
    v_and_b32 v33, 0xffff0000, v33
    v_mfma_f32_16x16x32_bf16 v[144:147], a[176:179], v[20:23], v[144:147]
    s_waitcnt lgkmcnt(0)
    s_bfe_u32 s67, s89, 0x30004
    s_lshl_b32 s67, s67, 7
    v_mfma_f32_16x16x32_bf16 v[148:151], a[108:111], v[24:27], 0
    s_add_u32 m0, s74, 114688
    s_add_u32 s67, s67, s86
    v_add_u32 v13, s75, v12
    v_mfma_f32_16x16x32_bf16 v[148:151], a[144:147], v[28:31], v[148:151]
    ds_read_b128 v[16:19], v13 offset:0
    v_lshlrev_b32 v34, 16, v35
    v_mfma_f32_16x16x32_bf16 v[152:155], a[112:115], v[24:27], 0
    buffer_load_dwordx4 v4, s[40:43], s67 offen offset:0 lds
    v_xad_u32 v14, v12, 64, s75
    v_mfma_f32_16x16x32_bf16 v[152:155], a[148:151], v[28:31], v[152:155]
    ds_read_b128 v[20:23], v14 offset:0
    v_and_b32 v35, 0xffff0000, v35
    v_mfma_f32_16x16x32_bf16 v[156:159], a[116:119], v[24:27], 0
    v_mul_f32 v36, v32, v32
    v_mul_f32 v37, v33, v33
    v_mfma_f32_16x16x32_bf16 v[156:159], a[152:155], v[28:31], v[156:159]
    v_mul_f32 v38, v34, v34
    v_mul_f32 v39, v35, v35
    v_mfma_f32_16x16x32_bf16 v[160:163], a[120:123], v[24:27], 0
    buffer_load_dwordx4 v5, s[40:43], s67 offen offset:1024 lds
    v_fmaak_f32 v36, v9, v36, 0xc0135761
    v_mfma_f32_16x16x32_bf16 v[160:163], a[156:159], v[28:31], v[160:163]
    v_fmaak_f32 v37, v9, v37, 0xc0135761
    v_fmaak_f32 v38, v9, v38, 0xc0135761
    v_mfma_f32_16x16x32_bf16 v[164:167], a[124:127], v[24:27], 0
    v_fmaak_f32 v39, v9, v39, 0xc0135761
    v_mul_f32 v36, v32, v36
    v_mfma_f32_16x16x32_bf16 v[164:167], a[160:163], v[28:31], v[164:167]
    v_mul_f32 v37, v33, v37
    v_mul_f32 v38, v34, v38
    v_mfma_f32_16x16x32_bf16 v[168:171], a[128:131], v[24:27], 0
    buffer_load_dwordx4 v6, s[40:43], s67 offen offset:2048 lds
    v_mul_f32 v39, v35, v39
    v_mfma_f32_16x16x32_bf16 v[168:171], a[164:167], v[28:31], v[168:171]
    v_exp_f32 v36, v36
    v_mfma_f32_16x16x32_bf16 v[172:175], a[132:135], v[24:27], 0
    v_exp_f32 v37, v37
    v_mfma_f32_16x16x32_bf16 v[172:175], a[168:171], v[28:31], v[172:175]
    v_exp_f32 v38, v38
    v_mfma_f32_16x16x32_bf16 v[176:179], a[136:139], v[24:27], 0
    buffer_load_dwordx4 v7, s[40:43], s67 offen offset:3072 lds
    v_mfma_f32_16x16x32_bf16 v[176:179], a[172:175], v[28:31], v[176:179]
    v_exp_f32 v39, v39
    v_mfma_f32_16x16x32_bf16 v[180:183], a[140:143], v[24:27], 0
    v_add_f32 v36, 1.0, v36
    v_add_f32 v37, 1.0, v37
    v_mfma_f32_16x16x32_bf16 v[180:183], a[176:179], v[28:31], v[180:183]
    s_waitcnt lgkmcnt(0)
    s_bfe_u32 s67, s89, 0x30004
    s_lshl_b32 s67, s67, 7
    v_mfma_f32_16x16x32_bf16 v[184:187], a[108:111], v[16:19], 0
    s_add_u32 m0, s74, 131072
    s_add_u32 s67, s67, s87
    v_add_f32 v38, 1.0, v38
    v_mfma_f32_16x16x32_bf16 v[184:187], a[144:147], v[20:23], v[184:187]
    ds_read_b128 v[24:27], v13 offset:2048
    v_add_f32 v39, 1.0, v39
    v_mfma_f32_16x16x32_bf16 v[188:191], a[112:115], v[16:19], 0
    buffer_load_dwordx4 v4, s[40:43], s67 offen offset:0 lds
    v_mfma_f32_16x16x32_bf16 v[188:191], a[148:151], v[20:23], v[188:191]
    ds_read_b128 v[28:31], v14 offset:2048
    v_mfma_f32_16x16x32_bf16 v[192:195], a[116:119], v[16:19], 0
    v_rcp_f32 v36, v36
    v_mfma_f32_16x16x32_bf16 v[192:195], a[152:155], v[20:23], v[192:195]
    buffer_load_dwordx4 v5, s[40:43], s67 offen offset:1024 lds
    v_mfma_f32_16x16x32_bf16 v[196:199], a[120:123], v[16:19], 0
    v_rcp_f32 v37, v37
    v_mfma_f32_16x16x32_bf16 v[196:199], a[156:159], v[20:23], v[196:199]
    v_rcp_f32 v38, v38
    v_mfma_f32_16x16x32_bf16 v[200:203], a[124:127], v[16:19], 0
    v_rcp_f32 v39, v39
    v_mfma_f32_16x16x32_bf16 v[200:203], a[160:163], v[20:23], v[200:203]
    v_mul_f32 v32, v32, v36
    v_mul_f32 v33, v33, v37
    v_mfma_f32_16x16x32_bf16 v[204:207], a[128:131], v[16:19], 0
    buffer_load_dwordx4 v6, s[40:43], s67 offen offset:2048 lds
    v_mul_f32 v34, v34, v38
    v_mfma_f32_16x16x32_bf16 v[204:207], a[164:167], v[20:23], v[204:207]
    v_mul_f32 v35, v35, v39
    v_cvt_pk_bf16_f32 v36, v32, v33
    v_mfma_f32_16x16x32_bf16 v[208:211], a[132:135], v[16:19], 0
    v_cvt_pk_bf16_f32 v37, v34, v35
    v_accvgpr_write_b32 a86, v36
    v_mfma_f32_16x16x32_bf16 v[208:211], a[168:171], v[20:23], v[208:211]
    v_accvgpr_write_b32 a87, v37
    v_accvgpr_read_b32 v33, a88
    v_mfma_f32_16x16x32_bf16 v[212:215], a[136:139], v[16:19], 0
    buffer_load_dwordx4 v7, s[40:43], s67 offen offset:3072 lds
    v_accvgpr_read_b32 v35, a89
    v_mfma_f32_16x16x32_bf16 v[212:215], a[172:175], v[20:23], v[212:215]
    v_lshlrev_b32 v32, 16, v33
    v_and_b32 v33, 0xffff0000, v33
    v_mfma_f32_16x16x32_bf16 v[216:219], a[140:143], v[16:19], 0
    s_bfe_u32 s67, s89, 0x30008
    s_lshl_b32 s67, s67, 7
    s_add_u32 m0, s74, 147456
    v_mfma_f32_16x16x32_bf16 v[216:219], a[176:179], v[20:23], v[216:219]
    s_waitcnt lgkmcnt(0)
    s_add_u32 s67, s67, s84
    v_lshlrev_b32 v34, 16, v35
    v_mfma_f32_16x16x32_bf16 v[220:223], a[108:111], v[24:27], 0
    buffer_load_dwordx4 v4, s[40:43], s67 offen offset:0 lds
    v_and_b32 v35, 0xffff0000, v35
    v_mfma_f32_16x16x32_bf16 v[220:223], a[144:147], v[28:31], v[220:223]
    ds_read_b128 v[16:19], v13 offset:16384
    v_mul_f32 v36, v32, v32
    v_mfma_f32_16x16x32_bf16 v[224:227], a[112:115], v[24:27], 0
    v_mul_f32 v37, v33, v33
    v_mul_f32 v38, v34, v34
    v_mfma_f32_16x16x32_bf16 v[224:227], a[148:151], v[28:31], v[224:227]
    ds_read_b128 v[20:23], v14 offset:16384
    v_mul_f32 v39, v35, v35
    v_mfma_f32_16x16x32_bf16 v[228:231], a[116:119], v[24:27], 0
    v_fmaak_f32 v36, v9, v36, 0xc0135761
    v_fmaak_f32 v37, v9, v37, 0xc0135761
    v_mfma_f32_16x16x32_bf16 v[228:231], a[152:155], v[28:31], v[228:231]
    buffer_load_dwordx4 v5, s[40:43], s67 offen offset:1024 lds
    v_fmaak_f32 v38, v9, v38, 0xc0135761
    v_mfma_f32_16x16x32_bf16 v[232:235], a[120:123], v[24:27], 0
    v_fmaak_f32 v39, v9, v39, 0xc0135761
    v_mul_f32 v36, v32, v36
    v_mfma_f32_16x16x32_bf16 v[232:235], a[156:159], v[28:31], v[232:235]
    v_mul_f32 v37, v33, v37
    v_mul_f32 v38, v34, v38
    v_mfma_f32_16x16x32_bf16 v[236:239], a[124:127], v[24:27], 0
    v_mul_f32 v39, v35, v39
    v_mfma_f32_16x16x32_bf16 v[236:239], a[160:163], v[28:31], v[236:239]
    buffer_load_dwordx4 v6, s[40:43], s67 offen offset:2048 lds
    v_mfma_f32_16x16x32_bf16 v[240:243], a[128:131], v[24:27], 0
    v_exp_f32 v36, v36
    v_mfma_f32_16x16x32_bf16 v[240:243], a[164:167], v[28:31], v[240:243]
    v_exp_f32 v37, v37
    v_mfma_f32_16x16x32_bf16 v[244:247], a[132:135], v[24:27], 0
    v_exp_f32 v38, v38
    v_mfma_f32_16x16x32_bf16 v[244:247], a[168:171], v[28:31], v[244:247]
    buffer_load_dwordx4 v7, s[40:43], s67 offen offset:3072 lds
    v_mfma_f32_16x16x32_bf16 v[248:251], a[136:139], v[24:27], 0
    v_exp_f32 v39, v39
    v_mfma_f32_16x16x32_bf16 v[248:251], a[172:175], v[28:31], v[248:251]
    v_add_f32 v36, 1.0, v36
    v_add_f32 v37, 1.0, v37
    v_mfma_f32_16x16x32_bf16 v[252:255], a[140:143], v[24:27], 0
    v_add_f32 v38, 1.0, v38
    v_add_f32 v39, 1.0, v39
    v_mfma_f32_16x16x32_bf16 v[252:255], a[176:179], v[28:31], v[252:255]
    s_waitcnt vmcnt(24)
    s_waitcnt vmcnt(15)
    s_waitcnt lgkmcnt(0)
    v_mfma_f32_16x16x32_bf16 a[0:3], a[180:183], v[16:19], a[0:3]
    s_bfe_u32 s73, s89, 0x30008
    s_mul_i32 s73, s73, 294912
    s_add_u32 s73, s73, s88
    v_mfma_f32_16x16x32_bf16 a[0:3], a[216:219], v[20:23], a[0:3]
    ds_read_b128 v[24:27], v13 offset:18432
    v_mfma_f32_16x16x32_bf16 a[4:7], a[220:223], v[20:23], a[4:7]
    buffer_load_dwordx4 a[108:111], v1, s[48:51], s73 offen offset:0 sc1
    v_mfma_f32_16x16x32_bf16 a[4:7], a[184:187], v[16:19], a[4:7]
    ds_read_b128 v[28:31], v14 offset:18432
    v_mfma_f32_16x16x32_bf16 a[8:11], a[188:191], v[16:19], a[8:11]
    buffer_load_dwordx4 a[112:115], v1, s[48:51], s73 offen offset:1024 sc1
    v_mfma_f32_16x16x32_bf16 a[8:11], a[224:227], v[20:23], a[8:11]
    v_rcp_f32 v36, v36
    v_mfma_f32_16x16x32_bf16 a[12:15], a[228:231], v[20:23], a[12:15]
    v_rcp_f32 v37, v37
    v_mfma_f32_16x16x32_bf16 a[12:15], a[192:195], v[16:19], a[12:15]
    v_rcp_f32 v38, v38
    v_mfma_f32_16x16x32_bf16 a[16:19], a[196:199], v[16:19], a[16:19]
    v_rcp_f32 v39, v39
    v_mfma_f32_16x16x32_bf16 a[16:19], a[232:235], v[20:23], a[16:19]
    buffer_load_dwordx4 a[116:119], v1, s[48:51], s73 offen offset:2048 sc1
    v_mul_f32 v32, v32, v36
    v_mfma_f32_16x16x32_bf16 a[20:23], a[236:239], v[20:23], a[20:23]
    v_mul_f32 v33, v33, v37
    v_mul_f32 v34, v34, v38
    v_mfma_f32_16x16x32_bf16 a[20:23], a[200:203], v[16:19], a[20:23]
    v_mul_f32 v35, v35, v39
    v_cvt_pk_bf16_f32 v36, v32, v33
    v_mfma_f32_16x16x32_bf16 a[24:27], a[204:207], v[16:19], a[24:27]
    v_cvt_pk_bf16_f32 v37, v34, v35
    v_accvgpr_write_b32 a88, v36
    v_mfma_f32_16x16x32_bf16 a[24:27], a[240:243], v[20:23], a[24:27]
    buffer_load_dwordx4 a[120:123], v1, s[48:51], s73 offen offset:3072 sc1
    v_accvgpr_write_b32 a89, v37
    v_mfma_f32_16x16x32_bf16 a[28:31], a[244:247], v[20:23], a[28:31]
    v_accvgpr_read_b32 v33, a90
    v_accvgpr_read_b32 v35, a91
    v_mfma_f32_16x16x32_bf16 a[28:31], a[208:211], v[16:19], a[28:31]
    v_lshlrev_b32 v32, 16, v33
    v_and_b32 v33, 0xffff0000, v33
    v_mfma_f32_16x16x32_bf16 a[32:35], a[212:215], v[16:19], a[32:35]
    v_lshlrev_b32 v34, 16, v35
    v_and_b32 v35, 0xffff0000, v35
    v_mfma_f32_16x16x32_bf16 a[32:35], a[248:251], v[20:23], a[32:35]
    s_waitcnt lgkmcnt(0)
    buffer_load_dwordx4 a[124:127], v2, s[48:51], s73 offen offset:0 sc1
    v_mfma_f32_16x16x32_bf16 a[68:71], a[212:215], v[24:27], a[68:71]
    v_mul_f32 v36, v32, v32
    v_mul_f32 v37, v33, v33
    v_mfma_f32_16x16x32_bf16 a[68:71], a[248:251], v[28:31], a[68:71]
    s_waitcnt vmcnt(17)
    ds_read_b128 v[16:19], v13 offset:32768
    v_mfma_f32_16x16x32_bf16 a[64:67], a[244:247], v[28:31], a[64:67]
    v_mul_f32 v38, v34, v34
    v_mul_f32 v39, v35, v35
    v_mfma_f32_16x16x32_bf16 a[64:67], a[208:211], v[24:27], a[64:67]
    ds_read_b128 v[20:23], v14 offset:32768
    v_fmaak_f32 v36, v9, v36, 0xc0135761
    v_mfma_f32_16x16x32_bf16 a[60:63], a[204:207], v[24:27], a[60:63]
    buffer_load_dwordx4 a[128:131], v2, s[48:51], s73 offen offset:1024 sc1
    v_fmaak_f32 v37, v9, v37, 0xc0135761
    v_mfma_f32_16x16x32_bf16 a[60:63], a[240:243], v[28:31], a[60:63]
    v_fmaak_f32 v38, v9, v38, 0xc0135761
    v_fmaak_f32 v39, v9, v39, 0xc0135761
    v_mfma_f32_16x16x32_bf16 a[56:59], a[236:239], v[28:31], a[56:59]
    v_mul_f32 v36, v32, v36
    v_mul_f32 v37, v33, v37
    v_mfma_f32_16x16x32_bf16 a[56:59], a[200:203], v[24:27], a[56:59]
    v_mul_f32 v38, v34, v38
    v_mul_f32 v39, v35, v39
    v_mfma_f32_16x16x32_bf16 a[52:55], a[196:199], v[24:27], a[52:55]
    buffer_load_dwordx4 a[132:135], v2, s[48:51], s73 offen offset:2048 sc1
    v_mfma_f32_16x16x32_bf16 a[52:55], a[232:235], v[28:31], a[52:55]
    v_exp_f32 v36, v36
    v_mfma_f32_16x16x32_bf16 a[48:51], a[228:231], v[28:31], a[48:51]
    v_exp_f32 v37, v37
    v_mfma_f32_16x16x32_bf16 a[48:51], a[192:195], v[24:27], a[48:51]
    v_exp_f32 v38, v38
    v_mfma_f32_16x16x32_bf16 a[44:47], a[188:191], v[24:27], a[44:47]
    buffer_load_dwordx4 a[136:139], v2, s[48:51], s73 offen offset:3072 sc1
    v_mfma_f32_16x16x32_bf16 a[44:47], a[224:227], v[28:31], a[44:47]
    v_exp_f32 v39, v39
    v_mfma_f32_16x16x32_bf16 a[40:43], a[220:223], v[28:31], a[40:43]
    v_add_f32 v36, 1.0, v36
    v_add_f32 v37, 1.0, v37
    v_mfma_f32_16x16x32_bf16 a[40:43], a[184:187], v[24:27], a[40:43]
    v_add_f32 v38, 1.0, v38
    v_add_f32 v39, 1.0, v39
    v_mfma_f32_16x16x32_bf16 a[36:39], a[180:183], v[24:27], a[36:39]
    v_rcp_f32 v36, v36
    v_mfma_f32_16x16x32_bf16 a[36:39], a[216:219], v[28:31], a[36:39]
    s_waitcnt lgkmcnt(0)
    buffer_load_dwordx4 a[140:143], v3, s[48:51], s73 offen offset:0 sc1
    v_mfma_f32_16x16x32_bf16 v[40:43], a[180:183], v[16:19], v[40:43]
    v_rcp_f32 v37, v37
    v_mfma_f32_16x16x32_bf16 v[40:43], a[216:219], v[20:23], v[40:43]
    ds_read_b128 v[24:27], v13 offset:34816
    s_bfe_u32 s73, s89, 0x30008
    v_mfma_f32_16x16x32_bf16 v[44:47], a[220:223], v[20:23], v[44:47]
    s_mul_i32 s73, s73, 294912
    s_add_u32 s73, s73, s88
    s_add_u32 s73, s73, 147456
    v_mfma_f32_16x16x32_bf16 v[44:47], a[184:187], v[16:19], v[44:47]
    ds_read_b128 v[28:31], v14 offset:34816
    v_mfma_f32_16x16x32_bf16 v[48:51], a[188:191], v[16:19], v[48:51]
    buffer_load_dwordx4 a[144:147], v1, s[48:51], s73 offen offset:0 sc1
    v_mfma_f32_16x16x32_bf16 v[48:51], a[224:227], v[20:23], v[48:51]
    v_rcp_f32 v38, v38
    v_mfma_f32_16x16x32_bf16 v[52:55], a[228:231], v[20:23], v[52:55]
    v_rcp_f32 v39, v39
    v_mfma_f32_16x16x32_bf16 v[52:55], a[192:195], v[16:19], v[52:55]
    v_mul_f32 v32, v32, v36
    v_mul_f32 v33, v33, v37
    v_mfma_f32_16x16x32_bf16 v[56:59], a[196:199], v[16:19], v[56:59]
    buffer_load_dwordx4 a[148:151], v1, s[48:51], s73 offen offset:1024 sc1
    v_mul_f32 v34, v34, v38
    v_mfma_f32_16x16x32_bf16 v[56:59], a[232:235], v[20:23], v[56:59]
    v_mul_f32 v35, v35, v39
    v_cvt_pk_bf16_f32 v36, v32, v33
    v_mfma_f32_16x16x32_bf16 v[60:63], a[236:239], v[20:23], v[60:63]
    v_cvt_pk_bf16_f32 v37, v34, v35
    v_accvgpr_write_b32 a90, v36
    v_mfma_f32_16x16x32_bf16 v[60:63], a[200:203], v[16:19], v[60:63]
    v_accvgpr_write_b32 a91, v37
    v_accvgpr_read_b32 v33, a92
    v_mfma_f32_16x16x32_bf16 v[64:67], a[204:207], v[16:19], v[64:67]
    buffer_load_dwordx4 a[152:155], v1, s[48:51], s73 offen offset:2048 sc1
    v_accvgpr_read_b32 v35, a93
    v_mfma_f32_16x16x32_bf16 v[64:67], a[240:243], v[20:23], v[64:67]
    v_lshlrev_b32 v32, 16, v33
    v_and_b32 v33, 0xffff0000, v33
    v_mfma_f32_16x16x32_bf16 v[68:71], a[244:247], v[20:23], v[68:71]
    v_lshlrev_b32 v34, 16, v35
    v_and_b32 v35, 0xffff0000, v35
    v_mfma_f32_16x16x32_bf16 v[68:71], a[208:211], v[16:19], v[68:71]
    v_mul_f32 v36, v32, v32
    v_mul_f32 v37, v33, v33
    v_mfma_f32_16x16x32_bf16 v[72:75], a[212:215], v[16:19], v[72:75]
    buffer_load_dwordx4 a[156:159], v1, s[48:51], s73 offen offset:3072 sc1
    v_mul_f32 v38, v34, v34
    v_mfma_f32_16x16x32_bf16 v[72:75], a[248:251], v[20:23], v[72:75]
    s_waitcnt lgkmcnt(0)
    v_mul_f32 v39, v35, v35
    v_fmaak_f32 v36, v9, v36, 0xc0135761
    v_mfma_f32_16x16x32_bf16 v[108:111], a[212:215], v[24:27], v[108:111]
    v_fmaak_f32 v37, v9, v37, 0xc0135761
    v_fmaak_f32 v38, v9, v38, 0xc0135761
    v_mfma_f32_16x16x32_bf16 v[108:111], a[248:251], v[28:31], v[108:111]
    s_waitcnt vmcnt(21)
    ds_read_b128 v[16:19], v13 offset:49152
    v_mfma_f32_16x16x32_bf16 v[104:107], a[244:247], v[28:31], v[104:107]
    v_fmaak_f32 v39, v9, v39, 0xc0135761
    v_mul_f32 v36, v32, v36
    v_mfma_f32_16x16x32_bf16 v[104:107], a[208:211], v[24:27], v[104:107]
    ds_read_b128 v[20:23], v14 offset:49152
    v_mul_f32 v37, v33, v37
    v_mfma_f32_16x16x32_bf16 v[100:103], a[204:207], v[24:27], v[100:103]
    buffer_load_dwordx4 a[160:163], v2, s[48:51], s73 offen offset:0 sc1
    v_mul_f32 v38, v34, v38
    v_mfma_f32_16x16x32_bf16 v[100:103], a[240:243], v[28:31], v[100:103]
    v_mul_f32 v39, v35, v39
    v_mfma_f32_16x16x32_bf16 v[96:99], a[236:239], v[28:31], v[96:99]
    v_exp_f32 v36, v36
    v_mfma_f32_16x16x32_bf16 v[96:99], a[200:203], v[24:27], v[96:99]
    buffer_load_dwordx4 a[164:167], v2, s[48:51], s73 offen offset:1024 sc1
    v_mfma_f32_16x16x32_bf16 v[92:95], a[196:199], v[24:27], v[92:95]
    v_exp_f32 v37, v37
    v_mfma_f32_16x16x32_bf16 v[92:95], a[232:235], v[28:31], v[92:95]
    v_exp_f32 v38, v38
    v_mfma_f32_16x16x32_bf16 v[88:91], a[228:231], v[28:31], v[88:91]
    v_exp_f32 v39, v39
    v_mfma_f32_16x16x32_bf16 v[88:91], a[192:195], v[24:27], v[88:91]
    buffer_load_dwordx4 a[168:171], v2, s[48:51], s73 offen offset:2048 sc1
    v_add_f32 v36, 1.0, v36
    v_mfma_f32_16x16x32_bf16 v[84:87], a[188:191], v[24:27], v[84:87]
    v_add_f32 v37, 1.0, v37
    v_add_f32 v38, 1.0, v38
    v_mfma_f32_16x16x32_bf16 v[84:87], a[224:227], v[28:31], v[84:87]
    v_add_f32 v39, 1.0, v39
    v_mfma_f32_16x16x32_bf16 v[80:83], a[220:223], v[28:31], v[80:83]
    v_rcp_f32 v36, v36
    v_mfma_f32_16x16x32_bf16 v[80:83], a[184:187], v[24:27], v[80:83]
    v_rcp_f32 v37, v37
    v_mfma_f32_16x16x32_bf16 v[76:79], a[180:183], v[24:27], v[76:79]
    buffer_load_dwordx4 a[172:175], v2, s[48:51], s73 offen offset:3072 sc1
    v_mfma_f32_16x16x32_bf16 v[76:79], a[216:219], v[28:31], v[76:79]
    s_waitcnt lgkmcnt(0)
    v_rcp_f32 v38, v38
    v_mfma_f32_16x16x32_bf16 v[112:115], a[180:183], v[16:19], v[112:115]
    v_rcp_f32 v39, v39
    v_mfma_f32_16x16x32_bf16 v[112:115], a[216:219], v[20:23], v[112:115]
    ds_read_b128 v[24:27], v13 offset:51200
    v_mul_f32 v32, v32, v36
    v_mfma_f32_16x16x32_bf16 v[116:119], a[220:223], v[20:23], v[116:119]
    buffer_load_dwordx4 a[176:179], v3, s[48:51], s73 offen offset:0 sc1
    v_mul_f32 v33, v33, v37
    v_mfma_f32_16x16x32_bf16 v[116:119], a[184:187], v[16:19], v[116:119]
    ds_read_b128 v[28:31], v14 offset:51200
    v_mul_f32 v34, v34, v38
    v_mfma_f32_16x16x32_bf16 v[120:123], a[188:191], v[16:19], v[120:123]
    v_mul_f32 v35, v35, v39
    v_cvt_pk_bf16_f32 v36, v32, v33
    v_mfma_f32_16x16x32_bf16 v[120:123], a[224:227], v[20:23], v[120:123]
    s_bfe_u32 s67, s89, 0x30008
    s_lshl_b32 s67, s67, 7
    s_add_u32 m0, s74, 16384
    v_mfma_f32_16x16x32_bf16 v[124:127], a[228:231], v[20:23], v[124:127]
    s_add_u32 s67, s67, s86
    v_cvt_pk_bf16_f32 v37, v34, v35
    v_accvgpr_write_b32 a92, v36
    v_mfma_f32_16x16x32_bf16 v[124:127], a[192:195], v[16:19], v[124:127]
    buffer_load_dwordx4 v4, s[40:43], s67 offen offset:0 lds
    v_accvgpr_write_b32 a93, v37
    v_mfma_f32_16x16x32_bf16 v[128:131], a[196:199], v[16:19], v[128:131]
    v_accvgpr_read_b32 v33, a94
    v_accvgpr_read_b32 v35, a95
    v_mfma_f32_16x16x32_bf16 v[128:131], a[232:235], v[20:23], v[128:131]
    v_lshlrev_b32 v32, 16, v33
    v_and_b32 v33, 0xffff0000, v33
    v_mfma_f32_16x16x32_bf16 v[132:135], a[236:239], v[20:23], v[132:135]
    v_lshlrev_b32 v34, 16, v35
    v_and_b32 v35, 0xffff0000, v35
    v_mfma_f32_16x16x32_bf16 v[132:135], a[200:203], v[16:19], v[132:135]
    buffer_load_dwordx4 v5, s[40:43], s67 offen offset:1024 lds
    v_mul_f32 v36, v32, v32
    v_mfma_f32_16x16x32_bf16 v[136:139], a[204:207], v[16:19], v[136:139]
    v_mul_f32 v37, v33, v33
    v_mul_f32 v38, v34, v34
    v_mfma_f32_16x16x32_bf16 v[136:139], a[240:243], v[20:23], v[136:139]
    v_mul_f32 v39, v35, v35
    v_fmaak_f32 v36, v9, v36, 0xc0135761
    v_mfma_f32_16x16x32_bf16 v[140:143], a[244:247], v[20:23], v[140:143]
    v_fmaak_f32 v37, v9, v37, 0xc0135761
    v_fmaak_f32 v38, v9, v38, 0xc0135761
    v_mfma_f32_16x16x32_bf16 v[140:143], a[208:211], v[16:19], v[140:143]
    buffer_load_dwordx4 v6, s[40:43], s67 offen offset:2048 lds
    v_fmaak_f32 v39, v9, v39, 0xc0135761
    v_mfma_f32_16x16x32_bf16 v[144:147], a[212:215], v[16:19], v[144:147]
    v_mul_f32 v36, v32, v36
    v_mul_f32 v37, v33, v37
    v_mfma_f32_16x16x32_bf16 v[144:147], a[248:251], v[20:23], v[144:147]
    s_waitcnt lgkmcnt(0)
    v_mul_f32 v38, v34, v38
    v_mul_f32 v39, v35, v39
    v_mfma_f32_16x16x32_bf16 v[180:183], a[212:215], v[24:27], v[180:183]
    v_add_u32 v13, s63, v12
    v_exp_f32 v36, v36
    v_mfma_f32_16x16x32_bf16 v[180:183], a[248:251], v[28:31], v[180:183]
    s_waitcnt vmcnt(25)
    ds_read_b128 v[16:19], v13 offset:0
    v_mfma_f32_16x16x32_bf16 v[176:179], a[244:247], v[28:31], v[176:179]
    buffer_load_dwordx4 v7, s[40:43], s67 offen offset:3072 lds
    v_xad_u32 v14, v12, 64, s63
    v_mfma_f32_16x16x32_bf16 v[176:179], a[208:211], v[24:27], v[176:179]
    ds_read_b128 v[20:23], v14 offset:0
    v_mfma_f32_16x16x32_bf16 v[172:175], a[204:207], v[24:27], v[172:175]
    s_bfe_u32 s67, s89, 0x30008
    s_lshl_b32 s67, s67, 7
    s_add_u32 m0, s74, 32768
    v_mfma_f32_16x16x32_bf16 v[172:175], a[240:243], v[28:31], v[172:175]
    s_add_u32 s67, s67, s87
    v_exp_f32 v37, v37
    v_mfma_f32_16x16x32_bf16 v[168:171], a[236:239], v[28:31], v[168:171]
    buffer_load_dwordx4 v4, s[40:43], s67 offen offset:0 lds
    v_mfma_f32_16x16x32_bf16 v[168:171], a[200:203], v[24:27], v[168:171]
    v_exp_f32 v38, v38
    v_mfma_f32_16x16x32_bf16 v[164:167], a[196:199], v[24:27], v[164:167]
    v_exp_f32 v39, v39
    v_mfma_f32_16x16x32_bf16 v[164:167], a[232:235], v[28:31], v[164:167]
    v_add_f32 v36, 1.0, v36
    v_add_f32 v37, 1.0, v37
    v_mfma_f32_16x16x32_bf16 v[160:163], a[228:231], v[28:31], v[160:163]
    buffer_load_dwordx4 v5, s[40:43], s67 offen offset:1024 lds
    v_add_f32 v38, 1.0, v38
    v_mfma_f32_16x16x32_bf16 v[160:163], a[192:195], v[24:27], v[160:163]
    v_add_f32 v39, 1.0, v39
    v_mfma_f32_16x16x32_bf16 v[156:159], a[188:191], v[24:27], v[156:159]
    v_rcp_f32 v36, v36
    v_mfma_f32_16x16x32_bf16 v[156:159], a[224:227], v[28:31], v[156:159]
    v_rcp_f32 v37, v37
    v_mfma_f32_16x16x32_bf16 v[152:155], a[220:223], v[28:31], v[152:155]
    v_rcp_f32 v38, v38
    v_mfma_f32_16x16x32_bf16 v[152:155], a[184:187], v[24:27], v[152:155]
    buffer_load_dwordx4 v6, s[40:43], s67 offen offset:2048 lds
    v_mfma_f32_16x16x32_bf16 v[148:151], a[180:183], v[24:27], v[148:151]
    v_rcp_f32 v39, v39
    v_mfma_f32_16x16x32_bf16 v[148:151], a[216:219], v[28:31], v[148:151]
    s_waitcnt lgkmcnt(0)
    v_mul_f32 v32, v32, v36
    v_mul_f32 v33, v33, v37
    v_mfma_f32_16x16x32_bf16 v[184:187], a[180:183], v[16:19], v[184:187]
    v_mul_f32 v34, v34, v38
    v_mul_f32 v35, v35, v39
    v_mfma_f32_16x16x32_bf16 v[184:187], a[216:219], v[20:23], v[184:187]
    ds_read_b128 v[24:27], v13 offset:2048
    v_cvt_pk_bf16_f32 v36, v32, v33
    v_mfma_f32_16x16x32_bf16 v[188:191], a[220:223], v[20:23], v[188:191]
    buffer_load_dwordx4 v7, s[40:43], s67 offen offset:3072 lds
    v_cvt_pk_bf16_f32 v37, v34, v35
    v_mfma_f32_16x16x32_bf16 v[188:191], a[184:187], v[16:19], v[188:191]
    ds_read_b128 v[28:31], v14 offset:2048
    v_accvgpr_write_b32 a94, v36
    v_mfma_f32_16x16x32_bf16 v[192:195], a[188:191], v[16:19], v[192:195]
    s_bfe_u32 s67, s89, 0x3000c
    s_lshl_b32 s67, s67, 7
    s_add_u32 m0, s74, 49152
    v_mfma_f32_16x16x32_bf16 v[192:195], a[224:227], v[20:23], v[192:195]
    s_add_u32 s67, s67, s84
    v_accvgpr_write_b32 a95, v37
    v_accvgpr_read_b32 v33, a96
    v_mfma_f32_16x16x32_bf16 v[196:199], a[228:231], v[20:23], v[196:199]
    buffer_load_dwordx4 v4, s[40:43], s67 offen offset:0 lds
    v_accvgpr_read_b32 v35, a97
    v_mfma_f32_16x16x32_bf16 v[196:199], a[192:195], v[16:19], v[196:199]
    v_lshlrev_b32 v32, 16, v33
    v_and_b32 v33, 0xffff0000, v33
    v_mfma_f32_16x16x32_bf16 v[200:203], a[196:199], v[16:19], v[200:203]
    v_lshlrev_b32 v34, 16, v35
    v_and_b32 v35, 0xffff0000, v35
    v_mfma_f32_16x16x32_bf16 v[200:203], a[232:235], v[20:23], v[200:203]
    v_mul_f32 v36, v32, v32
    v_mul_f32 v37, v33, v33
    v_mfma_f32_16x16x32_bf16 v[204:207], a[236:239], v[20:23], v[204:207]
    buffer_load_dwordx4 v5, s[40:43], s67 offen offset:1024 lds
    v_mul_f32 v38, v34, v34
    v_mfma_f32_16x16x32_bf16 v[204:207], a[200:203], v[16:19], v[204:207]
    v_mul_f32 v39, v35, v35
    v_fmaak_f32 v36, v9, v36, 0xc0135761
    v_mfma_f32_16x16x32_bf16 v[208:211], a[204:207], v[16:19], v[208:211]
    v_fmaak_f32 v37, v9, v37, 0xc0135761
    v_fmaak_f32 v38, v9, v38, 0xc0135761
    v_mfma_f32_16x16x32_bf16 v[208:211], a[240:243], v[20:23], v[208:211]
    v_fmaak_f32 v39, v9, v39, 0xc0135761
    v_mul_f32 v36, v32, v36
    v_mfma_f32_16x16x32_bf16 v[212:215], a[244:247], v[20:23], v[212:215]
    buffer_load_dwordx4 v6, s[40:43], s67 offen offset:2048 lds
    v_mul_f32 v37, v33, v37
    v_mfma_f32_16x16x32_bf16 v[212:215], a[208:211], v[16:19], v[212:215]
    v_mul_f32 v38, v34, v38
    v_mul_f32 v39, v35, v39
    v_mfma_f32_16x16x32_bf16 v[216:219], a[212:215], v[16:19], v[216:219]
    v_exp_f32 v36, v36
    v_mfma_f32_16x16x32_bf16 v[216:219], a[248:251], v[20:23], v[216:219]
    s_waitcnt lgkmcnt(0)
    v_exp_f32 v37, v37
    v_mfma_f32_16x16x32_bf16 v[252:255], a[212:215], v[24:27], v[252:255]
    v_exp_f32 v38, v38
    v_mfma_f32_16x16x32_bf16 v[252:255], a[248:251], v[28:31], v[252:255]
    s_waitcnt vmcnt(29)
    ds_read_b128 v[16:19], v13 offset:16384
    v_mfma_f32_16x16x32_bf16 v[248:251], a[244:247], v[28:31], v[248:251]
    buffer_load_dwordx4 v7, s[40:43], s67 offen offset:3072 lds
    v_mfma_f32_16x16x32_bf16 v[248:251], a[208:211], v[24:27], v[248:251]
    ds_read_b128 v[20:23], v14 offset:16384
    v_mfma_f32_16x16x32_bf16 v[244:247], a[204:207], v[24:27], v[244:247]
    v_exp_f32 v39, v39
    v_mfma_f32_16x16x32_bf16 v[244:247], a[240:243], v[28:31], v[244:247]
    v_add_f32 v36, 1.0, v36
    v_add_f32 v37, 1.0, v37
    v_mfma_f32_16x16x32_bf16 v[240:243], a[236:239], v[28:31], v[240:243]
    v_add_f32 v38, 1.0, v38
    v_add_f32 v39, 1.0, v39
    v_mfma_f32_16x16x32_bf16 v[240:243], a[200:203], v[24:27], v[240:243]
    v_rcp_f32 v36, v36
    v_mfma_f32_16x16x32_bf16 v[236:239], a[196:199], v[24:27], v[236:239]
    v_rcp_f32 v37, v37
    v_mfma_f32_16x16x32_bf16 v[236:239], a[232:235], v[28:31], v[236:239]
    v_rcp_f32 v38, v38
    v_mfma_f32_16x16x32_bf16 v[232:235], a[228:231], v[28:31], v[232:235]
    v_rcp_f32 v39, v39
    v_mfma_f32_16x16x32_bf16 v[232:235], a[192:195], v[24:27], v[232:235]
    v_mul_f32 v32, v32, v36
    v_mul_f32 v33, v33, v37
    v_mfma_f32_16x16x32_bf16 v[228:231], a[188:191], v[24:27], v[228:231]
    v_mul_f32 v34, v34, v38
    v_mul_f32 v35, v35, v39
    v_mfma_f32_16x16x32_bf16 v[228:231], a[224:227], v[28:31], v[228:231]
    v_cvt_pk_bf16_f32 v36, v32, v33
    v_cvt_pk_bf16_f32 v37, v34, v35
    v_mfma_f32_16x16x32_bf16 v[224:227], a[220:223], v[28:31], v[224:227]
    v_accvgpr_write_b32 a96, v36
    v_accvgpr_write_b32 a97, v37
    v_mfma_f32_16x16x32_bf16 v[224:227], a[184:187], v[24:27], v[224:227]
    v_accvgpr_read_b32 v33, a98
    v_accvgpr_read_b32 v35, a99
    v_mfma_f32_16x16x32_bf16 v[220:223], a[180:183], v[24:27], v[220:223]
    v_lshlrev_b32 v32, 16, v33
    v_and_b32 v33, 0xffff0000, v33
    v_mfma_f32_16x16x32_bf16 v[220:223], a[216:219], v[28:31], v[220:223]
    s_waitcnt vmcnt(21)
    s_waitcnt vmcnt(12)
    s_waitcnt lgkmcnt(0)
    v_mfma_f32_16x16x32_bf16 a[0:3], a[108:111], v[16:19], a[0:3]
    s_bfe_u32 s73, s89, 0x3000c
    s_mul_i32 s73, s73, 294912
    s_add_u32 s73, s73, s88
    v_mfma_f32_16x16x32_bf16 a[0:3], a[144:147], v[20:23], a[0:3]
    ds_read_b128 v[24:27], v13 offset:18432
    v_lshlrev_b32 v34, 16, v35
    v_mfma_f32_16x16x32_bf16 a[4:7], a[148:151], v[20:23], a[4:7]
    buffer_load_dwordx4 a[180:183], v1, s[48:51], s73 offen offset:0 sc1
    v_and_b32 v35, 0xffff0000, v35
    v_mfma_f32_16x16x32_bf16 a[4:7], a[112:115], v[16:19], a[4:7]
    ds_read_b128 v[28:31], v14 offset:18432
    v_mul_f32 v36, v32, v32
    v_mfma_f32_16x16x32_bf16 a[8:11], a[116:119], v[16:19], a[8:11]
    buffer_load_dwordx4 a[184:187], v1, s[48:51], s73 offen offset:1024 sc1
    v_mul_f32 v37, v33, v33
    v_mfma_f32_16x16x32_bf16 a[8:11], a[152:155], v[20:23], a[8:11]
    buffer_load_dwordx4 a[188:191], v1, s[48:51], s73 offen offset:2048 sc1
    v_mul_f32 v38, v34, v34
    v_mfma_f32_16x16x32_bf16 a[12:15], a[156:159], v[20:23], a[12:15]
    v_mul_f32 v39, v35, v35
    v_fmaak_f32 v36, v9, v36, 0xc0135761
    v_mfma_f32_16x16x32_bf16 a[12:15], a[120:123], v[16:19], a[12:15]
    v_fmaak_f32 v37, v9, v37, 0xc0135761
    v_fmaak_f32 v38, v9, v38, 0xc0135761
    v_mfma_f32_16x16x32_bf16 a[16:19], a[124:127], v[16:19], a[16:19]
    v_fmaak_f32 v39, v9, v39, 0xc0135761
    v_mul_f32 v36, v32, v36
    v_mfma_f32_16x16x32_bf16 a[16:19], a[160:163], v[20:23], a[16:19]
    buffer_load_dwordx4 a[192:195], v1, s[48:51], s73 offen offset:3072 sc1
    v_mul_f32 v37, v33, v37
    v_mfma_f32_16x16x32_bf16 a[20:23], a[164:167], v[20:23], a[20:23]
    v_mul_f32 v38, v34, v38
    v_mul_f32 v39, v35, v39
    v_mfma_f32_16x16x32_bf16 a[20:23], a[128:131], v[16:19], a[20:23]
    v_exp_f32 v36, v36
    v_mfma_f32_16x16x32_bf16 a[24:27], a[132:135], v[16:19], a[24:27]
    v_exp_f32 v37, v37
    v_mfma_f32_16x16x32_bf16 a[24:27], a[168:171], v[20:23], a[24:27]
    v_exp_f32 v38, v38
    v_mfma_f32_16x16x32_bf16 a[28:31], a[172:175], v[20:23], a[28:31]
    buffer_load_dwordx4 a[196:199], v2, s[48:51], s73 offen offset:0 sc1
    v_mfma_f32_16x16x32_bf16 a[28:31], a[136:139], v[16:19], a[28:31]
    v_exp_f32 v39, v39
    v_mfma_f32_16x16x32_bf16 a[32:35], a[140:143], v[16:19], a[32:35]
    v_add_f32 v36, 1.0, v36
    v_add_f32 v37, 1.0, v37
    v_mfma_f32_16x16x32_bf16 a[32:35], a[176:179], v[20:23], a[32:35]
    s_waitcnt lgkmcnt(0)
    v_add_f32 v38, 1.0, v38
    v_add_f32 v39, 1.0, v39
    v_mfma_f32_16x16x32_bf16 a[68:71], a[140:143], v[24:27], a[68:71]
    buffer_load_dwordx4 a[200:203], v2, s[48:51], s73 offen offset:1024 sc1
    v_add_u32 v13, 0, v12
    v_mfma_f32_16x16x32_bf16 a[68:71], a[176:179], v[28:31], a[68:71]
    ds_read_b128 v[16:19], v13 offset:0
    v_mfma_f32_16x16x32_bf16 a[64:67], a[172:175], v[28:31], a[64:67]
    v_xad_u32 v14, v12, 64, 0
    v_rcp_f32 v36, v36
    v_mfma_f32_16x16x32_bf16 a[64:67], a[136:139], v[24:27], a[64:67]
    ds_read_b128 v[20:23], v14 offset:0
    v_mfma_f32_16x16x32_bf16 a[60:63], a[132:135], v[24:27], a[60:63]
    buffer_load_dwordx4 a[204:207], v2, s[48:51], s73 offen offset:2048 sc1
    v_mfma_f32_16x16x32_bf16 a[60:63], a[168:171], v[28:31], a[60:63]
    v_rcp_f32 v37, v37
    v_mfma_f32_16x16x32_bf16 a[56:59], a[164:167], v[28:31], a[56:59]
    v_rcp_f32 v38, v38
    v_mfma_f32_16x16x32_bf16 a[56:59], a[128:131], v[24:27], a[56:59]
    v_rcp_f32 v39, v39
    v_mfma_f32_16x16x32_bf16 a[52:55], a[124:127], v[24:27], a[52:55]
    v_mul_f32 v32, v32, v36
    v_mul_f32 v33, v33, v37
    v_mfma_f32_16x16x32_bf16 a[52:55], a[160:163], v[28:31], a[52:55]
    buffer_load_dwordx4 a[208:211], v2, s[48:51], s73 offen offset:3072 sc1
    v_mul_f32 v34, v34, v38
    v_mfma_f32_16x16x32_bf16 a[48:51], a[156:159], v[28:31], a[48:51]
    v_mul_f32 v35, v35, v39
    v_cvt_pk_bf16_f32 v36, v32, v33
    v_mfma_f32_16x16x32_bf16 a[48:51], a[120:123], v[24:27], a[48:51]
    v_cvt_pk_bf16_f32 v37, v34, v35
    v_accvgpr_write_b32 a98, v36
    v_mfma_f32_16x16x32_bf16 a[44:47], a[116:119], v[24:27], a[44:47]
    v_accvgpr_write_b32 a99, v37
    v_accvgpr_read_b32 v33, a100
    v_mfma_f32_16x16x32_bf16 a[44:47], a[152:155], v[28:31], a[44:47]
    buffer_load_dwordx4 a[212:215], v3, s[48:51], s73 offen offset:0 sc1
    v_accvgpr_read_b32 v35, a101
    v_mfma_f32_16x16x32_bf16 a[40:43], a[148:151], v[28:31], a[40:43]
    v_lshlrev_b32 v32, 16, v33
    v_and_b32 v33, 0xffff0000, v33
    v_mfma_f32_16x16x32_bf16 a[40:43], a[112:115], v[24:27], a[40:43]
    v_lshlrev_b32 v34, 16, v35
    v_and_b32 v35, 0xffff0000, v35
    v_mfma_f32_16x16x32_bf16 a[36:39], a[108:111], v[24:27], a[36:39]
    s_bfe_u32 s73, s89, 0x3000c
    s_mul_i32 s73, s73, 294912
    s_add_u32 s73, s73, s88
    v_mfma_f32_16x16x32_bf16 a[36:39], a[144:147], v[28:31], a[36:39]
    s_waitcnt lgkmcnt(0)
    s_add_u32 s73, s73, 147456
    v_mul_f32 v36, v32, v32
    v_mfma_f32_16x16x32_bf16 v[40:43], a[108:111], v[16:19], v[40:43]
    buffer_load_dwordx4 a[216:219], v1, s[48:51], s73 offen offset:0 sc1
    v_mul_f32 v37, v33, v33
    v_mfma_f32_16x16x32_bf16 v[40:43], a[144:147], v[20:23], v[40:43]
    ds_read_b128 v[24:27], v13 offset:2048
    v_mul_f32 v38, v34, v34
    v_mfma_f32_16x16x32_bf16 v[44:47], a[148:151], v[20:23], v[44:47]
    v_mul_f32 v39, v35, v35
    v_fmaak_f32 v36, v9, v36, 0xc0135761
    v_mfma_f32_16x16x32_bf16 v[44:47], a[112:115], v[16:19], v[44:47]
    ds_read_b128 v[28:31], v14 offset:2048
    v_fmaak_f32 v37, v9, v37, 0xc0135761
    v_mfma_f32_16x16x32_bf16 v[48:51], a[116:119], v[16:19], v[48:51]
    buffer_load_dwordx4 a[220:223], v1, s[48:51], s73 offen offset:1024 sc1
    v_fmaak_f32 v38, v9, v38, 0xc0135761
    v_mfma_f32_16x16x32_bf16 v[48:51], a[152:155], v[20:23], v[48:51]
    v_fmaak_f32 v39, v9, v39, 0xc0135761
    v_mul_f32 v36, v32, v36
    v_mfma_f32_16x16x32_bf16 v[52:55], a[156:159], v[20:23], v[52:55]
    v_mul_f32 v37, v33, v37
    v_mul_f32 v38, v34, v38
    v_mfma_f32_16x16x32_bf16 v[52:55], a[120:123], v[16:19], v[52:55]
    v_mul_f32 v39, v35, v39
    v_mfma_f32_16x16x32_bf16 v[56:59], a[124:127], v[16:19], v[56:59]
    buffer_load_dwordx4 a[224:227], v1, s[48:51], s73 offen offset:2048 sc1
    v_mfma_f32_16x16x32_bf16 v[56:59], a[160:163], v[20:23], v[56:59]
    v_exp_f32 v36, v36
    v_mfma_f32_16x16x32_bf16 v[60:63], a[164:167], v[20:23], v[60:63]
    v_exp_f32 v37, v37
    v_mfma_f32_16x16x32_bf16 v[60:63], a[128:131], v[16:19], v[60:63]
    v_exp_f32 v38, v38
    v_mfma_f32_16x16x32_bf16 v[64:67], a[132:135], v[16:19], v[64:67]
    v_exp_f32 v39, v39
    v_mfma_f32_16x16x32_bf16 v[64:67], a[168:171], v[20:23], v[64:67]
    buffer_load_dwordx4 a[228:231], v1, s[48:51], s73 offen offset:3072 sc1
    v_add_f32 v36, 1.0, v36
    v_mfma_f32_16x16x32_bf16 v[68:71], a[172:175], v[20:23], v[68:71]
    v_add_f32 v37, 1.0, v37
    v_add_f32 v38, 1.0, v38
    v_mfma_f32_16x16x32_bf16 v[68:71], a[136:139], v[16:19], v[68:71]
    v_add_f32 v39, 1.0, v39
    v_mfma_f32_16x16x32_bf16 v[72:75], a[140:143], v[16:19], v[72:75]
    v_rcp_f32 v36, v36
    v_mfma_f32_16x16x32_bf16 v[72:75], a[176:179], v[20:23], v[72:75]
    s_waitcnt lgkmcnt(0)
    buffer_load_dwordx4 a[232:235], v2, s[48:51], s73 offen offset:0 sc1
    v_mfma_f32_16x16x32_bf16 v[108:111], a[140:143], v[24:27], v[108:111]
    v_rcp_f32 v37, v37
    v_mfma_f32_16x16x32_bf16 v[108:111], a[176:179], v[28:31], v[108:111]
    s_waitcnt vmcnt(22)
    ds_read_b128 v[16:19], v13 offset:16384
    v_mfma_f32_16x16x32_bf16 v[104:107], a[172:175], v[28:31], v[104:107]
    v_rcp_f32 v38, v38
    v_mfma_f32_16x16x32_bf16 v[104:107], a[136:139], v[24:27], v[104:107]
    ds_read_b128 v[20:23], v14 offset:16384
    v_mfma_f32_16x16x32_bf16 v[100:103], a[132:135], v[24:27], v[100:103]
    buffer_load_dwordx4 a[236:239], v2, s[48:51], s73 offen offset:1024 sc1
    v_mfma_f32_16x16x32_bf16 v[100:103], a[168:171], v[28:31], v[100:103]
    v_rcp_f32 v39, v39
    v_mfma_f32_16x16x32_bf16 v[96:99], a[164:167], v[28:31], v[96:99]
    v_mul_f32 v32, v32, v36
    v_mul_f32 v33, v33, v37
    v_mfma_f32_16x16x32_bf16 v[96:99], a[128:131], v[24:27], v[96:99]
    v_mul_f32 v34, v34, v38
    v_mul_f32 v35, v35, v39
    v_mfma_f32_16x16x32_bf16 v[92:95], a[124:127], v[24:27], v[92:95]
    buffer_load_dwordx4 a[240:243], v2, s[48:51], s73 offen offset:2048 sc1
    v_cvt_pk_bf16_f32 v36, v32, v33
    v_mfma_f32_16x16x32_bf16 v[92:95], a[160:163], v[28:31], v[92:95]
    v_cvt_pk_bf16_f32 v37, v34, v35
    v_accvgpr_write_b32 a100, v36
    v_mfma_f32_16x16x32_bf16 v[88:91], a[156:159], v[28:31], v[88:91]
    v_accvgpr_write_b32 a101, v37
    v_accvgpr_read_b32 v33, a102
    v_mfma_f32_16x16x32_bf16 v[88:91], a[120:123], v[24:27], v[88:91]
    v_accvgpr_read_b32 v35, a103
    v_lshlrev_b32 v32, 16, v33
    v_mfma_f32_16x16x32_bf16 v[84:87], a[116:119], v[24:27], v[84:87]
    buffer_load_dwordx4 a[244:247], v2, s[48:51], s73 offen offset:3072 sc1
    v_and_b32 v33, 0xffff0000, v33
    v_mfma_f32_16x16x32_bf16 v[84:87], a[152:155], v[28:31], v[84:87]
    v_lshlrev_b32 v34, 16, v35
    v_and_b32 v35, 0xffff0000, v35
    v_mfma_f32_16x16x32_bf16 v[80:83], a[148:151], v[28:31], v[80:83]
    v_mul_f32 v36, v32, v32
    v_mul_f32 v37, v33, v33
    v_mfma_f32_16x16x32_bf16 v[80:83], a[112:115], v[24:27], v[80:83]
    v_mul_f32 v38, v34, v34
    v_mul_f32 v39, v35, v35
    v_mfma_f32_16x16x32_bf16 v[76:79], a[108:111], v[24:27], v[76:79]
    v_fmaak_f32 v36, v9, v36, 0xc0135761
    v_fmaak_f32 v37, v9, v37, 0xc0135761
    v_mfma_f32_16x16x32_bf16 v[76:79], a[144:147], v[28:31], v[76:79]
    s_waitcnt lgkmcnt(0)
    buffer_load_dwordx4 a[248:251], v3, s[48:51], s73 offen offset:0 sc1
    v_mfma_f32_16x16x32_bf16 v[112:115], a[108:111], v[16:19], v[112:115]
    v_fmaak_f32 v38, v9, v38, 0xc0135761
    v_fmaak_f32 v39, v9, v39, 0xc0135761
    v_mfma_f32_16x16x32_bf16 v[112:115], a[144:147], v[20:23], v[112:115]
    ds_read_b128 v[24:27], v13 offset:18432
    s_bfe_u32 s67, s89, 0x3000c
    v_mfma_f32_16x16x32_bf16 v[116:119], a[148:151], v[20:23], v[116:119]
    s_lshl_b32 s67, s67, 7
    s_add_u32 m0, s74, 65536
    s_add_u32 s67, s67, s85
    v_mfma_f32_16x16x32_bf16 v[116:119], a[112:115], v[16:19], v[116:119]
    ds_read_b128 v[28:31], v14 offset:18432
    v_mul_f32 v36, v32, v36
    v_mfma_f32_16x16x32_bf16 v[120:123], a[116:119], v[16:19], v[120:123]
    buffer_load_dwordx4 v4, s[40:43], s67 offen offset:0 lds
    v_mul_f32 v37, v33, v37
    v_mfma_f32_16x16x32_bf16 v[120:123], a[152:155], v[20:23], v[120:123]
    v_mul_f32 v38, v34, v38
    v_mul_f32 v39, v35, v39
    v_mfma_f32_16x16x32_bf16 v[124:127], a[156:159], v[20:23], v[124:127]
    v_exp_f32 v36, v36
    v_mfma_f32_16x16x32_bf16 v[124:127], a[120:123], v[16:19], v[124:127]
    buffer_load_dwordx4 v5, s[40:43], s67 offen offset:1024 lds
    v_mfma_f32_16x16x32_bf16 v[128:131], a[124:127], v[16:19], v[128:131]
    v_exp_f32 v37, v37
    v_mfma_f32_16x16x32_bf16 v[128:131], a[160:163], v[20:23], v[128:131]
    v_exp_f32 v38, v38
    v_mfma_f32_16x16x32_bf16 v[132:135], a[164:167], v[20:23], v[132:135]
    v_exp_f32 v39, v39
    v_mfma_f32_16x16x32_bf16 v[132:135], a[128:131], v[16:19], v[132:135]
    v_add_f32 v36, 1.0, v36
    v_add_f32 v37, 1.0, v37
    v_mfma_f32_16x16x32_bf16 v[136:139], a[132:135], v[16:19], v[136:139]
    buffer_load_dwordx4 v6, s[40:43], s67 offen offset:2048 lds
    v_add_f32 v38, 1.0, v38
    v_mfma_f32_16x16x32_bf16 v[136:139], a[168:171], v[20:23], v[136:139]
    v_add_f32 v39, 1.0, v39
    v_mfma_f32_16x16x32_bf16 v[140:143], a[172:175], v[20:23], v[140:143]
    v_rcp_f32 v36, v36
    v_mfma_f32_16x16x32_bf16 v[140:143], a[136:139], v[16:19], v[140:143]
    v_rcp_f32 v37, v37
    v_mfma_f32_16x16x32_bf16 v[144:147], a[140:143], v[16:19], v[144:147]
    buffer_load_dwordx4 v7, s[40:43], s67 offen offset:3072 lds
    v_mfma_f32_16x16x32_bf16 v[144:147], a[176:179], v[20:23], v[144:147]
    s_waitcnt lgkmcnt(0)
    v_rcp_f32 v38, v38
    v_mfma_f32_16x16x32_bf16 v[180:183], a[140:143], v[24:27], v[180:183]
    s_bfe_u32 s67, s89, 0x3000c
    s_lshl_b32 s67, s67, 7
    s_add_u32 m0, s74, 81920
    v_mfma_f32_16x16x32_bf16 v[180:183], a[176:179], v[28:31], v[180:183]
    s_waitcnt vmcnt(26)
    ds_read_b128 v[16:19], v13 offset:32768
    v_mfma_f32_16x16x32_bf16 v[176:179], a[172:175], v[28:31], v[176:179]
    s_add_u32 s67, s67, s86
    v_rcp_f32 v39, v39
    v_mfma_f32_16x16x32_bf16 v[176:179], a[136:139], v[24:27], v[176:179]
    ds_read_b128 v[20:23], v14 offset:32768
    v_mul_f32 v32, v32, v36
    v_mfma_f32_16x16x32_bf16 v[172:175], a[132:135], v[24:27], v[172:175]
    buffer_load_dwordx4 v4, s[40:43], s67 offen offset:0 lds
    v_mul_f32 v33, v33, v37
    v_mfma_f32_16x16x32_bf16 v[172:175], a[168:171], v[28:31], v[172:175]
    v_mul_f32 v34, v34, v38
    v_mul_f32 v35, v35, v39
    v_mfma_f32_16x16x32_bf16 v[168:171], a[164:167], v[28:31], v[168:171]
    v_cvt_pk_bf16_f32 v36, v32, v33
    v_cvt_pk_bf16_f32 v37, v34, v35
    v_mfma_f32_16x16x32_bf16 v[168:171], a[128:131], v[24:27], v[168:171]
    buffer_load_dwordx4 v5, s[40:43], s67 offen offset:1024 lds
    v_accvgpr_write_b32 a102, v36
    v_mfma_f32_16x16x32_bf16 v[164:167], a[124:127], v[24:27], v[164:167]
    v_accvgpr_write_b32 a103, v37
    v_accvgpr_read_b32 v33, a104
    v_mfma_f32_16x16x32_bf16 v[164:167], a[160:163], v[28:31], v[164:167]
    v_accvgpr_read_b32 v35, a105
    v_lshlrev_b32 v32, 16, v33
    v_mfma_f32_16x16x32_bf16 v[160:163], a[156:159], v[28:31], v[160:163]
    v_and_b32 v33, 0xffff0000, v33
    v_lshlrev_b32 v34, 16, v35
    v_mfma_f32_16x16x32_bf16 v[160:163], a[120:123], v[24:27], v[160:163]
    buffer_load_dwordx4 v6, s[40:43], s67 offen offset:2048 lds
    v_and_b32 v35, 0xffff0000, v35
    v_mfma_f32_16x16x32_bf16 v[156:159], a[116:119], v[24:27], v[156:159]
    v_mul_f32 v36, v32, v32
    v_mul_f32 v37, v33, v33
    v_mfma_f32_16x16x32_bf16 v[156:159], a[152:155], v[28:31], v[156:159]
    v_mul_f32 v38, v34, v34
    v_mul_f32 v39, v35, v35
    v_mfma_f32_16x16x32_bf16 v[152:155], a[148:151], v[28:31], v[152:155]
    v_fmaak_f32 v36, v9, v36, 0xc0135761
    v_fmaak_f32 v37, v9, v37, 0xc0135761
    v_mfma_f32_16x16x32_bf16 v[152:155], a[112:115], v[24:27], v[152:155]
    v_fmaak_f32 v38, v9, v38, 0xc0135761
    v_fmaak_f32 v39, v9, v39, 0xc0135761
    v_mfma_f32_16x16x32_bf16 v[148:151], a[108:111], v[24:27], v[148:151]
    buffer_load_dwordx4 v7, s[40:43], s67 offen offset:3072 lds
    v_mul_f32 v36, v32, v36
    v_mfma_f32_16x16x32_bf16 v[148:151], a[144:147], v[28:31], v[148:151]
    s_waitcnt lgkmcnt(0)
    v_mul_f32 v37, v33, v37
    v_mul_f32 v38, v34, v38
    v_mfma_f32_16x16x32_bf16 v[184:187], a[108:111], v[16:19], v[184:187]
    s_bfe_u32 s67, s89, 0x3000c
    s_lshl_b32 s67, s67, 7
    s_add_u32 m0, s74, 98304
    v_mfma_f32_16x16x32_bf16 v[184:187], a[144:147], v[20:23], v[184:187]
    ds_read_b128 v[24:27], v13 offset:34816
    s_add_u32 s67, s67, s87
    v_mfma_f32_16x16x32_bf16 v[188:191], a[148:151], v[20:23], v[188:191]
    buffer_load_dwordx4 v4, s[40:43], s67 offen offset:0 lds
    v_mul_f32 v39, v35, v39
    v_mfma_f32_16x16x32_bf16 v[188:191], a[112:115], v[16:19], v[188:191]
    ds_read_b128 v[28:31], v14 offset:34816
    v_mfma_f32_16x16x32_bf16 v[192:195], a[116:119], v[16:19], v[192:195]
    v_exp_f32 v36, v36
    v_mfma_f32_16x16x32_bf16 v[192:195], a[152:155], v[20:23], v[192:195]
    v_exp_f32 v37, v37
    v_mfma_f32_16x16x32_bf16 v[196:199], a[156:159], v[20:23], v[196:199]
    buffer_load_dwordx4 v5, s[40:43], s67 offen offset:1024 lds
    v_mfma_f32_16x16x32_bf16 v[196:199], a[120:123], v[16:19], v[196:199]
    v_exp_f32 v38, v38
    v_mfma_f32_16x16x32_bf16 v[200:203], a[124:127], v[16:19], v[200:203]
    v_exp_f32 v39, v39
    v_mfma_f32_16x16x32_bf16 v[200:203], a[160:163], v[20:23], v[200:203]
    v_add_f32 v36, 1.0, v36
    v_add_f32 v37, 1.0, v37
    v_mfma_f32_16x16x32_bf16 v[204:207], a[164:167], v[20:23], v[204:207]
    v_add_f32 v38, 1.0, v38
    v_add_f32 v39, 1.0, v39
    v_mfma_f32_16x16x32_bf16 v[204:207], a[128:131], v[16:19], v[204:207]
    buffer_load_dwordx4 v6, s[40:43], s67 offen offset:2048 lds
    v_mfma_f32_16x16x32_bf16 v[208:211], a[132:135], v[16:19], v[208:211]
    v_rcp_f32 v36, v36
    v_mfma_f32_16x16x32_bf16 v[208:211], a[168:171], v[20:23], v[208:211]
    v_rcp_f32 v37, v37
    v_mfma_f32_16x16x32_bf16 v[212:215], a[172:175], v[20:23], v[212:215]
    v_rcp_f32 v38, v38
    v_mfma_f32_16x16x32_bf16 v[212:215], a[136:139], v[16:19], v[212:215]
    buffer_load_dwordx4 v7, s[40:43], s67 offen offset:3072 lds
    v_mfma_f32_16x16x32_bf16 v[216:219], a[140:143], v[16:19], v[216:219]
    v_rcp_f32 v39, v39
    v_mfma_f32_16x16x32_bf16 v[216:219], a[176:179], v[20:23], v[216:219]
    s_waitcnt lgkmcnt(0)
    s_bfe_u32 s67, s89, 0x30010
    s_lshl_b32 s67, s67, 7
    v_mfma_f32_16x16x32_bf16 v[252:255], a[140:143], v[24:27], v[252:255]
    s_add_u32 m0, s74, 114688
    s_add_u32 s67, s67, s84
    v_mul_f32 v32, v32, v36
    v_mfma_f32_16x16x32_bf16 v[252:255], a[176:179], v[28:31], v[252:255]
    s_waitcnt vmcnt(30)
    ds_read_b128 v[16:19], v13 offset:49152
    v_mfma_f32_16x16x32_bf16 v[248:251], a[172:175], v[28:31], v[248:251]
    buffer_load_dwordx4 v4, s[40:43], s67 offen offset:0 lds
    v_mul_f32 v33, v33, v37
    v_mfma_f32_16x16x32_bf16 v[248:251], a[136:139], v[24:27], v[248:251]
    ds_read_b128 v[20:23], v14 offset:49152
    v_mul_f32 v34, v34, v38
    v_mfma_f32_16x16x32_bf16 v[244:247], a[132:135], v[24:27], v[244:247]
    v_mul_f32 v35, v35, v39
    v_cvt_pk_bf16_f32 v36, v32, v33
    v_mfma_f32_16x16x32_bf16 v[244:247], a[168:171], v[28:31], v[244:247]
    v_cvt_pk_bf16_f32 v37, v34, v35
    v_accvgpr_write_b32 a104, v36
    v_mfma_f32_16x16x32_bf16 v[240:243], a[164:167], v[28:31], v[240:243]
    buffer_load_dwordx4 v5, s[40:43], s67 offen offset:1024 lds
    v_accvgpr_write_b32 a105, v37
    v_mfma_f32_16x16x32_bf16 v[240:243], a[128:131], v[24:27], v[240:243]
    v_accvgpr_read_b32 v33, a106
    v_accvgpr_read_b32 v35, a107
    v_mfma_f32_16x16x32_bf16 v[236:239], a[124:127], v[24:27], v[236:239]
    v_lshlrev_b32 v32, 16, v33
    v_and_b32 v33, 0xffff0000, v33
    v_mfma_f32_16x16x32_bf16 v[236:239], a[160:163], v[28:31], v[236:239]
    v_lshlrev_b32 v34, 16, v35
    v_and_b32 v35, 0xffff0000, v35
    v_mfma_f32_16x16x32_bf16 v[232:235], a[156:159], v[28:31], v[232:235]
    buffer_load_dwordx4 v6, s[40:43], s67 offen offset:2048 lds
    v_mul_f32 v36, v32, v32
    v_mfma_f32_16x16x32_bf16 v[232:235], a[120:123], v[24:27], v[232:235]
    v_mul_f32 v37, v33, v33
    v_mul_f32 v38, v34, v34
    v_mfma_f32_16x16x32_bf16 v[228:231], a[116:119], v[24:27], v[228:231]
    v_mul_f32 v39, v35, v35
    v_fmaak_f32 v36, v9, v36, 0xc0135761
    v_mfma_f32_16x16x32_bf16 v[228:231], a[152:155], v[28:31], v[228:231]
    v_fmaak_f32 v37, v9, v37, 0xc0135761
    v_fmaak_f32 v38, v9, v38, 0xc0135761
    v_mfma_f32_16x16x32_bf16 v[224:227], a[148:151], v[28:31], v[224:227]
    v_fmaak_f32 v39, v9, v39, 0xc0135761
    v_mul_f32 v36, v32, v36
    v_mfma_f32_16x16x32_bf16 v[224:227], a[112:115], v[24:27], v[224:227]
    buffer_load_dwordx4 v7, s[40:43], s67 offen offset:3072 lds
    v_mul_f32 v37, v33, v37
    v_mfma_f32_16x16x32_bf16 v[220:223], a[108:111], v[24:27], v[220:223]
    v_mul_f32 v38, v34, v38
    v_mul_f32 v39, v35, v39
    v_mfma_f32_16x16x32_bf16 v[220:223], a[144:147], v[28:31], v[220:223]
    s_waitcnt vmcnt(25)
    s_waitcnt vmcnt(16)
    s_waitcnt lgkmcnt(0)
    v_mfma_f32_16x16x32_bf16 a[0:3], a[180:183], v[16:19], a[0:3]
    s_bfe_u32 s73, s89, 0x30010
    s_mul_i32 s73, s73, 294912
    s_add_u32 s73, s73, s88
    v_mfma_f32_16x16x32_bf16 a[0:3], a[216:219], v[20:23], a[0:3]
    ds_read_b128 v[24:27], v13 offset:51200
    v_mfma_f32_16x16x32_bf16 a[4:7], a[220:223], v[20:23], a[4:7]
    buffer_load_dwordx4 a[108:111], v1, s[48:51], s73 offen offset:0 sc1
    v_mfma_f32_16x16x32_bf16 a[4:7], a[184:187], v[16:19], a[4:7]
    ds_read_b128 v[28:31], v14 offset:51200
    v_mfma_f32_16x16x32_bf16 a[8:11], a[188:191], v[16:19], a[8:11]
    v_exp_f32 v36, v36
    v_mfma_f32_16x16x32_bf16 a[8:11], a[224:227], v[20:23], a[8:11]
    buffer_load_dwordx4 a[112:115], v1, s[48:51], s73 offen offset:1024 sc1
    v_mfma_f32_16x16x32_bf16 a[12:15], a[228:231], v[20:23], a[12:15]
    v_exp_f32 v37, v37
    v_mfma_f32_16x16x32_bf16 a[12:15], a[192:195], v[16:19], a[12:15]
    v_exp_f32 v38, v38
    v_mfma_f32_16x16x32_bf16 a[16:19], a[196:199], v[16:19], a[16:19]
    v_exp_f32 v39, v39
    v_mfma_f32_16x16x32_bf16 a[16:19], a[232:235], v[20:23], a[16:19]
    v_add_f32 v36, 1.0, v36
    v_add_f32 v37, 1.0, v37
    v_mfma_f32_16x16x32_bf16 a[20:23], a[236:239], v[20:23], a[20:23]
    buffer_load_dwordx4 a[116:119], v1, s[48:51], s73 offen offset:2048 sc1
    v_add_f32 v38, 1.0, v38
    v_mfma_f32_16x16x32_bf16 a[20:23], a[200:203], v[16:19], a[20:23]
    v_add_f32 v39, 1.0, v39
    v_mfma_f32_16x16x32_bf16 a[24:27], a[204:207], v[16:19], a[24:27]
    v_rcp_f32 v36, v36
    v_mfma_f32_16x16x32_bf16 a[24:27], a[240:243], v[20:23], a[24:27]
    v_rcp_f32 v37, v37
    v_mfma_f32_16x16x32_bf16 a[28:31], a[244:247], v[20:23], a[28:31]
    buffer_load_dwordx4 a[120:123], v1, s[48:51], s73 offen offset:3072 sc1
    v_mfma_f32_16x16x32_bf16 a[28:31], a[208:211], v[16:19], a[28:31]
    v_rcp_f32 v38, v38
    v_mfma_f32_16x16x32_bf16 a[32:35], a[212:215], v[16:19], a[32:35]
    v_rcp_f32 v39, v39
    v_mfma_f32_16x16x32_bf16 a[32:35], a[248:251], v[20:23], a[32:35]
    s_waitcnt lgkmcnt(0)
    v_mul_f32 v32, v32, v36
    v_mul_f32 v33, v33, v37
    v_mfma_f32_16x16x32_bf16 a[68:71], a[212:215], v[24:27], a[68:71]
    buffer_load_dwordx4 a[124:127], v2, s[48:51], s73 offen offset:0 sc1
    v_add_u32 v13, s75, v12
    v_mfma_f32_16x16x32_bf16 a[68:71], a[248:251], v[28:31], a[68:71]
    s_waitcnt vmcnt(17)
    ds_read_b128 v[16:19], v13 offset:0
    v_mfma_f32_16x16x32_bf16 a[64:67], a[244:247], v[28:31], a[64:67]
    v_xad_u32 v14, v12, 64, s75
    s_barrier
    s_cmp_lg_u32 s3, 0
    s_cbranch_scc1 KM_nj
    v_mov_b32 v8, s95
    s_mov_b64 exec, 1
    buffer_store_dword v8, v1, s[48:51], s90 offen sc1
    s_mov_b64 exec, -1
KM_nj:
    v_mfma_f32_16x16x32_bf16 a[64:67], a[208:211], v[24:27], a[64:67]
    ds_read_b128 v[20:23], v14 offset:0
    v_mul_f32 v34, v34, v38
    v_mfma_f32_16x16x32_bf16 a[60:63], a[204:207], v[24:27], a[60:63]
    v_mul_f32 v35, v35, v39
    v_cvt_pk_bf16_f32 v36, v32, v33
    v_mfma_f32_16x16x32_bf16 a[60:63], a[240:243], v[28:31], a[60:63]
    buffer_load_dwordx4 a[128:131], v2, s[48:51], s73 offen offset:1024 sc1
    v_cvt_pk_bf16_f32 v37, v34, v35
    v_mfma_f32_16x16x32_bf16 a[56:59], a[236:239], v[28:31], a[56:59]
    v_accvgpr_write_b32 a106, v36
    v_accvgpr_write_b32 a107, v37
    v_mfma_f32_16x16x32_bf16 a[56:59], a[200:203], v[24:27], a[56:59]
    v_mfma_f32_16x16x32_bf16 a[52:55], a[196:199], v[24:27], a[52:55]
    v_mfma_f32_16x16x32_bf16 a[52:55], a[232:235], v[28:31], a[52:55]
    buffer_load_dwordx4 a[132:135], v2, s[48:51], s73 offen offset:2048 sc1
    v_mfma_f32_16x16x32_bf16 a[48:51], a[228:231], v[28:31], a[48:51]
    v_mfma_f32_16x16x32_bf16 a[48:51], a[192:195], v[24:27], a[48:51]
    v_mfma_f32_16x16x32_bf16 a[44:47], a[188:191], v[24:27], a[44:47]
    v_mfma_f32_16x16x32_bf16 a[44:47], a[224:227], v[28:31], a[44:47]
    v_mfma_f32_16x16x32_bf16 a[40:43], a[220:223], v[28:31], a[40:43]
    buffer_load_dwordx4 a[136:139], v2, s[48:51], s73 offen offset:3072 sc1
    v_mfma_f32_16x16x32_bf16 a[40:43], a[184:187], v[24:27], a[40:43]
    v_mfma_f32_16x16x32_bf16 a[36:39], a[180:183], v[24:27], a[36:39]
    v_mfma_f32_16x16x32_bf16 a[36:39], a[216:219], v[28:31], a[36:39]
    s_waitcnt lgkmcnt(0)
    v_mfma_f32_16x16x32_bf16 v[40:43], a[180:183], v[16:19], v[40:43]
    buffer_load_dwordx4 a[140:143], v3, s[48:51], s73 offen offset:0 sc1
    v_mfma_f32_16x16x32_bf16 v[40:43], a[216:219], v[20:23], v[40:43]
    ds_read_b128 v[24:27], v13 offset:2048
    v_mfma_f32_16x16x32_bf16 v[44:47], a[220:223], v[20:23], v[44:47]
    s_bfe_u32 s73, s89, 0x30010
    s_mul_i32 s73, s73, 294912
    s_add_u32 s73, s73, s88
    v_mfma_f32_16x16x32_bf16 v[44:47], a[184:187], v[16:19], v[44:47]
    ds_read_b128 v[28:31], v14 offset:2048
    s_add_u32 s73, s73, 147456
    v_mfma_f32_16x16x32_bf16 v[48:51], a[188:191], v[16:19], v[48:51]
    buffer_load_dwordx4 a[144:147], v1, s[48:51], s73 offen offset:0 sc1
    v_mfma_f32_16x16x32_bf16 v[48:51], a[224:227], v[20:23], v[48:51]
    v_mfma_f32_16x16x32_bf16 v[52:55], a[228:231], v[20:23], v[52:55]
    v_mfma_f32_16x16x32_bf16 v[52:55], a[192:195], v[16:19], v[52:55]
    v_mfma_f32_16x16x32_bf16 v[56:59], a[196:199], v[16:19], v[56:59]
    v_mfma_f32_16x16x32_bf16 v[56:59], a[232:235], v[20:23], v[56:59]
    buffer_load_dwordx4 a[148:151], v1, s[48:51], s73 offen offset:1024 sc1
    v_mfma_f32_16x16x32_bf16 v[60:63], a[236:239], v[20:23], v[60:63]
    v_mfma_f32_16x16x32_bf16 v[60:63], a[200:203], v[16:19], v[60:63]
    v_mfma_f32_16x16x32_bf16 v[64:67], a[204:207], v[16:19], v[64:67]
    v_mfma_f32_16x16x32_bf16 v[64:67], a[240:243], v[20:23], v[64:67]
    buffer_load_dwordx4 a[152:155], v1, s[48:51], s73 offen offset:2048 sc1
    v_mfma_f32_16x16x32_bf16 v[68:71], a[244:247], v[20:23], v[68:71]
    v_mfma_f32_16x16x32_bf16 v[68:71], a[208:211], v[16:19], v[68:71]
    v_mfma_f32_16x16x32_bf16 v[72:75], a[212:215], v[16:19], v[72:75]
    v_mfma_f32_16x16x32_bf16 v[72:75], a[248:251], v[20:23], v[72:75]
    s_waitcnt lgkmcnt(0)
    buffer_load_dwordx4 a[156:159], v1, s[48:51], s73 offen offset:3072 sc1
    v_mfma_f32_16x16x32_bf16 v[108:111], a[212:215], v[24:27], v[108:111]
    v_mfma_f32_16x16x32_bf16 v[108:111], a[248:251], v[28:31], v[108:111]
    s_waitcnt vmcnt(21)
    ds_read_b128 v[16:19], v13 offset:16384
    v_mfma_f32_16x16x32_bf16 v[104:107], a[244:247], v[28:31], v[104:107]
    v_mfma_f32_16x16x32_bf16 v[104:107], a[208:211], v[24:27], v[104:107]
    ds_read_b128 v[20:23], v14 offset:16384
    v_mfma_f32_16x16x32_bf16 v[100:103], a[204:207], v[24:27], v[100:103]
    buffer_load_dwordx4 a[160:163], v2, s[48:51], s73 offen offset:0 sc1
    v_mfma_f32_16x16x32_bf16 v[100:103], a[240:243], v[28:31], v[100:103]
    v_mfma_f32_16x16x32_bf16 v[96:99], a[236:239], v[28:31], v[96:99]
    v_mfma_f32_16x16x32_bf16 v[96:99], a[200:203], v[24:27], v[96:99]
    v_mfma_f32_16x16x32_bf16 v[92:95], a[196:199], v[24:27], v[92:95]
    buffer_load_dwordx4 a[164:167], v2, s[48:51], s73 offen offset:1024 sc1
    v_mfma_f32_16x16x32_bf16 v[92:95], a[232:235], v[28:31], v[92:95]
    v_mfma_f32_16x16x32_bf16 v[88:91], a[228:231], v[28:31], v[88:91]
    v_mfma_f32_16x16x32_bf16 v[88:91], a[192:195], v[24:27], v[88:91]
    v_mfma_f32_16x16x32_bf16 v[84:87], a[188:191], v[24:27], v[84:87]
    v_mfma_f32_16x16x32_bf16 v[84:87], a[224:227], v[28:31], v[84:87]
    buffer_load_dwordx4 a[168:171], v2, s[48:51], s73 offen offset:2048 sc1
    v_mfma_f32_16x16x32_bf16 v[80:83], a[220:223], v[28:31], v[80:83]
    v_mfma_f32_16x16x32_bf16 v[80:83], a[184:187], v[24:27], v[80:83]
    v_mfma_f32_16x16x32_bf16 v[76:79], a[180:183], v[24:27], v[76:79]
    v_mfma_f32_16x16x32_bf16 v[76:79], a[216:219], v[28:31], v[76:79]
    s_waitcnt lgkmcnt(0)
    buffer_load_dwordx4 a[172:175], v2, s[48:51], s73 offen offset:3072 sc1
    v_mfma_f32_16x16x32_bf16 v[112:115], a[180:183], v[16:19], v[112:115]
    v_mfma_f32_16x16x32_bf16 v[112:115], a[216:219], v[20:23], v[112:115]
    ds_read_b128 v[24:27], v13 offset:18432
    v_mfma_f32_16x16x32_bf16 v[116:119], a[220:223], v[20:23], v[116:119]
    v_mfma_f32_16x16x32_bf16 v[116:119], a[184:187], v[16:19], v[116:119]
    ds_read_b128 v[28:31], v14 offset:18432
    v_mfma_f32_16x16x32_bf16 v[120:123], a[188:191], v[16:19], v[120:123]
    buffer_load_dwordx4 a[176:179], v3, s[48:51], s73 offen offset:0 sc1
    v_mfma_f32_16x16x32_bf16 v[120:123], a[224:227], v[20:23], v[120:123]
    v_mfma_f32_16x16x32_bf16 v[124:127], a[228:231], v[20:23], v[124:127]
    s_bfe_u32 s67, s89, 0x30010
    s_lshl_b32 s67, s67, 7
    s_add_u32 m0, s74, 131072
    v_mfma_f32_16x16x32_bf16 v[124:127], a[192:195], v[16:19], v[124:127]
    s_add_u32 s67, s67, s85
    v_mfma_f32_16x16x32_bf16 v[128:131], a[196:199], v[16:19], v[128:131]
    buffer_load_dwordx4 v4, s[40:43], s67 offen offset:0 lds
    v_mfma_f32_16x16x32_bf16 v[128:131], a[232:235], v[20:23], v[128:131]
    v_mfma_f32_16x16x32_bf16 v[132:135], a[236:239], v[20:23], v[132:135]
    v_mfma_f32_16x16x32_bf16 v[132:135], a[200:203], v[16:19], v[132:135]
    v_mfma_f32_16x16x32_bf16 v[136:139], a[204:207], v[16:19], v[136:139]
    buffer_load_dwordx4 v5, s[40:43], s67 offen offset:1024 lds
    v_mfma_f32_16x16x32_bf16 v[136:139], a[240:243], v[20:23], v[136:139]
    v_mfma_f32_16x16x32_bf16 v[140:143], a[244:247], v[20:23], v[140:143]
    v_mfma_f32_16x16x32_bf16 v[140:143], a[208:211], v[16:19], v[140:143]
    v_mfma_f32_16x16x32_bf16 v[144:147], a[212:215], v[16:19], v[144:147]
    buffer_load_dwordx4 v6, s[40:43], s67 offen offset:2048 lds
    v_mfma_f32_16x16x32_bf16 v[144:147], a[248:251], v[20:23], v[144:147]
    s_waitcnt lgkmcnt(0)
    v_mfma_f32_16x16x32_bf16 v[180:183], a[212:215], v[24:27], v[180:183]
    v_mfma_f32_16x16x32_bf16 v[180:183], a[248:251], v[28:31], v[180:183]
    s_waitcnt vmcnt(25)
    ds_read_b128 v[16:19], v13 offset:32768
    v_mfma_f32_16x16x32_bf16 v[176:179], a[244:247], v[28:31], v[176:179]
    v_mfma_f32_16x16x32_bf16 v[176:179], a[208:211], v[24:27], v[176:179]
    ds_read_b128 v[20:23], v14 offset:32768
    v_mfma_f32_16x16x32_bf16 v[172:175], a[204:207], v[24:27], v[172:175]
    buffer_load_dwordx4 v7, s[40:43], s67 offen offset:3072 lds
    v_mfma_f32_16x16x32_bf16 v[172:175], a[240:243], v[28:31], v[172:175]
    s_bfe_u32 s67, s89, 0x30010
    s_lshl_b32 s67, s67, 7
    s_add_u32 m0, s74, 147456
    v_mfma_f32_16x16x32_bf16 v[168:171], a[236:239], v[28:31], v[168:171]
    s_add_u32 s67, s67, s86
    v_mfma_f32_16x16x32_bf16 v[168:171], a[200:203], v[24:27], v[168:171]
    buffer_load_dwordx4 v4, s[40:43], s67 offen offset:0 lds
    v_mfma_f32_16x16x32_bf16 v[164:167], a[196:199], v[24:27], v[164:167]
    v_mfma_f32_16x16x32_bf16 v[164:167], a[232:235], v[28:31], v[164:167]
    v_mfma_f32_16x16x32_bf16 v[160:163], a[228:231], v[28:31], v[160:163]
    v_mfma_f32_16x16x32_bf16 v[160:163], a[192:195], v[24:27], v[160:163]
    v_mfma_f32_16x16x32_bf16 v[156:159], a[188:191], v[24:27], v[156:159]
    buffer_load_dwordx4 v5, s[40:43], s67 offen offset:1024 lds
    v_mfma_f32_16x16x32_bf16 v[156:159], a[224:227], v[28:31], v[156:159]
    v_mfma_f32_16x16x32_bf16 v[152:155], a[220:223], v[28:31], v[152:155]
    v_mfma_f32_16x16x32_bf16 v[152:155], a[184:187], v[24:27], v[152:155]
    v_mfma_f32_16x16x32_bf16 v[148:151], a[180:183], v[24:27], v[148:151]
    buffer_load_dwordx4 v6, s[40:43], s67 offen offset:2048 lds
    v_mfma_f32_16x16x32_bf16 v[148:151], a[216:219], v[28:31], v[148:151]
    s_waitcnt lgkmcnt(0)
    v_mfma_f32_16x16x32_bf16 v[184:187], a[180:183], v[16:19], v[184:187]
    v_mfma_f32_16x16x32_bf16 v[184:187], a[216:219], v[20:23], v[184:187]
    ds_read_b128 v[24:27], v13 offset:34816
    v_mfma_f32_16x16x32_bf16 v[188:191], a[220:223], v[20:23], v[188:191]
    buffer_load_dwordx4 v7, s[40:43], s67 offen offset:3072 lds
    v_mfma_f32_16x16x32_bf16 v[188:191], a[184:187], v[16:19], v[188:191]
    ds_read_b128 v[28:31], v14 offset:34816
    v_mfma_f32_16x16x32_bf16 v[192:195], a[188:191], v[16:19], v[192:195]
    v_mfma_f32_16x16x32_bf16 v[192:195], a[224:227], v[20:23], v[192:195]
    s_bfe_u32 s67, s89, 0x30010
    s_lshl_b32 s67, s67, 7
    s_add_u32 m0, s74, 0
    v_mfma_f32_16x16x32_bf16 v[196:199], a[228:231], v[20:23], v[196:199]
    s_add_u32 s67, s67, s87
    v_mfma_f32_16x16x32_bf16 v[196:199], a[192:195], v[16:19], v[196:199]
    buffer_load_dwordx4 v4, s[40:43], s67 offen offset:0 lds
    v_mfma_f32_16x16x32_bf16 v[200:203], a[196:199], v[16:19], v[200:203]
    v_mfma_f32_16x16x32_bf16 v[200:203], a[232:235], v[20:23], v[200:203]
    v_mfma_f32_16x16x32_bf16 v[204:207], a[236:239], v[20:23], v[204:207]
    v_mfma_f32_16x16x32_bf16 v[204:207], a[200:203], v[16:19], v[204:207]
    buffer_load_dwordx4 v5, s[40:43], s67 offen offset:1024 lds
    v_mfma_f32_16x16x32_bf16 v[208:211], a[204:207], v[16:19], v[208:211]
    v_mfma_f32_16x16x32_bf16 v[208:211], a[240:243], v[20:23], v[208:211]
    v_mfma_f32_16x16x32_bf16 v[212:215], a[244:247], v[20:23], v[212:215]
    v_mfma_f32_16x16x32_bf16 v[212:215], a[208:211], v[16:19], v[212:215]
    buffer_load_dwordx4 v6, s[40:43], s67 offen offset:2048 lds
    v_mfma_f32_16x16x32_bf16 v[216:219], a[212:215], v[16:19], v[216:219]
    v_mfma_f32_16x16x32_bf16 v[216:219], a[248:251], v[20:23], v[216:219]
    s_waitcnt lgkmcnt(0)
    v_mfma_f32_16x16x32_bf16 v[252:255], a[212:215], v[24:27], v[252:255]
    v_mfma_f32_16x16x32_bf16 v[252:255], a[248:251], v[28:31], v[252:255]
    s_waitcnt vmcnt(29)
    ds_read_b128 v[16:19], v13 offset:49152
    v_mfma_f32_16x16x32_bf16 v[248:251], a[244:247], v[28:31], v[248:251]
    buffer_load_dwordx4 v7, s[40:43], s67 offen offset:3072 lds
    v_mfma_f32_16x16x32_bf16 v[248:251], a[208:211], v[24:27], v[248:251]
    ds_read_b128 v[20:23], v14 offset:49152
    v_mfma_f32_16x16x32_bf16 v[244:247], a[204:207], v[24:27], v[244:247]
    s_bfe_u32 s67, s89, 0x30014
    s_lshl_b32 s67, s67, 7
    s_add_u32 m0, s74, 16384
    v_mfma_f32_16x16x32_bf16 v[244:247], a[240:243], v[28:31], v[244:247]
    s_add_u32 s67, s67, s84
    v_mfma_f32_16x16x32_bf16 v[240:243], a[236:239], v[28:31], v[240:243]
    buffer_load_dwordx4 v4, s[40:43], s67 offen offset:0 lds
    v_mfma_f32_16x16x32_bf16 v[240:243], a[200:203], v[24:27], v[240:243]
    v_mfma_f32_16x16x32_bf16 v[236:239], a[196:199], v[24:27], v[236:239]
    v_mfma_f32_16x16x32_bf16 v[236:239], a[232:235], v[28:31], v[236:239]
    v_mfma_f32_16x16x32_bf16 v[232:235], a[228:231], v[28:31], v[232:235]
    v_mfma_f32_16x16x32_bf16 v[232:235], a[192:195], v[24:27], v[232:235]
    buffer_load_dwordx4 v5, s[40:43], s67 offen offset:1024 lds
    v_mfma_f32_16x16x32_bf16 v[228:231], a[188:191], v[24:27], v[228:231]
    v_mfma_f32_16x16x32_bf16 v[228:231], a[224:227], v[28:31], v[228:231]
    v_mfma_f32_16x16x32_bf16 v[224:227], a[220:223], v[28:31], v[224:227]
    v_mfma_f32_16x16x32_bf16 v[224:227], a[184:187], v[24:27], v[224:227]
    buffer_load_dwordx4 v6, s[40:43], s67 offen offset:2048 lds
    v_mfma_f32_16x16x32_bf16 v[220:223], a[180:183], v[24:27], v[220:223]
    v_mfma_f32_16x16x32_bf16 v[220:223], a[216:219], v[28:31], v[220:223]
    s_waitcnt vmcnt(24)
    s_waitcnt vmcnt(15)
    s_waitcnt lgkmcnt(0)
    v_mfma_f32_16x16x32_bf16 a[0:3], a[108:111], v[16:19], a[0:3]
    v_mfma_f32_16x16x32_bf16 a[0:3], a[144:147], v[20:23], a[0:3]
    ds_read_b128 v[24:27], v13 offset:51200
    v_mfma_f32_16x16x32_bf16 a[4:7], a[148:151], v[20:23], a[4:7]
    buffer_load_dwordx4 v7, s[40:43], s67 offen offset:3072 lds
    v_mfma_f32_16x16x32_bf16 a[4:7], a[112:115], v[16:19], a[4:7]
    ds_read_b128 v[28:31], v14 offset:51200
    v_mfma_f32_16x16x32_bf16 a[8:11], a[116:119], v[16:19], a[8:11]
    s_bfe_u32 s73, s89, 0x30014
    s_mul_i32 s73, s73, 294912
    s_add_u32 s73, s73, s88
    v_mfma_f32_16x16x32_bf16 a[8:11], a[152:155], v[20:23], a[8:11]
    v_mfma_f32_16x16x32_bf16 a[12:15], a[156:159], v[20:23], a[12:15]
    buffer_load_dwordx4 a[180:183], v1, s[48:51], s73 offen offset:0 sc1
    v_mfma_f32_16x16x32_bf16 a[12:15], a[120:123], v[16:19], a[12:15]
    v_mfma_f32_16x16x32_bf16 a[16:19], a[124:127], v[16:19], a[16:19]
    v_mfma_f32_16x16x32_bf16 a[16:19], a[160:163], v[20:23], a[16:19]
    v_mfma_f32_16x16x32_bf16 a[20:23], a[164:167], v[20:23], a[20:23]
    buffer_load_dwordx4 a[184:187], v1, s[48:51], s73 offen offset:1024 sc1
    v_mfma_f32_16x16x32_bf16 a[20:23], a[128:131], v[16:19], a[20:23]
    v_mfma_f32_16x16x32_bf16 a[24:27], a[132:135], v[16:19], a[24:27]
    v_mfma_f32_16x16x32_bf16 a[24:27], a[168:171], v[20:23], a[24:27]
    v_mfma_f32_16x16x32_bf16 a[28:31], a[172:175], v[20:23], a[28:31]
    buffer_load_dwordx4 a[188:191], v1, s[48:51], s73 offen offset:2048 sc1
    v_mfma_f32_16x16x32_bf16 a[28:31], a[136:139], v[16:19], a[28:31]
    v_mfma_f32_16x16x32_bf16 a[32:35], a[140:143], v[16:19], a[32:35]
    v_mfma_f32_16x16x32_bf16 a[32:35], a[176:179], v[20:23], a[32:35]
    s_waitcnt lgkmcnt(0)
    v_mfma_f32_16x16x32_bf16 a[68:71], a[140:143], v[24:27], a[68:71]
    v_add_u32 v13, s63, v12
    v_mfma_f32_16x16x32_bf16 a[68:71], a[176:179], v[28:31], a[68:71]
    s_waitcnt vmcnt(15)
    ds_read_b128 v[16:19], v13 offset:0
    v_mfma_f32_16x16x32_bf16 a[64:67], a[172:175], v[28:31], a[64:67]
    buffer_load_dwordx4 a[192:195], v1, s[48:51], s73 offen offset:3072 sc1
    v_xad_u32 v14, v12, 64, s63
    v_mfma_f32_16x16x32_bf16 a[64:67], a[136:139], v[24:27], a[64:67]
    ds_read_b128 v[20:23], v14 offset:0
    v_mfma_f32_16x16x32_bf16 a[60:63], a[132:135], v[24:27], a[60:63]
    v_mfma_f32_16x16x32_bf16 a[60:63], a[168:171], v[28:31], a[60:63]
    buffer_load_dwordx4 a[196:199], v2, s[48:51], s73 offen offset:0 sc1
    v_mfma_f32_16x16x32_bf16 a[56:59], a[164:167], v[28:31], a[56:59]
    v_mfma_f32_16x16x32_bf16 a[56:59], a[128:131], v[24:27], a[56:59]
    v_mfma_f32_16x16x32_bf16 a[52:55], a[124:127], v[24:27], a[52:55]
    v_mfma_f32_16x16x32_bf16 a[52:55], a[160:163], v[28:31], a[52:55]
    v_mfma_f32_16x16x32_bf16 a[48:51], a[156:159], v[28:31], a[48:51]
    buffer_load_dwordx4 a[200:203], v2, s[48:51], s73 offen offset:1024 sc1
    v_mfma_f32_16x16x32_bf16 a[48:51], a[120:123], v[24:27], a[48:51]
    v_mfma_f32_16x16x32_bf16 a[44:47], a[116:119], v[24:27], a[44:47]
    v_mfma_f32_16x16x32_bf16 a[44:47], a[152:155], v[28:31], a[44:47]
    v_mfma_f32_16x16x32_bf16 a[40:43], a[148:151], v[28:31], a[40:43]
    buffer_load_dwordx4 a[204:207], v2, s[48:51], s73 offen offset:2048 sc1
    v_mfma_f32_16x16x32_bf16 a[40:43], a[112:115], v[24:27], a[40:43]
    v_mfma_f32_16x16x32_bf16 a[36:39], a[108:111], v[24:27], a[36:39]
    v_mfma_f32_16x16x32_bf16 a[36:39], a[144:147], v[28:31], a[36:39]
    s_waitcnt lgkmcnt(0)
    v_mfma_f32_16x16x32_bf16 v[40:43], a[108:111], v[16:19], v[40:43]
    buffer_load_dwordx4 a[208:211], v2, s[48:51], s73 offen offset:3072 sc1
    v_mfma_f32_16x16x32_bf16 v[40:43], a[144:147], v[20:23], v[40:43]
    ds_read_b128 v[24:27], v13 offset:2048
    v_mfma_f32_16x16x32_bf16 v[44:47], a[148:151], v[20:23], v[44:47]
    v_mfma_f32_16x16x32_bf16 v[44:47], a[112:115], v[16:19], v[44:47]
    ds_read_b128 v[28:31], v14 offset:2048
    v_mfma_f32_16x16x32_bf16 v[48:51], a[116:119], v[16:19], v[48:51]
    v_mfma_f32_16x16x32_bf16 v[48:51], a[152:155], v[20:23], v[48:51]
    buffer_load_dwordx4 a[212:215], v3, s[48:51], s73 offen offset:0 sc1
    v_mfma_f32_16x16x32_bf16 v[52:55], a[156:159], v[20:23], v[52:55]
    v_mfma_f32_16x16x32_bf16 v[52:55], a[120:123], v[16:19], v[52:55]
    s_bfe_u32 s73, s89, 0x30014
    s_mul_i32 s73, s73, 294912
    s_add_u32 s73, s73, s88
    v_mfma_f32_16x16x32_bf16 v[56:59], a[124:127], v[16:19], v[56:59]
    s_add_u32 s73, s73, 147456
    v_mfma_f32_16x16x32_bf16 v[56:59], a[160:163], v[20:23], v[56:59]
    buffer_load_dwordx4 a[216:219], v1, s[48:51], s73 offen offset:0 sc1
    v_mfma_f32_16x16x32_bf16 v[60:63], a[164:167], v[20:23], v[60:63]
    v_mfma_f32_16x16x32_bf16 v[60:63], a[128:131], v[16:19], v[60:63]
    v_mfma_f32_16x16x32_bf16 v[64:67], a[132:135], v[16:19], v[64:67]
    v_mfma_f32_16x16x32_bf16 v[64:67], a[168:171], v[20:23], v[64:67]
    buffer_load_dwordx4 a[220:223], v1, s[48:51], s73 offen offset:1024 sc1
    v_mfma_f32_16x16x32_bf16 v[68:71], a[172:175], v[20:23], v[68:71]
    v_mfma_f32_16x16x32_bf16 v[68:71], a[136:139], v[16:19], v[68:71]
    v_mfma_f32_16x16x32_bf16 v[72:75], a[140:143], v[16:19], v[72:75]
    v_mfma_f32_16x16x32_bf16 v[72:75], a[176:179], v[20:23], v[72:75]
    s_waitcnt lgkmcnt(0)
    v_mfma_f32_16x16x32_bf16 v[108:111], a[140:143], v[24:27], v[108:111]
    buffer_load_dwordx4 a[224:227], v1, s[48:51], s73 offen offset:2048 sc1
    v_mfma_f32_16x16x32_bf16 v[108:111], a[176:179], v[28:31], v[108:111]
    s_waitcnt vmcnt(20)
    ds_read_b128 v[16:19], v13 offset:16384
    v_mfma_f32_16x16x32_bf16 v[104:107], a[172:175], v[28:31], v[104:107]
    v_mfma_f32_16x16x32_bf16 v[104:107], a[136:139], v[24:27], v[104:107]
    ds_read_b128 v[20:23], v14 offset:16384
    v_mfma_f32_16x16x32_bf16 v[100:103], a[132:135], v[24:27], v[100:103]
    buffer_load_dwordx4 a[228:231], v1, s[48:51], s73 offen offset:3072 sc1
    v_mfma_f32_16x16x32_bf16 v[100:103], a[168:171], v[28:31], v[100:103]
    v_mfma_f32_16x16x32_bf16 v[96:99], a[164:167], v[28:31], v[96:99]
    v_mfma_f32_16x16x32_bf16 v[96:99], a[128:131], v[24:27], v[96:99]
    v_mfma_f32_16x16x32_bf16 v[92:95], a[124:127], v[24:27], v[92:95]
    v_mfma_f32_16x16x32_bf16 v[92:95], a[160:163], v[28:31], v[92:95]
    buffer_load_dwordx4 a[232:235], v2, s[48:51], s73 offen offset:0 sc1
    v_mfma_f32_16x16x32_bf16 v[88:91], a[156:159], v[28:31], v[88:91]
    v_mfma_f32_16x16x32_bf16 v[88:91], a[120:123], v[24:27], v[88:91]
    v_mfma_f32_16x16x32_bf16 v[84:87], a[116:119], v[24:27], v[84:87]
    v_mfma_f32_16x16x32_bf16 v[84:87], a[152:155], v[28:31], v[84:87]
    buffer_load_dwordx4 a[236:239], v2, s[48:51], s73 offen offset:1024 sc1
    v_mfma_f32_16x16x32_bf16 v[80:83], a[148:151], v[28:31], v[80:83]
    v_mfma_f32_16x16x32_bf16 v[80:83], a[112:115], v[24:27], v[80:83]
    v_mfma_f32_16x16x32_bf16 v[76:79], a[108:111], v[24:27], v[76:79]
    v_mfma_f32_16x16x32_bf16 v[76:79], a[144:147], v[28:31], v[76:79]
    s_waitcnt lgkmcnt(0)
    buffer_load_dwordx4 a[240:243], v2, s[48:51], s73 offen offset:2048 sc1
    v_mfma_f32_16x16x32_bf16 v[112:115], a[108:111], v[16:19], v[112:115]
    v_mfma_f32_16x16x32_bf16 v[112:115], a[144:147], v[20:23], v[112:115]
    ds_read_b128 v[24:27], v13 offset:18432
    v_mfma_f32_16x16x32_bf16 v[116:119], a[148:151], v[20:23], v[116:119]
    v_mfma_f32_16x16x32_bf16 v[116:119], a[112:115], v[16:19], v[116:119]
    ds_read_b128 v[28:31], v14 offset:18432
    v_mfma_f32_16x16x32_bf16 v[120:123], a[116:119], v[16:19], v[120:123]
    buffer_load_dwordx4 a[244:247], v2, s[48:51], s73 offen offset:3072 sc1
    v_mfma_f32_16x16x32_bf16 v[120:123], a[152:155], v[20:23], v[120:123]
    v_mfma_f32_16x16x32_bf16 v[124:127], a[156:159], v[20:23], v[124:127]
    v_mfma_f32_16x16x32_bf16 v[124:127], a[120:123], v[16:19], v[124:127]
    v_mfma_f32_16x16x32_bf16 v[128:131], a[124:127], v[16:19], v[128:131]
    buffer_load_dwordx4 a[248:251], v3, s[48:51], s73 offen offset:0 sc1
    v_mfma_f32_16x16x32_bf16 v[128:131], a[160:163], v[20:23], v[128:131]
    v_mfma_f32_16x16x32_bf16 v[132:135], a[164:167], v[20:23], v[132:135]
    s_bfe_u32 s67, s89, 0x30014
    s_lshl_b32 s67, s67, 7
    s_add_u32 m0, s74, 32768
    v_mfma_f32_16x16x32_bf16 v[132:135], a[128:131], v[16:19], v[132:135]
    s_add_u32 s67, s67, s85
    v_mfma_f32_16x16x32_bf16 v[136:139], a[132:135], v[16:19], v[136:139]
    buffer_load_dwordx4 v4, s[40:43], s67 offen offset:0 lds
    v_mfma_f32_16x16x32_bf16 v[136:139], a[168:171], v[20:23], v[136:139]
    v_mfma_f32_16x16x32_bf16 v[140:143], a[172:175], v[20:23], v[140:143]
    v_mfma_f32_16x16x32_bf16 v[140:143], a[136:139], v[16:19], v[140:143]
    v_mfma_f32_16x16x32_bf16 v[144:147], a[140:143], v[16:19], v[144:147]
    v_mfma_f32_16x16x32_bf16 v[144:147], a[176:179], v[20:23], v[144:147]
    s_waitcnt lgkmcnt(0)
    buffer_load_dwordx4 v5, s[40:43], s67 offen offset:1024 lds
    v_mfma_f32_16x16x32_bf16 v[180:183], a[140:143], v[24:27], v[180:183]
    v_add_u32 v13, 0, v12
    v_mfma_f32_16x16x32_bf16 v[180:183], a[176:179], v[28:31], v[180:183]
    s_waitcnt vmcnt(24)
    ds_read_b128 v[16:19], v13 offset:0
    v_mfma_f32_16x16x32_bf16 v[176:179], a[172:175], v[28:31], v[176:179]
    v_xad_u32 v14, v12, 64, 0
    v_mfma_f32_16x16x32_bf16 v[176:179], a[136:139], v[24:27], v[176:179]
    ds_read_b128 v[20:23], v14 offset:0
    v_mfma_f32_16x16x32_bf16 v[172:175], a[132:135], v[24:27], v[172:175]
    buffer_load_dwordx4 v6, s[40:43], s67 offen offset:2048 lds
    v_mfma_f32_16x16x32_bf16 v[172:175], a[168:171], v[28:31], v[172:175]
    v_mfma_f32_16x16x32_bf16 v[168:171], a[164:167], v[28:31], v[168:171]
    v_mfma_f32_16x16x32_bf16 v[168:171], a[128:131], v[24:27], v[168:171]
    v_mfma_f32_16x16x32_bf16 v[164:167], a[124:127], v[24:27], v[164:167]
    buffer_load_dwordx4 v7, s[40:43], s67 offen offset:3072 lds
    v_mfma_f32_16x16x32_bf16 v[164:167], a[160:163], v[28:31], v[164:167]
    v_mfma_f32_16x16x32_bf16 v[160:163], a[156:159], v[28:31], v[160:163]
    s_bfe_u32 s67, s89, 0x30014
    s_lshl_b32 s67, s67, 7
    s_add_u32 m0, s74, 49152
    v_mfma_f32_16x16x32_bf16 v[160:163], a[120:123], v[24:27], v[160:163]
    s_add_u32 s67, s67, s86
    v_mfma_f32_16x16x32_bf16 v[156:159], a[116:119], v[24:27], v[156:159]
    buffer_load_dwordx4 v4, s[40:43], s67 offen offset:0 lds
    v_mfma_f32_16x16x32_bf16 v[156:159], a[152:155], v[28:31], v[156:159]
    v_mfma_f32_16x16x32_bf16 v[152:155], a[148:151], v[28:31], v[152:155]
    v_mfma_f32_16x16x32_bf16 v[152:155], a[112:115], v[24:27], v[152:155]
    v_mfma_f32_16x16x32_bf16 v[148:151], a[108:111], v[24:27], v[148:151]
    buffer_load_dwordx4 v5, s[40:43], s67 offen offset:1024 lds
    v_mfma_f32_16x16x32_bf16 v[148:151], a[144:147], v[28:31], v[148:151]
    s_waitcnt lgkmcnt(0)
    v_mfma_f32_16x16x32_bf16 v[184:187], a[108:111], v[16:19], v[184:187]
    v_mfma_f32_16x16x32_bf16 v[184:187], a[144:147], v[20:23], v[184:187]
    ds_read_b128 v[24:27], v13 offset:2048
    v_mfma_f32_16x16x32_bf16 v[188:191], a[148:151], v[20:23], v[188:191]
    v_mfma_f32_16x16x32_bf16 v[188:191], a[112:115], v[16:19], v[188:191]
    ds_read_b128 v[28:31], v14 offset:2048
    v_mfma_f32_16x16x32_bf16 v[192:195], a[116:119], v[16:19], v[192:195]
    buffer_load_dwordx4 v6, s[40:43], s67 offen offset:2048 lds
    v_mfma_f32_16x16x32_bf16 v[192:195], a[152:155], v[20:23], v[192:195]
    v_mfma_f32_16x16x32_bf16 v[196:199], a[156:159], v[20:23], v[196:199]
    v_mfma_f32_16x16x32_bf16 v[196:199], a[120:123], v[16:19], v[196:199]
    buffer_load_dwordx4 v7, s[40:43], s67 offen offset:3072 lds
    v_mfma_f32_16x16x32_bf16 v[200:203], a[124:127], v[16:19], v[200:203]
    v_mfma_f32_16x16x32_bf16 v[200:203], a[160:163], v[20:23], v[200:203]
    s_bfe_u32 s67, s89, 0x30014
    s_lshl_b32 s67, s67, 7
    s_add_u32 m0, s74, 65536
    v_mfma_f32_16x16x32_bf16 v[204:207], a[164:167], v[20:23], v[204:207]
    s_add_u32 s67, s67, s87
    v_mfma_f32_16x16x32_bf16 v[204:207], a[128:131], v[16:19], v[204:207]
    buffer_load_dwordx4 v4, s[40:43], s67 offen offset:0 lds
    v_mfma_f32_16x16x32_bf16 v[208:211], a[132:135], v[16:19], v[208:211]
    v_mfma_f32_16x16x32_bf16 v[208:211], a[168:171], v[20:23], v[208:211]
    v_mfma_f32_16x16x32_bf16 v[212:215], a[172:175], v[20:23], v[212:215]
    v_mfma_f32_16x16x32_bf16 v[212:215], a[136:139], v[16:19], v[212:215]
    v_mfma_f32_16x16x32_bf16 v[216:219], a[140:143], v[16:19], v[216:219]
    buffer_load_dwordx4 v5, s[40:43], s67 offen offset:1024 lds
    v_mfma_f32_16x16x32_bf16 v[216:219], a[176:179], v[20:23], v[216:219]
    s_waitcnt lgkmcnt(0)
    v_mfma_f32_16x16x32_bf16 v[252:255], a[140:143], v[24:27], v[252:255]
    v_mfma_f32_16x16x32_bf16 v[252:255], a[176:179], v[28:31], v[252:255]
    s_waitcnt vmcnt(28)
    ds_read_b128 v[16:19], v13 offset:16384
    v_mfma_f32_16x16x32_bf16 v[248:251], a[172:175], v[28:31], v[248:251]
    buffer_load_dwordx4 v6, s[40:43], s67 offen offset:2048 lds
    v_mfma_f32_16x16x32_bf16 v[248:251], a[136:139], v[24:27], v[248:251]
    ds_read_b128 v[20:23], v14 offset:16384
    v_mfma_f32_16x16x32_bf16 v[244:247], a[132:135], v[24:27], v[244:247]
    v_mfma_f32_16x16x32_bf16 v[244:247], a[168:171], v[28:31], v[244:247]
    v_mfma_f32_16x16x32_bf16 v[240:243], a[164:167], v[28:31], v[240:243]
    v_mfma_f32_16x16x32_bf16 v[240:243], a[128:131], v[24:27], v[240:243]
    buffer_load_dwordx4 v7, s[40:43], s67 offen offset:3072 lds
    v_mfma_f32_16x16x32_bf16 v[236:239], a[124:127], v[24:27], v[236:239]
    v_mfma_f32_16x16x32_bf16 v[236:239], a[160:163], v[28:31], v[236:239]
    s_bfe_u32 s67, s89, 0x30018
    s_lshl_b32 s67, s67, 7
    s_add_u32 m0, s74, 81920
    v_mfma_f32_16x16x32_bf16 v[232:235], a[156:159], v[28:31], v[232:235]
    s_add_u32 s67, s67, s84
    v_mfma_f32_16x16x32_bf16 v[232:235], a[120:123], v[24:27], v[232:235]
    buffer_load_dwordx4 v4, s[40:43], s67 offen offset:0 lds
    v_mfma_f32_16x16x32_bf16 v[228:231], a[116:119], v[24:27], v[228:231]
    v_mfma_f32_16x16x32_bf16 v[228:231], a[152:155], v[28:31], v[228:231]
    v_mfma_f32_16x16x32_bf16 v[224:227], a[148:151], v[28:31], v[224:227]
    v_mfma_f32_16x16x32_bf16 v[224:227], a[112:115], v[24:27], v[224:227]
    buffer_load_dwordx4 v5, s[40:43], s67 offen offset:1024 lds
    v_mfma_f32_16x16x32_bf16 v[220:223], a[108:111], v[24:27], v[220:223]
    v_mfma_f32_16x16x32_bf16 v[220:223], a[144:147], v[28:31], v[220:223]
    s_waitcnt vmcnt(23)
    s_waitcnt vmcnt(14)
    s_waitcnt lgkmcnt(0)
    v_mfma_f32_16x16x32_bf16 a[0:3], a[180:183], v[16:19], a[0:3]
    v_mfma_f32_16x16x32_bf16 a[0:3], a[216:219], v[20:23], a[0:3]
    ds_read_b128 v[24:27], v13 offset:18432
    v_mfma_f32_16x16x32_bf16 a[4:7], a[220:223], v[20:23], a[4:7]
    buffer_load_dwordx4 v6, s[40:43], s67 offen offset:2048 lds
    v_mfma_f32_16x16x32_bf16 a[4:7], a[184:187], v[16:19], a[4:7]
    ds_read_b128 v[28:31], v14 offset:18432
    v_mfma_f32_16x16x32_bf16 a[8:11], a[188:191], v[16:19], a[8:11]
    v_mfma_f32_16x16x32_bf16 a[8:11], a[224:227], v[20:23], a[8:11]
    v_mfma_f32_16x16x32_bf16 a[12:15], a[228:231], v[20:23], a[12:15]
    buffer_load_dwordx4 v7, s[40:43], s67 offen offset:3072 lds
    v_mfma_f32_16x16x32_bf16 a[12:15], a[192:195], v[16:19], a[12:15]
    v_mfma_f32_16x16x32_bf16 a[16:19], a[196:199], v[16:19], a[16:19]
    s_bfe_u32 s73, s89, 0x30018
    s_mul_i32 s73, s73, 294912
    s_add_u32 s73, s73, s88
    v_mfma_f32_16x16x32_bf16 a[16:19], a[232:235], v[20:23], a[16:19]
    v_mfma_f32_16x16x32_bf16 a[20:23], a[236:239], v[20:23], a[20:23]
    buffer_load_dwordx4 a[108:111], v1, s[48:51], s73 offen offset:0 sc1
    v_mfma_f32_16x16x32_bf16 a[20:23], a[200:203], v[16:19], a[20:23]
    v_mfma_f32_16x16x32_bf16 a[24:27], a[204:207], v[16:19], a[24:27]
    v_mfma_f32_16x16x32_bf16 a[24:27], a[240:243], v[20:23], a[24:27]
    v_mfma_f32_16x16x32_bf16 a[28:31], a[244:247], v[20:23], a[28:31]
    v_mfma_f32_16x16x32_bf16 a[28:31], a[208:211], v[16:19], a[28:31]
    buffer_load_dwordx4 a[112:115], v1, s[48:51], s73 offen offset:1024 sc1
    v_mfma_f32_16x16x32_bf16 a[32:35], a[212:215], v[16:19], a[32:35]
    v_mfma_f32_16x16x32_bf16 a[32:35], a[248:251], v[20:23], a[32:35]
    s_waitcnt lgkmcnt(0)
    v_mfma_f32_16x16x32_bf16 a[68:71], a[212:215], v[24:27], a[68:71]
    v_mfma_f32_16x16x32_bf16 a[68:71], a[248:251], v[28:31], a[68:71]
    s_waitcnt vmcnt(14)
    ds_read_b128 v[16:19], v13 offset:32768
    v_mfma_f32_16x16x32_bf16 a[64:67], a[244:247], v[28:31], a[64:67]
    buffer_load_dwordx4 a[116:119], v1, s[48:51], s73 offen offset:2048 sc1
    v_and_b32 v36, 3, v0
    v_xor_b32 v36, v36, v10
    v_lshrrev_b32 v37, 2, v0
    v_lshlrev_b32 v37, 6, v37
    v_lshl_add_u32 v36, v36, 4, v37
    s_lshr_b32 s92, s2, 1
    s_and_b32 s57, s2, 1
    s_lshl_b32 s57, s57, 7
    s_add_u32 s92, s92, s57
    s_lshl_b32 s93, s92, 14
    s_add_u32 s93, s93, s74
    s_add_u32 s93, s93, 0x280000
    s_cmp_ge_u32 s92, 72
    s_cselect_b32 s97, 1, 0
    s_cselect_b32 s57, 72, 0
    s_sub_u32 s57, s92, s57
    s_lshl_b32 s57, s57, 3
    s_add_u32 s97, s97, s57
    s_lshl_b32 s57, s3, 1
    s_add_u32 s97, s97, s57
    s_cmp_ge_u32 s92, 144
    s_cselect_b32 s97, 0, s97
    s_cselect_b32 s30, 0, s30
    s_cselect_b32 s57, 0x40000000, 0
    v_add_u32 v36, s57, v36
    s_lshl_b32 s59, s97, 12
    v_lshlrev_b32 v37, 7, v0
    v_and_b32 v37, 0xfff, v37
    v_lshrrev_b32 v33, 3, v0
    v_lshlrev_b32 v33, 7, v33
    v_and_b32 v34, 7, v0
    v_lshl_add_u32 v33, v34, 2, v33
    buffer_load_dword v32, v33, s[48:51], s83 offen sc1
    v_mfma_f32_16x16x32_bf16 a[64:67], a[208:211], v[24:27], a[64:67]
    ds_read_b128 v[20:23], v14 offset:32768
    v_mfma_f32_16x16x32_bf16 a[60:63], a[204:207], v[24:27], a[60:63]
    v_mfma_f32_16x16x32_bf16 a[60:63], a[240:243], v[28:31], a[60:63]
    v_mfma_f32_16x16x32_bf16 a[56:59], a[236:239], v[28:31], a[56:59]
    buffer_load_dwordx4 a[120:123], v1, s[48:51], s73 offen offset:3072 sc1
    v_mfma_f32_16x16x32_bf16 a[56:59], a[200:203], v[24:27], a[56:59]
    v_mfma_f32_16x16x32_bf16 a[52:55], a[196:199], v[24:27], a[52:55]
    v_mfma_f32_16x16x32_bf16 a[52:55], a[232:235], v[28:31], a[52:55]
    v_mfma_f32_16x16x32_bf16 a[48:51], a[228:231], v[28:31], a[48:51]
    buffer_load_dwordx4 a[124:127], v2, s[48:51], s73 offen offset:0 sc1
    v_mfma_f32_16x16x32_bf16 a[48:51], a[192:195], v[24:27], a[48:51]
    v_mfma_f32_16x16x32_bf16 a[44:47], a[188:191], v[24:27], a[44:47]
    v_mfma_f32_16x16x32_bf16 a[44:47], a[224:227], v[28:31], a[44:47]
    v_mfma_f32_16x16x32_bf16 a[40:43], a[220:223], v[28:31], a[40:43]
    buffer_load_dwordx4 a[128:131], v2, s[48:51], s73 offen offset:1024 sc1
    v_mfma_f32_16x16x32_bf16 a[40:43], a[184:187], v[24:27], a[40:43]
    v_mfma_f32_16x16x32_bf16 a[36:39], a[180:183], v[24:27], a[36:39]
    v_mfma_f32_16x16x32_bf16 a[36:39], a[216:219], v[28:31], a[36:39]
    s_waitcnt lgkmcnt(0)
    v_mfma_f32_16x16x32_bf16 v[40:43], a[180:183], v[16:19], v[40:43]
    v_mfma_f32_16x16x32_bf16 v[40:43], a[216:219], v[20:23], v[40:43]
    ds_read_b128 v[24:27], v13 offset:34816
    v_mfma_f32_16x16x32_bf16 v[44:47], a[220:223], v[20:23], v[44:47]
    buffer_load_dwordx4 a[132:135], v2, s[48:51], s73 offen offset:2048 sc1
    v_mfma_f32_16x16x32_bf16 v[44:47], a[184:187], v[16:19], v[44:47]
    ds_read_b128 v[28:31], v14 offset:34816
    v_mfma_f32_16x16x32_bf16 v[48:51], a[188:191], v[16:19], v[48:51]
    v_mfma_f32_16x16x32_bf16 v[48:51], a[224:227], v[20:23], v[48:51]
    buffer_load_dwordx4 a[136:139], v2, s[48:51], s73 offen offset:3072 sc1
    v_mfma_f32_16x16x32_bf16 v[52:55], a[228:231], v[20:23], v[52:55]
    v_mfma_f32_16x16x32_bf16 v[52:55], a[192:195], v[16:19], v[52:55]
    v_mfma_f32_16x16x32_bf16 v[56:59], a[196:199], v[16:19], v[56:59]
    v_mfma_f32_16x16x32_bf16 v[56:59], a[232:235], v[20:23], v[56:59]
    buffer_load_dwordx4 a[140:143], v3, s[48:51], s73 offen offset:0 sc1
    v_mfma_f32_16x16x32_bf16 v[60:63], a[236:239], v[20:23], v[60:63]
    v_mfma_f32_16x16x32_bf16 v[60:63], a[200:203], v[16:19], v[60:63]
    v_mfma_f32_16x16x32_bf16 v[64:67], a[204:207], v[16:19], v[64:67]
    s_bfe_u32 s73, s89, 0x30018
    s_mul_i32 s73, s73, 294912
    s_add_u32 s73, s73, s88
    v_mfma_f32_16x16x32_bf16 v[64:67], a[240:243], v[20:23], v[64:67]
    s_add_u32 s73, s73, 147456
    v_mfma_f32_16x16x32_bf16 v[68:71], a[244:247], v[20:23], v[68:71]
    buffer_load_dwordx4 a[144:147], v1, s[48:51], s73 offen offset:0 sc1
    v_mfma_f32_16x16x32_bf16 v[68:71], a[208:211], v[16:19], v[68:71]
    v_mfma_f32_16x16x32_bf16 v[72:75], a[212:215], v[16:19], v[72:75]
    v_mfma_f32_16x16x32_bf16 v[72:75], a[248:251], v[20:23], v[72:75]
    s_waitcnt lgkmcnt(0)
    v_mfma_f32_16x16x32_bf16 v[108:111], a[212:215], v[24:27], v[108:111]
    buffer_load_dwordx4 a[148:151], v1, s[48:51], s73 offen offset:1024 sc1
    v_mfma_f32_16x16x32_bf16 v[108:111], a[248:251], v[28:31], v[108:111]
    s_waitcnt vmcnt(20)
    ds_read_b128 v[16:19], v13 offset:49152
    v_mfma_f32_16x16x32_bf16 v[104:107], a[244:247], v[28:31], v[104:107]
    v_mfma_f32_16x16x32_bf16 v[104:107], a[208:211], v[24:27], v[104:107]
    ds_read_b128 v[20:23], v14 offset:49152
    v_mfma_f32_16x16x32_bf16 v[100:103], a[204:207], v[24:27], v[100:103]
    v_mfma_f32_16x16x32_bf16 v[100:103], a[240:243], v[28:31], v[100:103]
    buffer_load_dwordx4 a[152:155], v1, s[48:51], s73 offen offset:2048 sc1
    v_mfma_f32_16x16x32_bf16 v[96:99], a[236:239], v[28:31], v[96:99]
    v_mfma_f32_16x16x32_bf16 v[96:99], a[200:203], v[24:27], v[96:99]
    v_mfma_f32_16x16x32_bf16 v[92:95], a[196:199], v[24:27], v[92:95]
    v_mfma_f32_16x16x32_bf16 v[92:95], a[232:235], v[28:31], v[92:95]
    buffer_load_dwordx4 a[156:159], v1, s[48:51], s73 offen offset:3072 sc1
    v_mfma_f32_16x16x32_bf16 v[88:91], a[228:231], v[28:31], v[88:91]
    v_mfma_f32_16x16x32_bf16 v[88:91], a[192:195], v[24:27], v[88:91]
    v_mfma_f32_16x16x32_bf16 v[84:87], a[188:191], v[24:27], v[84:87]
    v_mfma_f32_16x16x32_bf16 v[84:87], a[224:227], v[28:31], v[84:87]
    buffer_load_dwordx4 a[160:163], v2, s[48:51], s73 offen offset:0 sc1
    v_mfma_f32_16x16x32_bf16 v[80:83], a[220:223], v[28:31], v[80:83]
    v_mfma_f32_16x16x32_bf16 v[80:83], a[184:187], v[24:27], v[80:83]
    v_mfma_f32_16x16x32_bf16 v[76:79], a[180:183], v[24:27], v[76:79]
    v_mfma_f32_16x16x32_bf16 v[76:79], a[216:219], v[28:31], v[76:79]
    s_waitcnt lgkmcnt(0)
    v_mfma_f32_16x16x32_bf16 v[112:115], a[180:183], v[16:19], v[112:115]
    buffer_load_dwordx4 a[164:167], v2, s[48:51], s73 offen offset:1024 sc1
    v_mfma_f32_16x16x32_bf16 v[112:115], a[216:219], v[20:23], v[112:115]
    ds_read_b128 v[24:27], v13 offset:51200
    v_mfma_f32_16x16x32_bf16 v[116:119], a[220:223], v[20:23], v[116:119]
    v_mfma_f32_16x16x32_bf16 v[116:119], a[184:187], v[16:19], v[116:119]
    ds_read_b128 v[28:31], v14 offset:51200
    v_mfma_f32_16x16x32_bf16 v[120:123], a[188:191], v[16:19], v[120:123]
    buffer_load_dwordx4 a[168:171], v2, s[48:51], s73 offen offset:2048 sc1
    v_mfma_f32_16x16x32_bf16 v[120:123], a[224:227], v[20:23], v[120:123]
    v_mfma_f32_16x16x32_bf16 v[124:127], a[228:231], v[20:23], v[124:127]
    v_mfma_f32_16x16x32_bf16 v[124:127], a[192:195], v[16:19], v[124:127]
    v_mfma_f32_16x16x32_bf16 v[128:131], a[196:199], v[16:19], v[128:131]
    buffer_load_dwordx4 a[172:175], v2, s[48:51], s73 offen offset:3072 sc1
    v_mfma_f32_16x16x32_bf16 v[128:131], a[232:235], v[20:23], v[128:131]
    v_mfma_f32_16x16x32_bf16 v[132:135], a[236:239], v[20:23], v[132:135]
    v_mfma_f32_16x16x32_bf16 v[132:135], a[200:203], v[16:19], v[132:135]
    v_mfma_f32_16x16x32_bf16 v[136:139], a[204:207], v[16:19], v[136:139]
    v_mfma_f32_16x16x32_bf16 v[136:139], a[240:243], v[20:23], v[136:139]
    buffer_load_dwordx4 a[176:179], v3, s[48:51], s73 offen offset:0 sc1
    v_mfma_f32_16x16x32_bf16 v[140:143], a[244:247], v[20:23], v[140:143]
    v_mfma_f32_16x16x32_bf16 v[140:143], a[208:211], v[16:19], v[140:143]
    s_bfe_u32 s67, s89, 0x30018
    s_lshl_b32 s67, s67, 7
    s_add_u32 m0, s74, 98304
    v_mfma_f32_16x16x32_bf16 v[144:147], a[212:215], v[16:19], v[144:147]
    s_add_u32 s67, s67, s85
    v_mfma_f32_16x16x32_bf16 v[144:147], a[248:251], v[20:23], v[144:147]
    s_waitcnt lgkmcnt(0)
    buffer_load_dwordx4 v4, s[40:43], s67 offen offset:0 lds
    v_mfma_f32_16x16x32_bf16 v[180:183], a[212:215], v[24:27], v[180:183]
    v_add_u32 v13, s75, v12
    v_mfma_f32_16x16x32_bf16 v[180:183], a[248:251], v[28:31], v[180:183]
    s_waitcnt vmcnt(24)
    ds_read_b128 v[16:19], v13 offset:0
    v_mfma_f32_16x16x32_bf16 v[176:179], a[244:247], v[28:31], v[176:179]
    v_xad_u32 v14, v12, 64, s75
    v_mfma_f32_16x16x32_bf16 v[176:179], a[208:211], v[24:27], v[176:179]
    ds_read_b128 v[20:23], v14 offset:0
    v_mfma_f32_16x16x32_bf16 v[172:175], a[204:207], v[24:27], v[172:175]
    buffer_load_dwordx4 v5, s[40:43], s67 offen offset:1024 lds
    v_mfma_f32_16x16x32_bf16 v[172:175], a[240:243], v[28:31], v[172:175]
    v_mfma_f32_16x16x32_bf16 v[168:171], a[236:239], v[28:31], v[168:171]
    v_mfma_f32_16x16x32_bf16 v[168:171], a[200:203], v[24:27], v[168:171]
    v_mfma_f32_16x16x32_bf16 v[164:167], a[196:199], v[24:27], v[164:167]
    buffer_load_dwordx4 v6, s[40:43], s67 offen offset:2048 lds
    v_mfma_f32_16x16x32_bf16 v[164:167], a[232:235], v[28:31], v[164:167]
    v_mfma_f32_16x16x32_bf16 v[160:163], a[228:231], v[28:31], v[160:163]
    v_mfma_f32_16x16x32_bf16 v[160:163], a[192:195], v[24:27], v[160:163]
    v_mfma_f32_16x16x32_bf16 v[156:159], a[188:191], v[24:27], v[156:159]
    buffer_load_dwordx4 v7, s[40:43], s67 offen offset:3072 lds
    v_mfma_f32_16x16x32_bf16 v[156:159], a[224:227], v[28:31], v[156:159]
    v_mfma_f32_16x16x32_bf16 v[152:155], a[220:223], v[28:31], v[152:155]
    v_mfma_f32_16x16x32_bf16 v[152:155], a[184:187], v[24:27], v[152:155]
    s_bfe_u32 s67, s89, 0x30018
    s_lshl_b32 s67, s67, 7
    s_add_u32 m0, s74, 114688
    v_mfma_f32_16x16x32_bf16 v[148:151], a[180:183], v[24:27], v[148:151]
    s_add_u32 s67, s67, s86
    v_mfma_f32_16x16x32_bf16 v[148:151], a[216:219], v[28:31], v[148:151]
    s_waitcnt lgkmcnt(0)
    buffer_load_dwordx4 v4, s[40:43], s67 offen offset:0 lds
    v_mfma_f32_16x16x32_bf16 v[184:187], a[180:183], v[16:19], v[184:187]
    v_mfma_f32_16x16x32_bf16 v[184:187], a[216:219], v[20:23], v[184:187]
    ds_read_b128 v[24:27], v13 offset:2048
    v_mfma_f32_16x16x32_bf16 v[188:191], a[220:223], v[20:23], v[188:191]
    v_mfma_f32_16x16x32_bf16 v[188:191], a[184:187], v[16:19], v[188:191]
    ds_read_b128 v[28:31], v14 offset:2048
    v_mfma_f32_16x16x32_bf16 v[192:195], a[188:191], v[16:19], v[192:195]
    buffer_load_dwordx4 v5, s[40:43], s67 offen offset:1024 lds
    v_mfma_f32_16x16x32_bf16 v[192:195], a[224:227], v[20:23], v[192:195]
    v_mfma_f32_16x16x32_bf16 v[196:199], a[228:231], v[20:23], v[196:199]
    v_mfma_f32_16x16x32_bf16 v[196:199], a[192:195], v[16:19], v[196:199]
    buffer_load_dwordx4 v6, s[40:43], s67 offen offset:2048 lds
    v_mfma_f32_16x16x32_bf16 v[200:203], a[196:199], v[16:19], v[200:203]
    v_mfma_f32_16x16x32_bf16 v[200:203], a[232:235], v[20:23], v[200:203]
    v_mfma_f32_16x16x32_bf16 v[204:207], a[236:239], v[20:23], v[204:207]
    v_mfma_f32_16x16x32_bf16 v[204:207], a[200:203], v[16:19], v[204:207]
    v_mfma_f32_16x16x32_bf16 v[208:211], a[204:207], v[16:19], v[208:211]
    buffer_load_dwordx4 v7, s[40:43], s67 offen offset:3072 lds
    v_mfma_f32_16x16x32_bf16 v[208:211], a[240:243], v[20:23], v[208:211]
    v_mfma_f32_16x16x32_bf16 v[212:215], a[244:247], v[20:23], v[212:215]
    s_bfe_u32 s67, s89, 0x30018
    s_lshl_b32 s67, s67, 7
    s_add_u32 m0, s74, 131072
    v_mfma_f32_16x16x32_bf16 v[212:215], a[208:211], v[16:19], v[212:215]
    s_add_u32 s67, s67, s87
    v_mfma_f32_16x16x32_bf16 v[216:219], a[212:215], v[16:19], v[216:219]
    buffer_load_dwordx4 v4, s[40:43], s67 offen offset:0 lds
    v_mfma_f32_16x16x32_bf16 v[216:219], a[248:251], v[20:23], v[216:219]
    s_waitcnt lgkmcnt(0)
    v_mfma_f32_16x16x32_bf16 v[252:255], a[212:215], v[24:27], v[252:255]
    v_mfma_f32_16x16x32_bf16 v[252:255], a[248:251], v[28:31], v[252:255]
    s_waitcnt vmcnt(28)
    ds_read_b128 v[16:19], v13 offset:16384
    v_mfma_f32_16x16x32_bf16 v[248:251], a[244:247], v[28:31], v[248:251]
    v_mfma_f32_16x16x32_bf16 v[248:251], a[208:211], v[24:27], v[248:251]
    ds_read_b128 v[20:23], v14 offset:16384
    v_mfma_f32_16x16x32_bf16 v[244:247], a[204:207], v[24:27], v[244:247]
    buffer_load_dwordx4 v5, s[40:43], s67 offen offset:1024 lds
    v_mfma_f32_16x16x32_bf16 v[244:247], a[240:243], v[28:31], v[244:247]
    v_mfma_f32_16x16x32_bf16 v[240:243], a[236:239], v[28:31], v[240:243]
    v_mfma_f32_16x16x32_bf16 v[240:243], a[200:203], v[24:27], v[240:243]
    buffer_load_dwordx4 v6, s[40:43], s67 offen offset:2048 lds
    v_mfma_f32_16x16x32_bf16 v[236:239], a[196:199], v[24:27], v[236:239]
    v_mfma_f32_16x16x32_bf16 v[236:239], a[232:235], v[28:31], v[236:239]
    v_mfma_f32_16x16x32_bf16 v[232:235], a[228:231], v[28:31], v[232:235]
    v_mfma_f32_16x16x32_bf16 v[232:235], a[192:195], v[24:27], v[232:235]
    buffer_load_dwordx4 v7, s[40:43], s67 offen offset:3072 lds
    v_mfma_f32_16x16x32_bf16 v[228:231], a[188:191], v[24:27], v[228:231]
    v_mfma_f32_16x16x32_bf16 v[228:231], a[224:227], v[28:31], v[228:231]
    v_mfma_f32_16x16x32_bf16 v[224:227], a[220:223], v[28:31], v[224:227]
    s_bfe_u32 s67, s89, 0x3001c
    s_lshl_b32 s67, s67, 7
    s_add_u32 m0, s74, 0
    v_mfma_f32_16x16x32_bf16 v[224:227], a[184:187], v[24:27], v[224:227]
    s_add_u32 s67, s67, s85
    v_mfma_f32_16x16x32_bf16 v[220:223], a[180:183], v[24:27], v[220:223]
    buffer_load_dwordx4 v4, s[40:43], s67 offen offset:0 lds
    v_mfma_f32_16x16x32_bf16 v[220:223], a[216:219], v[28:31], v[220:223]
    s_waitcnt vmcnt(22)
    s_waitcnt vmcnt(13)
    s_waitcnt lgkmcnt(0)
    v_mfma_f32_16x16x32_bf16 a[0:3], a[108:111], v[16:19], a[0:3]
    s_branch KM_za_chk
KM_za_poll:
    buffer_load_dword v32, v33, s[48:51], s83 offen sc1
    s_waitcnt vmcnt(0)
KM_za_chk:
    v_cmp_ne_u32 vcc, s95, v32
    s_sub_u32 s94, s94, 1
    s_cmp_lt_i32 s94, 1
    s_cbranch_scc1 KM_za_done
    s_cbranch_vccnz KM_za_poll
KM_za_done:
    s_barrier
    s_or_b32 s57, s2, s3
    s_cmp_lg_u32 s57, 0
    s_cbranch_scc1 KM_noep
    v_mov_b32 v32, s95
    s_mov_b32 s57, 0x7f8000
    s_mov_b64 exec, 1
    buffer_store_dword v32, v1, s[48:51], s57 offen sc1
    s_mov_b64 exec, -1
KM_noep:
    v_mfma_f32_16x16x32_bf16 a[0:3], a[144:147], v[20:23], a[0:3]
    ds_read_b128 v[24:27], v13 offset:18432
    v_mfma_f32_16x16x32_bf16 a[4:7], a[148:151], v[20:23], a[4:7]
    buffer_load_dwordx4 v5, s[40:43], s67 offen offset:1024 lds
    v_mfma_f32_16x16x32_bf16 a[4:7], a[112:115], v[16:19], a[4:7]
    ds_read_b128 v[28:31], v14 offset:18432
    v_mfma_f32_16x16x32_bf16 a[8:11], a[116:119], v[16:19], a[8:11]
    v_mfma_f32_16x16x32_bf16 a[8:11], a[152:155], v[20:23], a[8:11]
    v_mfma_f32_16x16x32_bf16 a[12:15], a[156:159], v[20:23], a[12:15]
    buffer_load_dwordx4 v6, s[40:43], s67 offen offset:2048 lds
    v_mfma_f32_16x16x32_bf16 a[12:15], a[120:123], v[16:19], a[12:15]
    v_mfma_f32_16x16x32_bf16 a[16:19], a[124:127], v[16:19], a[16:19]
    v_mfma_f32_16x16x32_bf16 a[16:19], a[160:163], v[20:23], a[16:19]
    v_mfma_f32_16x16x32_bf16 a[20:23], a[164:167], v[20:23], a[20:23]
    v_mfma_f32_16x16x32_bf16 a[20:23], a[128:131], v[16:19], a[20:23]
    buffer_load_dwordx4 v7, s[40:43], s67 offen offset:3072 lds
    v_mfma_f32_16x16x32_bf16 a[24:27], a[132:135], v[16:19], a[24:27]
    v_mfma_f32_16x16x32_bf16 a[24:27], a[168:171], v[20:23], a[24:27]
    s_bfe_u32 s73, s89, 0x3001c
    s_mul_i32 s73, s73, 294912
    s_add_u32 s73, s73, s88
    v_mfma_f32_16x16x32_bf16 a[28:31], a[172:175], v[20:23], a[28:31]
    v_mfma_f32_16x16x32_bf16 a[28:31], a[136:139], v[16:19], a[28:31]
    buffer_load_dwordx4 a[180:183], v1, s[48:51], s73 offen offset:0 sc1
    v_mfma_f32_16x16x32_bf16 a[32:35], a[140:143], v[16:19], a[32:35]
    v_mfma_f32_16x16x32_bf16 a[32:35], a[176:179], v[20:23], a[32:35]
    s_waitcnt lgkmcnt(0)
    v_mfma_f32_16x16x32_bf16 a[68:71], a[140:143], v[24:27], a[68:71]
    v_mfma_f32_16x16x32_bf16 a[68:71], a[176:179], v[28:31], a[68:71]
    s_waitcnt vmcnt(13)
    ds_read_b128 v[16:19], v13 offset:32768
    v_mfma_f32_16x16x32_bf16 a[64:67], a[172:175], v[28:31], a[64:67]
    buffer_load_dwordx4 a[184:187], v1, s[48:51], s73 offen offset:1024 sc1
    v_mfma_f32_16x16x32_bf16 a[64:67], a[136:139], v[24:27], a[64:67]
    ds_read_b128 v[20:23], v14 offset:32768
    v_mfma_f32_16x16x32_bf16 a[60:63], a[132:135], v[24:27], a[60:63]
    v_mfma_f32_16x16x32_bf16 a[60:63], a[168:171], v[28:31], a[60:63]
    v_mfma_f32_16x16x32_bf16 a[56:59], a[164:167], v[28:31], a[56:59]
    buffer_load_dwordx4 a[188:191], v1, s[48:51], s73 offen offset:2048 sc1
    v_mfma_f32_16x16x32_bf16 a[56:59], a[128:131], v[24:27], a[56:59]
    v_mfma_f32_16x16x32_bf16 a[52:55], a[124:127], v[24:27], a[52:55]
    v_mfma_f32_16x16x32_bf16 a[52:55], a[160:163], v[28:31], a[52:55]
    v_mfma_f32_16x16x32_bf16 a[48:51], a[156:159], v[28:31], a[48:51]
    buffer_load_dwordx4 a[192:195], v1, s[48:51], s73 offen offset:3072 sc1
    v_mfma_f32_16x16x32_bf16 a[48:51], a[120:123], v[24:27], a[48:51]
    v_mfma_f32_16x16x32_bf16 a[44:47], a[116:119], v[24:27], a[44:47]
    v_mfma_f32_16x16x32_bf16 a[44:47], a[152:155], v[28:31], a[44:47]
    v_mfma_f32_16x16x32_bf16 a[40:43], a[148:151], v[28:31], a[40:43]
    v_mfma_f32_16x16x32_bf16 a[40:43], a[112:115], v[24:27], a[40:43]
    buffer_load_dwordx4 a[196:199], v2, s[48:51], s73 offen offset:0 sc1
    v_mfma_f32_16x16x32_bf16 a[36:39], a[108:111], v[24:27], a[36:39]
    v_mfma_f32_16x16x32_bf16 a[36:39], a[144:147], v[28:31], a[36:39]
    s_waitcnt lgkmcnt(0)
    v_mfma_f32_16x16x32_bf16 v[40:43], a[108:111], v[16:19], v[40:43]
    v_mfma_f32_16x16x32_bf16 v[40:43], a[144:147], v[20:23], v[40:43]
    ds_read_b128 v[24:27], v13 offset:34816
    v_mfma_f32_16x16x32_bf16 v[44:47], a[148:151], v[20:23], v[44:47]
    buffer_load_dwordx4 a[200:203], v2, s[48:51], s73 offen offset:1024 sc1
    v_mfma_f32_16x16x32_bf16 v[44:47], a[112:115], v[16:19], v[44:47]
    ds_read_b128 v[28:31], v14 offset:34816
    v_mfma_f32_16x16x32_bf16 v[48:51], a[116:119], v[16:19], v[48:51]
    v_mfma_f32_16x16x32_bf16 v[48:51], a[152:155], v[20:23], v[48:51]
    buffer_load_dwordx4 a[204:207], v2, s[48:51], s73 offen offset:2048 sc1
    v_mfma_f32_16x16x32_bf16 v[52:55], a[156:159], v[20:23], v[52:55]
    v_mfma_f32_16x16x32_bf16 v[52:55], a[120:123], v[16:19], v[52:55]
    v_mfma_f32_16x16x32_bf16 v[56:59], a[124:127], v[16:19], v[56:59]
    v_mfma_f32_16x16x32_bf16 v[56:59], a[160:163], v[20:23], v[56:59]
    v_mfma_f32_16x16x32_bf16 v[60:63], a[164:167], v[20:23], v[60:63]
    buffer_load_dwordx4 a[208:211], v2, s[48:51], s73 offen offset:3072 sc1
    v_mfma_f32_16x16x32_bf16 v[60:63], a[128:131], v[16:19], v[60:63]
    v_mfma_f32_16x16x32_bf16 v[64:67], a[132:135], v[16:19], v[64:67]
    v_mfma_f32_16x16x32_bf16 v[64:67], a[168:171], v[20:23], v[64:67]
    v_mfma_f32_16x16x32_bf16 v[68:71], a[172:175], v[20:23], v[68:71]
    buffer_load_dwordx4 a[212:215], v3, s[48:51], s73 offen offset:0 sc1
    v_mfma_f32_16x16x32_bf16 v[68:71], a[136:139], v[16:19], v[68:71]
    v_mfma_f32_16x16x32_bf16 v[72:75], a[140:143], v[16:19], v[72:75]
    v_mfma_f32_16x16x32_bf16 v[72:75], a[176:179], v[20:23], v[72:75]
    s_waitcnt lgkmcnt(0)
    s_bfe_u32 s73, s89, 0x3001c
    s_mul_i32 s73, s73, 294912
    v_mfma_f32_16x16x32_bf16 v[108:111], a[140:143], v[24:27], v[108:111]
    s_add_u32 s73, s73, s88
    s_add_u32 s73, s73, 147456
    v_mfma_f32_16x16x32_bf16 v[108:111], a[176:179], v[28:31], v[108:111]
    s_waitcnt vmcnt(17)
    ds_read_b128 v[16:19], v13 offset:49152
    v_mfma_f32_16x16x32_bf16 v[104:107], a[172:175], v[28:31], v[104:107]
    buffer_load_dwordx4 a[216:219], v1, s[48:51], s73 offen offset:0 sc1
    v_mfma_f32_16x16x32_bf16 v[104:107], a[136:139], v[24:27], v[104:107]
    ds_read_b128 v[20:23], v14 offset:49152
    v_mfma_f32_16x16x32_bf16 v[100:103], a[132:135], v[24:27], v[100:103]
    v_mfma_f32_16x16x32_bf16 v[100:103], a[168:171], v[28:31], v[100:103]
    buffer_load_dwordx4 a[220:223], v1, s[48:51], s73 offen offset:1024 sc1
    v_mfma_f32_16x16x32_bf16 v[96:99], a[164:167], v[28:31], v[96:99]
    v_mfma_f32_16x16x32_bf16 v[96:99], a[128:131], v[24:27], v[96:99]
    v_mfma_f32_16x16x32_bf16 v[92:95], a[124:127], v[24:27], v[92:95]
    v_mfma_f32_16x16x32_bf16 v[92:95], a[160:163], v[28:31], v[92:95]
    buffer_load_dwordx4 a[224:227], v1, s[48:51], s73 offen offset:2048 sc1
    v_mfma_f32_16x16x32_bf16 v[88:91], a[156:159], v[28:31], v[88:91]
    v_mfma_f32_16x16x32_bf16 v[88:91], a[120:123], v[24:27], v[88:91]
    v_mfma_f32_16x16x32_bf16 v[84:87], a[116:119], v[24:27], v[84:87]
    v_mfma_f32_16x16x32_bf16 v[84:87], a[152:155], v[28:31], v[84:87]
    v_mfma_f32_16x16x32_bf16 v[80:83], a[148:151], v[28:31], v[80:83]
    buffer_load_dwordx4 a[228:231], v1, s[48:51], s73 offen offset:3072 sc1
    v_mfma_f32_16x16x32_bf16 v[80:83], a[112:115], v[24:27], v[80:83]
    v_mfma_f32_16x16x32_bf16 v[76:79], a[108:111], v[24:27], v[76:79]
    v_mfma_f32_16x16x32_bf16 v[76:79], a[144:147], v[28:31], v[76:79]
    s_waitcnt lgkmcnt(0)
    v_mfma_f32_16x16x32_bf16 v[112:115], a[108:111], v[16:19], v[112:115]
    buffer_load_dwordx4 a[232:235], v2, s[48:51], s73 offen offset:0 sc1
    v_mfma_f32_16x16x32_bf16 v[112:115], a[144:147], v[20:23], v[112:115]
    ds_read_b128 v[24:27], v13 offset:51200
    v_mfma_f32_16x16x32_bf16 v[116:119], a[148:151], v[20:23], v[116:119]
    v_mfma_f32_16x16x32_bf16 v[116:119], a[112:115], v[16:19], v[116:119]
    ds_read_b128 v[28:31], v14 offset:51200
    v_mfma_f32_16x16x32_bf16 v[120:123], a[116:119], v[16:19], v[120:123]
    buffer_load_dwordx4 a[236:239], v2, s[48:51], s73 offen offset:1024 sc1
    v_mfma_f32_16x16x32_bf16 v[120:123], a[152:155], v[20:23], v[120:123]
    v_mfma_f32_16x16x32_bf16 v[124:127], a[156:159], v[20:23], v[124:127]
    v_mfma_f32_16x16x32_bf16 v[124:127], a[120:123], v[16:19], v[124:127]
    v_mfma_f32_16x16x32_bf16 v[128:131], a[124:127], v[16:19], v[128:131]
    v_mfma_f32_16x16x32_bf16 v[128:131], a[160:163], v[20:23], v[128:131]
    buffer_load_dwordx4 a[240:243], v2, s[48:51], s73 offen offset:2048 sc1
    v_mfma_f32_16x16x32_bf16 v[132:135], a[164:167], v[20:23], v[132:135]
    v_mfma_f32_16x16x32_bf16 v[132:135], a[128:131], v[16:19], v[132:135]
    v_mfma_f32_16x16x32_bf16 v[136:139], a[132:135], v[16:19], v[136:139]
    v_mfma_f32_16x16x32_bf16 v[136:139], a[168:171], v[20:23], v[136:139]
    buffer_load_dwordx4 a[244:247], v2, s[48:51], s73 offen offset:3072 sc1
    v_mfma_f32_16x16x32_bf16 v[140:143], a[172:175], v[20:23], v[140:143]
    v_mfma_f32_16x16x32_bf16 v[140:143], a[136:139], v[16:19], v[140:143]
    v_mfma_f32_16x16x32_bf16 v[144:147], a[140:143], v[16:19], v[144:147]
    v_mfma_f32_16x16x32_bf16 v[144:147], a[176:179], v[20:23], v[144:147]
    s_waitcnt lgkmcnt(0)
    v_mfma_f32_16x16x32_bf16 v[180:183], a[140:143], v[24:27], v[180:183]
    buffer_load_dwordx4 a[248:251], v3, s[48:51], s73 offen offset:0 sc1
    v_add_u32 v13, s63, v12
    v_mfma_f32_16x16x32_bf16 v[180:183], a[176:179], v[28:31], v[180:183]
    s_waitcnt vmcnt(22)
    ds_read_b128 v[16:19], v13 offset:0
    v_mfma_f32_16x16x32_bf16 v[176:179], a[172:175], v[28:31], v[176:179]
    s_bfe_u32 s67, s89, 0x3001c
    s_lshl_b32 s67, s67, 7
    s_add_u32 m0, s74, 16384
    v_mfma_f32_16x16x32_bf16 v[176:179], a[136:139], v[24:27], v[176:179]
    v_xad_u32 v14, v12, 64, s63
    ds_read_b128 v[20:23], v14 offset:0
    v_mfma_f32_16x16x32_bf16 v[172:175], a[132:135], v[24:27], v[172:175]
    s_add_u32 s67, s67, s86
    v_mfma_f32_16x16x32_bf16 v[172:175], a[168:171], v[28:31], v[172:175]
    buffer_load_dwordx4 v4, s[40:43], s67 offen offset:0 lds
    v_mfma_f32_16x16x32_bf16 v[168:171], a[164:167], v[28:31], v[168:171]
    v_mfma_f32_16x16x32_bf16 v[168:171], a[128:131], v[24:27], v[168:171]
    v_mfma_f32_16x16x32_bf16 v[164:167], a[124:127], v[24:27], v[164:167]
    buffer_load_dwordx4 v5, s[40:43], s67 offen offset:1024 lds
    v_mfma_f32_16x16x32_bf16 v[164:167], a[160:163], v[28:31], v[164:167]
    v_mfma_f32_16x16x32_bf16 v[160:163], a[156:159], v[28:31], v[160:163]
    v_mfma_f32_16x16x32_bf16 v[160:163], a[120:123], v[24:27], v[160:163]
    v_mfma_f32_16x16x32_bf16 v[156:159], a[116:119], v[24:27], v[156:159]
    v_mfma_f32_16x16x32_bf16 v[156:159], a[152:155], v[28:31], v[156:159]
    buffer_load_dwordx4 v6, s[40:43], s67 offen offset:2048 lds
    v_mfma_f32_16x16x32_bf16 v[152:155], a[148:151], v[28:31], v[152:155]
    v_mfma_f32_16x16x32_bf16 v[152:155], a[112:115], v[24:27], v[152:155]
    v_mfma_f32_16x16x32_bf16 v[148:151], a[108:111], v[24:27], v[148:151]
    v_mfma_f32_16x16x32_bf16 v[148:151], a[144:147], v[28:31], v[148:151]
    s_waitcnt lgkmcnt(0)
    buffer_load_dwordx4 v7, s[40:43], s67 offen offset:3072 lds
    v_mfma_f32_16x16x32_bf16 v[184:187], a[108:111], v[16:19], v[184:187]
    v_mfma_f32_16x16x32_bf16 v[184:187], a[144:147], v[20:23], v[184:187]
    ds_read_b128 v[24:27], v13 offset:2048
    s_bfe_u32 s67, s89, 0x3001c
    v_mfma_f32_16x16x32_bf16 v[188:191], a[148:151], v[20:23], v[188:191]
    s_lshl_b32 s67, s67, 7
    s_add_u32 m0, s74, 32768
    s_add_u32 s67, s67, s87
    v_mfma_f32_16x16x32_bf16 v[188:191], a[112:115], v[16:19], v[188:191]
    ds_read_b128 v[28:31], v14 offset:2048
    v_add_u32 v13, 0, v12
    v_mfma_f32_16x16x32_bf16 v[192:195], a[116:119], v[16:19], v[192:195]
    buffer_load_dwordx4 v4, s[40:43], s67 offen offset:0 lds
    v_mfma_f32_16x16x32_bf16 v[192:195], a[152:155], v[20:23], v[192:195]
    v_mfma_f32_16x16x32_bf16 v[196:199], a[156:159], v[20:23], v[196:199]
    v_mfma_f32_16x16x32_bf16 v[196:199], a[120:123], v[16:19], v[196:199]
    v_mfma_f32_16x16x32_bf16 v[200:203], a[124:127], v[16:19], v[200:203]
    buffer_load_dwordx4 v5, s[40:43], s67 offen offset:1024 lds
    v_mfma_f32_16x16x32_bf16 v[200:203], a[160:163], v[20:23], v[200:203]
    v_mfma_f32_16x16x32_bf16 v[204:207], a[164:167], v[20:23], v[204:207]
    v_mfma_f32_16x16x32_bf16 v[204:207], a[128:131], v[16:19], v[204:207]
    v_mfma_f32_16x16x32_bf16 v[208:211], a[132:135], v[16:19], v[208:211]
    buffer_load_dwordx4 v6, s[40:43], s67 offen offset:2048 lds
    v_mfma_f32_16x16x32_bf16 v[208:211], a[168:171], v[20:23], v[208:211]
    v_mfma_f32_16x16x32_bf16 v[212:215], a[172:175], v[20:23], v[212:215]
    v_mfma_f32_16x16x32_bf16 v[212:215], a[136:139], v[16:19], v[212:215]
    v_mfma_f32_16x16x32_bf16 v[216:219], a[140:143], v[16:19], v[216:219]
    v_mfma_f32_16x16x32_bf16 v[216:219], a[176:179], v[20:23], v[216:219]
    s_waitcnt lgkmcnt(0)
    buffer_load_dwordx4 v7, s[40:43], s67 offen offset:3072 lds
    v_mfma_f32_16x16x32_bf16 v[252:255], a[140:143], v[24:27], v[252:255]
    v_mfma_f32_16x16x32_bf16 v[252:255], a[176:179], v[28:31], v[252:255]
    s_waitcnt vmcnt(26)
    ds_read_b128 v[16:19], v13 offset:0
    v_mfma_f32_16x16x32_bf16 v[248:251], a[172:175], v[28:31], v[248:251]
    s_bfe_u32 s67, s89, 0x3001c
    s_lshl_b32 s67, s67, 7
    s_add_u32 m0, s74, 147456
    v_mfma_f32_16x16x32_bf16 v[248:251], a[136:139], v[24:27], v[248:251]
    v_xad_u32 v14, v12, 64, 0
    ds_read_b128 v[20:23], v14 offset:0
    v_mfma_f32_16x16x32_bf16 v[244:247], a[132:135], v[24:27], v[244:247]
    s_add_u32 s67, s67, s84
    v_mfma_f32_16x16x32_bf16 v[244:247], a[168:171], v[28:31], v[244:247]
    buffer_load_dwordx4 v4, s[40:43], s67 offen offset:0 lds
    v_mfma_f32_16x16x32_bf16 v[240:243], a[164:167], v[28:31], v[240:243]
    v_mfma_f32_16x16x32_bf16 v[240:243], a[128:131], v[24:27], v[240:243]
    buffer_load_dwordx4 v5, s[40:43], s67 offen offset:1024 lds
    v_mfma_f32_16x16x32_bf16 v[236:239], a[124:127], v[24:27], v[236:239]
    v_mfma_f32_16x16x32_bf16 v[236:239], a[160:163], v[28:31], v[236:239]
    v_mfma_f32_16x16x32_bf16 v[232:235], a[156:159], v[28:31], v[232:235]
    v_mfma_f32_16x16x32_bf16 v[232:235], a[120:123], v[24:27], v[232:235]
    v_mfma_f32_16x16x32_bf16 v[228:231], a[116:119], v[24:27], v[228:231]
    buffer_load_dwordx4 v6, s[40:43], s67 offen offset:2048 lds
    v_mfma_f32_16x16x32_bf16 v[228:231], a[152:155], v[28:31], v[228:231]
    v_mfma_f32_16x16x32_bf16 v[224:227], a[148:151], v[28:31], v[224:227]
    v_mfma_f32_16x16x32_bf16 v[224:227], a[112:115], v[24:27], v[224:227]
    v_mfma_f32_16x16x32_bf16 v[220:223], a[108:111], v[24:27], v[220:223]
    buffer_load_dwordx4 v7, s[40:43], s67 offen offset:3072 lds
    v_mfma_f32_16x16x32_bf16 v[220:223], a[144:147], v[28:31], v[220:223]
    s_waitcnt vmcnt(21)
    s_waitcnt vmcnt(12)
    s_waitcnt lgkmcnt(0)
    v_mfma_f32_16x16x32_bf16 v[40:43], a[180:183], v[16:19], v[40:43]
    v_add_u32 v8, s74, v1
    v_add_u32 v9, 65536, v8
    v_add_u32 v11, 131072, v8
    v_mfma_f32_16x16x32_bf16 v[40:43], a[216:219], v[20:23], v[40:43]
    ds_read_b128 v[24:27], v13 offset:2048
    v_mfma_f32_16x16x32_bf16 v[44:47], a[220:223], v[20:23], v[44:47]
    buffer_load_dword a252, v37, s[28:31], s59 offen
    v_mfma_f32_16x16x32_bf16 v[44:47], a[184:187], v[16:19], v[44:47]
    ds_read_b128 v[28:31], v14 offset:2048
    v_mfma_f32_16x16x32_bf16 v[48:51], a[188:191], v[16:19], v[48:51]
    v_mfma_f32_16x16x32_bf16 v[48:51], a[224:227], v[20:23], v[48:51]
    v_mfma_f32_16x16x32_bf16 v[52:55], a[228:231], v[20:23], v[52:55]
    v_mfma_f32_16x16x32_bf16 v[52:55], a[192:195], v[16:19], v[52:55]
    v_mfma_f32_16x16x32_bf16 v[56:59], a[196:199], v[16:19], v[56:59]
    v_mfma_f32_16x16x32_bf16 v[56:59], a[232:235], v[20:23], v[56:59]
    v_mfma_f32_16x16x32_bf16 v[60:63], a[236:239], v[20:23], v[60:63]
    s_add_u32 m0, s74, 49152
    s_nop 0
    v_cvt_pk_bf16_f32 v40, v40, v41
    v_cvt_pk_bf16_f32 v41, v42, v43
    v_mfma_f32_16x16x32_bf16 v[60:63], a[200:203], v[16:19], v[60:63]
    v_cvt_pk_bf16_f32 v42, v44, v45
    v_cvt_pk_bf16_f32 v43, v46, v47
    v_mfma_f32_16x16x32_bf16 v[64:67], a[204:207], v[16:19], v[64:67]
    buffer_load_dwordx4 v36, s[48:51], s93 offen offset:0 sc1 lds
    ds_write_b128 v9, v[40:43] offset:0
    v_mfma_f32_16x16x32_bf16 v[64:67], a[240:243], v[20:23], v[64:67]
    v_accvgpr_read_b32 v44, a0
    v_accvgpr_read_b32 v45, a1
    v_accvgpr_read_b32 v46, a2
    v_mfma_f32_16x16x32_bf16 v[68:71], a[244:247], v[20:23], v[68:71]
    v_accvgpr_read_b32 v47, a3
    v_cvt_pk_bf16_f32 v48, v48, v49
    v_cvt_pk_bf16_f32 v49, v50, v51
    v_mfma_f32_16x16x32_bf16 v[68:71], a[208:211], v[16:19], v[68:71]
    buffer_load_dwordx4 v36, s[48:51], s93 offen offset:1024 sc1 lds
    v_cvt_pk_bf16_f32 v50, v52, v53
    v_cvt_pk_bf16_f32 v51, v54, v55
    v_mfma_f32_16x16x32_bf16 v[72:75], a[212:215], v[16:19], v[72:75]
    ds_write_b128 v9, v[48:51] offset:1024
    v_accvgpr_read_b32 v52, a4
    v_mfma_f32_16x16x32_bf16 v[72:75], a[248:251], v[20:23], v[72:75]
    s_waitcnt lgkmcnt(2)
    v_accvgpr_read_b32 v53, a5
    v_accvgpr_read_b32 v54, a6
    v_accvgpr_read_b32 v55, a7
    v_mfma_f32_16x16x32_bf16 v[76:79], a[180:183], v[24:27], v[76:79]
    buffer_load_dwordx4 v36, s[48:51], s93 offen offset:2048 sc1 lds
    v_cvt_pk_bf16_f32 v56, v56, v57
    v_cvt_pk_bf16_f32 v57, v58, v59
    v_mfma_f32_16x16x32_bf16 v[76:79], a[216:219], v[28:31], v[76:79]
    s_waitcnt vmcnt(12)
    ds_read_b128 v[16:19], v13 offset:16384
    v_cvt_pk_bf16_f32 v58, v60, v61
    v_mfma_f32_16x16x32_bf16 v[80:83], a[220:223], v[28:31], v[80:83]
    v_cvt_pk_bf16_f32 v59, v62, v63
    v_mfma_f32_16x16x32_bf16 v[80:83], a[184:187], v[24:27], v[80:83]
    ds_read_b128 v[20:23], v14 offset:16384
    buffer_load_dwordx4 v36, s[48:51], s93 offen offset:3072 sc1 lds
    v_mfma_f32_16x16x32_bf16 v[84:87], a[188:191], v[24:27], v[84:87]
    s_add_u32 s65, s81, 0
    s_add_u32 s65, s65, s77
    ds_write_b128 v9, v[56:59] offset:2048
    v_mfma_f32_16x16x32_bf16 v[84:87], a[224:227], v[28:31], v[84:87]
    v_accvgpr_read_b32 v60, a8
    v_accvgpr_read_b32 v61, a9
    v_accvgpr_read_b32 v62, a10
    v_mfma_f32_16x16x32_bf16 v[88:91], a[228:231], v[28:31], v[88:91]
    buffer_load_dwordx4 a[108:111], v1, s[48:51], s65 offen offset:0 sc1
    v_accvgpr_read_b32 v63, a11
    v_cvt_pk_bf16_f32 v64, v64, v65
    v_mfma_f32_16x16x32_bf16 v[88:91], a[192:195], v[24:27], v[88:91]
    v_cvt_pk_bf16_f32 v65, v66, v67
    v_cvt_pk_bf16_f32 v66, v68, v69
    v_cvt_pk_bf16_f32 v67, v70, v71
    v_mfma_f32_16x16x32_bf16 v[92:95], a[196:199], v[24:27], v[92:95]
    ds_write_b128 v9, v[64:67] offset:3072
    v_accvgpr_read_b32 v68, a12
    v_mfma_f32_16x16x32_bf16 v[92:95], a[232:235], v[28:31], v[92:95]
    buffer_load_dwordx4 a[112:115], v1, s[48:51], s65 offen offset:1024 sc1
    v_accvgpr_read_b32 v69, a13
    v_accvgpr_read_b32 v70, a14
    v_mfma_f32_16x16x32_bf16 v[96:99], a[236:239], v[28:31], v[96:99]
    v_accvgpr_read_b32 v71, a15
    v_cvt_pk_bf16_f32 v76, v76, v77
    v_cvt_pk_bf16_f32 v77, v78, v79
    v_mfma_f32_16x16x32_bf16 v[96:99], a[200:203], v[24:27], v[96:99]
    v_cvt_pk_bf16_f32 v78, v80, v81
    v_cvt_pk_bf16_f32 v79, v82, v83
    v_mfma_f32_16x16x32_bf16 v[100:103], a[204:207], v[24:27], v[100:103]
    buffer_load_dwordx4 a[116:119], v1, s[48:51], s65 offen offset:2048 sc1
    ds_write_b128 v9, v[76:79] offset:16384
    v_mfma_f32_16x16x32_bf16 v[100:103], a[240:243], v[28:31], v[100:103]
    v_accvgpr_read_b32 v80, a16
    v_accvgpr_read_b32 v81, a17
    v_accvgpr_read_b32 v82, a18
    v_mfma_f32_16x16x32_bf16 v[104:107], a[244:247], v[28:31], v[104:107]
    v_accvgpr_read_b32 v83, a19
    v_cvt_pk_bf16_f32 v84, v84, v85
    v_cvt_pk_bf16_f32 v85, v86, v87
    v_mfma_f32_16x16x32_bf16 v[104:107], a[208:211], v[24:27], v[104:107]
    buffer_load_dwordx4 a[120:123], v1, s[48:51], s65 offen offset:3072 sc1
    v_cvt_pk_bf16_f32 v86, v88, v89
    v_cvt_pk_bf16_f32 v87, v90, v91
    v_mfma_f32_16x16x32_bf16 v[108:111], a[212:215], v[24:27], v[108:111]
    ds_write_b128 v9, v[84:87] offset:17408
    v_accvgpr_read_b32 v88, a20
    v_mfma_f32_16x16x32_bf16 v[108:111], a[248:251], v[28:31], v[108:111]
    s_waitcnt lgkmcnt(4)
    v_accvgpr_read_b32 v89, a21
    v_accvgpr_read_b32 v90, a22
    v_accvgpr_read_b32 v91, a23
    v_mfma_f32_16x16x32_bf16 v[112:115], a[180:183], v[16:19], v[112:115]
    buffer_load_dwordx4 a[140:143], v3, s[48:51], s65 offen offset:0 sc1
    v_cvt_pk_bf16_f32 v92, v92, v93
    v_cvt_pk_bf16_f32 v93, v94, v95
    v_mfma_f32_16x16x32_bf16 v[112:115], a[216:219], v[20:23], v[112:115]
    ds_read_b128 v[24:27], v13 offset:18432
    v_cvt_pk_bf16_f32 v94, v96, v97
    v_cvt_pk_bf16_f32 v95, v98, v99
    v_mfma_f32_16x16x32_bf16 v[116:119], a[220:223], v[20:23], v[116:119]
    ds_write_b128 v9, v[92:95] offset:18432
    v_accvgpr_read_b32 v96, a24
    v_mfma_f32_16x16x32_bf16 v[116:119], a[184:187], v[16:19], v[116:119]
    ds_read_b128 v[28:31], v14 offset:18432
    buffer_load_dwordx4 a[124:127], v2, s[48:51], s65 offen offset:0 sc1
    v_mfma_f32_16x16x32_bf16 v[120:123], a[188:191], v[16:19], v[120:123]
    v_accvgpr_read_b32 v97, a25
    v_accvgpr_read_b32 v98, a26
    v_accvgpr_read_b32 v99, a27
    v_mfma_f32_16x16x32_bf16 v[120:123], a[224:227], v[20:23], v[120:123]
    v_cvt_pk_bf16_f32 v100, v100, v101
    v_cvt_pk_bf16_f32 v101, v102, v103
    v_cvt_pk_bf16_f32 v102, v104, v105
    v_mfma_f32_16x16x32_bf16 v[124:127], a[228:231], v[20:23], v[124:127]
    buffer_load_dwordx4 a[128:131], v2, s[48:51], s65 offen offset:1024 sc1
    v_cvt_pk_bf16_f32 v103, v106, v107
    v_mfma_f32_16x16x32_bf16 v[124:127], a[192:195], v[16:19], v[124:127]
    ds_write_b128 v9, v[100:103] offset:19456
    v_accvgpr_read_b32 v104, a28
    v_mfma_f32_16x16x32_bf16 v[128:131], a[196:199], v[16:19], v[128:131]
    v_accvgpr_read_b32 v105, a29
    v_accvgpr_read_b32 v106, a30
    v_accvgpr_read_b32 v107, a31
    v_mfma_f32_16x16x32_bf16 v[128:131], a[232:235], v[20:23], v[128:131]
    buffer_load_dwordx4 a[132:135], v2, s[48:51], s65 offen offset:2048 sc1
    v_cvt_pk_bf16_f32 v72, v72, v73
    v_cvt_pk_bf16_f32 v73, v74, v75
    v_mfma_f32_16x16x32_bf16 v[132:135], a[236:239], v[20:23], v[132:135]
    v_cvt_pk_bf16_f32 v74, v108, v109
    v_cvt_pk_bf16_f32 v75, v110, v111
    v_mfma_f32_16x16x32_bf16 v[132:135], a[200:203], v[16:19], v[132:135]
    ds_write_b128 v9, v[72:75] offset:32768
    v_accvgpr_read_b32 v108, a32
    v_mfma_f32_16x16x32_bf16 v[136:139], a[204:207], v[16:19], v[136:139]
    buffer_load_dwordx4 a[136:139], v2, s[48:51], s65 offen offset:3072 sc1
    v_accvgpr_read_b32 v109, a33
    v_accvgpr_read_b32 v110, a34
    v_mfma_f32_16x16x32_bf16 v[136:139], a[240:243], v[20:23], v[136:139]
    s_add_u32 s65, s81, 9216
    s_sub_u32 s65, s65, s77
    v_accvgpr_read_b32 v111, a35
    v_mfma_f32_16x16x32_bf16 v[140:143], a[244:247], v[20:23], v[140:143]
    v_cvt_pk_bf16_f32 v112, v112, v113
    v_cvt_pk_bf16_f32 v113, v114, v115
    v_cvt_pk_bf16_f32 v114, v116, v117
    v_mfma_f32_16x16x32_bf16 v[140:143], a[208:211], v[16:19], v[140:143]
    buffer_load_dwordx4 a[144:147], v1, s[48:51], s65 offen offset:0 sc1
    v_cvt_pk_bf16_f32 v115, v118, v119
    v_mfma_f32_16x16x32_bf16 v[144:147], a[212:215], v[16:19], v[144:147]
    ds_write_b128 v9, v[112:115] offset:33792
    v_accvgpr_read_b32 v116, a36
    v_mfma_f32_16x16x32_bf16 v[144:147], a[248:251], v[20:23], v[144:147]
    s_waitcnt lgkmcnt(3)
    v_accvgpr_read_b32 v117, a37
    v_accvgpr_read_b32 v118, a38
    v_accvgpr_read_b32 v119, a39
    v_mfma_f32_16x16x32_bf16 v[148:151], a[180:183], v[24:27], v[148:151]
    buffer_load_dwordx4 a[148:151], v1, s[48:51], s65 offen offset:1024 sc1
    v_cvt_pk_bf16_f32 v120, v120, v121
    v_cvt_pk_bf16_f32 v121, v122, v123
    v_mfma_f32_16x16x32_bf16 v[148:151], a[216:219], v[28:31], v[148:151]
    s_waitcnt vmcnt(20)
    ds_read_b128 v[16:19], v13 offset:32768
    v_cvt_pk_bf16_f32 v122, v124, v125
    v_mfma_f32_16x16x32_bf16 v[152:155], a[220:223], v[28:31], v[152:155]
    v_cvt_pk_bf16_f32 v123, v126, v127
    v_mfma_f32_16x16x32_bf16 v[152:155], a[184:187], v[24:27], v[152:155]
    ds_read_b128 v[20:23], v14 offset:32768
    buffer_load_dwordx4 a[152:155], v1, s[48:51], s65 offen offset:2048 sc1
    v_mfma_f32_16x16x32_bf16 v[156:159], a[188:191], v[24:27], v[156:159]
    ds_write_b128 v9, v[120:123] offset:34816
    v_accvgpr_read_b32 v124, a40
    v_mfma_f32_16x16x32_bf16 v[156:159], a[224:227], v[28:31], v[156:159]
    v_accvgpr_read_b32 v125, a41
    v_accvgpr_read_b32 v126, a42
    v_accvgpr_read_b32 v127, a43
    v_mfma_f32_16x16x32_bf16 v[160:163], a[228:231], v[28:31], v[160:163]
    buffer_load_dwordx4 a[156:159], v1, s[48:51], s65 offen offset:3072 sc1
    v_cvt_pk_bf16_f32 v128, v128, v129
    v_cvt_pk_bf16_f32 v129, v130, v131
    v_mfma_f32_16x16x32_bf16 v[160:163], a[192:195], v[24:27], v[160:163]
    v_cvt_pk_bf16_f32 v130, v132, v133
    v_cvt_pk_bf16_f32 v131, v134, v135
    v_mfma_f32_16x16x32_bf16 v[164:167], a[196:199], v[24:27], v[164:167]
    ds_write_b128 v9, v[128:131] offset:35840
    v_accvgpr_read_b32 v132, a44
    v_mfma_f32_16x16x32_bf16 v[164:167], a[232:235], v[28:31], v[164:167]
    buffer_load_dwordx4 a[176:179], v3, s[48:51], s65 offen offset:0 sc1
    v_accvgpr_read_b32 v133, a45
    v_accvgpr_read_b32 v134, a46
    v_mfma_f32_16x16x32_bf16 v[168:171], a[236:239], v[28:31], v[168:171]
    v_accvgpr_read_b32 v135, a47
    v_cvt_pk_bf16_f32 v136, v136, v137
    v_cvt_pk_bf16_f32 v137, v138, v139
    v_mfma_f32_16x16x32_bf16 v[168:171], a[200:203], v[24:27], v[168:171]
    v_cvt_pk_bf16_f32 v138, v140, v141
    v_cvt_pk_bf16_f32 v139, v142, v143
    v_mfma_f32_16x16x32_bf16 v[172:175], a[204:207], v[24:27], v[172:175]
    buffer_load_dwordx4 a[160:163], v2, s[48:51], s65 offen offset:0 sc1
    ds_write_b128 v9, v[136:139] offset:49152
    v_mfma_f32_16x16x32_bf16 v[172:175], a[240:243], v[28:31], v[172:175]
    v_accvgpr_read_b32 v140, a48
    v_accvgpr_read_b32 v141, a49
    v_accvgpr_read_b32 v142, a50
    v_mfma_f32_16x16x32_bf16 v[176:179], a[244:247], v[28:31], v[176:179]
    v_accvgpr_read_b32 v143, a51
    v_cvt_pk_bf16_f32 v148, v148, v149
    v_cvt_pk_bf16_f32 v149, v150, v151
    v_mfma_f32_16x16x32_bf16 v[176:179], a[208:211], v[24:27], v[176:179]
    buffer_load_dwordx4 a[164:167], v2, s[48:51], s65 offen offset:1024 sc1
    v_cvt_pk_bf16_f32 v150, v152, v153
    v_cvt_pk_bf16_f32 v151, v154, v155
    v_mfma_f32_16x16x32_bf16 v[180:183], a[212:215], v[24:27], v[180:183]
    ds_write_b128 v9, v[148:151] offset:50176
    v_accvgpr_read_b32 v152, a52
    v_mfma_f32_16x16x32_bf16 v[180:183], a[248:251], v[28:31], v[180:183]
    s_waitcnt lgkmcnt(4)
    v_accvgpr_read_b32 v153, a53
    v_accvgpr_read_b32 v154, a54
    v_accvgpr_read_b32 v155, a55
    v_mfma_f32_16x16x32_bf16 v[184:187], a[180:183], v[16:19], v[184:187]
    buffer_load_dwordx4 a[168:171], v2, s[48:51], s65 offen offset:2048 sc1
    v_cvt_pk_bf16_f32 v156, v156, v157
    v_cvt_pk_bf16_f32 v157, v158, v159
    v_mfma_f32_16x16x32_bf16 v[184:187], a[216:219], v[20:23], v[184:187]
    ds_read_b128 v[24:27], v13 offset:34816
    v_cvt_pk_bf16_f32 v158, v160, v161
    v_cvt_pk_bf16_f32 v159, v162, v163
    v_mfma_f32_16x16x32_bf16 v[188:191], a[220:223], v[20:23], v[188:191]
    ds_write_b128 v9, v[156:159] offset:51200
    v_accvgpr_read_b32 v160, a56
    v_mfma_f32_16x16x32_bf16 v[188:191], a[184:187], v[16:19], v[188:191]
    ds_read_b128 v[28:31], v14 offset:34816
    buffer_load_dwordx4 a[172:175], v2, s[48:51], s65 offen offset:3072 sc1
    v_mfma_f32_16x16x32_bf16 v[192:195], a[188:191], v[16:19], v[192:195]
    s_add_u32 s65, s81, 18432
    s_add_u32 s65, s65, s77
    v_accvgpr_read_b32 v161, a57
    v_accvgpr_read_b32 v162, a58
    v_mfma_f32_16x16x32_bf16 v[192:195], a[224:227], v[20:23], v[192:195]
    v_accvgpr_read_b32 v163, a59
    v_cvt_pk_bf16_f32 v164, v164, v165
    v_cvt_pk_bf16_f32 v165, v166, v167
    v_mfma_f32_16x16x32_bf16 v[196:199], a[228:231], v[20:23], v[196:199]
    buffer_load_dwordx4 a[0:3], v1, s[48:51], s65 offen offset:0 sc1
    v_cvt_pk_bf16_f32 v166, v168, v169
    v_cvt_pk_bf16_f32 v167, v170, v171
    v_mfma_f32_16x16x32_bf16 v[196:199], a[192:195], v[16:19], v[196:199]
    ds_write_b128 v9, v[164:167] offset:52224
    v_accvgpr_read_b32 v168, a60
    v_mfma_f32_16x16x32_bf16 v[200:203], a[196:199], v[16:19], v[200:203]
    v_accvgpr_read_b32 v169, a61
    v_accvgpr_read_b32 v170, a62
    v_accvgpr_read_b32 v171, a63
    v_mfma_f32_16x16x32_bf16 v[200:203], a[232:235], v[20:23], v[200:203]
    buffer_load_dwordx4 a[4:7], v1, s[48:51], s65 offen offset:1024 sc1
    v_cvt_pk_bf16_f32 v172, v172, v173
    v_cvt_pk_bf16_f32 v173, v174, v175
    v_mfma_f32_16x16x32_bf16 v[204:207], a[236:239], v[20:23], v[204:207]
    v_cvt_pk_bf16_f32 v174, v176, v177
    v_cvt_pk_bf16_f32 v175, v178, v179
    v_mfma_f32_16x16x32_bf16 v[204:207], a[200:203], v[16:19], v[204:207]
    ds_write_b128 v11, v[172:175] offset:0
    v_accvgpr_read_b32 v176, a64
    v_mfma_f32_16x16x32_bf16 v[208:211], a[204:207], v[16:19], v[208:211]
    buffer_load_dwordx4 a[8:11], v1, s[48:51], s65 offen offset:2048 sc1
    v_accvgpr_read_b32 v177, a65
    v_accvgpr_read_b32 v178, a66
    v_mfma_f32_16x16x32_bf16 v[208:211], a[240:243], v[20:23], v[208:211]
    v_accvgpr_read_b32 v179, a67
    v_cvt_pk_bf16_f32 v144, v144, v145
    v_cvt_pk_bf16_f32 v145, v146, v147
    v_mfma_f32_16x16x32_bf16 v[212:215], a[244:247], v[20:23], v[212:215]
    v_cvt_pk_bf16_f32 v146, v180, v181
    v_cvt_pk_bf16_f32 v147, v182, v183
    v_mfma_f32_16x16x32_bf16 v[212:215], a[208:211], v[16:19], v[212:215]
    buffer_load_dwordx4 a[12:15], v1, s[48:51], s65 offen offset:3072 sc1
    ds_write_b128 v11, v[144:147] offset:1024
    v_mfma_f32_16x16x32_bf16 v[216:219], a[212:215], v[16:19], v[216:219]
    v_accvgpr_read_b32 v180, a68
    v_accvgpr_read_b32 v181, a69
    v_accvgpr_read_b32 v182, a70
    v_mfma_f32_16x16x32_bf16 v[216:219], a[248:251], v[20:23], v[216:219]
    s_waitcnt lgkmcnt(3)
    v_accvgpr_read_b32 v183, a71
    v_mfma_f32_16x16x32_bf16 v[220:223], a[180:183], v[24:27], v[220:223]
    buffer_load_dwordx4 a[32:35], v3, s[48:51], s65 offen offset:0 sc1
    v_add_u32 v13, s63, v12
    v_cvt_pk_bf16_f32 v184, v184, v185
    v_mfma_f32_16x16x32_bf16 v[220:223], a[216:219], v[28:31], v[220:223]
    s_waitcnt vmcnt(28)
    ds_read_b128 v[16:19], v13 offset:16384
    v_cvt_pk_bf16_f32 v185, v186, v187
    v_mfma_f32_16x16x32_bf16 v[224:227], a[220:223], v[28:31], v[224:227]
    v_xad_u32 v14, v12, 64, s63
    v_cvt_pk_bf16_f32 v186, v188, v189
    v_cvt_pk_bf16_f32 v187, v190, v191
    v_mfma_f32_16x16x32_bf16 v[224:227], a[184:187], v[24:27], v[224:227]
    ds_read_b128 v[20:23], v14 offset:16384
    buffer_load_dwordx4 a[16:19], v2, s[48:51], s65 offen offset:0 sc1
    v_mfma_f32_16x16x32_bf16 v[228:231], a[188:191], v[24:27], v[228:231]
    ds_write_b128 v11, v[184:187] offset:2048
    v_cvt_pk_bf16_f32 v192, v192, v193
    v_mfma_f32_16x16x32_bf16 v[228:231], a[224:227], v[28:31], v[228:231]
    v_cvt_pk_bf16_f32 v193, v194, v195
    v_cvt_pk_bf16_f32 v194, v196, v197
    v_cvt_pk_bf16_f32 v195, v198, v199
    v_mfma_f32_16x16x32_bf16 v[232:235], a[228:231], v[28:31], v[232:235]
    buffer_load_dwordx4 a[20:23], v2, s[48:51], s65 offen offset:1024 sc1
    ds_write_b128 v11, v[192:195] offset:3072
    v_mfma_f32_16x16x32_bf16 v[232:235], a[192:195], v[24:27], v[232:235]
    v_cvt_pk_bf16_f32 v200, v200, v201
    v_cvt_pk_bf16_f32 v201, v202, v203
    v_cvt_pk_bf16_f32 v202, v204, v205
    v_mfma_f32_16x16x32_bf16 v[236:239], a[196:199], v[24:27], v[236:239]
    v_cvt_pk_bf16_f32 v203, v206, v207
    v_mfma_f32_16x16x32_bf16 v[236:239], a[232:235], v[28:31], v[236:239]
    buffer_load_dwordx4 a[24:27], v2, s[48:51], s65 offen offset:2048 sc1
    ds_write_b128 v8, v[200:203] offset:0
    v_mfma_f32_16x16x32_bf16 v[240:243], a[236:239], v[28:31], v[240:243]
    v_cvt_pk_bf16_f32 v208, v208, v209
    v_cvt_pk_bf16_f32 v209, v210, v211
    v_cvt_pk_bf16_f32 v210, v212, v213
    v_mfma_f32_16x16x32_bf16 v[240:243], a[200:203], v[24:27], v[240:243]
    v_cvt_pk_bf16_f32 v211, v214, v215
    v_mfma_f32_16x16x32_bf16 v[244:247], a[204:207], v[24:27], v[244:247]
    buffer_load_dwordx4 a[28:31], v2, s[48:51], s65 offen offset:3072 sc1
    ds_write_b128 v8, v[208:211] offset:1024
    v_mfma_f32_16x16x32_bf16 v[244:247], a[240:243], v[28:31], v[244:247]
    s_add_u32 s65, s81, 27648
    s_sub_u32 s65, s65, s77
    v_cvt_pk_bf16_f32 v220, v220, v221
    v_cvt_pk_bf16_f32 v221, v222, v223
    v_mfma_f32_16x16x32_bf16 v[248:251], a[244:247], v[28:31], v[248:251]
    v_cvt_pk_bf16_f32 v222, v224, v225
    v_cvt_pk_bf16_f32 v223, v226, v227
    v_mfma_f32_16x16x32_bf16 v[248:251], a[208:211], v[24:27], v[248:251]
    buffer_load_dwordx4 a[36:39], v1, s[48:51], s65 offen offset:0 sc1
    ds_write_b128 v8, v[220:223] offset:2048
    v_mfma_f32_16x16x32_bf16 v[252:255], a[212:215], v[24:27], v[252:255]
    v_cvt_pk_bf16_f32 v228, v228, v229
    v_cvt_pk_bf16_f32 v229, v230, v231
    v_cvt_pk_bf16_f32 v230, v232, v233
    v_mfma_f32_16x16x32_bf16 v[252:255], a[248:251], v[28:31], v[252:255]
    s_waitcnt lgkmcnt(5)
    v_cvt_pk_bf16_f32 v231, v234, v235
    v_mfma_f32_16x16x32_bf16 v[44:47], a[180:183], v[16:19], v[44:47]
    buffer_load_dwordx4 a[40:43], v1, s[48:51], s65 offen offset:1024 sc1
    ds_write_b128 v8, v[228:231] offset:3072
    v_mfma_f32_16x16x32_bf16 v[44:47], a[216:219], v[20:23], v[44:47]
    ds_read_b128 v[24:27], v13 offset:18432
    v_cvt_pk_bf16_f32 v236, v236, v237
    v_cvt_pk_bf16_f32 v237, v238, v239
    v_mfma_f32_16x16x32_bf16 v[52:55], a[220:223], v[20:23], v[52:55]
    v_cvt_pk_bf16_f32 v238, v240, v241
    v_cvt_pk_bf16_f32 v239, v242, v243
    v_mfma_f32_16x16x32_bf16 v[52:55], a[184:187], v[16:19], v[52:55]
    ds_read_b128 v[28:31], v14 offset:18432
    buffer_load_dwordx4 a[44:47], v1, s[48:51], s65 offen offset:2048 sc1
    v_mfma_f32_16x16x32_bf16 v[60:63], a[188:191], v[16:19], v[60:63]
    ds_write_b128 v8, v[236:239] offset:16384
    v_cvt_pk_bf16_f32 v244, v244, v245
    v_mfma_f32_16x16x32_bf16 v[60:63], a[224:227], v[20:23], v[60:63]
    v_cvt_pk_bf16_f32 v245, v246, v247
    v_cvt_pk_bf16_f32 v246, v248, v249
    v_cvt_pk_bf16_f32 v247, v250, v251
    v_mfma_f32_16x16x32_bf16 v[68:71], a[228:231], v[20:23], v[68:71]
    buffer_load_dwordx4 a[48:51], v1, s[48:51], s65 offen offset:3072 sc1
    ds_write_b128 v8, v[244:247] offset:17408
    v_mfma_f32_16x16x32_bf16 v[68:71], a[192:195], v[16:19], v[68:71]
    v_cvt_pk_bf16_f32 v216, v216, v217
    v_cvt_pk_bf16_f32 v217, v218, v219
    v_cvt_pk_bf16_f32 v218, v252, v253
    v_mfma_f32_16x16x32_bf16 v[80:83], a[196:199], v[16:19], v[80:83]
    v_cvt_pk_bf16_f32 v219, v254, v255
    v_mfma_f32_16x16x32_bf16 v[80:83], a[232:235], v[20:23], v[80:83]
    buffer_load_dwordx4 a[68:71], v3, s[48:51], s65 offen offset:0 sc1
    ds_write_b128 v8, v[216:219] offset:18432
    v_mfma_f32_16x16x32_bf16 v[88:91], a[236:239], v[20:23], v[88:91]
    v_mfma_f32_16x16x32_bf16 v[88:91], a[200:203], v[16:19], v[88:91]
    v_mfma_f32_16x16x32_bf16 v[96:99], a[204:207], v[16:19], v[96:99]
    buffer_load_dwordx4 a[52:55], v2, s[48:51], s65 offen offset:0 sc1
    v_mfma_f32_16x16x32_bf16 v[96:99], a[240:243], v[20:23], v[96:99]
    v_mfma_f32_16x16x32_bf16 v[104:107], a[244:247], v[20:23], v[104:107]
    v_mfma_f32_16x16x32_bf16 v[104:107], a[208:211], v[16:19], v[104:107]
    buffer_load_dwordx4 a[56:59], v2, s[48:51], s65 offen offset:1024 sc1
    v_mfma_f32_16x16x32_bf16 v[108:111], a[212:215], v[16:19], v[108:111]
    v_mfma_f32_16x16x32_bf16 v[108:111], a[248:251], v[20:23], v[108:111]
    s_waitcnt lgkmcnt(3)
    v_mfma_f32_16x16x32_bf16 v[116:119], a[180:183], v[24:27], v[116:119]
    buffer_load_dwordx4 a[60:63], v2, s[48:51], s65 offen offset:2048 sc1
    v_mfma_f32_16x16x32_bf16 v[116:119], a[216:219], v[28:31], v[116:119]
    v_mfma_f32_16x16x32_bf16 v[124:127], a[220:223], v[28:31], v[124:127]
    v_mfma_f32_16x16x32_bf16 v[124:127], a[184:187], v[24:27], v[124:127]
    buffer_load_dwordx4 a[64:67], v2, s[48:51], s65 offen offset:3072 sc1
    v_mfma_f32_16x16x32_bf16 v[132:135], a[188:191], v[24:27], v[132:135]
    v_mfma_f32_16x16x32_bf16 v[132:135], a[224:227], v[28:31], v[132:135]
    v_mfma_f32_16x16x32_bf16 v[140:143], a[228:231], v[28:31], v[140:143]
    v_mfma_f32_16x16x32_bf16 v[140:143], a[192:195], v[24:27], v[140:143]
    v_mfma_f32_16x16x32_bf16 v[152:155], a[196:199], v[24:27], v[152:155]
    v_mfma_f32_16x16x32_bf16 v[152:155], a[232:235], v[28:31], v[152:155]
    v_mfma_f32_16x16x32_bf16 v[160:163], a[236:239], v[28:31], v[160:163]
    v_mfma_f32_16x16x32_bf16 v[160:163], a[200:203], v[24:27], v[160:163]
    v_mfma_f32_16x16x32_bf16 v[168:171], a[204:207], v[24:27], v[168:171]
    v_mfma_f32_16x16x32_bf16 v[168:171], a[240:243], v[28:31], v[168:171]
    v_mfma_f32_16x16x32_bf16 v[176:179], a[244:247], v[28:31], v[176:179]
    v_mfma_f32_16x16x32_bf16 v[176:179], a[208:211], v[24:27], v[176:179]
    v_mfma_f32_16x16x32_bf16 v[180:183], a[212:215], v[24:27], v[180:183]
    v_mfma_f32_16x16x32_bf16 v[180:183], a[248:251], v[28:31], v[180:183]
    v_bfe_u32 v24, v0, 2, 2
    s_add_u32 s65, s81, 36864
    s_add_u32 s65, s65, s77
    buffer_load_dwordx4 a[180:183], v1, s[48:51], s65 offen offset:0 sc1
    v_cmp_eq_u32 vcc, v24, v10
    v_and_b32 v24, 1, v0
    buffer_load_dwordx4 a[184:187], v1, s[48:51], s65 offen offset:1024 sc1
    v_lshlrev_b32 v24, 4, v24
    v_mov_b32 v25, 0x3f80
    v_lshlrev_b32 v24, v24, v25
    buffer_load_dwordx4 a[188:191], v1, s[48:51], s65 offen offset:2048 sc1
    v_cndmask_b32 v24, 0, v24, vcc
    v_and_b32 v25, 2, v0
    v_cmp_eq_u32 vcc, 0, v25
    v_mov_b32 v16, 0
    v_mov_b32 v17, 0
    v_mov_b32 v20, 0
    v_mov_b32 v21, 0
    v_cndmask_b32 v18, 0, v24, vcc
    v_cndmask_b32 v19, v24, v21, vcc
    s_sub_u32 s57, s3, 1
    s_and_b32 s57, s57, 3
    s_lshl_b32 s57, s57, 12
    s_add_u32 s62, s57, 65536
    v_add_u32 v4, s62, v1
    s_sub_u32 s57, s3, 2
    s_and_b32 s57, s57, 3
    s_lshl_b32 s57, s57, 12
    s_add_u32 s62, s57, 65536
    v_add_u32 v5, s62, v1
    s_add_u32 s62, s57, 131072
    v_add_u32 v6, s62, v1
    s_sub_u32 s57, s3, 3
    s_and_b32 s57, s57, 3
    s_lshl_b32 s57, s57, 12
    v_add_u32 v7, s57, v1
    s_add_u32 s62, s57, 131072
    v_add_u32 v12, s62, v1
    s_waitcnt lgkmcnt(0)
    s_barrier
    ds_read_b128 v[40:43], v4 offset:0
    ds_read_b128 v[48:51], v5 offset:33792
    ds_read_b128 v[56:59], v12 offset:2048
    ds_read_b128 v[64:67], v4 offset:16384
    ds_read_b128 v[76:79], v5 offset:50176
    ds_read_b128 v[84:87], v7 offset:2048
    ds_read_b128 v[92:95], v4 offset:1024
    ds_read_b128 v[100:103], v5 offset:34816
    ds_read_b128 v[72:75], v12 offset:3072
    v_accvgpr_read_b32 v189, a72
    v_accvgpr_read_b32 v191, a73
    v_lshlrev_b32 v188, 16, v189
    v_and_b32 v189, 0xffff0000, v189
    v_lshlrev_b32 v190, 16, v191
    v_and_b32 v191, 0xffff0000, v191
    v_accvgpr_read_b32 v197, a76
    v_accvgpr_read_b32 v199, a77
    v_lshlrev_b32 v196, 16, v197
    v_and_b32 v197, 0xffff0000, v197
    v_lshlrev_b32 v198, 16, v199
    v_and_b32 v199, 0xffff0000, v199
    v_accvgpr_read_b32 v205, a74
    v_accvgpr_read_b32 v207, a75
    v_lshlrev_b32 v204, 16, v205
    v_and_b32 v205, 0xffff0000, v205
    v_lshlrev_b32 v206, 16, v207
    v_and_b32 v207, 0xffff0000, v207
    v_accvgpr_read_b32 v213, a78
    v_accvgpr_read_b32 v215, a79
    v_lshlrev_b32 v212, 16, v213
    v_and_b32 v213, 0xffff0000, v213
    v_lshlrev_b32 v214, 16, v215
    v_and_b32 v215, 0xffff0000, v215
    s_waitcnt lgkmcnt(8)
    v_mfma_f32_16x16x32_bf16 v[44:47], v[18:21], v[40:43], v[44:47]
    ds_read_b128 v[112:115], v4 offset:17408
    v_accvgpr_read_b32 v225, a80
    v_mfma_f32_16x16x32_bf16 v[52:55], v[16:19], v[40:43], v[52:55]
    s_waitcnt lgkmcnt(8)
    buffer_load_dwordx4 a[192:195], v1, s[48:51], s65 offen offset:3072 sc1
    v_mfma_f32_16x16x32_bf16 v[44:47], v[18:21], v[48:51], v[44:47]
    ds_read_b128 v[120:123], v5 offset:51200
    v_accvgpr_read_b32 v227, a81
    v_mfma_f32_16x16x32_bf16 v[52:55], v[16:19], v[48:51], v[52:55]
    s_waitcnt lgkmcnt(8)
    v_lshlrev_b32 v224, 16, v225
    v_and_b32 v225, 0xffff0000, v225
    v_mfma_f32_16x16x32_bf16 v[44:47], v[18:21], v[56:59], v[44:47]
    ds_read_b128 v[128:131], v7 offset:3072
    v_lshlrev_b32 v226, 16, v227
    v_mfma_f32_16x16x32_bf16 v[52:55], v[16:19], v[56:59], v[52:55]
    s_waitcnt lgkmcnt(8)
    buffer_load_dwordx4 a[212:215], v3, s[48:51], s65 offen offset:0 sc1
    v_mfma_f32_16x16x32_bf16 v[116:119], v[18:21], v[64:67], v[116:119]
    ds_read_b128 v[136:139], v4 offset:2048
    v_and_b32 v227, 0xffff0000, v227
    v_mfma_f32_16x16x32_bf16 v[124:127], v[16:19], v[64:67], v[124:127]
    s_waitcnt lgkmcnt(8)
    v_accvgpr_read_b32 v233, a84
    v_accvgpr_read_b32 v235, a85
    v_mfma_f32_16x16x32_bf16 v[116:119], v[18:21], v[76:79], v[116:119]
    ds_read_b128 v[148:151], v5 offset:35840
    v_lshlrev_b32 v232, 16, v233
    v_mfma_f32_16x16x32_bf16 v[124:127], v[16:19], v[76:79], v[124:127]
    s_waitcnt lgkmcnt(8)
    buffer_load_dwordx4 a[196:199], v2, s[48:51], s65 offen offset:0 sc1
    v_mfma_f32_16x16x32_bf16 v[116:119], v[18:21], v[84:87], v[116:119]
    ds_read_b128 v[156:159], v7 offset:0
    v_and_b32 v233, 0xffff0000, v233
    v_mfma_f32_16x16x32_bf16 v[124:127], v[16:19], v[84:87], v[124:127]
    s_waitcnt lgkmcnt(8)
    buffer_load_dwordx4 a[200:203], v2, s[48:51], s65 offen offset:1024 sc1
    v_mfma_f32_16x16x32_bf16 v[60:63], v[18:21], v[92:95], v[60:63]
    ds_read_b128 v[164:167], v4 offset:18432
    v_lshlrev_b32 v234, 16, v235
    v_mfma_f32_16x16x32_bf16 v[68:71], v[16:19], v[92:95], v[68:71]
    s_waitcnt lgkmcnt(8)
    v_and_b32 v235, 0xffff0000, v235
    v_accvgpr_read_b32 v241, a82
    v_mfma_f32_16x16x32_bf16 v[60:63], v[18:21], v[100:103], v[60:63]
    ds_read_b128 v[172:175], v5 offset:52224
    v_accvgpr_read_b32 v243, a83
    v_mfma_f32_16x16x32_bf16 v[68:71], v[16:19], v[100:103], v[68:71]
    s_waitcnt lgkmcnt(8)
    buffer_load_dwordx4 a[204:207], v2, s[48:51], s65 offen offset:2048 sc1
    v_mfma_f32_16x16x32_bf16 v[60:63], v[18:21], v[72:75], v[60:63]
    ds_read_b128 v[144:147], v7 offset:16384
    v_lshlrev_b32 v240, 16, v241
    v_mfma_f32_16x16x32_bf16 v[68:71], v[16:19], v[72:75], v[68:71]
    s_waitcnt lgkmcnt(8)
    v_and_b32 v241, 0xffff0000, v241
    v_lshlrev_b32 v242, 16, v243
    v_mfma_f32_16x16x32_bf16 v[132:135], v[18:21], v[112:115], v[132:135]
    ds_read_b128 v[184:187], v4 offset:3072
    v_and_b32 v243, 0xffff0000, v243
    v_mfma_f32_16x16x32_bf16 v[140:143], v[16:19], v[112:115], v[140:143]
    s_waitcnt lgkmcnt(8)
    v_accvgpr_read_b32 v249, a86
    v_accvgpr_read_b32 v251, a87
    v_mfma_f32_16x16x32_bf16 v[132:135], v[18:21], v[120:123], v[132:135]
    ds_read_b128 v[192:195], v5 offset:49152
    v_lshlrev_b32 v248, 16, v249
    v_mfma_f32_16x16x32_bf16 v[140:143], v[16:19], v[120:123], v[140:143]
    s_waitcnt lgkmcnt(8)
    v_and_b32 v249, 0xffff0000, v249
    v_lshlrev_b32 v250, 16, v251
    v_mfma_f32_16x16x32_bf16 v[132:135], v[18:21], v[128:131], v[132:135]
    ds_read_b128 v[200:203], v7 offset:1024
    v_and_b32 v251, 0xffff0000, v251
    v_mfma_f32_16x16x32_bf16 v[140:143], v[16:19], v[128:131], v[140:143]
    buffer_load_dwordx4 v[40:43], v1, s[28:31], s59 offen offset:0
    buffer_load_dwordx4 v[56:59], v1, s[28:31], s59 offen offset:1024
    buffer_load_dwordx4 v[76:79], v1, s[28:31], s59 offen offset:2048
    buffer_load_dwordx4 v[92:95], v1, s[28:31], s59 offen offset:3072
    s_lshl_b32 s57, s97, 1
    buffer_load_ushort a253, v16, s[32:35], s57 offen
    v_pk_mul_f32 v[44:45], v[44:45], v[188:189]
    v_pk_mul_f32 v[46:47], v[46:47], v[190:191]
    v_pk_mul_f32 v[52:53], v[52:53], v[196:197]
    v_pk_mul_f32 v[54:55], v[54:55], v[198:199]
    v_cvt_pk_bf16_f32 v24, v44, v45
    v_cvt_pk_bf16_f32 v25, v46, v47
    v_cvt_pk_bf16_f32 v26, v52, v53
    v_cvt_pk_bf16_f32 v27, v54, v55
    buffer_store_dwordx4 v[24:27], v1, s[48:51], s72 offen offset:0 sc1
    v_pk_mul_f32 v[116:117], v[116:117], v[204:205]
    v_pk_mul_f32 v[118:119], v[118:119], v[206:207]
    v_pk_mul_f32 v[124:125], v[124:125], v[212:213]
    v_pk_mul_f32 v[126:127], v[126:127], v[214:215]
    v_cvt_pk_bf16_f32 v28, v116, v117
    v_cvt_pk_bf16_f32 v29, v118, v119
    v_cvt_pk_bf16_f32 v30, v124, v125
    v_cvt_pk_bf16_f32 v31, v126, v127
    buffer_store_dwordx4 v[28:31], v1, s[48:51], s72 offen offset:1024 sc1
    s_add_u32 s72, s72, 4096
    v_pk_mul_f32 v[60:61], v[60:61], v[224:225]
    v_pk_mul_f32 v[62:63], v[62:63], v[226:227]
    v_pk_mul_f32 v[68:69], v[68:69], v[232:233]
    v_pk_mul_f32 v[70:71], v[70:71], v[234:235]
    v_cvt_pk_bf16_f32 v32, v60, v61
    v_cvt_pk_bf16_f32 v33, v62, v63
    v_cvt_pk_bf16_f32 v34, v68, v69
    v_cvt_pk_bf16_f32 v35, v70, v71
    buffer_store_dwordx4 v[32:35], v1, s[48:51], s72 offen offset:0 sc1
    v_pk_mul_f32 v[132:133], v[132:133], v[240:241]
    v_pk_mul_f32 v[134:135], v[134:135], v[242:243]
    v_pk_mul_f32 v[140:141], v[140:141], v[248:249]
    v_pk_mul_f32 v[142:143], v[142:143], v[250:251]
    v_cvt_pk_bf16_f32 v24, v132, v133
    v_cvt_pk_bf16_f32 v25, v134, v135
    v_cvt_pk_bf16_f32 v26, v140, v141
    v_cvt_pk_bf16_f32 v27, v142, v143
    buffer_store_dwordx4 v[24:27], v1, s[48:51], s72 offen offset:1024 sc1
    s_add_u32 s72, s72, 4096
    s_waitcnt lgkmcnt(8)
    v_mfma_f32_16x16x32_bf16 v[80:83], v[18:21], v[136:139], v[80:83]
    ds_read_b128 v[208:211], v4 offset:19456
    v_accvgpr_read_b32 v189, a88
    v_mfma_f32_16x16x32_bf16 v[88:91], v[16:19], v[136:139], v[88:91]
    s_waitcnt lgkmcnt(8)
    v_accvgpr_read_b32 v191, a89
    v_lshlrev_b32 v188, 16, v189
    v_mfma_f32_16x16x32_bf16 v[80:83], v[18:21], v[148:151], v[80:83]
    ds_read_b128 v[220:223], v6 offset:0
    v_and_b32 v189, 0xffff0000, v189
    v_mfma_f32_16x16x32_bf16 v[88:91], v[16:19], v[148:151], v[88:91]
    s_waitcnt lgkmcnt(8)
    v_lshlrev_b32 v190, 16, v191
    v_and_b32 v191, 0xffff0000, v191
    v_mfma_f32_16x16x32_bf16 v[80:83], v[18:21], v[156:159], v[80:83]
    ds_read_b128 v[228:231], v7 offset:17408
    v_accvgpr_read_b32 v197, a92
    v_mfma_f32_16x16x32_bf16 v[88:91], v[16:19], v[156:159], v[88:91]
    s_waitcnt lgkmcnt(8)
    v_accvgpr_read_b32 v199, a93
    v_lshlrev_b32 v196, 16, v197
    v_mfma_f32_16x16x32_bf16 v[152:155], v[18:21], v[164:167], v[152:155]
    ds_read_b128 v[236:239], v4 offset:32768
    v_and_b32 v197, 0xffff0000, v197
    v_mfma_f32_16x16x32_bf16 v[160:163], v[16:19], v[164:167], v[160:163]
    s_waitcnt lgkmcnt(8)
    v_lshlrev_b32 v198, 16, v199
    v_and_b32 v199, 0xffff0000, v199
    v_mfma_f32_16x16x32_bf16 v[152:155], v[18:21], v[172:175], v[152:155]
    ds_read_b128 v[244:247], v6 offset:1024
    v_accvgpr_read_b32 v205, a90
    v_mfma_f32_16x16x32_bf16 v[160:163], v[16:19], v[172:175], v[160:163]
    s_waitcnt lgkmcnt(8)
    v_accvgpr_read_b32 v207, a91
    v_lshlrev_b32 v204, 16, v205
    v_mfma_f32_16x16x32_bf16 v[152:155], v[18:21], v[144:147], v[152:155]
    ds_read_b128 v[216:219], v7 offset:18432
    v_and_b32 v205, 0xffff0000, v205
    v_mfma_f32_16x16x32_bf16 v[160:163], v[16:19], v[144:147], v[160:163]
    s_waitcnt lgkmcnt(8)
    v_lshlrev_b32 v206, 16, v207
    v_and_b32 v207, 0xffff0000, v207
    v_mfma_f32_16x16x32_bf16 v[96:99], v[18:21], v[184:187], v[96:99]
    v_accvgpr_read_b32 v213, a94
    v_accvgpr_read_b32 v215, a95
    v_mfma_f32_16x16x32_bf16 v[104:107], v[16:19], v[184:187], v[104:107]
    s_waitcnt lgkmcnt(7)
    v_lshlrev_b32 v212, 16, v213
    v_and_b32 v213, 0xffff0000, v213
    v_mfma_f32_16x16x32_bf16 v[96:99], v[18:21], v[192:195], v[96:99]
    v_lshlrev_b32 v214, 16, v215
    v_and_b32 v215, 0xffff0000, v215
    v_mfma_f32_16x16x32_bf16 v[104:107], v[16:19], v[192:195], v[104:107]
    s_waitcnt lgkmcnt(6)
    v_accvgpr_read_b32 v225, a96
    v_accvgpr_read_b32 v227, a97
    v_mfma_f32_16x16x32_bf16 v[96:99], v[18:21], v[200:203], v[96:99]
    v_lshlrev_b32 v224, 16, v225
    v_and_b32 v225, 0xffff0000, v225
    v_mfma_f32_16x16x32_bf16 v[104:107], v[16:19], v[200:203], v[104:107]
    s_waitcnt lgkmcnt(5)
    v_lshlrev_b32 v226, 16, v227
    v_and_b32 v227, 0xffff0000, v227
    v_mfma_f32_16x16x32_bf16 v[168:171], v[18:21], v[208:211], v[168:171]
    v_accvgpr_read_b32 v233, a100
    v_accvgpr_read_b32 v235, a101
    v_mfma_f32_16x16x32_bf16 v[176:179], v[16:19], v[208:211], v[176:179]
    s_waitcnt lgkmcnt(4)
    v_lshlrev_b32 v232, 16, v233
    v_and_b32 v233, 0xffff0000, v233
    v_mfma_f32_16x16x32_bf16 v[168:171], v[18:21], v[220:223], v[168:171]
    v_lshlrev_b32 v234, 16, v235
    v_and_b32 v235, 0xffff0000, v235
    v_mfma_f32_16x16x32_bf16 v[176:179], v[16:19], v[220:223], v[176:179]
    s_waitcnt lgkmcnt(3)
    v_accvgpr_read_b32 v241, a98
    v_accvgpr_read_b32 v243, a99
    v_mfma_f32_16x16x32_bf16 v[168:171], v[18:21], v[228:231], v[168:171]
    v_lshlrev_b32 v240, 16, v241
    v_and_b32 v241, 0xffff0000, v241
    v_mfma_f32_16x16x32_bf16 v[176:179], v[16:19], v[228:231], v[176:179]
    s_waitcnt lgkmcnt(2)
    v_lshlrev_b32 v242, 16, v243
    v_and_b32 v243, 0xffff0000, v243
    v_mfma_f32_16x16x32_bf16 v[108:111], v[18:21], v[236:239], v[108:111]
    v_accvgpr_read_b32 v249, a102
    v_accvgpr_read_b32 v251, a103
    v_mfma_f32_16x16x32_bf16 v[180:183], v[16:19], v[236:239], v[180:183]
    s_waitcnt lgkmcnt(1)
    v_lshlrev_b32 v248, 16, v249
    v_and_b32 v249, 0xffff0000, v249
    v_mfma_f32_16x16x32_bf16 v[108:111], v[18:21], v[244:247], v[108:111]
    v_lshlrev_b32 v250, 16, v251
    v_and_b32 v251, 0xffff0000, v251
    v_mfma_f32_16x16x32_bf16 v[180:183], v[16:19], v[244:247], v[180:183]
    s_waitcnt lgkmcnt(0)
    v_accvgpr_read_b32 v253, a104
    v_accvgpr_read_b32 v255, a105
    v_mfma_f32_16x16x32_bf16 v[108:111], v[18:21], v[216:219], v[108:111]
    v_lshlrev_b32 v252, 16, v253
    v_and_b32 v253, 0xffff0000, v253
    v_mfma_f32_16x16x32_bf16 v[180:183], v[16:19], v[216:219], v[180:183]
    v_lshlrev_b32 v254, 16, v255
    v_and_b32 v255, 0xffff0000, v255
    v_accvgpr_read_b32 v37, a106
    v_accvgpr_read_b32 v39, a107
    v_lshlrev_b32 v36, 16, v37
    v_and_b32 v37, 0xffff0000, v37
    v_lshlrev_b32 v38, 16, v39
    v_and_b32 v39, 0xffff0000, v39
    s_waitcnt vmcnt(53)
    s_barrier
    v_pk_mul_f32 v[80:81], v[80:81], v[188:189]
    v_pk_mul_f32 v[82:83], v[82:83], v[190:191]
    v_pk_mul_f32 v[88:89], v[88:89], v[196:197]
    v_pk_mul_f32 v[90:91], v[90:91], v[198:199]
    v_cvt_pk_bf16_f32 v28, v80, v81
    v_cvt_pk_bf16_f32 v29, v82, v83
    v_cvt_pk_bf16_f32 v30, v88, v89
    v_cvt_pk_bf16_f32 v31, v90, v91
    buffer_store_dwordx4 v[28:31], v1, s[48:51], s72 offen offset:0 sc1
    v_pk_mul_f32 v[152:153], v[152:153], v[204:205]
    v_pk_mul_f32 v[154:155], v[154:155], v[206:207]
    v_pk_mul_f32 v[160:161], v[160:161], v[212:213]
    v_pk_mul_f32 v[162:163], v[162:163], v[214:215]
    v_cvt_pk_bf16_f32 v32, v152, v153
    v_cvt_pk_bf16_f32 v33, v154, v155
    v_cvt_pk_bf16_f32 v34, v160, v161
    v_cvt_pk_bf16_f32 v35, v162, v163
    buffer_store_dwordx4 v[32:35], v1, s[48:51], s72 offen offset:1024 sc1
    s_add_u32 s72, s72, 4096
    v_pk_mul_f32 v[96:97], v[96:97], v[224:225]
    v_pk_mul_f32 v[98:99], v[98:99], v[226:227]
    v_pk_mul_f32 v[104:105], v[104:105], v[232:233]
    v_pk_mul_f32 v[106:107], v[106:107], v[234:235]
    v_cvt_pk_bf16_f32 v24, v96, v97
    v_cvt_pk_bf16_f32 v25, v98, v99
    v_cvt_pk_bf16_f32 v26, v104, v105
    v_cvt_pk_bf16_f32 v27, v106, v107
    buffer_store_dwordx4 v[24:27], v1, s[48:51], s72 offen offset:0 sc1
    v_pk_mul_f32 v[168:169], v[168:169], v[240:241]
    v_pk_mul_f32 v[170:171], v[170:171], v[242:243]
    v_pk_mul_f32 v[176:177], v[176:177], v[248:249]
    v_pk_mul_f32 v[178:179], v[178:179], v[250:251]
    v_cvt_pk_bf16_f32 v28, v168, v169
    v_cvt_pk_bf16_f32 v29, v170, v171
    v_cvt_pk_bf16_f32 v30, v176, v177
    v_cvt_pk_bf16_f32 v31, v178, v179
    buffer_store_dwordx4 v[28:31], v1, s[48:51], s72 offen offset:1024 sc1
    s_add_u32 s72, s72, 4096
    v_pk_mul_f32 v[108:109], v[108:109], v[252:253]
    v_pk_mul_f32 v[110:111], v[110:111], v[254:255]
    v_pk_mul_f32 v[180:181], v[180:181], v[36:37]
    v_pk_mul_f32 v[182:183], v[182:183], v[38:39]
    v_cvt_pk_bf16_f32 v32, v108, v109
    v_cvt_pk_bf16_f32 v33, v110, v111
    v_cvt_pk_bf16_f32 v34, v180, v181
    v_cvt_pk_bf16_f32 v35, v182, v183
    buffer_store_dwordx4 v[32:35], v1, s[48:51], s64 offen sc1
    s_mul_i32 s66, s3, 11264
    s_lshl_b32 s61, s3, 11
    s_add_u32 s61, s61, 155648
    s_mul_i32 s75, s3, 3072
    s_add_u32 s75, s75, 133120
    s_xor_b32 s57, s3, 0
    s_lshl_b32 s57, s57, 10
    v_add_u32 v4, s57, v1
    s_xor_b32 s57, s3, 1
    s_lshl_b32 s57, s57, 10
    v_add_u32 v5, s57, v1
    s_xor_b32 s57, s3, 2
    s_lshl_b32 s57, s57, 10
    v_add_u32 v6, s57, v1
    s_xor_b32 s57, s3, 3
    s_lshl_b32 s57, s57, 10
    v_add_u32 v7, s57, v1
    v_and_b32 v8, 15, v0
    v_mov_b32 v9, v10
    v_and_b32 v14, 7, v0
    v_lshlrev_b32 v14, 2, v14
    s_cmp_ge_u32 s92, 144
    s_cbranch_scc1 KM_noconv
    v_mov_b32 v72, 0
    v_mov_b32 v73, 0
    v_mov_b32 v74, 0
    v_mov_b32 v75, 0
    v_bfe_u32 v10, v0, 1, 2
    v_mul_u32_u24 v10, 4160, v10
    v_and_b32 v11, 1, v0
    v_lshl_add_u32 v10, v11, 4, v10
    v_add_u32 v10, s91, v10
    v_add_u32 v11, 49088, v1
    s_mov_b64 exec, 0xff
    ds_write_b128 v10, v[72:75]
    s_mov_b64 exec, 0xf
    ds_write_b128 v11, v[72:75]
    s_mov_b64 exec, -1
    v_add_u32 v16, s91, v1
    v_add_u32 v10, 1, v8
    v_and_b32 v11, 3, v10
    v_mul_u32_u24 v11, 4158, v11
    v_lshl_add_u32 v11, v10, 1, v11
    v_lshl_add_u32 v11, v9, 4, v11
    v_add_u32 v17, s91, v11
    v_lshlrev_b32 v18, 1, v8
    v_sub_u32 v18, v18, v9
    v_add_u32 v18, 1, v18
    s_mov_b32 s63, 49152
    s_waitcnt vmcnt(9)
    v_mov_b32 v50, v56 wave_rol:1
    v_mov_b32 v51, v57 wave_rol:1
    v_mov_b32 v66, v76 wave_rol:1
    v_mov_b32 v67, v77 wave_rol:1
    v_mov_b32 v86, v92 wave_rol:1
    v_mov_b32 v87, v93 wave_rol:1
    v_mov_b32 v102, v92 wave_shl:1
    v_mov_b32 v103, v93 wave_shl:1
    v_mov_b32 v50, v40 wave_shl:1
    v_mov_b32 v51, v41 wave_shl:1
    v_mov_b32 v66, v56 wave_shl:1
    v_mov_b32 v67, v57 wave_shl:1
    v_mov_b32 v86, v76 wave_shl:1
    v_mov_b32 v87, v77 wave_shl:1
    ds_write_b128 v16, v[40:43] offset:32
    v_alignbit_b32 v112, v41, v40, 16
    v_alignbit_b32 v113, v42, v41, 16
    v_alignbit_b32 v114, v43, v42, 16
    v_alignbit_b32 v115, v50, v43, 16
    ds_write_b128 v16, v[112:115] offset:4192
    v_mov_b32 v120, v41
    v_mov_b32 v121, v42
    v_mov_b32 v122, v43
    v_mov_b32 v123, v50
    ds_write_b128 v16, v[120:123] offset:8352
    v_alignbit_b32 v128, v42, v41, 16
    v_alignbit_b32 v129, v43, v42, 16
    v_alignbit_b32 v130, v50, v43, 16
    v_alignbit_b32 v131, v51, v50, 16
    ds_write_b128 v16, v[128:131] offset:12512
    v_lshlrev_b32 v12, 16, v40
    v_mov_b32 v13, v112
    s_mov_b64 exec, 1
    ds_write_b32 v16, v12 offset:4188
    ds_write_b32 v16, v40 offset:8348
    ds_write_b64 v16, v[12:13] offset:12504
    s_mov_b64 exec, -1
    buffer_load_dwordx4 a[208:211], v2, s[48:51], s65 offen offset:3072 sc1
    s_add_u32 s65, s81, 46080
    s_sub_u32 s65, s65, s77
    buffer_load_dwordx4 a[216:219], v1, s[48:51], s65 offen offset:0 sc1
    ds_write_b128 v16, v[56:59] offset:1056
    v_alignbit_b32 v136, v57, v56, 16
    v_alignbit_b32 v137, v58, v57, 16
    v_alignbit_b32 v138, v59, v58, 16
    v_alignbit_b32 v139, v66, v59, 16
    ds_write_b128 v16, v[136:139] offset:5216
    v_mov_b32 v148, v57
    v_mov_b32 v149, v58
    v_mov_b32 v150, v59
    v_mov_b32 v151, v66
    ds_write_b128 v16, v[148:151] offset:9376
    v_alignbit_b32 v156, v58, v57, 16
    v_alignbit_b32 v157, v59, v58, 16
    v_alignbit_b32 v158, v66, v59, 16
    v_alignbit_b32 v159, v67, v66, 16
    ds_write_b128 v16, v[156:159] offset:13536
    buffer_load_dwordx4 a[220:223], v1, s[48:51], s65 offen offset:1024 sc1
    buffer_load_dwordx4 a[224:227], v1, s[48:51], s65 offen offset:2048 sc1
    ds_write_b128 v16, v[76:79] offset:2080
    v_alignbit_b32 v164, v77, v76, 16
    v_alignbit_b32 v165, v78, v77, 16
    v_alignbit_b32 v166, v79, v78, 16
    v_alignbit_b32 v167, v86, v79, 16
    ds_write_b128 v16, v[164:167] offset:6240
    v_mov_b32 v172, v77
    v_mov_b32 v173, v78
    v_mov_b32 v174, v79
    v_mov_b32 v175, v86
    ds_write_b128 v16, v[172:175] offset:10400
    v_alignbit_b32 v144, v78, v77, 16
    v_alignbit_b32 v145, v79, v78, 16
    v_alignbit_b32 v146, v86, v79, 16
    v_alignbit_b32 v147, v87, v86, 16
    ds_write_b128 v16, v[144:147] offset:14560
    buffer_load_dwordx4 a[228:231], v1, s[48:51], s65 offen offset:3072 sc1
    buffer_load_dwordx4 a[248:251], v3, s[48:51], s65 offen offset:0 sc1
    ds_write_b128 v16, v[92:95] offset:3104
    v_alignbit_b32 v184, v93, v92, 16
    v_alignbit_b32 v185, v94, v93, 16
    v_alignbit_b32 v186, v95, v94, 16
    v_alignbit_b32 v187, v102, v95, 16
    ds_write_b128 v16, v[184:187] offset:7264
    v_mov_b32 v192, v93
    v_mov_b32 v193, v94
    v_mov_b32 v194, v95
    v_mov_b32 v195, v102
    ds_write_b128 v16, v[192:195] offset:11424
    v_alignbit_b32 v200, v94, v93, 16
    v_alignbit_b32 v201, v95, v94, 16
    v_alignbit_b32 v202, v102, v95, 16
    v_alignbit_b32 v203, v103, v102, 16
    ds_write_b128 v16, v[200:203] offset:15584
    buffer_load_dwordx4 a[232:235], v2, s[48:51], s65 offen offset:0 sc1
    buffer_load_dwordx4 a[236:239], v2, s[48:51], s65 offen offset:1024 sc1
    v_add_u32 v10, 0, v18
    v_bfe_u32 v11, v10, 2, 2
    v_xor_b32 v11, s3, v11
    v_lshl_add_u32 v11, v11, 4, s63
    v_max_i32 v19, -1, v10
    v_lshl_add_u32 v20, v10, 6, v11
    v_lshl_add_u32 v21, v19, 6, v11
    v_add_u32 v10, 4294967292, v18
    v_bfe_u32 v11, v10, 2, 2
    v_xor_b32 v11, s3, v11
    v_lshl_add_u32 v11, v11, 4, s63
    v_max_i32 v19, -1, v10
    v_lshl_add_u32 v22, v10, 6, v11
    v_lshl_add_u32 v23, v19, 6, v11
    v_accvgpr_read_b32 v30, a253
    v_lshl_add_u32 v10, v9, 3, v8
    v_sub_u32 v10, 15, v10
    v_and_b32 v11, 1, v10
    v_lshlrev_b32 v11, 4, v11
    v_lshlrev_b32 v30, v11, v30
    v_ashrrev_i32 v10, 1, v10
    v_cmp_eq_u32 s[20:21], 0, v10
    v_cmp_eq_u32 s[22:23], 1, v10
    v_cmp_eq_u32 s[24:25], 2, v10
    v_cmp_eq_u32 s[26:27], 3, v10
    v_cndmask_b32 v24, 0, v30, s[20:21]
    v_cndmask_b32 v25, 0, v30, s[22:23]
    v_cndmask_b32 v26, 0, v30, s[24:25]
    v_cndmask_b32 v27, 0, v30, s[26:27]
    v_lshrrev_b32 v28, 2, v8
    v_lshlrev_b32 v28, 7, v28
    v_lshl_add_u32 v28, v9, 5, v28
    v_and_b32 v12, 3, v8
    v_lshl_add_u32 v28, v12, 3, v28
    s_add_u32 s59, s59, 0x500000
    s_and_b32 s57, s97, 7
    s_lshl_b32 s57, s57, 2
    s_lshr_b32 s97, s97, 3
    s_lshl_b32 s97, s97, 7
    s_add_u32 s97, s97, s57
    s_add_u32 s97, s97, 0x11c0000
    s_waitcnt lgkmcnt(0)
    ds_read_b128 v[252:255], v20 offset:14336
    ds_read_b128 v[248:251], v20 offset:12288
    ds_read_b128 v[244:247], v20 offset:10240
    ds_read_b128 v[240:243], v20 offset:8192
    ds_read_b128 v[236:239], v20 offset:6144
    ds_read_b128 v[232:235], v20 offset:4096
    ds_read_b128 v[228:231], v20 offset:2048
    ds_read_b128 v[224:227], v21
    ds_read_b64 v[192:193], v17 offset:0
    ds_read_b64 v[194:195], v17 offset:8
    ds_read_b64 v[196:197], v17 offset:512
    ds_read_b64 v[198:199], v17 offset:520
    ds_read_b64 v[200:201], v17 offset:1024
    ds_read_b64 v[202:203], v17 offset:1032
    s_waitcnt lgkmcnt(13)
    v_mfma_f32_16x16x32_bf16 v[188:191], v[24:27], v[252:255], 0
    ds_read_b64 v[204:205], v17 offset:1536
    s_waitcnt lgkmcnt(13)
    v_mfma_f32_16x16x32_bf16 v[184:187], v[24:27], v[248:251], 0
    ds_read_b64 v[206:207], v17 offset:1544
    s_waitcnt lgkmcnt(13)
    v_mfma_f32_16x16x32_bf16 v[180:183], v[24:27], v[244:247], 0
    ds_read_b64 v[208:209], v17 offset:2048
    s_waitcnt lgkmcnt(13)
    v_mfma_f32_16x16x32_bf16 v[176:179], v[24:27], v[240:243], 0
    ds_read_b64 v[210:211], v17 offset:2056
    s_waitcnt lgkmcnt(13)
    v_mfma_f32_16x16x32_bf16 v[172:175], v[24:27], v[236:239], 0
    ds_read_b64 v[212:213], v17 offset:2560
    s_waitcnt lgkmcnt(13)
    v_mfma_f32_16x16x32_bf16 v[168:171], v[24:27], v[232:235], 0
    ds_read_b64 v[214:215], v17 offset:2568
    s_waitcnt lgkmcnt(13)
    v_mfma_f32_16x16x32_bf16 v[164:167], v[24:27], v[228:231], 0
    ds_read_b64 v[216:217], v17 offset:3072
    s_waitcnt lgkmcnt(13)
    v_mfma_f32_16x16x32_bf16 v[160:163], v[24:27], v[224:227], 0
    ds_read_b64 v[218:219], v17 offset:3080
    ds_read_b64 v[220:221], v17 offset:3584
    ds_read_b64 v[222:223], v17 offset:3592
    s_waitcnt lgkmcnt(14)
    v_mfma_f32_16x16x32_bf16 v[188:191], v[192:195], v[252:255], v[188:191]
    ds_read_b128 v[156:159], v22 offset:4096
    v_mfma_f32_16x16x32_bf16 v[184:187], v[192:195], v[248:251], v[184:187]
    ds_read_b128 v[152:155], v22 offset:2048
    v_mfma_f32_16x16x32_bf16 v[180:183], v[192:195], v[244:247], v[180:183]
    ds_read_b128 v[148:151], v23
    v_mfma_f32_16x16x32_bf16 v[176:179], v[192:195], v[240:243], v[176:179]
    buffer_load_dwordx4 a[240:243], v2, s[48:51], s65 offen offset:2048 sc1
    v_mfma_f32_16x16x32_bf16 v[172:175], v[192:195], v[236:239], v[172:175]
    v_mfma_f32_16x16x32_bf16 v[168:171], v[192:195], v[232:235], v[168:171]
    v_mfma_f32_16x16x32_bf16 v[164:167], v[192:195], v[228:231], v[164:167]
    buffer_load_dwordx4 a[244:247], v2, s[48:51], s65 offen offset:3072 sc1
    v_mfma_f32_16x16x32_bf16 v[160:163], v[192:195], v[224:227], v[160:163]
    ds_read_b64 v[192:193], v17 offset:64
    s_waitcnt lgkmcnt(15)
    v_mfma_f32_16x16x32_bf16 v[188:191], v[196:199], v[248:251], v[188:191]
    ds_read_b64 v[194:195], v17 offset:72
    s_add_u32 s65, s81, 55296
    v_mfma_f32_16x16x32_bf16 v[184:187], v[196:199], v[244:247], v[184:187]
    ds_read_b128 v[252:255], v22 offset:14336
    s_add_u32 s65, s65, s77
    v_mfma_f32_16x16x32_bf16 v[180:183], v[196:199], v[240:243], v[180:183]
    buffer_load_dwordx4 a[72:75], v1, s[48:51], s65 offen offset:0 sc1
    v_add_u32 v10, 4294967288, v18
    v_mfma_f32_16x16x32_bf16 v[176:179], v[196:199], v[236:239], v[176:179]
    v_bfe_u32 v11, v10, 2, 2
    v_xor_b32 v11, s3, v11
    v_mfma_f32_16x16x32_bf16 v[172:175], v[196:199], v[232:235], v[172:175]
    v_lshl_add_u32 v11, v11, 4, s63
    v_max_i32 v19, -1, v10
    v_mfma_f32_16x16x32_bf16 v[168:171], v[196:199], v[228:231], v[168:171]
    v_lshl_add_u32 v20, v10, 6, v11
    v_lshl_add_u32 v21, v19, 6, v11
    v_mfma_f32_16x16x32_bf16 v[164:167], v[196:199], v[224:227], v[164:167]
    ds_read_b64 v[196:197], v17 offset:576
    s_waitcnt lgkmcnt(15)
    v_mfma_f32_16x16x32_bf16 v[188:191], v[200:203], v[244:247], v[188:191]
    ds_read_b64 v[198:199], v17 offset:584
    v_mfma_f32_16x16x32_bf16 v[184:187], v[200:203], v[240:243], v[184:187]
    ds_read_b128 v[248:251], v22 offset:12288
    v_mfma_f32_16x16x32_bf16 v[180:183], v[200:203], v[236:239], v[180:183]
    buffer_load_dwordx4 a[76:79], v1, s[48:51], s65 offen offset:1024 sc1
    v_mfma_f32_16x16x32_bf16 v[176:179], v[200:203], v[232:235], v[176:179]
    buffer_load_dwordx4 a[80:83], v1, s[48:51], s65 offen offset:2048 sc1
    v_mfma_f32_16x16x32_bf16 v[172:175], v[200:203], v[228:231], v[172:175]
    s_waitcnt vmcnt(13)
    v_mov_b32 v12, s95
    v_mul_u32_u24 v13, 16640, v0
    s_mov_b64 exec, 255
    buffer_store_dword v12, v13, s[48:51], s79 offen sc1
    s_mov_b64 exec, -1
    v_mfma_f32_16x16x32_bf16 v[168:171], v[200:203], v[224:227], v[168:171]
    ds_read_b64 v[200:201], v17 offset:1088
    s_waitcnt lgkmcnt(15)
    v_mfma_f32_16x16x32_bf16 v[188:191], v[204:207], v[240:243], v[188:191]
    ds_read_b64 v[202:203], v17 offset:1096
    v_mfma_f32_16x16x32_bf16 v[184:187], v[204:207], v[236:239], v[184:187]
    ds_read_b128 v[244:247], v22 offset:10240
    v_mfma_f32_16x16x32_bf16 v[180:183], v[204:207], v[232:235], v[180:183]
    buffer_load_dwordx4 a[84:87], v1, s[48:51], s65 offen offset:3072 sc1
    v_mfma_f32_16x16x32_bf16 v[176:179], v[204:207], v[228:231], v[176:179]
    v_mfma_f32_16x16x32_bf16 v[172:175], v[204:207], v[224:227], v[172:175]
    ds_read_b64 v[204:205], v17 offset:1600
    s_waitcnt lgkmcnt(15)
    v_mfma_f32_16x16x32_bf16 v[188:191], v[208:211], v[236:239], v[188:191]
    ds_read_b64 v[206:207], v17 offset:1608
    v_mfma_f32_16x16x32_bf16 v[184:187], v[208:211], v[232:235], v[184:187]
    ds_read_b128 v[240:243], v22 offset:8192
    v_mfma_f32_16x16x32_bf16 v[180:183], v[208:211], v[228:231], v[180:183]
    buffer_load_dwordx4 a[104:107], v3, s[48:51], s65 offen offset:0 sc1
    v_mfma_f32_16x16x32_bf16 v[176:179], v[208:211], v[224:227], v[176:179]
    ds_read_b64 v[208:209], v17 offset:2112
    s_waitcnt lgkmcnt(15)
    v_mfma_f32_16x16x32_bf16 v[188:191], v[212:215], v[232:235], v[188:191]
    ds_read_b64 v[210:211], v17 offset:2120
    v_mfma_f32_16x16x32_bf16 v[184:187], v[212:215], v[228:231], v[184:187]
    ds_read_b128 v[236:239], v22 offset:6144
    v_mfma_f32_16x16x32_bf16 v[180:183], v[212:215], v[224:227], v[180:183]
    ds_read_b64 v[212:213], v17 offset:2624
    s_waitcnt lgkmcnt(15)
    v_mfma_f32_16x16x32_bf16 v[188:191], v[216:219], v[228:231], v[188:191]
    ds_read_b64 v[214:215], v17 offset:2632
    v_mfma_f32_16x16x32_bf16 v[184:187], v[216:219], v[224:227], v[184:187]
    ds_read_b64 v[216:217], v17 offset:3136
    s_waitcnt lgkmcnt(15)
    v_mfma_f32_16x16x32_bf16 v[188:191], v[220:223], v[224:227], v[188:191]
    ds_read_b64 v[218:219], v17 offset:3144
    s_waitcnt lgkmcnt(15)
    v_mfma_f32_16x16x32_bf16 v[188:191], v[192:195], v[252:255], v[188:191]
    ds_read_b64 v[220:221], v17 offset:3648
    s_waitcnt lgkmcnt(14)
    v_mfma_f32_16x16x32_bf16 v[184:187], v[192:195], v[248:251], v[184:187]
    ds_read_b64 v[222:223], v17 offset:3656
    s_waitcnt lgkmcnt(12)
    v_mfma_f32_16x16x32_bf16 v[180:183], v[192:195], v[244:247], v[180:183]
    ds_read_b128 v[232:235], v20 offset:4096
    s_waitcnt lgkmcnt(10)
    v_mfma_f32_16x16x32_bf16 v[176:179], v[192:195], v[240:243], v[176:179]
    ds_read_b128 v[228:231], v20 offset:2048
    s_waitcnt lgkmcnt(8)
    v_mfma_f32_16x16x32_bf16 v[172:175], v[192:195], v[236:239], v[172:175]
    ds_read_b128 v[224:227], v21
    v_mfma_f32_16x16x32_bf16 v[168:171], v[192:195], v[156:159], v[168:171]
    buffer_load_dwordx4 a[88:91], v2, s[48:51], s65 offen offset:0 sc1
    v_mfma_f32_16x16x32_bf16 v[164:167], v[192:195], v[152:155], v[164:167]
    buffer_load_dwordx4 a[92:95], v2, s[48:51], s65 offen offset:1024 sc1
    v_mfma_f32_16x16x32_bf16 v[160:163], v[192:195], v[148:151], v[160:163]
    ds_read_b64 v[192:193], v17 offset:128
    v_mfma_f32_16x16x32_bf16 v[188:191], v[196:199], v[248:251], v[188:191]
    ds_read_b64 v[194:195], v17 offset:136
    v_add_u32 v10, 4294967284, v18
    v_mfma_f32_16x16x32_bf16 v[184:187], v[196:199], v[244:247], v[184:187]
    ds_read_b128 v[252:255], v20 offset:14336
    v_bfe_u32 v11, v10, 2, 2
    v_mfma_f32_16x16x32_bf16 v[180:183], v[196:199], v[240:243], v[180:183]
    buffer_load_dwordx4 a[96:99], v2, s[48:51], s65 offen offset:2048 sc1
    v_xor_b32 v11, s3, v11
    v_mfma_f32_16x16x32_bf16 v[176:179], v[196:199], v[236:239], v[176:179]
    v_lshl_add_u32 v11, v11, 4, s63
    v_max_i32 v19, -1, v10
    v_mfma_f32_16x16x32_bf16 v[172:175], v[196:199], v[156:159], v[172:175]
    buffer_load_dwordx4 a[100:103], v2, s[48:51], s65 offen offset:3072 sc1
    v_lshl_add_u32 v22, v10, 6, v11
    v_mfma_f32_16x16x32_bf16 v[168:171], v[196:199], v[152:155], v[168:171]
    v_lshl_add_u32 v23, v19, 6, v11
    v_mfma_f32_16x16x32_bf16 v[164:167], v[196:199], v[148:151], v[164:167]
    ds_read_b64 v[196:197], v17 offset:640
    s_add_u32 m0, s66, 0
    v_mfma_f32_16x16x32_bf16 v[188:191], v[200:203], v[244:247], v[188:191]
    ds_read_b64 v[198:199], v17 offset:648
    s_add_u32 s65, s81, 64512
    v_mfma_f32_16x16x32_bf16 v[184:187], v[200:203], v[240:243], v[184:187]
    ds_read_b128 v[248:251], v20 offset:12288
    s_sub_u32 s65, s65, s77
    v_mfma_f32_16x16x32_bf16 v[180:183], v[200:203], v[236:239], v[180:183]
    buffer_load_dwordx4 v1, s[48:51], s65 offen offset:0 sc1 lds
    v_mfma_f32_16x16x32_bf16 v[176:179], v[200:203], v[156:159], v[176:179]
    v_mfma_f32_16x16x32_bf16 v[172:175], v[200:203], v[152:155], v[172:175]
    v_mfma_f32_16x16x32_bf16 v[168:171], v[200:203], v[148:151], v[168:171]
    ds_read_b64 v[200:201], v17 offset:1152
    v_mfma_f32_16x16x32_bf16 v[188:191], v[204:207], v[240:243], v[188:191]
    ds_read_b64 v[202:203], v17 offset:1160
    v_mfma_f32_16x16x32_bf16 v[184:187], v[204:207], v[236:239], v[184:187]
    ds_read_b128 v[244:247], v20 offset:10240
    v_mfma_f32_16x16x32_bf16 v[180:183], v[204:207], v[156:159], v[180:183]
    buffer_load_dwordx4 v1, s[48:51], s65 offen offset:1024 sc1 lds
    v_mfma_f32_16x16x32_bf16 v[176:179], v[204:207], v[152:155], v[176:179]
    buffer_load_dwordx4 v1, s[48:51], s65 offen offset:2048 sc1 lds
    v_mfma_f32_16x16x32_bf16 v[172:175], v[204:207], v[148:151], v[172:175]
    ds_read_b64 v[204:205], v17 offset:1664
    v_mfma_f32_16x16x32_bf16 v[188:191], v[208:211], v[236:239], v[188:191]
    ds_read_b64 v[206:207], v17 offset:1672
    v_mfma_f32_16x16x32_bf16 v[184:187], v[208:211], v[156:159], v[184:187]
    ds_read_b128 v[240:243], v20 offset:8192
    v_mfma_f32_16x16x32_bf16 v[180:183], v[208:211], v[152:155], v[180:183]
    buffer_load_dwordx4 v1, s[48:51], s65 offen offset:3072 sc1 lds
    v_mfma_f32_16x16x32_bf16 v[176:179], v[208:211], v[148:151], v[176:179]
    ds_read_b64 v[208:209], v17 offset:2176
    s_waitcnt lgkmcnt(15)
    v_mfma_f32_16x16x32_bf16 v[188:191], v[212:215], v[156:159], v[188:191]
    ds_read_b64 v[210:211], v17 offset:2184
    v_mfma_f32_16x16x32_bf16 v[184:187], v[212:215], v[152:155], v[184:187]
    ds_read_b128 v[236:239], v20 offset:6144
    s_add_u32 m0, s66, 4096
    v_mfma_f32_16x16x32_bf16 v[180:183], v[212:215], v[148:151], v[180:183]
    ds_read_b64 v[212:213], v17 offset:2688
    s_waitcnt lgkmcnt(15)
    v_mfma_f32_16x16x32_bf16 v[188:191], v[216:219], v[152:155], v[188:191]
    ds_read_b64 v[214:215], v17 offset:2696
    s_add_u32 s65, s81, 68608
    v_mfma_f32_16x16x32_bf16 v[184:187], v[216:219], v[148:151], v[184:187]
    ds_read_b64 v[216:217], v17 offset:3200
    s_waitcnt lgkmcnt(15)
    v_mfma_f32_16x16x32_bf16 v[188:191], v[220:223], v[148:151], v[188:191]
    ds_read_b64 v[218:219], v17 offset:3208
    s_waitcnt lgkmcnt(15)
    v_mfma_f32_16x16x32_bf16 v[188:191], v[192:195], v[252:255], v[188:191]
    ds_read_b64 v[220:221], v17 offset:3712
    s_waitcnt lgkmcnt(14)
    v_mfma_f32_16x16x32_bf16 v[184:187], v[192:195], v[248:251], v[184:187]
    ds_read_b64 v[222:223], v17 offset:3720
    s_waitcnt lgkmcnt(12)
    v_mfma_f32_16x16x32_bf16 v[180:183], v[192:195], v[244:247], v[180:183]
    ds_read_b128 v[156:159], v22 offset:4096
    s_waitcnt lgkmcnt(10)
    v_mfma_f32_16x16x32_bf16 v[176:179], v[192:195], v[240:243], v[176:179]
    ds_read_b128 v[152:155], v22 offset:2048
    s_waitcnt lgkmcnt(8)
    v_mfma_f32_16x16x32_bf16 v[172:175], v[192:195], v[236:239], v[172:175]
    ds_read_b128 v[148:151], v23
    s_sub_u32 s65, s65, s77
    v_mfma_f32_16x16x32_bf16 v[168:171], v[192:195], v[232:235], v[168:171]
    buffer_load_dwordx4 v1, s[48:51], s65 offen offset:0 sc1 lds
    v_mfma_f32_16x16x32_bf16 v[164:167], v[192:195], v[228:231], v[164:167]
    buffer_load_dwordx4 v1, s[48:51], s65 offen offset:1024 sc1 lds
    v_mfma_f32_16x16x32_bf16 v[160:163], v[192:195], v[224:227], v[160:163]
    ds_read_b64 v[192:193], v17 offset:192
    v_mfma_f32_16x16x32_bf16 v[188:191], v[196:199], v[248:251], v[188:191]
    ds_read_b64 v[194:195], v17 offset:200
    v_add_u32 v10, 4294967280, v18
    v_mfma_f32_16x16x32_bf16 v[184:187], v[196:199], v[244:247], v[184:187]
    ds_read_b128 v[252:255], v22 offset:14336
    v_bfe_u32 v11, v10, 2, 2
    v_mfma_f32_16x16x32_bf16 v[180:183], v[196:199], v[240:243], v[180:183]
    buffer_load_dwordx4 v1, s[48:51], s65 offen offset:2048 sc1 lds
    v_xor_b32 v11, s3, v11
    v_mfma_f32_16x16x32_bf16 v[176:179], v[196:199], v[236:239], v[176:179]
    v_lshl_add_u32 v11, v11, 4, s63
    v_max_i32 v19, -1, v10
    v_mfma_f32_16x16x32_bf16 v[172:175], v[196:199], v[232:235], v[172:175]
    buffer_load_dwordx4 v1, s[48:51], s65 offen offset:3072 sc1 lds
    v_lshl_add_u32 v20, v10, 6, v11
    v_mfma_f32_16x16x32_bf16 v[168:171], v[196:199], v[228:231], v[168:171]
    v_lshl_add_u32 v21, v19, 6, v11
    v_mfma_f32_16x16x32_bf16 v[164:167], v[196:199], v[224:227], v[164:167]
    ds_read_b64 v[196:197], v17 offset:704
    s_add_u32 m0, s66, 8192
    v_mfma_f32_16x16x32_bf16 v[188:191], v[200:203], v[244:247], v[188:191]
    ds_read_b64 v[198:199], v17 offset:712
    s_add_u32 s65, s81, 72704
    v_mfma_f32_16x16x32_bf16 v[184:187], v[200:203], v[240:243], v[184:187]
    ds_read_b128 v[248:251], v22 offset:12288
    s_sub_u32 s65, s65, s77
    v_mfma_f32_16x16x32_bf16 v[180:183], v[200:203], v[236:239], v[180:183]
    buffer_load_dwordx4 v1, s[48:51], s65 offen offset:0 sc1 lds
    v_mfma_f32_16x16x32_bf16 v[176:179], v[200:203], v[232:235], v[176:179]
    s_add_u32 m0, s66, 8192
    s_add_u32 s65, s81, 72704
    v_mfma_f32_16x16x32_bf16 v[172:175], v[200:203], v[228:231], v[172:175]
    v_mfma_f32_16x16x32_bf16 v[168:171], v[200:203], v[224:227], v[168:171]
    ds_read_b64 v[200:201], v17 offset:1216
    v_mfma_f32_16x16x32_bf16 v[188:191], v[204:207], v[240:243], v[188:191]
    ds_read_b64 v[202:203], v17 offset:1224
    v_mfma_f32_16x16x32_bf16 v[184:187], v[204:207], v[236:239], v[184:187]
    ds_read_b128 v[244:247], v22 offset:10240
    v_mfma_f32_16x16x32_bf16 v[180:183], v[204:207], v[232:235], v[180:183]
    buffer_load_dwordx4 v1, s[48:51], s65 offen offset:1024 sc1 lds
    v_mfma_f32_16x16x32_bf16 v[176:179], v[204:207], v[228:231], v[176:179]
    buffer_load_dwordx4 v1, s[48:51], s65 offen offset:2048 sc1 lds
    v_mfma_f32_16x16x32_bf16 v[172:175], v[204:207], v[224:227], v[172:175]
    ds_read_b64 v[204:205], v17 offset:1728
    v_mfma_f32_16x16x32_bf16 v[188:191], v[208:211], v[236:239], v[188:191]
    ds_read_b64 v[206:207], v17 offset:1736
    v_mfma_f32_16x16x32_bf16 v[184:187], v[208:211], v[232:235], v[184:187]
    ds_read_b128 v[240:243], v22 offset:8192
    s_add_u32 m0, s61, 0
    v_mfma_f32_16x16x32_bf16 v[180:183], v[208:211], v[228:231], v[180:183]
    s_add_u32 s65, s81, 75776
    v_mfma_f32_16x16x32_bf16 v[176:179], v[208:211], v[224:227], v[176:179]
    ds_read_b64 v[208:209], v17 offset:2240
    s_waitcnt lgkmcnt(15)
    v_mfma_f32_16x16x32_bf16 v[188:191], v[212:215], v[232:235], v[188:191]
    ds_read_b64 v[210:211], v17 offset:2248
    v_mfma_f32_16x16x32_bf16 v[184:187], v[212:215], v[228:231], v[184:187]
    ds_read_b128 v[236:239], v22 offset:6144
    v_mfma_f32_16x16x32_bf16 v[180:183], v[212:215], v[224:227], v[180:183]
    ds_read_b64 v[212:213], v17 offset:2752
    s_waitcnt lgkmcnt(15)
    v_mfma_f32_16x16x32_bf16 v[188:191], v[216:219], v[228:231], v[188:191]
    ds_read_b64 v[214:215], v17 offset:2760
    v_mfma_f32_16x16x32_bf16 v[184:187], v[216:219], v[224:227], v[184:187]
    ds_read_b64 v[216:217], v17 offset:3264
    s_waitcnt lgkmcnt(15)
    v_mfma_f32_16x16x32_bf16 v[188:191], v[220:223], v[224:227], v[188:191]
    ds_read_b64 v[218:219], v17 offset:3272
    s_waitcnt lgkmcnt(15)
    v_mfma_f32_16x16x32_bf16 v[188:191], v[192:195], v[252:255], v[188:191]
    ds_read_b64 v[220:221], v17 offset:3776
    s_waitcnt lgkmcnt(14)
    v_mfma_f32_16x16x32_bf16 v[184:187], v[192:195], v[248:251], v[184:187]
    ds_read_b64 v[222:223], v17 offset:3784
    s_waitcnt lgkmcnt(12)
    v_mfma_f32_16x16x32_bf16 v[180:183], v[192:195], v[244:247], v[180:183]
    ds_read_b128 v[232:235], v20 offset:4096
    s_waitcnt lgkmcnt(10)
    v_mfma_f32_16x16x32_bf16 v[176:179], v[192:195], v[240:243], v[176:179]
    ds_read_b128 v[228:231], v20 offset:2048
    s_waitcnt lgkmcnt(8)
    v_mfma_f32_16x16x32_bf16 v[172:175], v[192:195], v[236:239], v[172:175]
    ds_read_b128 v[224:227], v21
    v_mfma_f32_16x16x32_bf16 v[168:171], v[192:195], v[156:159], v[168:171]
    buffer_load_dwordx4 v1, s[48:51], s65 offen offset:0 sc1 lds
    v_mfma_f32_16x16x32_bf16 v[164:167], v[192:195], v[152:155], v[164:167]
    buffer_load_dwordx4 v1, s[48:51], s65 offen offset:1024 sc1 lds
    v_mfma_f32_16x16x32_bf16 v[160:163], v[192:195], v[148:151], v[160:163]
    ds_read_b64 v[192:193], v17 offset:256
    s_add_u32 m0, s75, 0
    v_mfma_f32_16x16x32_bf16 v[188:191], v[196:199], v[248:251], v[188:191]
    ds_read_b64 v[194:195], v17 offset:264
    s_add_u32 s65, s81, 77824
    v_mfma_f32_16x16x32_bf16 v[184:187], v[196:199], v[244:247], v[184:187]
    ds_read_b128 v[252:255], v20 offset:14336
    v_add_u32 v10, 4294967276, v18
    v_mfma_f32_16x16x32_bf16 v[180:183], v[196:199], v[240:243], v[180:183]
    buffer_load_dwordx4 v1, s[48:51], s65 offen offset:0 sc1 lds
    v_bfe_u32 v11, v10, 2, 2
    v_mfma_f32_16x16x32_bf16 v[176:179], v[196:199], v[236:239], v[176:179]
    v_xor_b32 v11, s3, v11
    v_lshl_add_u32 v11, v11, 4, s63
    v_mfma_f32_16x16x32_bf16 v[172:175], v[196:199], v[156:159], v[172:175]
    buffer_load_dwordx4 v1, s[48:51], s65 offen offset:1024 sc1 lds
    v_max_i32 v19, -1, v10
    v_mfma_f32_16x16x32_bf16 v[168:171], v[196:199], v[152:155], v[168:171]
    v_lshl_add_u32 v22, v10, 6, v11
    v_lshl_add_u32 v23, v19, 6, v11
    v_mfma_f32_16x16x32_bf16 v[164:167], v[196:199], v[148:151], v[164:167]
    ds_read_b64 v[196:197], v17 offset:768
    v_mfma_f32_16x16x32_bf16 v[188:191], v[200:203], v[244:247], v[188:191]
    ds_read_b64 v[198:199], v17 offset:776
    v_mfma_f32_16x16x32_bf16 v[184:187], v[200:203], v[240:243], v[184:187]
    ds_read_b128 v[248:251], v20 offset:12288
    v_mfma_f32_16x16x32_bf16 v[180:183], v[200:203], v[236:239], v[180:183]
    buffer_load_dwordx4 v1, s[48:51], s65 offen offset:2048 sc1 lds
    v_mfma_f32_16x16x32_bf16 v[176:179], v[200:203], v[156:159], v[176:179]
    v_mfma_f32_16x16x32_bf16 v[172:175], v[200:203], v[152:155], v[172:175]
    v_mfma_f32_16x16x32_bf16 v[168:171], v[200:203], v[148:151], v[168:171]
    ds_read_b64 v[200:201], v17 offset:1280
    v_mfma_f32_16x16x32_bf16 v[188:191], v[204:207], v[240:243], v[188:191]
    ds_read_b64 v[202:203], v17 offset:1288
    v_mfma_f32_16x16x32_bf16 v[184:187], v[204:207], v[236:239], v[184:187]
    ds_read_b128 v[244:247], v20 offset:10240
    v_mfma_f32_16x16x32_bf16 v[180:183], v[204:207], v[156:159], v[180:183]
    v_mfma_f32_16x16x32_bf16 v[176:179], v[204:207], v[152:155], v[176:179]
    v_mfma_f32_16x16x32_bf16 v[172:175], v[204:207], v[148:151], v[172:175]
    ds_read_b64 v[204:205], v17 offset:1792
    v_mfma_f32_16x16x32_bf16 v[188:191], v[208:211], v[236:239], v[188:191]
    ds_read_b64 v[206:207], v17 offset:1800
    v_mfma_f32_16x16x32_bf16 v[184:187], v[208:211], v[156:159], v[184:187]
    ds_read_b128 v[240:243], v20 offset:8192
    v_mfma_f32_16x16x32_bf16 v[180:183], v[208:211], v[152:155], v[180:183]
    v_mfma_f32_16x16x32_bf16 v[176:179], v[208:211], v[148:151], v[176:179]
    ds_read_b64 v[208:209], v17 offset:2304
    s_waitcnt lgkmcnt(15)
    v_mfma_f32_16x16x32_bf16 v[188:191], v[212:215], v[156:159], v[188:191]
    ds_read_b64 v[210:211], v17 offset:2312
    v_mfma_f32_16x16x32_bf16 v[184:187], v[212:215], v[152:155], v[184:187]
    buffer_load_dword v31, v14, s[48:51], s82 offen sc1
    ds_read_b128 v[236:239], v20 offset:6144
    v_mfma_f32_16x16x32_bf16 v[180:183], v[212:215], v[148:151], v[180:183]
    ds_read_b64 v[212:213], v17 offset:2816
    s_waitcnt lgkmcnt(15)
    v_mfma_f32_16x16x32_bf16 v[188:191], v[216:219], v[152:155], v[188:191]
    ds_read_b64 v[214:215], v17 offset:2824
    v_mfma_f32_16x16x32_bf16 v[184:187], v[216:219], v[148:151], v[184:187]
    ds_read_b64 v[216:217], v17 offset:3328
    s_waitcnt lgkmcnt(15)
    v_mfma_f32_16x16x32_bf16 v[188:191], v[220:223], v[148:151], v[188:191]
    ds_read_b64 v[218:219], v17 offset:3336
    s_waitcnt lgkmcnt(15)
    v_mfma_f32_16x16x32_bf16 v[188:191], v[192:195], v[252:255], v[188:191]
    ds_read_b64 v[220:221], v17 offset:3840
    s_waitcnt lgkmcnt(14)
    v_mfma_f32_16x16x32_bf16 v[184:187], v[192:195], v[248:251], v[184:187]
    ds_read_b64 v[222:223], v17 offset:3848
    s_waitcnt lgkmcnt(12)
    v_mfma_f32_16x16x32_bf16 v[180:183], v[192:195], v[244:247], v[180:183]
    ds_read_b128 v[156:159], v22 offset:4096
    s_waitcnt lgkmcnt(10)
    v_mfma_f32_16x16x32_bf16 v[176:179], v[192:195], v[240:243], v[176:179]
    ds_read_b128 v[152:155], v22 offset:2048
    s_waitcnt lgkmcnt(8)
    v_mfma_f32_16x16x32_bf16 v[172:175], v[192:195], v[236:239], v[172:175]
    ds_read_b128 v[148:151], v23
    v_mfma_f32_16x16x32_bf16 v[168:171], v[192:195], v[232:235], v[168:171]
    v_mfma_f32_16x16x32_bf16 v[164:167], v[192:195], v[228:231], v[164:167]
    v_mfma_f32_16x16x32_bf16 v[160:163], v[192:195], v[224:227], v[160:163]
    ds_read_b64 v[192:193], v17 offset:320
    v_mfma_f32_16x16x32_bf16 v[188:191], v[196:199], v[248:251], v[188:191]
    ds_read_b64 v[194:195], v17 offset:328
    v_add_u32 v10, 4294967272, v18
    v_mfma_f32_16x16x32_bf16 v[184:187], v[196:199], v[244:247], v[184:187]
    ds_read_b128 v[252:255], v22 offset:14336
    v_bfe_u32 v11, v10, 2, 2
    v_mfma_f32_16x16x32_bf16 v[180:183], v[196:199], v[240:243], v[180:183]
    v_xor_b32 v11, s3, v11
    v_lshl_add_u32 v11, v11, 4, s63
    v_mfma_f32_16x16x32_bf16 v[176:179], v[196:199], v[236:239], v[176:179]
    v_max_i32 v19, -1, v10
    v_lshl_add_u32 v20, v10, 6, v11
    v_mfma_f32_16x16x32_bf16 v[172:175], v[196:199], v[232:235], v[172:175]
    v_lshl_add_u32 v21, v19, 6, v11
    v_mfma_f32_16x16x32_bf16 v[168:171], v[196:199], v[228:231], v[168:171]
    v_mfma_f32_16x16x32_bf16 v[164:167], v[196:199], v[224:227], v[164:167]
    ds_read_b64 v[196:197], v17 offset:832
    v_mfma_f32_16x16x32_bf16 v[188:191], v[200:203], v[244:247], v[188:191]
    ds_read_b64 v[198:199], v17 offset:840
    v_mfma_f32_16x16x32_bf16 v[184:187], v[200:203], v[240:243], v[184:187]
    ds_read_b128 v[248:251], v22 offset:12288
    v_mfma_f32_16x16x32_bf16 v[180:183], v[200:203], v[236:239], v[180:183]
    v_mfma_f32_16x16x32_bf16 v[176:179], v[200:203], v[232:235], v[176:179]
    v_mfma_f32_16x16x32_bf16 v[172:175], v[200:203], v[228:231], v[172:175]
    v_mfma_f32_16x16x32_bf16 v[168:171], v[200:203], v[224:227], v[168:171]
    ds_read_b64 v[200:201], v17 offset:1344
    v_mfma_f32_16x16x32_bf16 v[188:191], v[204:207], v[240:243], v[188:191]
    ds_read_b64 v[202:203], v17 offset:1352
    v_mfma_f32_16x16x32_bf16 v[184:187], v[204:207], v[236:239], v[184:187]
    ds_read_b128 v[244:247], v22 offset:10240
    v_mfma_f32_16x16x32_bf16 v[180:183], v[204:207], v[232:235], v[180:183]
    v_mfma_f32_16x16x32_bf16 v[176:179], v[204:207], v[228:231], v[176:179]
    v_mfma_f32_16x16x32_bf16 v[172:175], v[204:207], v[224:227], v[172:175]
    ds_read_b64 v[204:205], v17 offset:1856
    v_mfma_f32_16x16x32_bf16 v[188:191], v[208:211], v[236:239], v[188:191]
    ds_read_b64 v[206:207], v17 offset:1864
    v_mfma_f32_16x16x32_bf16 v[184:187], v[208:211], v[232:235], v[184:187]
    ds_read_b128 v[240:243], v22 offset:8192
    v_mfma_f32_16x16x32_bf16 v[180:183], v[208:211], v[228:231], v[180:183]
    v_mfma_f32_16x16x32_bf16 v[176:179], v[208:211], v[224:227], v[176:179]
    ds_read_b64 v[208:209], v17 offset:2368
    s_waitcnt lgkmcnt(15)
    v_mfma_f32_16x16x32_bf16 v[188:191], v[212:215], v[232:235], v[188:191]
    ds_read_b64 v[210:211], v17 offset:2376
    v_mfma_f32_16x16x32_bf16 v[184:187], v[212:215], v[228:231], v[184:187]
    ds_read_b128 v[236:239], v22 offset:6144
    v_mfma_f32_16x16x32_bf16 v[180:183], v[212:215], v[224:227], v[180:183]
    ds_read_b64 v[212:213], v17 offset:2880
    s_waitcnt lgkmcnt(15)
    v_mfma_f32_16x16x32_bf16 v[188:191], v[216:219], v[228:231], v[188:191]
    ds_read_b64 v[214:215], v17 offset:2888
    v_mfma_f32_16x16x32_bf16 v[184:187], v[216:219], v[224:227], v[184:187]
    ds_read_b64 v[216:217], v17 offset:3392
    s_waitcnt lgkmcnt(15)
    v_mfma_f32_16x16x32_bf16 v[188:191], v[220:223], v[224:227], v[188:191]
    ds_read_b64 v[218:219], v17 offset:3400
    s_waitcnt lgkmcnt(15)
    v_mfma_f32_16x16x32_bf16 v[188:191], v[192:195], v[252:255], v[188:191]
    ds_read_b64 v[220:221], v17 offset:3904
    s_waitcnt lgkmcnt(14)
    v_mfma_f32_16x16x32_bf16 v[184:187], v[192:195], v[248:251], v[184:187]
    ds_read_b64 v[222:223], v17 offset:3912
    s_waitcnt lgkmcnt(12)
    v_mfma_f32_16x16x32_bf16 v[180:183], v[192:195], v[244:247], v[180:183]
    ds_read_b128 v[232:235], v20 offset:4096
    s_waitcnt lgkmcnt(10)
    v_mfma_f32_16x16x32_bf16 v[176:179], v[192:195], v[240:243], v[176:179]
    ds_read_b128 v[228:231], v20 offset:2048
    s_waitcnt lgkmcnt(8)
    v_mfma_f32_16x16x32_bf16 v[172:175], v[192:195], v[236:239], v[172:175]
    ds_read_b128 v[224:227], v21
    v_mfma_f32_16x16x32_bf16 v[168:171], v[192:195], v[156:159], v[168:171]
    v_mfma_f32_16x16x32_bf16 v[164:167], v[192:195], v[152:155], v[164:167]
    v_mfma_f32_16x16x32_bf16 v[160:163], v[192:195], v[148:151], v[160:163]
    ds_read_b64 v[192:193], v17 offset:384
    v_mfma_f32_16x16x32_bf16 v[188:191], v[196:199], v[248:251], v[188:191]
    ds_read_b64 v[194:195], v17 offset:392
    v_add_u32 v10, 4294967268, v18
    v_mfma_f32_16x16x32_bf16 v[184:187], v[196:199], v[244:247], v[184:187]
    s_waitcnt vmcnt(0)
    v_cmp_ne_u32 vcc, s95, v31
    s_cbranch_vccz KM_hfc_done
    s_load_dwordx8 s[20:27], s[48:49], s82 glc
    s_branch KM_hfc_chk
KM_hfc_poll:
    s_load_dwordx8 s[20:27], s[48:49], s82 glc
KM_hfc_chk:
    s_sub_u32 s94, s94, 1
    s_cmp_lt_i32 s94, 1
    s_waitcnt lgkmcnt(0)
    s_cbranch_scc1 KM_hfc_done
    s_cmp_lg_u32 s20, s95
    s_cbranch_scc1 KM_hfc_poll
    s_cmp_lg_u32 s21, s95
    s_cbranch_scc1 KM_hfc_poll
    s_cmp_lg_u32 s22, s95
    s_cbranch_scc1 KM_hfc_poll
    s_cmp_lg_u32 s23, s95
    s_cbranch_scc1 KM_hfc_poll
    s_cmp_lg_u32 s24, s95
    s_cbranch_scc1 KM_hfc_poll
    s_cmp_lg_u32 s25, s95
    s_cbranch_scc1 KM_hfc_poll
    s_cmp_lg_u32 s26, s95
    s_cbranch_scc1 KM_hfc_poll
    s_cmp_lg_u32 s27, s95
    s_cbranch_scc1 KM_hfc_poll
KM_hfc_done:
    ds_read_b128 v[252:255], v20 offset:14336
    v_mfma_f32_16x16x32_bf16 v[180:183], v[196:199], v[240:243], v[180:183]
    s_add_u32 s84, s80, 0
    s_add_u32 s84, s84, s78
    v_bfe_u32 v11, v10, 2, 2
    v_mfma_f32_16x16x32_bf16 v[176:179], v[196:199], v[236:239], v[176:179]
    buffer_load_dwordx4 v[36:39], v4, s[48:51], s84 offen sc1
    v_xor_b32 v11, s3, v11
    v_mfma_f32_16x16x32_bf16 v[172:175], v[196:199], v[156:159], v[172:175]
    buffer_load_dwordx4 v[40:43], v5, s[48:51], s84 offen sc1
    v_lshl_add_u32 v11, v11, 4, s63
    v_mfma_f32_16x16x32_bf16 v[168:171], v[196:199], v[152:155], v[168:171]
    v_max_i32 v19, -1, v10
    v_lshl_add_u32 v22, v10, 6, v11
    v_mfma_f32_16x16x32_bf16 v[164:167], v[196:199], v[148:151], v[164:167]
    ds_read_b64 v[196:197], v17 offset:896
    v_lshl_add_u32 v23, v19, 6, v11
    v_mfma_f32_16x16x32_bf16 v[188:191], v[200:203], v[244:247], v[188:191]
    ds_read_b64 v[198:199], v17 offset:904
    v_mfma_f32_16x16x32_bf16 v[184:187], v[200:203], v[240:243], v[184:187]
    ds_read_b128 v[248:251], v20 offset:12288
    v_mfma_f32_16x16x32_bf16 v[180:183], v[200:203], v[236:239], v[180:183]
    buffer_load_dwordx4 v[44:47], v6, s[48:51], s84 offen sc1
    v_mfma_f32_16x16x32_bf16 v[176:179], v[200:203], v[156:159], v[176:179]
    buffer_load_dwordx4 v[48:51], v7, s[48:51], s84 offen sc1
    v_mfma_f32_16x16x32_bf16 v[172:175], v[200:203], v[152:155], v[172:175]
    v_mfma_f32_16x16x32_bf16 v[168:171], v[200:203], v[148:151], v[168:171]
    ds_read_b64 v[200:201], v17 offset:1408
    s_add_u32 s84, s80, 4096
    v_mfma_f32_16x16x32_bf16 v[188:191], v[204:207], v[240:243], v[188:191]
    ds_read_b64 v[202:203], v17 offset:1416
    s_add_u32 s84, s84, s78
    v_mfma_f32_16x16x32_bf16 v[184:187], v[204:207], v[236:239], v[184:187]
    ds_read_b128 v[244:247], v20 offset:10240
    v_mfma_f32_16x16x32_bf16 v[180:183], v[204:207], v[156:159], v[180:183]
    buffer_load_dwordx4 v[52:55], v4, s[48:51], s84 offen sc1
    v_mfma_f32_16x16x32_bf16 v[176:179], v[204:207], v[152:155], v[176:179]
    v_mfma_f32_16x16x32_bf16 v[172:175], v[204:207], v[148:151], v[172:175]
    ds_read_b64 v[204:205], v17 offset:1920
    v_mfma_f32_16x16x32_bf16 v[188:191], v[208:211], v[236:239], v[188:191]
    ds_read_b64 v[206:207], v17 offset:1928
    v_mfma_f32_16x16x32_bf16 v[184:187], v[208:211], v[156:159], v[184:187]
    ds_read_b128 v[240:243], v20 offset:8192
    v_mfma_f32_16x16x32_bf16 v[180:183], v[208:211], v[152:155], v[180:183]
    buffer_load_dwordx4 v[56:59], v5, s[48:51], s84 offen sc1
    v_mfma_f32_16x16x32_bf16 v[176:179], v[208:211], v[148:151], v[176:179]
    ds_read_b64 v[208:209], v17 offset:2432
    s_waitcnt lgkmcnt(15)
    v_mfma_f32_16x16x32_bf16 v[188:191], v[212:215], v[156:159], v[188:191]
    ds_read_b64 v[210:211], v17 offset:2440
    v_mfma_f32_16x16x32_bf16 v[184:187], v[212:215], v[152:155], v[184:187]
    ds_read_b128 v[236:239], v20 offset:6144
    v_mfma_f32_16x16x32_bf16 v[180:183], v[212:215], v[148:151], v[180:183]
    ds_read_b64 v[212:213], v17 offset:2944
    s_waitcnt lgkmcnt(15)
    v_mfma_f32_16x16x32_bf16 v[188:191], v[216:219], v[152:155], v[188:191]
    ds_read_b64 v[214:215], v17 offset:2952
    v_mfma_f32_16x16x32_bf16 v[184:187], v[216:219], v[148:151], v[184:187]
    ds_read_b64 v[216:217], v17 offset:3456
    s_waitcnt lgkmcnt(15)
    v_mfma_f32_16x16x32_bf16 v[188:191], v[220:223], v[148:151], v[188:191]
    ds_read_b64 v[218:219], v17 offset:3464
    s_waitcnt lgkmcnt(15)
    v_mfma_f32_16x16x32_bf16 v[188:191], v[192:195], v[252:255], v[188:191]
    ds_read_b64 v[220:221], v17 offset:3968
    s_waitcnt lgkmcnt(14)
    v_mfma_f32_16x16x32_bf16 v[184:187], v[192:195], v[248:251], v[184:187]
    ds_read_b64 v[222:223], v17 offset:3976
    s_waitcnt lgkmcnt(12)
    v_mfma_f32_16x16x32_bf16 v[180:183], v[192:195], v[244:247], v[180:183]
    ds_read_b128 v[156:159], v22 offset:4096
    s_waitcnt lgkmcnt(10)
    v_mfma_f32_16x16x32_bf16 v[176:179], v[192:195], v[240:243], v[176:179]
    ds_read_b128 v[152:155], v22 offset:2048
    s_waitcnt lgkmcnt(8)
    v_mfma_f32_16x16x32_bf16 v[172:175], v[192:195], v[236:239], v[172:175]
    ds_read_b128 v[148:151], v23
    v_mfma_f32_16x16x32_bf16 v[168:171], v[192:195], v[232:235], v[168:171]
    buffer_load_dwordx4 v[60:63], v6, s[48:51], s84 offen sc1
    v_mfma_f32_16x16x32_bf16 v[164:167], v[192:195], v[228:231], v[164:167]
    buffer_load_dwordx4 v[64:67], v7, s[48:51], s84 offen sc1
    v_mfma_f32_16x16x32_bf16 v[160:163], v[192:195], v[224:227], v[160:163]
    ds_read_b64 v[192:193], v17 offset:448
    s_add_u32 s84, s80, 8192
    v_mfma_f32_16x16x32_bf16 v[188:191], v[196:199], v[248:251], v[188:191]
    ds_read_b64 v[194:195], v17 offset:456
    s_sub_u32 s84, s84, s78
    v_mfma_f32_16x16x32_bf16 v[184:187], v[196:199], v[244:247], v[184:187]
    ds_read_b128 v[252:255], v22 offset:14336
    v_mfma_f32_16x16x32_bf16 v[180:183], v[196:199], v[240:243], v[180:183]
    buffer_load_dwordx4 v[68:71], v4, s[48:51], s84 offen sc1
    v_mfma_f32_16x16x32_bf16 v[176:179], v[196:199], v[236:239], v[176:179]
    v_mfma_f32_16x16x32_bf16 v[172:175], v[196:199], v[232:235], v[172:175]
    buffer_load_dwordx4 v[72:75], v5, s[48:51], s84 offen sc1
    v_mfma_f32_16x16x32_bf16 v[168:171], v[196:199], v[228:231], v[168:171]
    v_mfma_f32_16x16x32_bf16 v[164:167], v[196:199], v[224:227], v[164:167]
    ds_read_b64 v[196:197], v17 offset:960
    v_mfma_f32_16x16x32_bf16 v[188:191], v[200:203], v[244:247], v[188:191]
    ds_read_b64 v[198:199], v17 offset:968
    v_mfma_f32_16x16x32_bf16 v[184:187], v[200:203], v[240:243], v[184:187]
    ds_read_b128 v[248:251], v22 offset:12288
    v_mfma_f32_16x16x32_bf16 v[180:183], v[200:203], v[236:239], v[180:183]
    buffer_load_dwordx4 v[76:79], v6, s[48:51], s84 offen sc1
    v_mfma_f32_16x16x32_bf16 v[176:179], v[200:203], v[232:235], v[176:179]
    v_mfma_f32_16x16x32_bf16 v[172:175], v[200:203], v[228:231], v[172:175]
    v_mfma_f32_16x16x32_bf16 v[168:171], v[200:203], v[224:227], v[168:171]
    ds_read_b64 v[200:201], v17 offset:1472
    v_mfma_f32_16x16x32_bf16 v[188:191], v[204:207], v[240:243], v[188:191]
    ds_read_b64 v[202:203], v17 offset:1480
    v_mfma_f32_16x16x32_bf16 v[184:187], v[204:207], v[236:239], v[184:187]
    ds_read_b128 v[244:247], v22 offset:10240
    v_mfma_f32_16x16x32_bf16 v[180:183], v[204:207], v[232:235], v[180:183]
    buffer_load_dwordx4 v[80:83], v7, s[48:51], s84 offen sc1
    v_mfma_f32_16x16x32_bf16 v[176:179], v[204:207], v[228:231], v[176:179]
    s_add_u32 s84, s80, 12288
    s_sub_u32 s84, s84, s78
    v_mfma_f32_16x16x32_bf16 v[172:175], v[204:207], v[224:227], v[172:175]
    ds_read_b64 v[204:205], v17 offset:1984
    v_mfma_f32_16x16x32_bf16 v[188:191], v[208:211], v[236:239], v[188:191]
    ds_read_b64 v[206:207], v17 offset:1992
    v_mfma_f32_16x16x32_bf16 v[184:187], v[208:211], v[232:235], v[184:187]
    ds_read_b128 v[240:243], v22 offset:8192
    v_mfma_f32_16x16x32_bf16 v[180:183], v[208:211], v[228:231], v[180:183]
    buffer_load_dwordx4 v[84:87], v4, s[48:51], s84 offen sc1
    v_mfma_f32_16x16x32_bf16 v[176:179], v[208:211], v[224:227], v[176:179]
    ds_read_b64 v[208:209], v17 offset:2496
    s_waitcnt lgkmcnt(15)
    v_mfma_f32_16x16x32_bf16 v[188:191], v[212:215], v[232:235], v[188:191]
    ds_read_b64 v[210:211], v17 offset:2504
    v_mfma_f32_16x16x32_bf16 v[184:187], v[212:215], v[228:231], v[184:187]
    ds_read_b128 v[236:239], v22 offset:6144
    v_mfma_f32_16x16x32_bf16 v[180:183], v[212:215], v[224:227], v[180:183]
    ds_read_b64 v[212:213], v17 offset:3008
    s_waitcnt lgkmcnt(15)
    v_mfma_f32_16x16x32_bf16 v[188:191], v[216:219], v[228:231], v[188:191]
    ds_read_b64 v[214:215], v17 offset:3016
    v_mfma_f32_16x16x32_bf16 v[184:187], v[216:219], v[224:227], v[184:187]
    ds_read_b64 v[216:217], v17 offset:3520
    s_waitcnt lgkmcnt(15)
    v_mfma_f32_16x16x32_bf16 v[188:191], v[220:223], v[224:227], v[188:191]
    ds_read_b64 v[218:219], v17 offset:3528
    s_waitcnt lgkmcnt(15)
    v_mfma_f32_16x16x32_bf16 v[188:191], v[192:195], v[252:255], v[188:191]
    ds_read_b64 v[220:221], v17 offset:4032
    s_waitcnt lgkmcnt(14)
    v_mfma_f32_16x16x32_bf16 v[184:187], v[192:195], v[248:251], v[184:187]
    ds_read_b64 v[222:223], v17 offset:4040
    s_waitcnt lgkmcnt(12)
    v_mfma_f32_16x16x32_bf16 v[180:183], v[192:195], v[244:247], v[180:183]
    s_waitcnt lgkmcnt(9)
    buffer_load_dwordx4 v[88:91], v5, s[48:51], s84 offen sc1
    v_mfma_f32_16x16x32_bf16 v[176:179], v[192:195], v[240:243], v[176:179]
    s_waitcnt lgkmcnt(6)
    buffer_load_dwordx4 v[92:95], v6, s[48:51], s84 offen sc1
    v_mfma_f32_16x16x32_bf16 v[172:175], v[192:195], v[236:239], v[172:175]
    v_mfma_f32_16x16x32_bf16 v[168:171], v[192:195], v[156:159], v[168:171]
    buffer_load_dwordx4 v[96:99], v7, s[48:51], s84 offen sc1
    v_mfma_f32_16x16x32_bf16 v[164:167], v[192:195], v[152:155], v[164:167]
    v_mfma_f32_16x16x32_bf16 v[160:163], v[192:195], v[148:151], v[160:163]
    s_add_u32 s84, s80, 16384
    s_add_u32 s84, s84, s78
    v_mfma_f32_16x16x32_bf16 v[188:191], v[196:199], v[248:251], v[188:191]
    v_mfma_f32_16x16x32_bf16 v[184:187], v[196:199], v[244:247], v[184:187]
    buffer_load_dwordx4 v[100:103], v4, s[48:51], s84 offen sc1
    v_mfma_f32_16x16x32_bf16 v[180:183], v[196:199], v[240:243], v[180:183]
    v_mfma_f32_16x16x32_bf16 v[176:179], v[196:199], v[236:239], v[176:179]
    v_mfma_f32_16x16x32_bf16 v[172:175], v[196:199], v[156:159], v[172:175]
    v_mfma_f32_16x16x32_bf16 v[168:171], v[196:199], v[152:155], v[168:171]
    buffer_load_dwordx4 v[104:107], v5, s[48:51], s84 offen sc1
    v_mfma_f32_16x16x32_bf16 v[164:167], v[196:199], v[148:151], v[164:167]
    v_mfma_f32_16x16x32_bf16 v[188:191], v[200:203], v[244:247], v[188:191]
    v_cvt_pk_bf16_f32 v18, v160, v161
    v_cvt_pk_bf16_f32 v19, v162, v163
    v_mfma_f32_16x16x32_bf16 v[184:187], v[200:203], v[240:243], v[184:187]
    buffer_store_dwordx2 v[18:19], v28, s[48:51], s59 offen offset:0 sc1
    v_mfma_f32_16x16x32_bf16 v[180:183], v[200:203], v[236:239], v[180:183]
    buffer_load_dwordx4 v[108:111], v6, s[48:51], s84 offen sc1
    v_mfma_f32_16x16x32_bf16 v[176:179], v[200:203], v[156:159], v[176:179]
    v_mfma_f32_16x16x32_bf16 v[172:175], v[200:203], v[152:155], v[172:175]
    v_mfma_f32_16x16x32_bf16 v[168:171], v[200:203], v[148:151], v[168:171]
    v_mfma_f32_16x16x32_bf16 v[188:191], v[204:207], v[240:243], v[188:191]
    buffer_load_dwordx4 v[112:115], v7, s[48:51], s84 offen sc1
    v_mfma_f32_16x16x32_bf16 v[184:187], v[204:207], v[236:239], v[184:187]
    v_cvt_pk_bf16_f32 v20, v164, v165
    v_cvt_pk_bf16_f32 v21, v166, v167
    v_mfma_f32_16x16x32_bf16 v[180:183], v[204:207], v[156:159], v[180:183]
    buffer_store_dwordx2 v[20:21], v28, s[48:51], s59 offen offset:512 sc1
    v_mfma_f32_16x16x32_bf16 v[176:179], v[204:207], v[152:155], v[176:179]
    s_add_u32 s84, s80, 20480
    s_add_u32 s84, s84, s78
    v_mfma_f32_16x16x32_bf16 v[172:175], v[204:207], v[148:151], v[172:175]
    buffer_load_dwordx4 v[116:119], v4, s[48:51], s84 offen sc1
    v_mfma_f32_16x16x32_bf16 v[188:191], v[208:211], v[236:239], v[188:191]
    v_mfma_f32_16x16x32_bf16 v[184:187], v[208:211], v[156:159], v[184:187]
    v_mfma_f32_16x16x32_bf16 v[180:183], v[208:211], v[152:155], v[180:183]
    v_cvt_pk_bf16_f32 v22, v168, v169
    v_cvt_pk_bf16_f32 v23, v170, v171
    v_mfma_f32_16x16x32_bf16 v[176:179], v[208:211], v[148:151], v[176:179]
    s_waitcnt lgkmcnt(4)
    buffer_store_dwordx2 v[22:23], v28, s[48:51], s59 offen offset:1024 sc1
    v_mfma_f32_16x16x32_bf16 v[188:191], v[212:215], v[156:159], v[188:191]
    buffer_load_dwordx4 v[120:123], v5, s[48:51], s84 offen sc1
    v_mfma_f32_16x16x32_bf16 v[184:187], v[212:215], v[152:155], v[184:187]
    v_mfma_f32_16x16x32_bf16 v[180:183], v[212:215], v[148:151], v[180:183]
    s_waitcnt lgkmcnt(2)
    v_mfma_f32_16x16x32_bf16 v[188:191], v[216:219], v[152:155], v[188:191]
    v_cvt_pk_bf16_f32 v24, v172, v173
    v_cvt_pk_bf16_f32 v25, v174, v175
    v_mfma_f32_16x16x32_bf16 v[184:187], v[216:219], v[148:151], v[184:187]
    s_waitcnt lgkmcnt(0)
    buffer_load_dwordx4 v[124:127], v6, s[48:51], s84 offen sc1
    v_mfma_f32_16x16x32_bf16 v[188:191], v[220:223], v[148:151], v[188:191]
    buffer_store_dwordx2 v[24:25], v28, s[48:51], s59 offen offset:1536 sc1
    buffer_load_dwordx4 v[128:131], v7, s[48:51], s84 offen sc1
    s_add_u32 s84, s80, 24576
    s_sub_u32 s84, s84, s78
    buffer_load_dwordx4 v[132:135], v4, s[48:51], s84 offen sc1
    buffer_load_dwordx4 v[136:139], v5, s[48:51], s84 offen sc1
    buffer_load_dwordx4 v[140:143], v6, s[48:51], s84 offen sc1
    s_nop 7
    v_cvt_pk_bf16_f32 v26, v176, v177
    v_cvt_pk_bf16_f32 v27, v178, v179
    buffer_store_dwordx2 v[26:27], v28, s[48:51], s59 offen offset:2048 sc1
    v_cvt_pk_bf16_f32 v18, v180, v181
    v_cvt_pk_bf16_f32 v19, v182, v183
    buffer_store_dwordx2 v[18:19], v28, s[48:51], s59 offen offset:2560 sc1
    v_cvt_pk_bf16_f32 v20, v184, v185
    v_cvt_pk_bf16_f32 v21, v186, v187
    buffer_store_dwordx2 v[20:21], v28, s[48:51], s59 offen offset:3072 sc1
    v_cvt_pk_bf16_f32 v22, v188, v189
    v_cvt_pk_bf16_f32 v23, v190, v191
    buffer_store_dwordx2 v[22:23], v28, s[48:51], s59 offen offset:3584 sc1
    s_waitcnt vmcnt(31)
    s_waitcnt vmcnt(27)
    v_mfma_f32_16x16x32_bf16 v[164:167], a[108:111], v[40:43], 0
    buffer_load_dwordx4 v[144:147], v7, s[48:51], s84 offen sc1
    v_mfma_f32_16x16x32_bf16 v[164:167], a[124:127], v[56:59], v[164:167]
    v_mfma_f32_16x16x32_bf16 v[180:183], a[112:115], v[40:43], 0
    v_mfma_f32_16x16x32_bf16 v[180:183], a[128:131], v[56:59], v[180:183]
    s_lshl_b32 s85, s70, 6
    s_lshr_b32 s57, s3, 1
    s_lshl_b32 s57, s57, 5
    v_mfma_f32_16x16x32_bf16 v[196:199], a[116:119], v[40:43], 0
    s_add_u32 s85, s85, s57
    s_and_b32 s57, s3, 1
    s_lshl_b32 s57, s57, 2
    v_mfma_f32_16x16x32_bf16 v[196:199], a[132:135], v[56:59], v[196:199]
    s_add_u32 s85, s85, s57
    s_lshl_b32 s86, s85, 3
    s_add_u32 s86, s86, 0x240000
    v_mfma_f32_16x16x32_bf16 v[212:215], a[120:123], v[40:43], 0
    s_mul_i32 s85, s85, 1152
    s_mul_i32 s57, s71, 144
    s_add_u32 s85, s85, s57
    v_mfma_f32_16x16x32_bf16 v[212:215], a[136:139], v[56:59], v[212:215]
    s_mul_i32 s87, s3, 3072
    s_add_u32 s87, s87, 133120
    v_add_u32 v10, 0, v0
    v_mfma_f32_16x16x32_bf16 v[228:231], a[140:143], v[40:43], 0
    v_mul_u32_u24 v11, 7282, v10
    v_lshrrev_b32 v11, 16, v11
    v_mfma_f32_16x16x32_bf16 v[244:247], a[140:143], v[56:59], 0
    v_mul_u32_u24 v12, 9, v11
    v_sub_u32 v10, v10, v12
    v_mfma_f32_16x16x32_bf16 v[168:171], a[108:111], v[44:47], 0
    v_and_b32 v12, 0xfc, v11
    v_add_u32 v11, v11, v12
    v_mfma_f32_16x16x32_bf16 v[168:171], a[124:127], v[60:63], v[168:171]
    v_mul_u32_u24 v11, 1152, v11
    v_lshl_add_u32 v16, v10, 4, v11
    v_mfma_f32_16x16x32_bf16 v[184:187], a[112:115], v[44:47], 0
    v_add_u32 v10, 64, v0
    v_mul_u32_u24 v11, 7282, v10
    v_mfma_f32_16x16x32_bf16 v[184:187], a[128:131], v[60:63], v[184:187]
    v_lshrrev_b32 v11, 16, v11
    v_mul_u32_u24 v12, 9, v11
    v_mfma_f32_16x16x32_bf16 v[200:203], a[116:119], v[44:47], 0
    v_sub_u32 v10, v10, v12
    v_and_b32 v12, 0xfc, v11
    v_mfma_f32_16x16x32_bf16 v[200:203], a[132:135], v[60:63], v[200:203]
    v_add_u32 v11, v11, v12
    v_mul_u32_u24 v11, 1152, v11
    v_mfma_f32_16x16x32_bf16 v[216:219], a[120:123], v[44:47], 0
    v_lshl_add_u32 v17, v10, 4, v11
    v_add_u32 v10, 128, v0
    v_mfma_f32_16x16x32_bf16 v[216:219], a[136:139], v[60:63], v[216:219]
    v_mul_u32_u24 v11, 7282, v10
    v_lshrrev_b32 v11, 16, v11
    v_mfma_f32_16x16x32_bf16 v[232:235], a[140:143], v[44:47], 0
    v_mul_u32_u24 v12, 9, v11
    v_sub_u32 v10, v10, v12
    v_mfma_f32_16x16x32_bf16 v[248:251], a[140:143], v[60:63], 0
    v_and_b32 v12, 0xfc, v11
    v_add_u32 v11, v11, v12
    v_mfma_f32_16x16x32_bf16 v[172:175], a[108:111], v[48:51], 0
    v_mul_u32_u24 v11, 1152, v11
    v_lshl_add_u32 v18, v10, 4, v11
    v_mfma_f32_16x16x32_bf16 v[172:175], a[124:127], v[64:67], v[172:175]
    v_lshlrev_b32 v10, 28, v9
    v_or_b32 v18, v18, v10
    v_mfma_f32_16x16x32_bf16 v[188:191], a[112:115], v[48:51], 0
    v_and_b32 v10, 12, v8
    v_add_lshl_u32 v19, v10, v8, 3
    v_mfma_f32_16x16x32_bf16 v[188:191], a[128:131], v[64:67], v[188:191]
    v_mul_u32_u24 v20, 144, v8
    v_add_u32 v20, s87, v20
    v_mfma_f32_16x16x32_bf16 v[204:207], a[116:119], v[48:51], 0
    v_lshl_add_u32 v21, v9, 3, v20
    v_lshl_add_u32 v20, v9, 4, v20
    v_mfma_f32_16x16x32_bf16 v[204:207], a[132:135], v[64:67], v[204:207]
    v_min_u32 v22, 35, v0
    v_and_b32 v10, 3, v22
    v_mfma_f32_16x16x32_bf16 v[220:223], a[120:123], v[48:51], 0
    v_lshrrev_b32 v22, 2, v22
    v_lshlrev_b32 v22, 7, v22
    v_mfma_f32_16x16x32_bf16 v[220:223], a[136:139], v[64:67], v[220:223]
    v_lshl_add_u32 v22, v10, 3, v22
    s_mul_i32 s88, s71, 1152
    s_add_u32 s88, s88, 0x11c0000
    v_mfma_f32_16x16x32_bf16 v[236:239], a[140:143], v[48:51], 0
    v_lshrrev_b32 v23, 3, v0
    v_lshlrev_b32 v23, 12, v23
    v_mfma_f32_16x16x32_bf16 v[252:255], a[140:143], v[64:67], 0
    s_waitcnt vmcnt(1)
    v_mov_b32 v30, s95
    s_mov_b64 exec, 1
    buffer_store_dword v30, v1, s[48:51], s97 offen sc1
    s_mov_b64 exec, -1
    v_mfma_f32_16x16x32_bf16 v[160:163], a[108:111], v[36:39], 0
    v_and_b32 v10, 7, v0
    v_lshl_add_u32 v23, v10, 4, v23
    s_mul_i32 s89, s71, 294912
    v_mfma_f32_16x16x32_bf16 v[160:163], a[124:127], v[52:55], v[160:163]
    s_lshl_b32 s57, s70, 7
    s_add_u32 s89, s89, s57
    s_add_u32 s89, s89, 0x500000
    v_mfma_f32_16x16x32_bf16 v[176:179], a[112:115], v[36:39], 0
    s_lshl_b32 s57, s3, 13
    s_add_u32 s67, s89, s57
    s_add_u32 s67, s67, 262144
    v_mfma_f32_16x16x32_bf16 v[176:179], a[128:131], v[52:55], v[176:179]
    s_lshl_b32 s57, s3, 15
    s_add_u32 s89, s89, s57
    s_add_u32 s73, s89, 131072
    v_mfma_f32_16x16x32_bf16 v[192:195], a[116:119], v[36:39], 0
    s_lshl_b32 s57, s3, 10
    s_add_u32 s57, s57, 145408
    v_add_u32 v24, s57, v1
    v_mfma_f32_16x16x32_bf16 v[192:195], a[132:135], v[52:55], v[192:195]
    v_bfe_u32 v10, v0, 2, 2
    v_lshl_add_u32 v11, v9, 3, v10
    v_mfma_f32_16x16x32_bf16 v[208:211], a[120:123], v[36:39], 0
    v_lshl_add_u32 v12, v9, 2, v10
    v_and_b32 v10, 1, v0
    v_mfma_f32_16x16x32_bf16 v[208:211], a[136:139], v[52:55], v[208:211]
    v_lshlrev_b32 v10, 6, v10
    v_bfe_u32 v13, v0, 1, 1
    v_mfma_f32_16x16x32_bf16 v[224:227], a[140:143], v[36:39], 0
    v_lshl_add_u32 v10, v13, 3, v10
    s_and_b32 s57, s3, 1
    s_lshl_b32 s57, s57, 5
    v_mfma_f32_16x16x32_bf16 v[240:243], a[140:143], v[52:55], 0
    s_add_u32 s84, s80, 28672
    s_sub_u32 s84, s84, s78
    s_lshr_b32 s62, s3, 1
    v_mfma_f32_16x16x32_bf16 v[164:167], a[144:147], v[72:75], v[164:167]
    buffer_load_dwordx4 v[36:39], v4, s[48:51], s84 offen sc1
    s_lshl_b32 s62, s62, 4
    v_mfma_f32_16x16x32_bf16 v[164:167], a[160:163], v[88:91], v[164:167]
    buffer_load_dwordx4 v[40:43], v5, s[48:51], s84 offen sc1
    s_add_u32 s57, s57, s62
    v_mfma_f32_16x16x32_bf16 v[180:183], a[164:167], v[88:91], v[180:183]
    buffer_load_dwordx4 v[44:47], v6, s[48:51], s84 offen sc1
    s_add_u32 s57, s57, 145408
    v_mfma_f32_16x16x32_bf16 v[180:183], a[148:151], v[72:75], v[180:183]
    buffer_load_dwordx4 v[48:51], v7, s[48:51], s84 offen sc1
    v_add_u32 v10, s57, v10
    v_mfma_f32_16x16x32_bf16 v[196:199], a[152:155], v[72:75], v[196:199]
    s_add_u32 s84, s80, 32768
    s_add_u32 s84, s84, s78
    v_lshl_add_u32 v25, v11, 7, v10
    v_mfma_f32_16x16x32_bf16 v[196:199], a[168:171], v[88:91], v[196:199]
    buffer_load_dwordx4 v[52:55], v4, s[48:51], s84 offen sc1
    v_lshl_add_u32 v26, v12, 7, v10
    v_mfma_f32_16x16x32_bf16 v[212:215], a[172:175], v[88:91], v[212:215]
    buffer_load_dwordx4 v[56:59], v5, s[48:51], s84 offen sc1
    v_add_u32 v27, s91, v1
    v_mfma_f32_16x16x32_bf16 v[212:215], a[156:159], v[72:75], v[212:215]
    buffer_load_dwordx4 v[60:63], v6, s[48:51], s84 offen sc1
    s_xor_b32 s57, s3, 0
    v_mfma_f32_16x16x32_bf16 v[228:231], a[176:179], v[72:75], v[228:231]
    buffer_load_dwordx4 v[64:67], v7, s[48:51], s84 offen sc1
    s_mul_i32 s57, s57, 16640
    v_mfma_f32_16x16x32_bf16 v[244:247], a[176:179], v[88:91], v[244:247]
    s_add_u32 s57, s57, 65536
    v_add_u32 v32, s57, v1
    s_xor_b32 s57, s3, 1
    v_mfma_f32_16x16x32_bf16 v[168:171], a[144:147], v[76:79], v[168:171]
    s_mul_i32 s57, s57, 16640
    s_add_u32 s57, s57, 65536
    v_add_u32 v33, s57, v1
    v_mfma_f32_16x16x32_bf16 v[168:171], a[160:163], v[92:95], v[168:171]
    s_xor_b32 s57, s3, 2
    s_mul_i32 s57, s57, 16640
    s_add_u32 s57, s57, 65536
    v_mfma_f32_16x16x32_bf16 v[184:187], a[164:167], v[92:95], v[184:187]
    v_add_u32 v34, s57, v1
    s_xor_b32 s57, s3, 3
    s_mul_i32 s57, s57, 16640
    v_mfma_f32_16x16x32_bf16 v[184:187], a[148:151], v[76:79], v[184:187]
    s_add_u32 s57, s57, 65536
    v_add_u32 v35, s57, v1
    s_mov_b32 s16, -1
    v_mfma_f32_16x16x32_bf16 v[200:203], a[152:155], v[76:79], v[200:203]
    s_mov_b32 s17, 0
    s_lshl_b32 s57, s3, 8
    s_add_u32 s57, s57, 153600
    v_mfma_f32_16x16x32_bf16 v[200:203], a[168:171], v[92:95], v[200:203]
    v_add_u32 v11, s57, v1
    v_lshlrev_b32 v12, 5, v0
    v_mfma_f32_16x16x32_bf16 v[216:219], a[172:175], v[92:95], v[216:219]
    v_and_b32 v12, 1024, v12
    v_sub_u32 v12, 512, v12
    v_mfma_f32_16x16x32_bf16 v[216:219], a[156:159], v[76:79], v[216:219]
    v_add_u32 v13, s87, v1
    v_mfma_f32_16x16x32_bf16 v[232:235], a[176:179], v[76:79], v[232:235]
    v_mfma_f32_16x16x32_bf16 v[248:251], a[176:179], v[92:95], v[248:251]
    v_mfma_f32_16x16x32_bf16 v[172:175], a[144:147], v[80:83], v[172:175]
    v_mfma_f32_16x16x32_bf16 v[172:175], a[160:163], v[96:99], v[172:175]
    v_mfma_f32_16x16x32_bf16 v[188:191], a[164:167], v[96:99], v[188:191]
    v_mfma_f32_16x16x32_bf16 v[188:191], a[148:151], v[80:83], v[188:191]
    v_mfma_f32_16x16x32_bf16 v[204:207], a[152:155], v[80:83], v[204:207]
    v_mfma_f32_16x16x32_bf16 v[204:207], a[168:171], v[96:99], v[204:207]
    v_mfma_f32_16x16x32_bf16 v[220:223], a[172:175], v[96:99], v[220:223]
    v_mfma_f32_16x16x32_bf16 v[220:223], a[156:159], v[80:83], v[220:223]
    v_mfma_f32_16x16x32_bf16 v[236:239], a[176:179], v[80:83], v[236:239]
    v_mfma_f32_16x16x32_bf16 v[252:255], a[176:179], v[96:99], v[252:255]
    v_mfma_f32_16x16x32_bf16 v[160:163], a[144:147], v[68:71], v[160:163]
    v_mfma_f32_16x16x32_bf16 v[160:163], a[160:163], v[84:87], v[160:163]
    v_mfma_f32_16x16x32_bf16 v[176:179], a[164:167], v[84:87], v[176:179]
    v_mfma_f32_16x16x32_bf16 v[176:179], a[148:151], v[68:71], v[176:179]
    v_mfma_f32_16x16x32_bf16 v[192:195], a[152:155], v[68:71], v[192:195]
    v_mfma_f32_16x16x32_bf16 v[192:195], a[168:171], v[84:87], v[192:195]
    v_mfma_f32_16x16x32_bf16 v[208:211], a[172:175], v[84:87], v[208:211]
    v_mfma_f32_16x16x32_bf16 v[208:211], a[156:159], v[68:71], v[208:211]
    v_mfma_f32_16x16x32_bf16 v[224:227], a[176:179], v[68:71], v[224:227]
    v_mfma_f32_16x16x32_bf16 v[240:243], a[176:179], v[84:87], v[240:243]
    s_add_u32 s84, s80, 36864
    s_add_u32 s84, s84, s78
    v_mfma_f32_16x16x32_bf16 v[164:167], a[0:3], v[104:107], v[164:167]
    buffer_load_dwordx4 v[68:71], v4, s[48:51], s84 offen sc1
    v_mfma_f32_16x16x32_bf16 v[164:167], a[16:19], v[120:123], v[164:167]
    buffer_load_dwordx4 v[72:75], v5, s[48:51], s84 offen sc1
    v_mfma_f32_16x16x32_bf16 v[180:183], a[20:23], v[120:123], v[180:183]
    buffer_load_dwordx4 v[76:79], v6, s[48:51], s84 offen sc1
    v_mfma_f32_16x16x32_bf16 v[180:183], a[4:7], v[104:107], v[180:183]
    buffer_load_dwordx4 v[80:83], v7, s[48:51], s84 offen sc1
    v_mfma_f32_16x16x32_bf16 v[196:199], a[8:11], v[104:107], v[196:199]
    s_add_u32 s84, s80, 40960
    s_sub_u32 s84, s84, s78
    v_mfma_f32_16x16x32_bf16 v[196:199], a[24:27], v[120:123], v[196:199]
    buffer_load_dwordx4 v[84:87], v4, s[48:51], s84 offen sc1
    v_mfma_f32_16x16x32_bf16 v[212:215], a[28:31], v[120:123], v[212:215]
    buffer_load_dwordx4 v[88:91], v5, s[48:51], s84 offen sc1
    v_mfma_f32_16x16x32_bf16 v[212:215], a[12:15], v[104:107], v[212:215]
    buffer_load_dwordx4 v[92:95], v6, s[48:51], s84 offen sc1
    v_mfma_f32_16x16x32_bf16 v[228:231], a[32:35], v[104:107], v[228:231]
    buffer_load_dwordx4 v[96:99], v7, s[48:51], s84 offen sc1
    v_mfma_f32_16x16x32_bf16 v[244:247], a[32:35], v[120:123], v[244:247]
    v_mfma_f32_16x16x32_bf16 v[168:171], a[0:3], v[108:111], v[168:171]
    v_mfma_f32_16x16x32_bf16 v[168:171], a[16:19], v[124:127], v[168:171]
    v_mfma_f32_16x16x32_bf16 v[184:187], a[20:23], v[124:127], v[184:187]
    v_mfma_f32_16x16x32_bf16 v[184:187], a[4:7], v[108:111], v[184:187]
    v_mfma_f32_16x16x32_bf16 v[200:203], a[8:11], v[108:111], v[200:203]
    v_mfma_f32_16x16x32_bf16 v[200:203], a[24:27], v[124:127], v[200:203]
    v_mfma_f32_16x16x32_bf16 v[216:219], a[28:31], v[124:127], v[216:219]
    v_mfma_f32_16x16x32_bf16 v[216:219], a[12:15], v[108:111], v[216:219]
    v_mfma_f32_16x16x32_bf16 v[232:235], a[32:35], v[108:111], v[232:235]
    v_mfma_f32_16x16x32_bf16 v[248:251], a[32:35], v[124:127], v[248:251]
    v_mfma_f32_16x16x32_bf16 v[172:175], a[0:3], v[112:115], v[172:175]
    v_mfma_f32_16x16x32_bf16 v[172:175], a[16:19], v[128:131], v[172:175]
    v_mfma_f32_16x16x32_bf16 v[188:191], a[20:23], v[128:131], v[188:191]
    v_mfma_f32_16x16x32_bf16 v[188:191], a[4:7], v[112:115], v[188:191]
    v_mfma_f32_16x16x32_bf16 v[204:207], a[8:11], v[112:115], v[204:207]
    v_mfma_f32_16x16x32_bf16 v[204:207], a[24:27], v[128:131], v[204:207]
    v_mfma_f32_16x16x32_bf16 v[220:223], a[28:31], v[128:131], v[220:223]
    v_mfma_f32_16x16x32_bf16 v[220:223], a[12:15], v[112:115], v[220:223]
    v_mfma_f32_16x16x32_bf16 v[236:239], a[32:35], v[112:115], v[236:239]
    v_mfma_f32_16x16x32_bf16 v[252:255], a[32:35], v[128:131], v[252:255]
    v_mfma_f32_16x16x32_bf16 v[160:163], a[0:3], v[100:103], v[160:163]
    v_mfma_f32_16x16x32_bf16 v[160:163], a[16:19], v[116:119], v[160:163]
    v_mfma_f32_16x16x32_bf16 v[176:179], a[20:23], v[116:119], v[176:179]
    v_mfma_f32_16x16x32_bf16 v[176:179], a[4:7], v[100:103], v[176:179]
    v_mfma_f32_16x16x32_bf16 v[192:195], a[8:11], v[100:103], v[192:195]
    v_mfma_f32_16x16x32_bf16 v[192:195], a[24:27], v[116:119], v[192:195]
    v_mfma_f32_16x16x32_bf16 v[208:211], a[28:31], v[116:119], v[208:211]
    v_mfma_f32_16x16x32_bf16 v[208:211], a[12:15], v[100:103], v[208:211]
    v_mfma_f32_16x16x32_bf16 v[224:227], a[32:35], v[100:103], v[224:227]
    v_mfma_f32_16x16x32_bf16 v[240:243], a[32:35], v[116:119], v[240:243]
    s_waitcnt vmcnt(17)
    s_waitcnt vmcnt(12)
    s_add_u32 s84, s80, 45056
    v_mfma_f32_16x16x32_bf16 v[164:167], a[36:39], v[136:139], v[164:167]
    s_sub_u32 s84, s84, s78
    v_mfma_f32_16x16x32_bf16 v[164:167], a[52:55], v[40:43], v[164:167]
    buffer_load_dwordx4 v[100:103], v4, s[48:51], s84 offen sc1
    v_mfma_f32_16x16x32_bf16 v[180:183], a[56:59], v[40:43], v[180:183]
    buffer_load_dwordx4 v[104:107], v5, s[48:51], s84 offen sc1
    v_mfma_f32_16x16x32_bf16 v[180:183], a[40:43], v[136:139], v[180:183]
    buffer_load_dwordx4 v[108:111], v6, s[48:51], s84 offen sc1
    v_mfma_f32_16x16x32_bf16 v[196:199], a[44:47], v[136:139], v[196:199]
    buffer_load_dwordx4 v[112:115], v7, s[48:51], s84 offen sc1
    v_add_u32 v30, s66, v1
    v_mfma_f32_16x16x32_bf16 v[196:199], a[60:63], v[40:43], v[196:199]
    s_add_u32 s84, s80, 49152
    s_add_u32 s84, s84, s78
    s_nop 0
    v_mfma_f32_16x16x32_bf16 v[212:215], a[64:67], v[40:43], v[212:215]
    buffer_load_dwordx4 v[116:119], v4, s[48:51], s84 offen sc1
    v_mfma_f32_16x16x32_bf16 v[212:215], a[48:51], v[136:139], v[212:215]
    buffer_load_dwordx4 v[120:123], v5, s[48:51], s84 offen sc1
    v_mfma_f32_16x16x32_bf16 v[228:231], a[68:71], v[136:139], v[228:231]
    buffer_load_dwordx4 v[124:127], v6, s[48:51], s84 offen sc1
    v_mfma_f32_16x16x32_bf16 v[244:247], a[68:71], v[40:43], v[244:247]
    buffer_load_dwordx4 v[128:131], v7, s[48:51], s84 offen sc1
    v_mfma_f32_16x16x32_bf16 v[168:171], a[36:39], v[140:143], v[168:171]
    ds_read_b128 a[108:111], v30 offset:0
    v_mfma_f32_16x16x32_bf16 v[168:171], a[52:55], v[44:47], v[168:171]
    ds_read_b128 a[112:115], v30 offset:1024
    v_mfma_f32_16x16x32_bf16 v[184:187], a[56:59], v[44:47], v[184:187]
    ds_read_b128 a[116:119], v30 offset:2048
    v_mfma_f32_16x16x32_bf16 v[184:187], a[40:43], v[140:143], v[184:187]
    ds_read_b128 a[120:123], v30 offset:3072
    v_mfma_f32_16x16x32_bf16 v[200:203], a[44:47], v[140:143], v[200:203]
    ds_read_b128 a[124:127], v30 offset:4096
    v_mfma_f32_16x16x32_bf16 v[200:203], a[60:63], v[44:47], v[200:203]
    ds_read_b128 a[128:131], v30 offset:5120
    v_mfma_f32_16x16x32_bf16 v[216:219], a[64:67], v[44:47], v[216:219]
    ds_read_b128 a[132:135], v30 offset:6144
    v_mfma_f32_16x16x32_bf16 v[216:219], a[48:51], v[140:143], v[216:219]
    ds_read_b128 a[136:139], v30 offset:7168
    v_mfma_f32_16x16x32_bf16 v[232:235], a[68:71], v[140:143], v[232:235]
    ds_read_b128 a[140:143], v30 offset:8192
    v_mfma_f32_16x16x32_bf16 v[248:251], a[68:71], v[44:47], v[248:251]
    ds_read_b128 a[144:147], v30 offset:9216
    v_mfma_f32_16x16x32_bf16 v[172:175], a[36:39], v[144:147], v[172:175]
    ds_read_b128 a[148:151], v30 offset:10240
    v_add_u32 v30, s61, v1
    v_mfma_f32_16x16x32_bf16 v[172:175], a[52:55], v[48:51], v[172:175]
    s_nop 0
    ds_read_b128 a[152:155], v30 offset:0
    v_mfma_f32_16x16x32_bf16 v[188:191], a[56:59], v[48:51], v[188:191]
    ds_read_b128 a[156:159], v30 offset:1024
    v_add_u32 v30, s75, v1
    v_mfma_f32_16x16x32_bf16 v[188:191], a[40:43], v[144:147], v[188:191]
    s_nop 0
    ds_read_b128 a[160:163], v30 offset:0
    v_mfma_f32_16x16x32_bf16 v[204:207], a[44:47], v[144:147], v[204:207]
    ds_read_b128 a[164:167], v30 offset:1024
    v_mfma_f32_16x16x32_bf16 v[204:207], a[60:63], v[48:51], v[204:207]
    ds_read_b128 a[168:171], v30 offset:2048
    v_mfma_f32_16x16x32_bf16 v[220:223], a[64:67], v[48:51], v[220:223]
    v_mfma_f32_16x16x32_bf16 v[220:223], a[48:51], v[144:147], v[220:223]
    v_mfma_f32_16x16x32_bf16 v[236:239], a[68:71], v[144:147], v[236:239]
    v_mfma_f32_16x16x32_bf16 v[252:255], a[68:71], v[48:51], v[252:255]
    v_mfma_f32_16x16x32_bf16 v[160:163], a[36:39], v[132:135], v[160:163]
    v_mfma_f32_16x16x32_bf16 v[160:163], a[52:55], v[36:39], v[160:163]
    s_waitcnt lgkmcnt(0)
    v_mfma_f32_16x16x32_bf16 v[176:179], a[56:59], v[36:39], v[176:179]
    v_mfma_f32_16x16x32_bf16 v[176:179], a[40:43], v[132:135], v[176:179]
    v_mfma_f32_16x16x32_bf16 v[192:195], a[44:47], v[132:135], v[192:195]
    v_mfma_f32_16x16x32_bf16 v[192:195], a[60:63], v[36:39], v[192:195]
    v_mfma_f32_16x16x32_bf16 v[208:211], a[64:67], v[36:39], v[208:211]
    v_mfma_f32_16x16x32_bf16 v[208:211], a[48:51], v[132:135], v[208:211]
    v_mfma_f32_16x16x32_bf16 v[224:227], a[68:71], v[132:135], v[224:227]
    v_mfma_f32_16x16x32_bf16 v[240:243], a[68:71], v[36:39], v[240:243]
    s_waitcnt vmcnt(16)
    s_cmp_lg_u32 s76, 0
    s_cbranch_scc1 KM_swc8b
    s_bitcmp1_b32 s3, 0
    s_cbranch_scc1 KM_swc8a
    v_swap_b32 v54, v56
    v_swap_b32 v55, v57
    v_swap_b32 v62, v64
    v_swap_b32 v63, v65
    s_branch KM_swc8b
KM_swc8a:
    v_swap_b32 v52, v58
    v_swap_b32 v53, v59
    v_swap_b32 v60, v66
    v_swap_b32 v61, v67
KM_swc8b:
    s_nop 1
    s_waitcnt vmcnt(12)
    v_mfma_f32_16x16x32_bf16 v[164:167], a[180:183], v[56:59], v[164:167]
    s_add_u32 s84, s80, 53248
    s_add_u32 s84, s84, s78
    v_mfma_f32_16x16x32_bf16 v[164:167], a[196:199], v[72:75], v[164:167]
    buffer_load_dwordx4 v[132:135], v4, s[48:51], s84 offen sc1
    v_mfma_f32_16x16x32_bf16 v[180:183], a[200:203], v[72:75], v[180:183]
    buffer_load_dwordx4 v[136:139], v5, s[48:51], s84 offen sc1
    v_mfma_f32_16x16x32_bf16 v[180:183], a[184:187], v[56:59], v[180:183]
    buffer_load_dwordx4 v[140:143], v6, s[48:51], s84 offen sc1
    v_mfma_f32_16x16x32_bf16 v[196:199], a[188:191], v[56:59], v[196:199]
    buffer_load_dwordx4 v[144:147], v7, s[48:51], s84 offen sc1
    v_mfma_f32_16x16x32_bf16 v[196:199], a[204:207], v[72:75], v[196:199]
    s_add_u32 s65, s81, 73728
    v_mfma_f32_16x16x32_bf16 v[212:215], a[208:211], v[72:75], v[212:215]
    buffer_load_dwordx4 a[176:179], v3, s[48:51], s65 offen offset:0 sc1
    v_mfma_f32_16x16x32_bf16 v[212:215], a[192:195], v[56:59], v[212:215]
    buffer_load_dwordx4 a[172:175], v2, s[48:51], s65 offen offset:3072 sc1
    v_mfma_f32_16x16x32_bf16 v[228:231], a[212:215], v[56:59], v[228:231]
    s_add_u32 s84, s80, 57344
    s_sub_u32 s84, s84, s78
    v_mfma_f32_16x16x32_bf16 v[244:247], a[212:215], v[72:75], v[244:247]
    buffer_load_dwordx4 v[36:39], v4, s[48:51], s84 offen sc1
    v_mfma_f32_16x16x32_bf16 v[168:171], a[180:183], v[60:63], v[168:171]
    buffer_load_dwordx4 v[40:43], v5, s[48:51], s84 offen sc1
    v_mfma_f32_16x16x32_bf16 v[168:171], a[196:199], v[76:79], v[168:171]
    buffer_load_dwordx4 v[44:47], v6, s[48:51], s84 offen sc1
    v_mfma_f32_16x16x32_bf16 v[184:187], a[200:203], v[76:79], v[184:187]
    buffer_load_dwordx4 v[48:51], v7, s[48:51], s84 offen sc1
    v_mfma_f32_16x16x32_bf16 v[184:187], a[184:187], v[60:63], v[184:187]
    v_mfma_f32_16x16x32_bf16 v[200:203], a[188:191], v[60:63], v[200:203]
    v_mfma_f32_16x16x32_bf16 v[200:203], a[204:207], v[76:79], v[200:203]
    v_mfma_f32_16x16x32_bf16 v[216:219], a[208:211], v[76:79], v[216:219]
    v_mfma_f32_16x16x32_bf16 v[216:219], a[192:195], v[60:63], v[216:219]
    v_mfma_f32_16x16x32_bf16 v[232:235], a[212:215], v[60:63], v[232:235]
    v_mfma_f32_16x16x32_bf16 v[248:251], a[212:215], v[76:79], v[248:251]
    v_mfma_f32_16x16x32_bf16 v[172:175], a[180:183], v[64:67], v[172:175]
    v_mfma_f32_16x16x32_bf16 v[172:175], a[196:199], v[80:83], v[172:175]
    v_mfma_f32_16x16x32_bf16 v[188:191], a[200:203], v[80:83], v[188:191]
    v_mfma_f32_16x16x32_bf16 v[188:191], a[184:187], v[64:67], v[188:191]
    v_mfma_f32_16x16x32_bf16 v[204:207], a[188:191], v[64:67], v[204:207]
    v_mfma_f32_16x16x32_bf16 v[204:207], a[204:207], v[80:83], v[204:207]
    v_mfma_f32_16x16x32_bf16 v[220:223], a[208:211], v[80:83], v[220:223]
    v_mfma_f32_16x16x32_bf16 v[220:223], a[192:195], v[64:67], v[220:223]
    v_mfma_f32_16x16x32_bf16 v[236:239], a[212:215], v[64:67], v[236:239]
    v_mfma_f32_16x16x32_bf16 v[252:255], a[212:215], v[80:83], v[252:255]
    v_mfma_f32_16x16x32_bf16 v[160:163], a[180:183], v[52:55], v[160:163]
    v_mfma_f32_16x16x32_bf16 v[160:163], a[196:199], v[68:71], v[160:163]
    v_mfma_f32_16x16x32_bf16 v[176:179], a[200:203], v[68:71], v[176:179]
    v_mfma_f32_16x16x32_bf16 v[176:179], a[184:187], v[52:55], v[176:179]
    v_mfma_f32_16x16x32_bf16 v[192:195], a[188:191], v[52:55], v[192:195]
    v_mfma_f32_16x16x32_bf16 v[192:195], a[204:207], v[68:71], v[192:195]
    v_mfma_f32_16x16x32_bf16 v[208:211], a[208:211], v[68:71], v[208:211]
    v_mfma_f32_16x16x32_bf16 v[208:211], a[192:195], v[52:55], v[208:211]
    v_mfma_f32_16x16x32_bf16 v[224:227], a[212:215], v[52:55], v[224:227]
    v_mfma_f32_16x16x32_bf16 v[240:243], a[212:215], v[68:71], v[240:243]
    s_waitcnt vmcnt(18)
    s_cmp_lg_u32 s76, 1
    s_cbranch_scc1 KM_swc10b
    s_bitcmp1_b32 s3, 0
    s_cbranch_scc1 KM_swc10a
    v_swap_b32 v86, v88
    v_swap_b32 v87, v89
    v_swap_b32 v94, v96
    v_swap_b32 v95, v97
    s_branch KM_swc10b
KM_swc10a:
    v_swap_b32 v84, v90
    v_swap_b32 v85, v91
    v_swap_b32 v92, v98
    v_swap_b32 v93, v99
KM_swc10b:
    s_nop 1
    s_waitcnt vmcnt(14)
    s_add_u32 m0, s87, 0
    s_nop 0
    buffer_load_dwordx4 v16, s[36:39], s85 offen lds
    s_add_u32 m0, s87, 1024
    s_nop 0
    buffer_load_dwordx4 v17, s[36:39], s85 offen lds
    s_add_u32 m0, s87, 2048
    s_nop 0
    buffer_load_dwordx4 v18, s[36:39], s85 offen lds
    buffer_load_dwordx2 v[28:29], v19, s[48:51], s86 offen sc1
    v_mfma_f32_16x16x32_bf16 v[164:167], a[216:219], v[88:91], v[164:167]
    s_add_u32 s84, s80, 61440
    s_sub_u32 s84, s84, s78
    v_mfma_f32_16x16x32_bf16 v[164:167], a[232:235], v[104:107], v[164:167]
    buffer_load_dwordx4 v[52:55], v4, s[48:51], s84 offen sc1
    v_mfma_f32_16x16x32_bf16 v[180:183], a[236:239], v[104:107], v[180:183]
    buffer_load_dwordx4 v[56:59], v5, s[48:51], s84 offen sc1
    v_mfma_f32_16x16x32_bf16 v[180:183], a[220:223], v[88:91], v[180:183]
    buffer_load_dwordx4 v[60:63], v6, s[48:51], s84 offen sc1
    v_mfma_f32_16x16x32_bf16 v[196:199], a[224:227], v[88:91], v[196:199]
    buffer_load_dwordx4 v[64:67], v7, s[48:51], s84 offen sc1
    v_mfma_f32_16x16x32_bf16 v[196:199], a[240:243], v[104:107], v[196:199]
    s_add_u32 s84, s80, 65536
    v_mfma_f32_16x16x32_bf16 v[212:215], a[244:247], v[104:107], v[212:215]
    buffer_load_dwordx4 v[68:71], v4, s[48:51], s84 offen sc1
    v_mfma_f32_16x16x32_bf16 v[212:215], a[228:231], v[88:91], v[212:215]
    buffer_load_dwordx4 v[72:75], v5, s[48:51], s84 offen sc1
    v_mfma_f32_16x16x32_bf16 v[228:231], a[248:251], v[88:91], v[228:231]
    buffer_load_dwordx4 v[76:79], v6, s[48:51], s84 offen sc1
    v_mfma_f32_16x16x32_bf16 v[244:247], a[248:251], v[104:107], v[244:247]
    buffer_load_dwordx4 v[80:83], v7, s[48:51], s84 offen sc1
    v_mfma_f32_16x16x32_bf16 v[168:171], a[216:219], v[92:95], v[168:171]
    v_mfma_f32_16x16x32_bf16 v[168:171], a[232:235], v[108:111], v[168:171]
    v_mfma_f32_16x16x32_bf16 v[184:187], a[236:239], v[108:111], v[184:187]
    v_mfma_f32_16x16x32_bf16 v[184:187], a[220:223], v[92:95], v[184:187]
    v_mfma_f32_16x16x32_bf16 v[200:203], a[224:227], v[92:95], v[200:203]
    v_mfma_f32_16x16x32_bf16 v[200:203], a[240:243], v[108:111], v[200:203]
    v_mfma_f32_16x16x32_bf16 v[216:219], a[244:247], v[108:111], v[216:219]
    v_mfma_f32_16x16x32_bf16 v[216:219], a[228:231], v[92:95], v[216:219]
    v_mfma_f32_16x16x32_bf16 v[232:235], a[248:251], v[92:95], v[232:235]
    v_mfma_f32_16x16x32_bf16 v[248:251], a[248:251], v[108:111], v[248:251]
    v_mfma_f32_16x16x32_bf16 v[172:175], a[216:219], v[96:99], v[172:175]
    v_mfma_f32_16x16x32_bf16 v[172:175], a[232:235], v[112:115], v[172:175]
    v_mfma_f32_16x16x32_bf16 v[188:191], a[236:239], v[112:115], v[188:191]
    v_mfma_f32_16x16x32_bf16 v[188:191], a[220:223], v[96:99], v[188:191]
    v_mfma_f32_16x16x32_bf16 v[204:207], a[224:227], v[96:99], v[204:207]
    v_mfma_f32_16x16x32_bf16 v[204:207], a[240:243], v[112:115], v[204:207]
    v_mfma_f32_16x16x32_bf16 v[220:223], a[244:247], v[112:115], v[220:223]
    v_mfma_f32_16x16x32_bf16 v[220:223], a[228:231], v[96:99], v[220:223]
    v_mfma_f32_16x16x32_bf16 v[236:239], a[248:251], v[96:99], v[236:239]
    v_mfma_f32_16x16x32_bf16 v[252:255], a[248:251], v[112:115], v[252:255]
    v_mfma_f32_16x16x32_bf16 v[160:163], a[216:219], v[84:87], v[160:163]
    v_mfma_f32_16x16x32_bf16 v[160:163], a[232:235], v[100:103], v[160:163]
    v_mfma_f32_16x16x32_bf16 v[176:179], a[236:239], v[100:103], v[176:179]
    v_mfma_f32_16x16x32_bf16 v[176:179], a[220:223], v[84:87], v[176:179]
    v_mfma_f32_16x16x32_bf16 v[192:195], a[224:227], v[84:87], v[192:195]
    v_mfma_f32_16x16x32_bf16 v[192:195], a[240:243], v[100:103], v[192:195]
    v_mfma_f32_16x16x32_bf16 v[208:211], a[244:247], v[100:103], v[208:211]
    v_mfma_f32_16x16x32_bf16 v[208:211], a[228:231], v[84:87], v[208:211]
    v_mfma_f32_16x16x32_bf16 v[224:227], a[248:251], v[84:87], v[224:227]
    v_mfma_f32_16x16x32_bf16 v[240:243], a[248:251], v[100:103], v[240:243]
    s_waitcnt vmcnt(22)
    s_waitcnt vmcnt(18)
    s_add_u32 s84, s80, 69632
    v_mfma_f32_16x16x32_bf16 v[164:167], a[72:75], v[120:123], v[164:167]
    buffer_load_dwordx4 v[84:87], v4, s[48:51], s84 offen sc1
    v_mfma_f32_16x16x32_bf16 v[164:167], a[88:91], v[136:139], v[164:167]
    buffer_load_dwordx4 v[88:91], v5, s[48:51], s84 offen sc1
    v_mfma_f32_16x16x32_bf16 v[180:183], a[92:95], v[136:139], v[180:183]
    buffer_load_dwordx4 v[92:95], v6, s[48:51], s84 offen sc1
    v_mfma_f32_16x16x32_bf16 v[180:183], a[76:79], v[120:123], v[180:183]
    buffer_load_dwordx4 v[96:99], v7, s[48:51], s84 offen sc1
    v_mfma_f32_16x16x32_bf16 v[196:199], a[80:83], v[120:123], v[196:199]
    v_mfma_f32_16x16x32_bf16 v[196:199], a[96:99], v[136:139], v[196:199]
    v_mfma_f32_16x16x32_bf16 v[212:215], a[100:103], v[136:139], v[212:215]
    v_mfma_f32_16x16x32_bf16 v[212:215], a[84:87], v[120:123], v[212:215]
    v_mfma_f32_16x16x32_bf16 v[228:231], a[104:107], v[120:123], v[228:231]
    v_mfma_f32_16x16x32_bf16 v[244:247], a[104:107], v[136:139], v[244:247]
    v_mfma_f32_16x16x32_bf16 v[168:171], a[72:75], v[124:127], v[168:171]
    v_mfma_f32_16x16x32_bf16 v[168:171], a[88:91], v[140:143], v[168:171]
    v_mfma_f32_16x16x32_bf16 v[184:187], a[92:95], v[140:143], v[184:187]
    v_mfma_f32_16x16x32_bf16 v[184:187], a[76:79], v[124:127], v[184:187]
    v_mfma_f32_16x16x32_bf16 v[200:203], a[80:83], v[124:127], v[200:203]
    v_mfma_f32_16x16x32_bf16 v[200:203], a[96:99], v[140:143], v[200:203]
    v_mfma_f32_16x16x32_bf16 v[216:219], a[100:103], v[140:143], v[216:219]
    v_mfma_f32_16x16x32_bf16 v[216:219], a[84:87], v[124:127], v[216:219]
    v_mfma_f32_16x16x32_bf16 v[232:235], a[104:107], v[124:127], v[232:235]
    v_mfma_f32_16x16x32_bf16 v[248:251], a[104:107], v[140:143], v[248:251]
    v_mfma_f32_16x16x32_bf16 v[172:175], a[72:75], v[128:131], v[172:175]
    v_mfma_f32_16x16x32_bf16 v[172:175], a[88:91], v[144:147], v[172:175]
    v_mfma_f32_16x16x32_bf16 v[188:191], a[92:95], v[144:147], v[188:191]
    v_mfma_f32_16x16x32_bf16 v[188:191], a[76:79], v[128:131], v[188:191]
    v_mfma_f32_16x16x32_bf16 v[204:207], a[80:83], v[128:131], v[204:207]
    v_mfma_f32_16x16x32_bf16 v[204:207], a[96:99], v[144:147], v[204:207]
    v_mfma_f32_16x16x32_bf16 v[220:223], a[100:103], v[144:147], v[220:223]
    v_mfma_f32_16x16x32_bf16 v[220:223], a[84:87], v[128:131], v[220:223]
    v_mfma_f32_16x16x32_bf16 v[236:239], a[104:107], v[128:131], v[236:239]
    v_mfma_f32_16x16x32_bf16 v[252:255], a[104:107], v[144:147], v[252:255]
    v_mfma_f32_16x16x32_bf16 v[160:163], a[72:75], v[116:119], v[160:163]
    v_mfma_f32_16x16x32_bf16 v[160:163], a[88:91], v[132:135], v[160:163]
    v_mfma_f32_16x16x32_bf16 v[176:179], a[92:95], v[132:135], v[176:179]
    v_mfma_f32_16x16x32_bf16 v[176:179], a[76:79], v[116:119], v[176:179]
    v_mfma_f32_16x16x32_bf16 v[192:195], a[80:83], v[116:119], v[192:195]
    v_mfma_f32_16x16x32_bf16 v[192:195], a[96:99], v[132:135], v[192:195]
    v_mfma_f32_16x16x32_bf16 v[208:211], a[100:103], v[132:135], v[208:211]
    v_mfma_f32_16x16x32_bf16 v[208:211], a[84:87], v[116:119], v[208:211]
    v_mfma_f32_16x16x32_bf16 v[224:227], a[104:107], v[116:119], v[224:227]
    v_mfma_f32_16x16x32_bf16 v[240:243], a[104:107], v[132:135], v[240:243]
    s_waitcnt vmcnt(16)
    s_waitcnt vmcnt(8)
    buffer_load_dwordx2 v[30:31], v22, s[48:51], s88 offen sc1
    v_mfma_f32_16x16x32_bf16 v[164:167], a[108:111], v[40:43], v[164:167]
    ds_read_b128 v[138:141], v20
    ds_read_b128 v[142:145], v20 offset:64
    ds_read_b64 v[146:147], v21 offset:128
    v_mfma_f32_16x16x32_bf16 v[164:167], a[124:127], v[56:59], v[164:167]
    v_mul_f32 v28, v28, v29
    v_mfma_f32_16x16x32_bf16 v[180:183], a[128:131], v[56:59], v[180:183]
    v_mfma_f32_16x16x32_bf16 v[180:183], a[112:115], v[40:43], v[180:183]
    v_mfma_f32_16x16x32_bf16 v[196:199], a[116:119], v[40:43], v[196:199]
    v_mfma_f32_16x16x32_bf16 v[196:199], a[132:135], v[56:59], v[196:199]
    v_mfma_f32_16x16x32_bf16 v[212:215], a[136:139], v[56:59], v[212:215]
    v_mfma_f32_16x16x32_bf16 v[212:215], a[120:123], v[40:43], v[212:215]
    s_waitcnt lgkmcnt(0)
    v_lshlrev_b32 v100, 16, v138
    v_and_b32 v101, 0xffff0000, v138
    v_mfma_f32_16x16x32_bf16 v[228:231], a[140:143], v[40:43], v[228:231]
    v_lshlrev_b32 v102, 16, v139
    v_and_b32 v103, 0xffff0000, v139
    v_mfma_f32_16x16x32_bf16 v[244:247], a[140:143], v[56:59], v[244:247]
    v_lshlrev_b32 v104, 16, v140
    v_and_b32 v105, 0xffff0000, v140
    v_mfma_f32_16x16x32_bf16 v[168:171], a[108:111], v[44:47], v[168:171]
    v_lshlrev_b32 v106, 16, v141
    v_and_b32 v107, 0xffff0000, v141
    v_mfma_f32_16x16x32_bf16 v[168:171], a[124:127], v[60:63], v[168:171]
    v_lshlrev_b32 v108, 16, v142
    v_and_b32 v109, 0xffff0000, v142
    v_mfma_f32_16x16x32_bf16 v[184:187], a[128:131], v[60:63], v[184:187]
    v_lshlrev_b32 v110, 16, v143
    v_and_b32 v111, 0xffff0000, v143
    v_mfma_f32_16x16x32_bf16 v[184:187], a[112:115], v[44:47], v[184:187]
    v_lshlrev_b32 v112, 16, v144
    v_and_b32 v113, 0xffff0000, v144
    v_mfma_f32_16x16x32_bf16 v[200:203], a[116:119], v[44:47], v[200:203]
    v_lshlrev_b32 v114, 16, v145
    v_and_b32 v115, 0xffff0000, v145
    v_mfma_f32_16x16x32_bf16 v[200:203], a[132:135], v[60:63], v[200:203]
    v_lshlrev_b32 v116, 16, v146
    v_and_b32 v117, 0xffff0000, v146
    v_mfma_f32_16x16x32_bf16 v[216:219], a[136:139], v[60:63], v[216:219]
    v_lshlrev_b32 v118, 16, v147
    v_and_b32 v119, 0xffff0000, v147
    v_mfma_f32_16x16x32_bf16 v[216:219], a[120:123], v[44:47], v[216:219]
    v_fma_f32 v120, v100, v29, -v28
    v_fma_f32 v121, v101, v29, -v28
    v_mfma_f32_16x16x32_bf16 v[232:235], a[140:143], v[44:47], v[232:235]
    v_fma_f32 v122, v102, v29, -v28
    v_fma_f32 v123, v103, v29, -v28
    v_mfma_f32_16x16x32_bf16 v[248:251], a[140:143], v[60:63], v[248:251]
    v_fma_f32 v124, v104, v29, -v28
    v_fma_f32 v125, v105, v29, -v28
    v_mfma_f32_16x16x32_bf16 v[172:175], a[108:111], v[48:51], v[172:175]
    v_fma_f32 v126, v106, v29, -v28
    v_fma_f32 v127, v107, v29, -v28
    v_mfma_f32_16x16x32_bf16 v[172:175], a[124:127], v[64:67], v[172:175]
    v_fma_f32 v128, v108, v29, -v28
    v_fma_f32 v129, v109, v29, -v28
    v_mfma_f32_16x16x32_bf16 v[188:191], a[128:131], v[64:67], v[188:191]
    v_fma_f32 v130, v110, v29, -v28
    v_fma_f32 v131, v111, v29, -v28
    v_mfma_f32_16x16x32_bf16 v[188:191], a[112:115], v[48:51], v[188:191]
    v_fma_f32 v132, v112, v29, -v28
    v_fma_f32 v133, v113, v29, -v28
    v_mfma_f32_16x16x32_bf16 v[204:207], a[116:119], v[48:51], v[204:207]
    v_fma_f32 v134, v114, v29, -v28
    v_fma_f32 v135, v115, v29, -v28
    v_mfma_f32_16x16x32_bf16 v[204:207], a[132:135], v[64:67], v[204:207]
    v_fma_f32 v136, v116, v29, -v28
    v_fma_f32 v137, v117, v29, -v28
    v_mfma_f32_16x16x32_bf16 v[220:223], a[136:139], v[64:67], v[220:223]
    v_fma_f32 v138, v118, v29, -v28
    v_fma_f32 v139, v119, v29, -v28
    v_mfma_f32_16x16x32_bf16 v[220:223], a[120:123], v[48:51], v[220:223]
    v_mfma_f32_16x16x32_bf16 v[236:239], a[140:143], v[48:51], v[236:239]
    v_mfma_f32_16x16x32_bf16 v[252:255], a[140:143], v[64:67], v[252:255]
    v_mfma_f32_16x16x32_bf16 v[160:163], a[108:111], v[36:39], v[160:163]
    v_mfma_f32_16x16x32_bf16 v[160:163], a[124:127], v[52:55], v[160:163]
    v_mfma_f32_16x16x32_bf16 v[176:179], a[128:131], v[52:55], v[176:179]
    v_mfma_f32_16x16x32_bf16 v[176:179], a[112:115], v[36:39], v[176:179]
    v_mfma_f32_16x16x32_bf16 v[192:195], a[116:119], v[36:39], v[192:195]
    v_mfma_f32_16x16x32_bf16 v[192:195], a[132:135], v[52:55], v[192:195]
    v_mfma_f32_16x16x32_bf16 v[208:211], a[136:139], v[52:55], v[208:211]
    v_mfma_f32_16x16x32_bf16 v[208:211], a[120:123], v[36:39], v[208:211]
    v_mfma_f32_16x16x32_bf16 v[224:227], a[140:143], v[36:39], v[224:227]
    v_mfma_f32_16x16x32_bf16 v[240:243], a[140:143], v[52:55], v[240:243]
    s_waitcnt vmcnt(5)
    s_waitcnt vmcnt(1)
    s_bitcmp1_b32 s3, 0
    s_cbranch_scc1 KM_swc17a
    v_swap_b32 v86, v88
    v_swap_b32 v87, v89
    v_swap_b32 v94, v96
    v_swap_b32 v95, v97
    s_branch KM_swc17b
KM_swc17a:
    v_swap_b32 v84, v90
    v_swap_b32 v85, v91
    v_swap_b32 v92, v98
    v_swap_b32 v93, v99
KM_swc17b:
    s_nop 1
    s_waitcnt vmcnt(0)
    s_branch KM_yfc_chk
KM_yfc_poll:
    buffer_load_dwordx2 v[30:31], v22, s[48:51], s88 offen sc1
    s_waitcnt vmcnt(0)
KM_yfc_chk:
    v_xor_b32 v30, s95, v30
    v_xor_b32 v31, s95, v31
    v_or_b32 v30, v30, v31
    v_cmp_ne_u32 vcc, 0, v30
    s_sub_u32 s94, s94, 1
    s_cmp_lt_i32 s94, 1
    s_cbranch_scc1 KM_yfc_done
    s_cbranch_vccnz KM_yfc_poll
KM_yfc_done:
    v_lshlrev_b32 v30, 28, v9
    v_or_b32 v30, v30, v23
    buffer_load_dwordx4 v[148:151], v23, s[48:51], s89 offen sc1
    buffer_load_dwordx4 v[152:155], v23, s[48:51], s73 offen sc1
    buffer_load_dwordx4 v[156:159], v30, s[48:51], s67 offen sc1
    v_mfma_f32_16x16x32_bf16 v[164:167], a[144:147], v[72:75], v[164:167]
    v_mfma_f32_16x16x32_bf16 v[164:167], a[160:163], v[88:91], v[164:167]
    v_mfma_f32_16x16x32_bf16 v[180:183], a[164:167], v[88:91], v[180:183]
    v_mfma_f32_16x16x32_bf16 v[180:183], a[148:151], v[72:75], v[180:183]
    v_mfma_f32_16x16x32_bf16 v[196:199], a[152:155], v[72:75], v[196:199]
    v_mfma_f32_16x16x32_bf16 v[196:199], a[168:171], v[88:91], v[196:199]
    v_mfma_f32_16x16x32_bf16 v[212:215], a[172:175], v[88:91], v[212:215]
    v_mfma_f32_16x16x32_bf16 v[212:215], a[156:159], v[72:75], v[212:215]
    v_mfma_f32_16x16x32_bf16 v[228:231], a[176:179], v[72:75], v[228:231]
    v_mfma_f32_16x16x32_bf16 v[244:247], a[176:179], v[88:91], v[244:247]
    v_mfma_f32_16x16x32_bf16 v[168:171], a[144:147], v[76:79], v[168:171]
    v_mfma_f32_16x16x32_bf16 v[168:171], a[160:163], v[92:95], v[168:171]
    v_mfma_f32_16x16x32_bf16 v[184:187], a[164:167], v[92:95], v[184:187]
    v_mfma_f32_16x16x32_bf16 v[184:187], a[148:151], v[76:79], v[184:187]
    ds_write_b128 v27, v[164:167] offset:0
    v_mfma_f32_16x16x32_bf16 v[200:203], a[152:155], v[76:79], v[200:203]
    ds_write_b128 v27, v[180:183] offset:1024
    v_mfma_f32_16x16x32_bf16 v[200:203], a[168:171], v[92:95], v[200:203]
    ds_write_b128 v27, v[196:199] offset:2048
    v_mfma_f32_16x16x32_bf16 v[216:219], a[172:175], v[92:95], v[216:219]
    ds_write_b128 v27, v[212:215] offset:3072
    v_mfma_f32_16x16x32_bf16 v[216:219], a[156:159], v[76:79], v[216:219]
    v_cndmask_b32 v228, v244, v228, s[16:17]
    v_cndmask_b32 v229, v245, v229, s[16:17]
    v_mfma_f32_16x16x32_bf16 v[232:235], a[176:179], v[76:79], v[232:235]
    v_cndmask_b32 v230, v246, v230, s[16:17]
    v_cndmask_b32 v231, v247, v231, s[16:17]
    v_mfma_f32_16x16x32_bf16 v[248:251], a[176:179], v[92:95], v[248:251]
    ds_write_b128 v27, v[228:231] offset:13312
    v_mfma_f32_16x16x32_bf16 v[172:175], a[144:147], v[80:83], v[172:175]
    v_mfma_f32_16x16x32_bf16 v[172:175], a[160:163], v[96:99], v[172:175]
    v_mfma_f32_16x16x32_bf16 v[188:191], a[164:167], v[96:99], v[188:191]
    v_mfma_f32_16x16x32_bf16 v[188:191], a[148:151], v[80:83], v[188:191]
    ds_write_b128 v27, v[168:171] offset:4096
    v_mfma_f32_16x16x32_bf16 v[204:207], a[152:155], v[80:83], v[204:207]
    ds_write_b128 v27, v[184:187] offset:5120
    v_mfma_f32_16x16x32_bf16 v[204:207], a[168:171], v[96:99], v[204:207]
    ds_write_b128 v27, v[200:203] offset:6144
    v_mfma_f32_16x16x32_bf16 v[220:223], a[172:175], v[96:99], v[220:223]
    ds_write_b128 v27, v[216:219] offset:7168
    v_mfma_f32_16x16x32_bf16 v[220:223], a[156:159], v[80:83], v[220:223]
    v_cndmask_b32 v232, v248, v232, s[16:17]
    v_cndmask_b32 v233, v249, v233, s[16:17]
    v_mfma_f32_16x16x32_bf16 v[236:239], a[176:179], v[80:83], v[236:239]
    v_cndmask_b32 v234, v250, v234, s[16:17]
    v_cndmask_b32 v235, v251, v235, s[16:17]
    v_mfma_f32_16x16x32_bf16 v[252:255], a[176:179], v[96:99], v[252:255]
    ds_write_b128 v27, v[232:235] offset:14336
    v_mfma_f32_16x16x32_bf16 v[160:163], a[144:147], v[68:71], v[160:163]
    v_mfma_f32_16x16x32_bf16 v[160:163], a[160:163], v[84:87], v[160:163]
    v_mfma_f32_16x16x32_bf16 v[176:179], a[164:167], v[84:87], v[176:179]
    v_mfma_f32_16x16x32_bf16 v[176:179], a[148:151], v[68:71], v[176:179]
    ds_write_b128 v27, v[172:175] offset:8192
    v_mfma_f32_16x16x32_bf16 v[192:195], a[152:155], v[68:71], v[192:195]
    ds_write_b128 v27, v[188:191] offset:9216
    v_mfma_f32_16x16x32_bf16 v[192:195], a[168:171], v[84:87], v[192:195]
    ds_write_b128 v27, v[204:207] offset:10240
    v_mfma_f32_16x16x32_bf16 v[208:211], a[172:175], v[84:87], v[208:211]
    ds_write_b128 v27, v[220:223] offset:11264
    v_mfma_f32_16x16x32_bf16 v[208:211], a[156:159], v[68:71], v[208:211]
    v_cndmask_b32 v236, v252, v236, s[16:17]
    v_cndmask_b32 v237, v253, v237, s[16:17]
    v_mfma_f32_16x16x32_bf16 v[224:227], a[176:179], v[68:71], v[224:227]
    v_cndmask_b32 v238, v254, v238, s[16:17]
    v_cndmask_b32 v239, v255, v239, s[16:17]
    v_mfma_f32_16x16x32_bf16 v[240:243], a[176:179], v[84:87], v[240:243]
    ds_write_b128 v27, v[236:239] offset:15360
    s_nop 7
    v_cndmask_b32 v224, v240, v224, s[16:17]
    v_cndmask_b32 v225, v241, v225, s[16:17]
    v_cndmask_b32 v226, v242, v226, s[16:17]
    v_cndmask_b32 v227, v243, v227, s[16:17]
    ds_write_b128 v27, v[224:227] offset:12288
    s_waitcnt vmcnt(0)
    ds_write_b128 v24, v[148:151]
    ds_write_b128 v24, v[152:155] offset:4096
    s_mov_b64 exec, 0xffff
    ds_write_b128 v11, v[156:159]
    s_mov_b64 exec, -1
    s_branch KM_epi
KM_noconv:
    s_lshl_b32 s85, s70, 6
    s_lshr_b32 s57, s3, 1
    s_lshl_b32 s57, s57, 5
    s_add_u32 s85, s85, s57
    s_and_b32 s57, s3, 1
    s_lshl_b32 s57, s57, 2
    s_add_u32 s85, s85, s57
    s_lshl_b32 s86, s85, 3
    s_add_u32 s86, s86, 0x240000
    s_mul_i32 s85, s85, 1152
    s_mul_i32 s57, s71, 144
    s_add_u32 s85, s85, s57
    s_mul_i32 s87, s3, 3072
    s_add_u32 s87, s87, 133120
    v_add_u32 v10, 0, v0
    buffer_load_dwordx4 a[208:211], v2, s[48:51], s65 offen offset:3072 sc1
    v_mul_u32_u24 v11, 7282, v10
    v_lshrrev_b32 v11, 16, v11
    v_mul_u32_u24 v12, 9, v11
    v_sub_u32 v10, v10, v12
    v_and_b32 v12, 0xfc, v11
    v_add_u32 v11, v11, v12
    s_add_u32 s65, s81, 46080
    s_sub_u32 s65, s65, s77
    buffer_load_dwordx4 a[216:219], v1, s[48:51], s65 offen offset:0 sc1
    v_mul_u32_u24 v11, 1152, v11
    v_lshl_add_u32 v16, v10, 4, v11
    v_add_u32 v10, 64, v0
    v_mul_u32_u24 v11, 7282, v10
    v_lshrrev_b32 v11, 16, v11
    v_mul_u32_u24 v12, 9, v11
    v_sub_u32 v10, v10, v12
    v_and_b32 v12, 0xfc, v11
    v_add_u32 v11, v11, v12
    v_mul_u32_u24 v11, 1152, v11
    v_lshl_add_u32 v17, v10, 4, v11
    v_add_u32 v10, 128, v0
    v_mul_u32_u24 v11, 7282, v10
    v_lshrrev_b32 v11, 16, v11
    buffer_load_dwordx4 a[220:223], v1, s[48:51], s65 offen offset:1024 sc1
    v_mul_u32_u24 v12, 9, v11
    v_sub_u32 v10, v10, v12
    v_and_b32 v12, 0xfc, v11
    v_add_u32 v11, v11, v12
    v_mul_u32_u24 v11, 1152, v11
    v_lshl_add_u32 v18, v10, 4, v11
    v_lshlrev_b32 v10, 28, v9
    v_or_b32 v18, v18, v10
    v_and_b32 v10, 12, v8
    v_add_lshl_u32 v19, v10, v8, 3
    v_mul_u32_u24 v20, 144, v8
    v_add_u32 v20, s87, v20
    v_lshl_add_u32 v21, v9, 3, v20
    buffer_load_dwordx4 a[224:227], v1, s[48:51], s65 offen offset:2048 sc1
    v_lshl_add_u32 v20, v9, 4, v20
    v_min_u32 v22, 35, v0
    v_and_b32 v10, 3, v22
    v_lshrrev_b32 v22, 2, v22
    v_lshlrev_b32 v22, 7, v22
    v_lshl_add_u32 v22, v10, 3, v22
    s_mul_i32 s88, s71, 1152
    s_add_u32 s88, s88, 0x11c0000
    v_lshrrev_b32 v23, 3, v0
    v_lshlrev_b32 v23, 12, v23
    v_and_b32 v10, 7, v0
    v_lshl_add_u32 v23, v10, 4, v23
    s_mul_i32 s89, s71, 294912
    s_lshl_b32 s57, s70, 7
    s_add_u32 s89, s89, s57
    s_add_u32 s89, s89, 0x500000
    s_lshl_b32 s57, s3, 13
    s_add_u32 s67, s89, s57
    s_add_u32 s67, s67, 262144
    s_lshl_b32 s57, s3, 15
    s_add_u32 s89, s89, s57
    s_add_u32 s73, s89, 131072
    s_lshl_b32 s57, s3, 10
    s_add_u32 s57, s57, 145408
    v_add_u32 v24, s57, v1
    buffer_load_dwordx4 a[228:231], v1, s[48:51], s65 offen offset:3072 sc1
    v_bfe_u32 v10, v0, 2, 2
    v_lshl_add_u32 v11, v9, 3, v10
    v_lshl_add_u32 v12, v9, 2, v10
    v_and_b32 v10, 1, v0
    v_lshlrev_b32 v10, 6, v10
    v_bfe_u32 v13, v0, 1, 1
    v_lshl_add_u32 v10, v13, 3, v10
    s_and_b32 s57, s3, 1
    s_lshl_b32 s57, s57, 5
    s_lshr_b32 s62, s3, 1
    s_lshl_b32 s62, s62, 4
    s_add_u32 s57, s57, s62
    s_add_u32 s57, s57, 145408
    v_add_u32 v10, s57, v10
    buffer_load_dwordx4 a[248:251], v3, s[48:51], s65 offen offset:0 sc1
    v_lshl_add_u32 v25, v11, 7, v10
    v_lshl_add_u32 v26, v12, 7, v10
    v_add_u32 v27, s91, v1
    s_xor_b32 s57, s3, 0
    s_mul_i32 s57, s57, 16640
    s_add_u32 s57, s57, 65536
    v_add_u32 v32, s57, v1
    s_xor_b32 s57, s3, 1
    s_mul_i32 s57, s57, 16640
    s_add_u32 s57, s57, 65536
    v_add_u32 v33, s57, v1
    s_xor_b32 s57, s3, 2
    s_mul_i32 s57, s57, 16640
    s_add_u32 s57, s57, 65536
    v_add_u32 v34, s57, v1
    s_xor_b32 s57, s3, 3
    s_mul_i32 s57, s57, 16640
    s_add_u32 s57, s57, 65536
    v_add_u32 v35, s57, v1
    buffer_load_dwordx4 a[232:235], v2, s[48:51], s65 offen offset:0 sc1
    s_mov_b32 s16, -1
    s_mov_b32 s17, 0
    s_lshl_b32 s57, s3, 8
    s_add_u32 s57, s57, 153600
    v_add_u32 v11, s57, v1
    v_lshlrev_b32 v12, 5, v0
    v_and_b32 v12, 1024, v12
    v_sub_u32 v12, 512, v12
    v_add_u32 v13, s87, v1
    buffer_load_dwordx4 a[236:239], v2, s[48:51], s65 offen offset:1024 sc1
    buffer_load_dwordx4 a[240:243], v2, s[48:51], s65 offen offset:2048 sc1
    buffer_load_dwordx4 a[244:247], v2, s[48:51], s65 offen offset:3072 sc1
    s_add_u32 s65, s81, 55296
    s_add_u32 s65, s65, s77
    buffer_load_dwordx4 a[72:75], v1, s[48:51], s65 offen offset:0 sc1
    buffer_load_dwordx4 a[76:79], v1, s[48:51], s65 offen offset:1024 sc1
    buffer_load_dwordx4 a[80:83], v1, s[48:51], s65 offen offset:2048 sc1
    buffer_load_dwordx4 a[84:87], v1, s[48:51], s65 offen offset:3072 sc1
    buffer_load_dwordx4 a[104:107], v3, s[48:51], s65 offen offset:0 sc1
    buffer_load_dwordx4 a[88:91], v2, s[48:51], s65 offen offset:0 sc1
    buffer_load_dwordx4 a[92:95], v2, s[48:51], s65 offen offset:1024 sc1
    buffer_load_dwordx4 a[96:99], v2, s[48:51], s65 offen offset:2048 sc1
    buffer_load_dwordx4 a[100:103], v2, s[48:51], s65 offen offset:3072 sc1
    s_add_u32 m0, s66, 0
    s_add_u32 s65, s81, 64512
    s_sub_u32 s65, s65, s77
    buffer_load_dwordx4 v1, s[48:51], s65 offen offset:0 sc1 lds
    buffer_load_dwordx4 v1, s[48:51], s65 offen offset:1024 sc1 lds
    buffer_load_dwordx4 v1, s[48:51], s65 offen offset:2048 sc1 lds
    buffer_load_dwordx4 v1, s[48:51], s65 offen offset:3072 sc1 lds
    s_waitcnt vmcnt(23)
    v_mov_b32 v10, s95
    v_mul_u32_u24 v30, 16640, v0
    s_mov_b64 exec, 255
    buffer_store_dword v10, v30, s[48:51], s79 offen sc1
    s_mov_b64 exec, -1
    s_add_u32 m0, s66, 4096
    s_add_u32 s65, s81, 68608
    s_sub_u32 s65, s65, s77
    buffer_load_dwordx4 v1, s[48:51], s65 offen offset:0 sc1 lds
    buffer_load_dwordx4 v1, s[48:51], s65 offen offset:1024 sc1 lds
    buffer_load_dwordx4 v1, s[48:51], s65 offen offset:2048 sc1 lds
    buffer_load_dwordx4 v1, s[48:51], s65 offen offset:3072 sc1 lds
    s_add_u32 m0, s66, 8192
    s_add_u32 s65, s81, 72704
    s_sub_u32 s65, s65, s77
    buffer_load_dwordx4 v1, s[48:51], s65 offen offset:0 sc1 lds
    s_add_u32 m0, s66, 8192
    s_add_u32 s65, s81, 72704
    buffer_load_dwordx4 v1, s[48:51], s65 offen offset:1024 sc1 lds
    buffer_load_dwordx4 v1, s[48:51], s65 offen offset:2048 sc1 lds
    s_add_u32 m0, s61, 0
    s_add_u32 s65, s81, 75776
    buffer_load_dwordx4 v1, s[48:51], s65 offen offset:0 sc1 lds
    buffer_load_dwordx4 v1, s[48:51], s65 offen offset:1024 sc1 lds
    s_add_u32 m0, s75, 0
    s_add_u32 s65, s81, 77824
    buffer_load_dwordx4 v1, s[48:51], s65 offen offset:0 sc1 lds
    buffer_load_dwordx4 v1, s[48:51], s65 offen offset:1024 sc1 lds
    buffer_load_dwordx4 v1, s[48:51], s65 offen offset:2048 sc1 lds
    s_load_dwordx8 s[20:27], s[48:49], s82 glc
    s_branch KM_hfn_chk
KM_hfn_poll:
    s_load_dwordx8 s[20:27], s[48:49], s82 glc
KM_hfn_chk:
    s_sub_u32 s94, s94, 1
    s_cmp_lt_i32 s94, 1
    s_waitcnt lgkmcnt(0)
    s_cbranch_scc1 KM_hfn_done
    s_cmp_lg_u32 s20, s95
    s_cbranch_scc1 KM_hfn_poll
    s_cmp_lg_u32 s21, s95
    s_cbranch_scc1 KM_hfn_poll
    s_cmp_lg_u32 s22, s95
    s_cbranch_scc1 KM_hfn_poll
    s_cmp_lg_u32 s23, s95
    s_cbranch_scc1 KM_hfn_poll
    s_cmp_lg_u32 s24, s95
    s_cbranch_scc1 KM_hfn_poll
    s_cmp_lg_u32 s25, s95
    s_cbranch_scc1 KM_hfn_poll
    s_cmp_lg_u32 s26, s95
    s_cbranch_scc1 KM_hfn_poll
    s_cmp_lg_u32 s27, s95
    s_cbranch_scc1 KM_hfn_poll
KM_hfn_done:
    s_add_u32 s84, s80, 0
    s_add_u32 s84, s84, s78
    buffer_load_dwordx4 v[36:39], v4, s[48:51], s84 offen sc1
    buffer_load_dwordx4 v[40:43], v5, s[48:51], s84 offen sc1
    buffer_load_dwordx4 v[44:47], v6, s[48:51], s84 offen sc1
    buffer_load_dwordx4 v[48:51], v7, s[48:51], s84 offen sc1
    s_add_u32 s84, s80, 4096
    s_add_u32 s84, s84, s78
    buffer_load_dwordx4 v[52:55], v4, s[48:51], s84 offen sc1
    buffer_load_dwordx4 v[56:59], v5, s[48:51], s84 offen sc1
    buffer_load_dwordx4 v[60:63], v6, s[48:51], s84 offen sc1
    buffer_load_dwordx4 v[64:67], v7, s[48:51], s84 offen sc1
    s_add_u32 s84, s80, 8192
    s_sub_u32 s84, s84, s78
    buffer_load_dwordx4 v[68:71], v4, s[48:51], s84 offen sc1
    buffer_load_dwordx4 v[72:75], v5, s[48:51], s84 offen sc1
    buffer_load_dwordx4 v[76:79], v6, s[48:51], s84 offen sc1
    buffer_load_dwordx4 v[80:83], v7, s[48:51], s84 offen sc1
    s_waitcnt vmcnt(8)
    s_waitcnt vmcnt(4)
    v_mfma_f32_16x16x32_bf16 v[164:167], a[108:111], v[40:43], 0
    s_add_u32 s84, s80, 12288
    s_sub_u32 s84, s84, s78
    v_mfma_f32_16x16x32_bf16 v[164:167], a[124:127], v[56:59], v[164:167]
    buffer_load_dwordx4 v[84:87], v4, s[48:51], s84 offen sc1
    v_mfma_f32_16x16x32_bf16 v[180:183], a[112:115], v[40:43], 0
    buffer_load_dwordx4 v[88:91], v5, s[48:51], s84 offen sc1
    v_mfma_f32_16x16x32_bf16 v[180:183], a[128:131], v[56:59], v[180:183]
    buffer_load_dwordx4 v[92:95], v6, s[48:51], s84 offen sc1
    v_mfma_f32_16x16x32_bf16 v[196:199], a[116:119], v[40:43], 0
    buffer_load_dwordx4 v[96:99], v7, s[48:51], s84 offen sc1
    v_mfma_f32_16x16x32_bf16 v[196:199], a[132:135], v[56:59], v[196:199]
    s_add_u32 s84, s80, 16384
    s_add_u32 s84, s84, s78
    v_mfma_f32_16x16x32_bf16 v[212:215], a[120:123], v[40:43], 0
    buffer_load_dwordx4 v[100:103], v4, s[48:51], s84 offen sc1
    v_mfma_f32_16x16x32_bf16 v[212:215], a[136:139], v[56:59], v[212:215]
    buffer_load_dwordx4 v[104:107], v5, s[48:51], s84 offen sc1
    v_mfma_f32_16x16x32_bf16 v[228:231], a[140:143], v[40:43], 0
    buffer_load_dwordx4 v[108:111], v6, s[48:51], s84 offen sc1
    v_mfma_f32_16x16x32_bf16 v[244:247], a[140:143], v[56:59], 0
    buffer_load_dwordx4 v[112:115], v7, s[48:51], s84 offen sc1
    v_mfma_f32_16x16x32_bf16 v[168:171], a[108:111], v[44:47], 0
    s_add_u32 s84, s80, 20480
    s_add_u32 s84, s84, s78
    v_mfma_f32_16x16x32_bf16 v[168:171], a[124:127], v[60:63], v[168:171]
    buffer_load_dwordx4 v[116:119], v4, s[48:51], s84 offen sc1
    v_mfma_f32_16x16x32_bf16 v[184:187], a[112:115], v[44:47], 0
    buffer_load_dwordx4 v[120:123], v5, s[48:51], s84 offen sc1
    v_mfma_f32_16x16x32_bf16 v[184:187], a[128:131], v[60:63], v[184:187]
    buffer_load_dwordx4 v[124:127], v6, s[48:51], s84 offen sc1
    v_mfma_f32_16x16x32_bf16 v[200:203], a[116:119], v[44:47], 0
    buffer_load_dwordx4 v[128:131], v7, s[48:51], s84 offen sc1
    v_mfma_f32_16x16x32_bf16 v[200:203], a[132:135], v[60:63], v[200:203]
    s_add_u32 s84, s80, 24576
    s_sub_u32 s84, s84, s78
    v_mfma_f32_16x16x32_bf16 v[216:219], a[120:123], v[44:47], 0
    buffer_load_dwordx4 v[132:135], v4, s[48:51], s84 offen sc1
    v_mfma_f32_16x16x32_bf16 v[216:219], a[136:139], v[60:63], v[216:219]
    buffer_load_dwordx4 v[136:139], v5, s[48:51], s84 offen sc1
    v_mfma_f32_16x16x32_bf16 v[232:235], a[140:143], v[44:47], 0
    buffer_load_dwordx4 v[140:143], v6, s[48:51], s84 offen sc1
    v_mfma_f32_16x16x32_bf16 v[248:251], a[140:143], v[60:63], 0
    buffer_load_dwordx4 v[144:147], v7, s[48:51], s84 offen sc1
    v_mfma_f32_16x16x32_bf16 v[172:175], a[108:111], v[48:51], 0
    v_mfma_f32_16x16x32_bf16 v[172:175], a[124:127], v[64:67], v[172:175]
    v_mfma_f32_16x16x32_bf16 v[188:191], a[112:115], v[48:51], 0
    v_mfma_f32_16x16x32_bf16 v[188:191], a[128:131], v[64:67], v[188:191]
    v_mfma_f32_16x16x32_bf16 v[204:207], a[116:119], v[48:51], 0
    v_mfma_f32_16x16x32_bf16 v[204:207], a[132:135], v[64:67], v[204:207]
    v_mfma_f32_16x16x32_bf16 v[220:223], a[120:123], v[48:51], 0
    v_mfma_f32_16x16x32_bf16 v[220:223], a[136:139], v[64:67], v[220:223]
    v_mfma_f32_16x16x32_bf16 v[236:239], a[140:143], v[48:51], 0
    v_mfma_f32_16x16x32_bf16 v[252:255], a[140:143], v[64:67], 0
    v_mfma_f32_16x16x32_bf16 v[160:163], a[108:111], v[36:39], 0
    v_mfma_f32_16x16x32_bf16 v[160:163], a[124:127], v[52:55], v[160:163]
    v_mfma_f32_16x16x32_bf16 v[176:179], a[112:115], v[36:39], 0
    v_mfma_f32_16x16x32_bf16 v[176:179], a[128:131], v[52:55], v[176:179]
    v_mfma_f32_16x16x32_bf16 v[192:195], a[116:119], v[36:39], 0
    v_mfma_f32_16x16x32_bf16 v[192:195], a[132:135], v[52:55], v[192:195]
    v_mfma_f32_16x16x32_bf16 v[208:211], a[120:123], v[36:39], 0
    v_mfma_f32_16x16x32_bf16 v[208:211], a[136:139], v[52:55], v[208:211]
    v_mfma_f32_16x16x32_bf16 v[224:227], a[140:143], v[36:39], 0
    v_mfma_f32_16x16x32_bf16 v[240:243], a[140:143], v[52:55], 0
    s_waitcnt vmcnt(16)
    s_waitcnt vmcnt(12)
    s_add_u32 s84, s80, 28672
    v_mfma_f32_16x16x32_bf16 v[164:167], a[144:147], v[72:75], v[164:167]
    s_sub_u32 s84, s84, s78
    v_mfma_f32_16x16x32_bf16 v[164:167], a[160:163], v[88:91], v[164:167]
    buffer_load_dwordx4 v[36:39], v4, s[48:51], s84 offen sc1
    v_mfma_f32_16x16x32_bf16 v[180:183], a[164:167], v[88:91], v[180:183]
    buffer_load_dwordx4 v[40:43], v5, s[48:51], s84 offen sc1
    v_mfma_f32_16x16x32_bf16 v[180:183], a[148:151], v[72:75], v[180:183]
    buffer_load_dwordx4 v[44:47], v6, s[48:51], s84 offen sc1
    v_mfma_f32_16x16x32_bf16 v[196:199], a[152:155], v[72:75], v[196:199]
    buffer_load_dwordx4 v[48:51], v7, s[48:51], s84 offen sc1
    v_mfma_f32_16x16x32_bf16 v[196:199], a[168:171], v[88:91], v[196:199]
    s_add_u32 s84, s80, 32768
    s_add_u32 s84, s84, s78
    v_mfma_f32_16x16x32_bf16 v[212:215], a[172:175], v[88:91], v[212:215]
    buffer_load_dwordx4 v[52:55], v4, s[48:51], s84 offen sc1
    v_mfma_f32_16x16x32_bf16 v[212:215], a[156:159], v[72:75], v[212:215]
    buffer_load_dwordx4 v[56:59], v5, s[48:51], s84 offen sc1
    v_mfma_f32_16x16x32_bf16 v[228:231], a[176:179], v[72:75], v[228:231]
    buffer_load_dwordx4 v[60:63], v6, s[48:51], s84 offen sc1
    v_mfma_f32_16x16x32_bf16 v[244:247], a[176:179], v[88:91], v[244:247]
    buffer_load_dwordx4 v[64:67], v7, s[48:51], s84 offen sc1
    v_mfma_f32_16x16x32_bf16 v[168:171], a[144:147], v[76:79], v[168:171]
    v_mfma_f32_16x16x32_bf16 v[168:171], a[160:163], v[92:95], v[168:171]
    v_mfma_f32_16x16x32_bf16 v[184:187], a[164:167], v[92:95], v[184:187]
    v_mfma_f32_16x16x32_bf16 v[184:187], a[148:151], v[76:79], v[184:187]
    v_mfma_f32_16x16x32_bf16 v[200:203], a[152:155], v[76:79], v[200:203]
    v_mfma_f32_16x16x32_bf16 v[200:203], a[168:171], v[92:95], v[200:203]
    v_mfma_f32_16x16x32_bf16 v[216:219], a[172:175], v[92:95], v[216:219]
    v_mfma_f32_16x16x32_bf16 v[216:219], a[156:159], v[76:79], v[216:219]
    v_mfma_f32_16x16x32_bf16 v[232:235], a[176:179], v[76:79], v[232:235]
    v_mfma_f32_16x16x32_bf16 v[248:251], a[176:179], v[92:95], v[248:251]
    v_mfma_f32_16x16x32_bf16 v[172:175], a[144:147], v[80:83], v[172:175]
    v_mfma_f32_16x16x32_bf16 v[172:175], a[160:163], v[96:99], v[172:175]
    v_mfma_f32_16x16x32_bf16 v[188:191], a[164:167], v[96:99], v[188:191]
    v_mfma_f32_16x16x32_bf16 v[188:191], a[148:151], v[80:83], v[188:191]
    v_mfma_f32_16x16x32_bf16 v[204:207], a[152:155], v[80:83], v[204:207]
    v_mfma_f32_16x16x32_bf16 v[204:207], a[168:171], v[96:99], v[204:207]
    v_mfma_f32_16x16x32_bf16 v[220:223], a[172:175], v[96:99], v[220:223]
    v_mfma_f32_16x16x32_bf16 v[220:223], a[156:159], v[80:83], v[220:223]
    v_mfma_f32_16x16x32_bf16 v[236:239], a[176:179], v[80:83], v[236:239]
    v_mfma_f32_16x16x32_bf16 v[252:255], a[176:179], v[96:99], v[252:255]
    v_mfma_f32_16x16x32_bf16 v[160:163], a[144:147], v[68:71], v[160:163]
    v_mfma_f32_16x16x32_bf16 v[160:163], a[160:163], v[84:87], v[160:163]
    v_mfma_f32_16x16x32_bf16 v[176:179], a[164:167], v[84:87], v[176:179]
    v_mfma_f32_16x16x32_bf16 v[176:179], a[148:151], v[68:71], v[176:179]
    v_mfma_f32_16x16x32_bf16 v[192:195], a[152:155], v[68:71], v[192:195]
    v_mfma_f32_16x16x32_bf16 v[192:195], a[168:171], v[84:87], v[192:195]
    v_mfma_f32_16x16x32_bf16 v[208:211], a[172:175], v[84:87], v[208:211]
    v_mfma_f32_16x16x32_bf16 v[208:211], a[156:159], v[68:71], v[208:211]
    v_mfma_f32_16x16x32_bf16 v[224:227], a[176:179], v[68:71], v[224:227]
    v_mfma_f32_16x16x32_bf16 v[240:243], a[176:179], v[84:87], v[240:243]
    s_waitcnt vmcnt(16)
    s_waitcnt vmcnt(12)
    s_add_u32 s84, s80, 36864
    v_mfma_f32_16x16x32_bf16 v[164:167], a[0:3], v[104:107], v[164:167]
    s_add_u32 s84, s84, s78
    v_mfma_f32_16x16x32_bf16 v[164:167], a[16:19], v[120:123], v[164:167]
    buffer_load_dwordx4 v[68:71], v4, s[48:51], s84 offen sc1
    v_mfma_f32_16x16x32_bf16 v[180:183], a[20:23], v[120:123], v[180:183]
    buffer_load_dwordx4 v[72:75], v5, s[48:51], s84 offen sc1
    v_mfma_f32_16x16x32_bf16 v[180:183], a[4:7], v[104:107], v[180:183]
    buffer_load_dwordx4 v[76:79], v6, s[48:51], s84 offen sc1
    v_mfma_f32_16x16x32_bf16 v[196:199], a[8:11], v[104:107], v[196:199]
    buffer_load_dwordx4 v[80:83], v7, s[48:51], s84 offen sc1
    v_mfma_f32_16x16x32_bf16 v[196:199], a[24:27], v[120:123], v[196:199]
    s_add_u32 s84, s80, 40960
    s_sub_u32 s84, s84, s78
    v_mfma_f32_16x16x32_bf16 v[212:215], a[28:31], v[120:123], v[212:215]
    buffer_load_dwordx4 v[84:87], v4, s[48:51], s84 offen sc1
    v_mfma_f32_16x16x32_bf16 v[212:215], a[12:15], v[104:107], v[212:215]
    buffer_load_dwordx4 v[88:91], v5, s[48:51], s84 offen sc1
    v_mfma_f32_16x16x32_bf16 v[228:231], a[32:35], v[104:107], v[228:231]
    buffer_load_dwordx4 v[92:95], v6, s[48:51], s84 offen sc1
    v_mfma_f32_16x16x32_bf16 v[244:247], a[32:35], v[120:123], v[244:247]
    buffer_load_dwordx4 v[96:99], v7, s[48:51], s84 offen sc1
    v_mfma_f32_16x16x32_bf16 v[168:171], a[0:3], v[108:111], v[168:171]
    v_mfma_f32_16x16x32_bf16 v[168:171], a[16:19], v[124:127], v[168:171]
    v_mfma_f32_16x16x32_bf16 v[184:187], a[20:23], v[124:127], v[184:187]
    v_mfma_f32_16x16x32_bf16 v[184:187], a[4:7], v[108:111], v[184:187]
    v_mfma_f32_16x16x32_bf16 v[200:203], a[8:11], v[108:111], v[200:203]
    v_mfma_f32_16x16x32_bf16 v[200:203], a[24:27], v[124:127], v[200:203]
    v_mfma_f32_16x16x32_bf16 v[216:219], a[28:31], v[124:127], v[216:219]
    v_mfma_f32_16x16x32_bf16 v[216:219], a[12:15], v[108:111], v[216:219]
    v_mfma_f32_16x16x32_bf16 v[232:235], a[32:35], v[108:111], v[232:235]
    v_mfma_f32_16x16x32_bf16 v[248:251], a[32:35], v[124:127], v[248:251]
    v_mfma_f32_16x16x32_bf16 v[172:175], a[0:3], v[112:115], v[172:175]
    v_mfma_f32_16x16x32_bf16 v[172:175], a[16:19], v[128:131], v[172:175]
    v_mfma_f32_16x16x32_bf16 v[188:191], a[20:23], v[128:131], v[188:191]
    v_mfma_f32_16x16x32_bf16 v[188:191], a[4:7], v[112:115], v[188:191]
    v_mfma_f32_16x16x32_bf16 v[204:207], a[8:11], v[112:115], v[204:207]
    v_mfma_f32_16x16x32_bf16 v[204:207], a[24:27], v[128:131], v[204:207]
    v_mfma_f32_16x16x32_bf16 v[220:223], a[28:31], v[128:131], v[220:223]
    v_mfma_f32_16x16x32_bf16 v[220:223], a[12:15], v[112:115], v[220:223]
    v_mfma_f32_16x16x32_bf16 v[236:239], a[32:35], v[112:115], v[236:239]
    v_mfma_f32_16x16x32_bf16 v[252:255], a[32:35], v[128:131], v[252:255]
    v_mfma_f32_16x16x32_bf16 v[160:163], a[0:3], v[100:103], v[160:163]
    v_mfma_f32_16x16x32_bf16 v[160:163], a[16:19], v[116:119], v[160:163]
    v_mfma_f32_16x16x32_bf16 v[176:179], a[20:23], v[116:119], v[176:179]
    v_mfma_f32_16x16x32_bf16 v[176:179], a[4:7], v[100:103], v[176:179]
    v_mfma_f32_16x16x32_bf16 v[192:195], a[8:11], v[100:103], v[192:195]
    v_mfma_f32_16x16x32_bf16 v[192:195], a[24:27], v[116:119], v[192:195]
    v_mfma_f32_16x16x32_bf16 v[208:211], a[28:31], v[116:119], v[208:211]
    v_mfma_f32_16x16x32_bf16 v[208:211], a[12:15], v[100:103], v[208:211]
    v_mfma_f32_16x16x32_bf16 v[224:227], a[32:35], v[100:103], v[224:227]
    v_mfma_f32_16x16x32_bf16 v[240:243], a[32:35], v[116:119], v[240:243]
    s_waitcnt vmcnt(16)
    s_waitcnt vmcnt(12)
    s_add_u32 s84, s80, 45056
    v_mfma_f32_16x16x32_bf16 v[164:167], a[36:39], v[136:139], v[164:167]
    s_sub_u32 s84, s84, s78
    v_mfma_f32_16x16x32_bf16 v[164:167], a[52:55], v[40:43], v[164:167]
    buffer_load_dwordx4 v[100:103], v4, s[48:51], s84 offen sc1
    v_mfma_f32_16x16x32_bf16 v[180:183], a[56:59], v[40:43], v[180:183]
    buffer_load_dwordx4 v[104:107], v5, s[48:51], s84 offen sc1
    v_mfma_f32_16x16x32_bf16 v[180:183], a[40:43], v[136:139], v[180:183]
    buffer_load_dwordx4 v[108:111], v6, s[48:51], s84 offen sc1
    v_mfma_f32_16x16x32_bf16 v[196:199], a[44:47], v[136:139], v[196:199]
    buffer_load_dwordx4 v[112:115], v7, s[48:51], s84 offen sc1
    v_add_u32 v30, s66, v1
    v_mfma_f32_16x16x32_bf16 v[196:199], a[60:63], v[40:43], v[196:199]
    s_add_u32 s84, s80, 49152
    s_add_u32 s84, s84, s78
    s_nop 0
    v_mfma_f32_16x16x32_bf16 v[212:215], a[64:67], v[40:43], v[212:215]
    buffer_load_dwordx4 v[116:119], v4, s[48:51], s84 offen sc1
    v_mfma_f32_16x16x32_bf16 v[212:215], a[48:51], v[136:139], v[212:215]
    buffer_load_dwordx4 v[120:123], v5, s[48:51], s84 offen sc1
    v_mfma_f32_16x16x32_bf16 v[228:231], a[68:71], v[136:139], v[228:231]
    buffer_load_dwordx4 v[124:127], v6, s[48:51], s84 offen sc1
    v_mfma_f32_16x16x32_bf16 v[244:247], a[68:71], v[40:43], v[244:247]
    buffer_load_dwordx4 v[128:131], v7, s[48:51], s84 offen sc1
    v_mfma_f32_16x16x32_bf16 v[168:171], a[36:39], v[140:143], v[168:171]
    ds_read_b128 a[108:111], v30 offset:0
    v_mfma_f32_16x16x32_bf16 v[168:171], a[52:55], v[44:47], v[168:171]
    ds_read_b128 a[112:115], v30 offset:1024
    v_mfma_f32_16x16x32_bf16 v[184:187], a[56:59], v[44:47], v[184:187]
    ds_read_b128 a[116:119], v30 offset:2048
    v_mfma_f32_16x16x32_bf16 v[184:187], a[40:43], v[140:143], v[184:187]
    ds_read_b128 a[120:123], v30 offset:3072
    v_mfma_f32_16x16x32_bf16 v[200:203], a[44:47], v[140:143], v[200:203]
    ds_read_b128 a[124:127], v30 offset:4096
    v_mfma_f32_16x16x32_bf16 v[200:203], a[60:63], v[44:47], v[200:203]
    ds_read_b128 a[128:131], v30 offset:5120
    v_mfma_f32_16x16x32_bf16 v[216:219], a[64:67], v[44:47], v[216:219]
    ds_read_b128 a[132:135], v30 offset:6144
    v_mfma_f32_16x16x32_bf16 v[216:219], a[48:51], v[140:143], v[216:219]
    ds_read_b128 a[136:139], v30 offset:7168
    v_mfma_f32_16x16x32_bf16 v[232:235], a[68:71], v[140:143], v[232:235]
    ds_read_b128 a[140:143], v30 offset:8192
    v_mfma_f32_16x16x32_bf16 v[248:251], a[68:71], v[44:47], v[248:251]
    ds_read_b128 a[144:147], v30 offset:9216
    v_mfma_f32_16x16x32_bf16 v[172:175], a[36:39], v[144:147], v[172:175]
    ds_read_b128 a[148:151], v30 offset:10240
    v_add_u32 v30, s61, v1
    v_mfma_f32_16x16x32_bf16 v[172:175], a[52:55], v[48:51], v[172:175]
    s_nop 0
    ds_read_b128 a[152:155], v30 offset:0
    v_mfma_f32_16x16x32_bf16 v[188:191], a[56:59], v[48:51], v[188:191]
    ds_read_b128 a[156:159], v30 offset:1024
    v_add_u32 v30, s75, v1
    v_mfma_f32_16x16x32_bf16 v[188:191], a[40:43], v[144:147], v[188:191]
    s_nop 0
    ds_read_b128 a[160:163], v30 offset:0
    v_mfma_f32_16x16x32_bf16 v[204:207], a[44:47], v[144:147], v[204:207]
    ds_read_b128 a[164:167], v30 offset:1024
    v_mfma_f32_16x16x32_bf16 v[204:207], a[60:63], v[48:51], v[204:207]
    ds_read_b128 a[168:171], v30 offset:2048
    v_mfma_f32_16x16x32_bf16 v[220:223], a[64:67], v[48:51], v[220:223]
    v_mfma_f32_16x16x32_bf16 v[220:223], a[48:51], v[144:147], v[220:223]
    v_mfma_f32_16x16x32_bf16 v[236:239], a[68:71], v[144:147], v[236:239]
    v_mfma_f32_16x16x32_bf16 v[252:255], a[68:71], v[48:51], v[252:255]
    v_mfma_f32_16x16x32_bf16 v[160:163], a[36:39], v[132:135], v[160:163]
    v_mfma_f32_16x16x32_bf16 v[160:163], a[52:55], v[36:39], v[160:163]
    s_waitcnt lgkmcnt(0)
    v_mfma_f32_16x16x32_bf16 v[176:179], a[56:59], v[36:39], v[176:179]
    v_mfma_f32_16x16x32_bf16 v[176:179], a[40:43], v[132:135], v[176:179]
    v_mfma_f32_16x16x32_bf16 v[192:195], a[44:47], v[132:135], v[192:195]
    v_mfma_f32_16x16x32_bf16 v[192:195], a[60:63], v[36:39], v[192:195]
    v_mfma_f32_16x16x32_bf16 v[208:211], a[64:67], v[36:39], v[208:211]
    v_mfma_f32_16x16x32_bf16 v[208:211], a[48:51], v[132:135], v[208:211]
    v_mfma_f32_16x16x32_bf16 v[224:227], a[68:71], v[132:135], v[224:227]
    v_mfma_f32_16x16x32_bf16 v[240:243], a[68:71], v[36:39], v[240:243]
    s_waitcnt vmcnt(16)
    s_cmp_lg_u32 s76, 0
    s_cbranch_scc1 KM_swn8b
    s_bitcmp1_b32 s3, 0
    s_cbranch_scc1 KM_swn8a
    v_swap_b32 v54, v56
    v_swap_b32 v55, v57
    v_swap_b32 v62, v64
    v_swap_b32 v63, v65
    s_branch KM_swn8b
KM_swn8a:
    v_swap_b32 v52, v58
    v_swap_b32 v53, v59
    v_swap_b32 v60, v66
    v_swap_b32 v61, v67
KM_swn8b:
    s_nop 1
    s_waitcnt vmcnt(12)
    v_mfma_f32_16x16x32_bf16 v[164:167], a[180:183], v[56:59], v[164:167]
    s_add_u32 s84, s80, 53248
    s_add_u32 s84, s84, s78
    v_mfma_f32_16x16x32_bf16 v[164:167], a[196:199], v[72:75], v[164:167]
    buffer_load_dwordx4 v[132:135], v4, s[48:51], s84 offen sc1
    v_mfma_f32_16x16x32_bf16 v[180:183], a[200:203], v[72:75], v[180:183]
    buffer_load_dwordx4 v[136:139], v5, s[48:51], s84 offen sc1
    v_mfma_f32_16x16x32_bf16 v[180:183], a[184:187], v[56:59], v[180:183]
    buffer_load_dwordx4 v[140:143], v6, s[48:51], s84 offen sc1
    v_mfma_f32_16x16x32_bf16 v[196:199], a[188:191], v[56:59], v[196:199]
    buffer_load_dwordx4 v[144:147], v7, s[48:51], s84 offen sc1
    v_mfma_f32_16x16x32_bf16 v[196:199], a[204:207], v[72:75], v[196:199]
    s_add_u32 s65, s81, 73728
    v_mfma_f32_16x16x32_bf16 v[212:215], a[208:211], v[72:75], v[212:215]
    buffer_load_dwordx4 a[176:179], v3, s[48:51], s65 offen offset:0 sc1
    v_mfma_f32_16x16x32_bf16 v[212:215], a[192:195], v[56:59], v[212:215]
    buffer_load_dwordx4 a[172:175], v2, s[48:51], s65 offen offset:3072 sc1
    v_mfma_f32_16x16x32_bf16 v[228:231], a[212:215], v[56:59], v[228:231]
    s_add_u32 s84, s80, 57344
    s_sub_u32 s84, s84, s78
    v_mfma_f32_16x16x32_bf16 v[244:247], a[212:215], v[72:75], v[244:247]
    buffer_load_dwordx4 v[36:39], v4, s[48:51], s84 offen sc1
    v_mfma_f32_16x16x32_bf16 v[168:171], a[180:183], v[60:63], v[168:171]
    buffer_load_dwordx4 v[40:43], v5, s[48:51], s84 offen sc1
    v_mfma_f32_16x16x32_bf16 v[168:171], a[196:199], v[76:79], v[168:171]
    buffer_load_dwordx4 v[44:47], v6, s[48:51], s84 offen sc1
    v_mfma_f32_16x16x32_bf16 v[184:187], a[200:203], v[76:79], v[184:187]
    buffer_load_dwordx4 v[48:51], v7, s[48:51], s84 offen sc1
    v_mfma_f32_16x16x32_bf16 v[184:187], a[184:187], v[60:63], v[184:187]
    v_mfma_f32_16x16x32_bf16 v[200:203], a[188:191], v[60:63], v[200:203]
    v_mfma_f32_16x16x32_bf16 v[200:203], a[204:207], v[76:79], v[200:203]
    v_mfma_f32_16x16x32_bf16 v[216:219], a[208:211], v[76:79], v[216:219]
    v_mfma_f32_16x16x32_bf16 v[216:219], a[192:195], v[60:63], v[216:219]
    v_mfma_f32_16x16x32_bf16 v[232:235], a[212:215], v[60:63], v[232:235]
    v_mfma_f32_16x16x32_bf16 v[248:251], a[212:215], v[76:79], v[248:251]
    v_mfma_f32_16x16x32_bf16 v[172:175], a[180:183], v[64:67], v[172:175]
    v_mfma_f32_16x16x32_bf16 v[172:175], a[196:199], v[80:83], v[172:175]
    v_mfma_f32_16x16x32_bf16 v[188:191], a[200:203], v[80:83], v[188:191]
    v_mfma_f32_16x16x32_bf16 v[188:191], a[184:187], v[64:67], v[188:191]
    v_mfma_f32_16x16x32_bf16 v[204:207], a[188:191], v[64:67], v[204:207]
    v_mfma_f32_16x16x32_bf16 v[204:207], a[204:207], v[80:83], v[204:207]
    v_mfma_f32_16x16x32_bf16 v[220:223], a[208:211], v[80:83], v[220:223]
    v_mfma_f32_16x16x32_bf16 v[220:223], a[192:195], v[64:67], v[220:223]
    v_mfma_f32_16x16x32_bf16 v[236:239], a[212:215], v[64:67], v[236:239]
    v_mfma_f32_16x16x32_bf16 v[252:255], a[212:215], v[80:83], v[252:255]
    v_mfma_f32_16x16x32_bf16 v[160:163], a[180:183], v[52:55], v[160:163]
    v_mfma_f32_16x16x32_bf16 v[160:163], a[196:199], v[68:71], v[160:163]
    v_mfma_f32_16x16x32_bf16 v[176:179], a[200:203], v[68:71], v[176:179]
    v_mfma_f32_16x16x32_bf16 v[176:179], a[184:187], v[52:55], v[176:179]
    v_mfma_f32_16x16x32_bf16 v[192:195], a[188:191], v[52:55], v[192:195]
    v_mfma_f32_16x16x32_bf16 v[192:195], a[204:207], v[68:71], v[192:195]
    v_mfma_f32_16x16x32_bf16 v[208:211], a[208:211], v[68:71], v[208:211]
    v_mfma_f32_16x16x32_bf16 v[208:211], a[192:195], v[52:55], v[208:211]
    v_mfma_f32_16x16x32_bf16 v[224:227], a[212:215], v[52:55], v[224:227]
    v_mfma_f32_16x16x32_bf16 v[240:243], a[212:215], v[68:71], v[240:243]
    s_waitcnt vmcnt(18)
    s_cmp_lg_u32 s76, 1
    s_cbranch_scc1 KM_swn10b
    s_bitcmp1_b32 s3, 0
    s_cbranch_scc1 KM_swn10a
    v_swap_b32 v86, v88
    v_swap_b32 v87, v89
    v_swap_b32 v94, v96
    v_swap_b32 v95, v97
    s_branch KM_swn10b
KM_swn10a:
    v_swap_b32 v84, v90
    v_swap_b32 v85, v91
    v_swap_b32 v92, v98
    v_swap_b32 v93, v99
KM_swn10b:
    s_nop 1
    s_waitcnt vmcnt(14)
    s_add_u32 m0, s87, 0
    s_nop 0
    buffer_load_dwordx4 v16, s[36:39], s85 offen lds
    s_add_u32 m0, s87, 1024
    s_nop 0
    buffer_load_dwordx4 v17, s[36:39], s85 offen lds
    s_add_u32 m0, s87, 2048
    s_nop 0
    buffer_load_dwordx4 v18, s[36:39], s85 offen lds
    buffer_load_dwordx2 v[28:29], v19, s[48:51], s86 offen sc1
    v_mfma_f32_16x16x32_bf16 v[164:167], a[216:219], v[88:91], v[164:167]
    s_add_u32 s84, s80, 61440
    s_sub_u32 s84, s84, s78
    v_mfma_f32_16x16x32_bf16 v[164:167], a[232:235], v[104:107], v[164:167]
    buffer_load_dwordx4 v[52:55], v4, s[48:51], s84 offen sc1
    v_mfma_f32_16x16x32_bf16 v[180:183], a[236:239], v[104:107], v[180:183]
    buffer_load_dwordx4 v[56:59], v5, s[48:51], s84 offen sc1
    v_mfma_f32_16x16x32_bf16 v[180:183], a[220:223], v[88:91], v[180:183]
    buffer_load_dwordx4 v[60:63], v6, s[48:51], s84 offen sc1
    v_mfma_f32_16x16x32_bf16 v[196:199], a[224:227], v[88:91], v[196:199]
    buffer_load_dwordx4 v[64:67], v7, s[48:51], s84 offen sc1
    v_mfma_f32_16x16x32_bf16 v[196:199], a[240:243], v[104:107], v[196:199]
    s_add_u32 s84, s80, 65536
    v_mfma_f32_16x16x32_bf16 v[212:215], a[244:247], v[104:107], v[212:215]
    buffer_load_dwordx4 v[68:71], v4, s[48:51], s84 offen sc1
    v_mfma_f32_16x16x32_bf16 v[212:215], a[228:231], v[88:91], v[212:215]
    buffer_load_dwordx4 v[72:75], v5, s[48:51], s84 offen sc1
    v_mfma_f32_16x16x32_bf16 v[228:231], a[248:251], v[88:91], v[228:231]
    buffer_load_dwordx4 v[76:79], v6, s[48:51], s84 offen sc1
    v_mfma_f32_16x16x32_bf16 v[244:247], a[248:251], v[104:107], v[244:247]
    buffer_load_dwordx4 v[80:83], v7, s[48:51], s84 offen sc1
    v_mfma_f32_16x16x32_bf16 v[168:171], a[216:219], v[92:95], v[168:171]
    v_mfma_f32_16x16x32_bf16 v[168:171], a[232:235], v[108:111], v[168:171]
    v_mfma_f32_16x16x32_bf16 v[184:187], a[236:239], v[108:111], v[184:187]
    v_mfma_f32_16x16x32_bf16 v[184:187], a[220:223], v[92:95], v[184:187]
    v_mfma_f32_16x16x32_bf16 v[200:203], a[224:227], v[92:95], v[200:203]
    v_mfma_f32_16x16x32_bf16 v[200:203], a[240:243], v[108:111], v[200:203]
    v_mfma_f32_16x16x32_bf16 v[216:219], a[244:247], v[108:111], v[216:219]
    v_mfma_f32_16x16x32_bf16 v[216:219], a[228:231], v[92:95], v[216:219]
    v_mfma_f32_16x16x32_bf16 v[232:235], a[248:251], v[92:95], v[232:235]
    v_mfma_f32_16x16x32_bf16 v[248:251], a[248:251], v[108:111], v[248:251]
    v_mfma_f32_16x16x32_bf16 v[172:175], a[216:219], v[96:99], v[172:175]
    v_mfma_f32_16x16x32_bf16 v[172:175], a[232:235], v[112:115], v[172:175]
    v_mfma_f32_16x16x32_bf16 v[188:191], a[236:239], v[112:115], v[188:191]
    v_mfma_f32_16x16x32_bf16 v[188:191], a[220:223], v[96:99], v[188:191]
    v_mfma_f32_16x16x32_bf16 v[204:207], a[224:227], v[96:99], v[204:207]
    v_mfma_f32_16x16x32_bf16 v[204:207], a[240:243], v[112:115], v[204:207]
    v_mfma_f32_16x16x32_bf16 v[220:223], a[244:247], v[112:115], v[220:223]
    v_mfma_f32_16x16x32_bf16 v[220:223], a[228:231], v[96:99], v[220:223]
    v_mfma_f32_16x16x32_bf16 v[236:239], a[248:251], v[96:99], v[236:239]
    v_mfma_f32_16x16x32_bf16 v[252:255], a[248:251], v[112:115], v[252:255]
    v_mfma_f32_16x16x32_bf16 v[160:163], a[216:219], v[84:87], v[160:163]
    v_mfma_f32_16x16x32_bf16 v[160:163], a[232:235], v[100:103], v[160:163]
    v_mfma_f32_16x16x32_bf16 v[176:179], a[236:239], v[100:103], v[176:179]
    v_mfma_f32_16x16x32_bf16 v[176:179], a[220:223], v[84:87], v[176:179]
    v_mfma_f32_16x16x32_bf16 v[192:195], a[224:227], v[84:87], v[192:195]
    v_mfma_f32_16x16x32_bf16 v[192:195], a[240:243], v[100:103], v[192:195]
    v_mfma_f32_16x16x32_bf16 v[208:211], a[244:247], v[100:103], v[208:211]
    v_mfma_f32_16x16x32_bf16 v[208:211], a[228:231], v[84:87], v[208:211]
    v_mfma_f32_16x16x32_bf16 v[224:227], a[248:251], v[84:87], v[224:227]
    v_mfma_f32_16x16x32_bf16 v[240:243], a[248:251], v[100:103], v[240:243]
    s_waitcnt vmcnt(22)
    s_waitcnt vmcnt(18)
    s_add_u32 s84, s80, 69632
    v_mfma_f32_16x16x32_bf16 v[164:167], a[72:75], v[120:123], v[164:167]
    buffer_load_dwordx4 v[84:87], v4, s[48:51], s84 offen sc1
    v_mfma_f32_16x16x32_bf16 v[164:167], a[88:91], v[136:139], v[164:167]
    buffer_load_dwordx4 v[88:91], v5, s[48:51], s84 offen sc1
    v_mfma_f32_16x16x32_bf16 v[180:183], a[92:95], v[136:139], v[180:183]
    buffer_load_dwordx4 v[92:95], v6, s[48:51], s84 offen sc1
    v_mfma_f32_16x16x32_bf16 v[180:183], a[76:79], v[120:123], v[180:183]
    buffer_load_dwordx4 v[96:99], v7, s[48:51], s84 offen sc1
    v_mfma_f32_16x16x32_bf16 v[196:199], a[80:83], v[120:123], v[196:199]
    v_mfma_f32_16x16x32_bf16 v[196:199], a[96:99], v[136:139], v[196:199]
    v_mfma_f32_16x16x32_bf16 v[212:215], a[100:103], v[136:139], v[212:215]
    v_mfma_f32_16x16x32_bf16 v[212:215], a[84:87], v[120:123], v[212:215]
    v_mfma_f32_16x16x32_bf16 v[228:231], a[104:107], v[120:123], v[228:231]
    v_mfma_f32_16x16x32_bf16 v[244:247], a[104:107], v[136:139], v[244:247]
    v_mfma_f32_16x16x32_bf16 v[168:171], a[72:75], v[124:127], v[168:171]
    v_mfma_f32_16x16x32_bf16 v[168:171], a[88:91], v[140:143], v[168:171]
    v_mfma_f32_16x16x32_bf16 v[184:187], a[92:95], v[140:143], v[184:187]
    v_mfma_f32_16x16x32_bf16 v[184:187], a[76:79], v[124:127], v[184:187]
    v_mfma_f32_16x16x32_bf16 v[200:203], a[80:83], v[124:127], v[200:203]
    v_mfma_f32_16x16x32_bf16 v[200:203], a[96:99], v[140:143], v[200:203]
    v_mfma_f32_16x16x32_bf16 v[216:219], a[100:103], v[140:143], v[216:219]
    v_mfma_f32_16x16x32_bf16 v[216:219], a[84:87], v[124:127], v[216:219]
    v_mfma_f32_16x16x32_bf16 v[232:235], a[104:107], v[124:127], v[232:235]
    v_mfma_f32_16x16x32_bf16 v[248:251], a[104:107], v[140:143], v[248:251]
    v_mfma_f32_16x16x32_bf16 v[172:175], a[72:75], v[128:131], v[172:175]
    v_mfma_f32_16x16x32_bf16 v[172:175], a[88:91], v[144:147], v[172:175]
    v_mfma_f32_16x16x32_bf16 v[188:191], a[92:95], v[144:147], v[188:191]
    v_mfma_f32_16x16x32_bf16 v[188:191], a[76:79], v[128:131], v[188:191]
    v_mfma_f32_16x16x32_bf16 v[204:207], a[80:83], v[128:131], v[204:207]
    v_mfma_f32_16x16x32_bf16 v[204:207], a[96:99], v[144:147], v[204:207]
    v_mfma_f32_16x16x32_bf16 v[220:223], a[100:103], v[144:147], v[220:223]
    v_mfma_f32_16x16x32_bf16 v[220:223], a[84:87], v[128:131], v[220:223]
    v_mfma_f32_16x16x32_bf16 v[236:239], a[104:107], v[128:131], v[236:239]
    v_mfma_f32_16x16x32_bf16 v[252:255], a[104:107], v[144:147], v[252:255]
    v_mfma_f32_16x16x32_bf16 v[160:163], a[72:75], v[116:119], v[160:163]
    v_mfma_f32_16x16x32_bf16 v[160:163], a[88:91], v[132:135], v[160:163]
    v_mfma_f32_16x16x32_bf16 v[176:179], a[92:95], v[132:135], v[176:179]
    v_mfma_f32_16x16x32_bf16 v[176:179], a[76:79], v[116:119], v[176:179]
    v_mfma_f32_16x16x32_bf16 v[192:195], a[80:83], v[116:119], v[192:195]
    v_mfma_f32_16x16x32_bf16 v[192:195], a[96:99], v[132:135], v[192:195]
    v_mfma_f32_16x16x32_bf16 v[208:211], a[100:103], v[132:135], v[208:211]
    v_mfma_f32_16x16x32_bf16 v[208:211], a[84:87], v[116:119], v[208:211]
    v_mfma_f32_16x16x32_bf16 v[224:227], a[104:107], v[116:119], v[224:227]
    v_mfma_f32_16x16x32_bf16 v[240:243], a[104:107], v[132:135], v[240:243]
    s_waitcnt vmcnt(16)
    s_waitcnt vmcnt(8)
    buffer_load_dwordx2 v[30:31], v22, s[48:51], s88 offen sc1
    v_mfma_f32_16x16x32_bf16 v[164:167], a[108:111], v[40:43], v[164:167]
    ds_read_b128 v[138:141], v20
    ds_read_b128 v[142:145], v20 offset:64
    ds_read_b64 v[146:147], v21 offset:128
    v_mfma_f32_16x16x32_bf16 v[164:167], a[124:127], v[56:59], v[164:167]
    v_mul_f32 v28, v28, v29
    v_mfma_f32_16x16x32_bf16 v[180:183], a[128:131], v[56:59], v[180:183]
    v_mfma_f32_16x16x32_bf16 v[180:183], a[112:115], v[40:43], v[180:183]
    v_mfma_f32_16x16x32_bf16 v[196:199], a[116:119], v[40:43], v[196:199]
    v_mfma_f32_16x16x32_bf16 v[196:199], a[132:135], v[56:59], v[196:199]
    v_mfma_f32_16x16x32_bf16 v[212:215], a[136:139], v[56:59], v[212:215]
    v_mfma_f32_16x16x32_bf16 v[212:215], a[120:123], v[40:43], v[212:215]
    s_waitcnt lgkmcnt(0)
    v_lshlrev_b32 v100, 16, v138
    v_and_b32 v101, 0xffff0000, v138
    v_mfma_f32_16x16x32_bf16 v[228:231], a[140:143], v[40:43], v[228:231]
    v_lshlrev_b32 v102, 16, v139
    v_and_b32 v103, 0xffff0000, v139
    v_mfma_f32_16x16x32_bf16 v[244:247], a[140:143], v[56:59], v[244:247]
    v_lshlrev_b32 v104, 16, v140
    v_and_b32 v105, 0xffff0000, v140
    v_mfma_f32_16x16x32_bf16 v[168:171], a[108:111], v[44:47], v[168:171]
    v_lshlrev_b32 v106, 16, v141
    v_and_b32 v107, 0xffff0000, v141
    v_mfma_f32_16x16x32_bf16 v[168:171], a[124:127], v[60:63], v[168:171]
    v_lshlrev_b32 v108, 16, v142
    v_and_b32 v109, 0xffff0000, v142
    v_mfma_f32_16x16x32_bf16 v[184:187], a[128:131], v[60:63], v[184:187]
    v_lshlrev_b32 v110, 16, v143
    v_and_b32 v111, 0xffff0000, v143
    v_mfma_f32_16x16x32_bf16 v[184:187], a[112:115], v[44:47], v[184:187]
    v_lshlrev_b32 v112, 16, v144
    v_and_b32 v113, 0xffff0000, v144
    v_mfma_f32_16x16x32_bf16 v[200:203], a[116:119], v[44:47], v[200:203]
    v_lshlrev_b32 v114, 16, v145
    v_and_b32 v115, 0xffff0000, v145
    v_mfma_f32_16x16x32_bf16 v[200:203], a[132:135], v[60:63], v[200:203]
    v_lshlrev_b32 v116, 16, v146
    v_and_b32 v117, 0xffff0000, v146
    v_mfma_f32_16x16x32_bf16 v[216:219], a[136:139], v[60:63], v[216:219]
    v_lshlrev_b32 v118, 16, v147
    v_and_b32 v119, 0xffff0000, v147
    v_mfma_f32_16x16x32_bf16 v[216:219], a[120:123], v[44:47], v[216:219]
    v_fma_f32 v120, v100, v29, -v28
    v_fma_f32 v121, v101, v29, -v28
    v_mfma_f32_16x16x32_bf16 v[232:235], a[140:143], v[44:47], v[232:235]
    v_fma_f32 v122, v102, v29, -v28
    v_fma_f32 v123, v103, v29, -v28
    v_mfma_f32_16x16x32_bf16 v[248:251], a[140:143], v[60:63], v[248:251]
    v_fma_f32 v124, v104, v29, -v28
    v_fma_f32 v125, v105, v29, -v28
    v_mfma_f32_16x16x32_bf16 v[172:175], a[108:111], v[48:51], v[172:175]
    v_fma_f32 v126, v106, v29, -v28
    v_fma_f32 v127, v107, v29, -v28
    v_mfma_f32_16x16x32_bf16 v[172:175], a[124:127], v[64:67], v[172:175]
    v_fma_f32 v128, v108, v29, -v28
    v_fma_f32 v129, v109, v29, -v28
    v_mfma_f32_16x16x32_bf16 v[188:191], a[128:131], v[64:67], v[188:191]
    v_fma_f32 v130, v110, v29, -v28
    v_fma_f32 v131, v111, v29, -v28
    v_mfma_f32_16x16x32_bf16 v[188:191], a[112:115], v[48:51], v[188:191]
    v_fma_f32 v132, v112, v29, -v28
    v_fma_f32 v133, v113, v29, -v28
    v_mfma_f32_16x16x32_bf16 v[204:207], a[116:119], v[48:51], v[204:207]
    v_fma_f32 v134, v114, v29, -v28
    v_fma_f32 v135, v115, v29, -v28
    v_mfma_f32_16x16x32_bf16 v[204:207], a[132:135], v[64:67], v[204:207]
    v_fma_f32 v136, v116, v29, -v28
    v_fma_f32 v137, v117, v29, -v28
    v_mfma_f32_16x16x32_bf16 v[220:223], a[136:139], v[64:67], v[220:223]
    v_fma_f32 v138, v118, v29, -v28
    v_fma_f32 v139, v119, v29, -v28
    v_mfma_f32_16x16x32_bf16 v[220:223], a[120:123], v[48:51], v[220:223]
    v_mfma_f32_16x16x32_bf16 v[236:239], a[140:143], v[48:51], v[236:239]
    v_mfma_f32_16x16x32_bf16 v[252:255], a[140:143], v[64:67], v[252:255]
    v_mfma_f32_16x16x32_bf16 v[160:163], a[108:111], v[36:39], v[160:163]
    v_mfma_f32_16x16x32_bf16 v[160:163], a[124:127], v[52:55], v[160:163]
    v_mfma_f32_16x16x32_bf16 v[176:179], a[128:131], v[52:55], v[176:179]
    v_mfma_f32_16x16x32_bf16 v[176:179], a[112:115], v[36:39], v[176:179]
    v_mfma_f32_16x16x32_bf16 v[192:195], a[116:119], v[36:39], v[192:195]
    v_mfma_f32_16x16x32_bf16 v[192:195], a[132:135], v[52:55], v[192:195]
    v_mfma_f32_16x16x32_bf16 v[208:211], a[136:139], v[52:55], v[208:211]
    v_mfma_f32_16x16x32_bf16 v[208:211], a[120:123], v[36:39], v[208:211]
    v_mfma_f32_16x16x32_bf16 v[224:227], a[140:143], v[36:39], v[224:227]
    v_mfma_f32_16x16x32_bf16 v[240:243], a[140:143], v[52:55], v[240:243]
    s_waitcnt vmcnt(5)
    s_waitcnt vmcnt(1)
    s_bitcmp1_b32 s3, 0
    s_cbranch_scc1 KM_swn17a
    v_swap_b32 v86, v88
    v_swap_b32 v87, v89
    v_swap_b32 v94, v96
    v_swap_b32 v95, v97
    s_branch KM_swn17b
KM_swn17a:
    v_swap_b32 v84, v90
    v_swap_b32 v85, v91
    v_swap_b32 v92, v98
    v_swap_b32 v93, v99
KM_swn17b:
    s_nop 1
    s_waitcnt vmcnt(0)
    s_branch KM_yfn_chk
KM_yfn_poll:
    buffer_load_dwordx2 v[30:31], v22, s[48:51], s88 offen sc1
    s_waitcnt vmcnt(0)
KM_yfn_chk:
    v_xor_b32 v30, s95, v30
    v_xor_b32 v31, s95, v31
    v_or_b32 v30, v30, v31
    v_cmp_ne_u32 vcc, 0, v30
    s_sub_u32 s94, s94, 1
    s_cmp_lt_i32 s94, 1
    s_cbranch_scc1 KM_yfn_done
    s_cbranch_vccnz KM_yfn_poll
KM_yfn_done:
    v_lshlrev_b32 v30, 28, v9
    v_or_b32 v30, v30, v23
    buffer_load_dwordx4 v[148:151], v23, s[48:51], s89 offen sc1
    buffer_load_dwordx4 v[152:155], v23, s[48:51], s73 offen sc1
    buffer_load_dwordx4 v[156:159], v30, s[48:51], s67 offen sc1
    v_mfma_f32_16x16x32_bf16 v[164:167], a[144:147], v[72:75], v[164:167]
    v_mfma_f32_16x16x32_bf16 v[164:167], a[160:163], v[88:91], v[164:167]
    v_mfma_f32_16x16x32_bf16 v[180:183], a[164:167], v[88:91], v[180:183]
    v_mfma_f32_16x16x32_bf16 v[180:183], a[148:151], v[72:75], v[180:183]
    v_mfma_f32_16x16x32_bf16 v[196:199], a[152:155], v[72:75], v[196:199]
    v_mfma_f32_16x16x32_bf16 v[196:199], a[168:171], v[88:91], v[196:199]
    v_mfma_f32_16x16x32_bf16 v[212:215], a[172:175], v[88:91], v[212:215]
    v_mfma_f32_16x16x32_bf16 v[212:215], a[156:159], v[72:75], v[212:215]
    v_mfma_f32_16x16x32_bf16 v[228:231], a[176:179], v[72:75], v[228:231]
    v_mfma_f32_16x16x32_bf16 v[244:247], a[176:179], v[88:91], v[244:247]
    v_mfma_f32_16x16x32_bf16 v[168:171], a[144:147], v[76:79], v[168:171]
    v_mfma_f32_16x16x32_bf16 v[168:171], a[160:163], v[92:95], v[168:171]
    v_mfma_f32_16x16x32_bf16 v[184:187], a[164:167], v[92:95], v[184:187]
    v_mfma_f32_16x16x32_bf16 v[184:187], a[148:151], v[76:79], v[184:187]
    ds_write_b128 v27, v[164:167] offset:0
    v_mfma_f32_16x16x32_bf16 v[200:203], a[152:155], v[76:79], v[200:203]
    ds_write_b128 v27, v[180:183] offset:1024
    v_mfma_f32_16x16x32_bf16 v[200:203], a[168:171], v[92:95], v[200:203]
    ds_write_b128 v27, v[196:199] offset:2048
    v_mfma_f32_16x16x32_bf16 v[216:219], a[172:175], v[92:95], v[216:219]
    ds_write_b128 v27, v[212:215] offset:3072
    v_mfma_f32_16x16x32_bf16 v[216:219], a[156:159], v[76:79], v[216:219]
    v_cndmask_b32 v228, v244, v228, s[16:17]
    v_cndmask_b32 v229, v245, v229, s[16:17]
    v_mfma_f32_16x16x32_bf16 v[232:235], a[176:179], v[76:79], v[232:235]
    v_cndmask_b32 v230, v246, v230, s[16:17]
    v_cndmask_b32 v231, v247, v231, s[16:17]
    v_mfma_f32_16x16x32_bf16 v[248:251], a[176:179], v[92:95], v[248:251]
    ds_write_b128 v27, v[228:231] offset:13312
    v_mfma_f32_16x16x32_bf16 v[172:175], a[144:147], v[80:83], v[172:175]
    v_mfma_f32_16x16x32_bf16 v[172:175], a[160:163], v[96:99], v[172:175]
    v_mfma_f32_16x16x32_bf16 v[188:191], a[164:167], v[96:99], v[188:191]
    v_mfma_f32_16x16x32_bf16 v[188:191], a[148:151], v[80:83], v[188:191]
    ds_write_b128 v27, v[168:171] offset:4096
    v_mfma_f32_16x16x32_bf16 v[204:207], a[152:155], v[80:83], v[204:207]
    ds_write_b128 v27, v[184:187] offset:5120
    v_mfma_f32_16x16x32_bf16 v[204:207], a[168:171], v[96:99], v[204:207]
    ds_write_b128 v27, v[200:203] offset:6144
    v_mfma_f32_16x16x32_bf16 v[220:223], a[172:175], v[96:99], v[220:223]
    ds_write_b128 v27, v[216:219] offset:7168
    v_mfma_f32_16x16x32_bf16 v[220:223], a[156:159], v[80:83], v[220:223]
    v_cndmask_b32 v232, v248, v232, s[16:17]
    v_cndmask_b32 v233, v249, v233, s[16:17]
    v_mfma_f32_16x16x32_bf16 v[236:239], a[176:179], v[80:83], v[236:239]
    v_cndmask_b32 v234, v250, v234, s[16:17]
    v_cndmask_b32 v235, v251, v235, s[16:17]
    v_mfma_f32_16x16x32_bf16 v[252:255], a[176:179], v[96:99], v[252:255]
    ds_write_b128 v27, v[232:235] offset:14336
    v_mfma_f32_16x16x32_bf16 v[160:163], a[144:147], v[68:71], v[160:163]
    v_mfma_f32_16x16x32_bf16 v[160:163], a[160:163], v[84:87], v[160:163]
    v_mfma_f32_16x16x32_bf16 v[176:179], a[164:167], v[84:87], v[176:179]
    v_mfma_f32_16x16x32_bf16 v[176:179], a[148:151], v[68:71], v[176:179]
    ds_write_b128 v27, v[172:175] offset:8192
    v_mfma_f32_16x16x32_bf16 v[192:195], a[152:155], v[68:71], v[192:195]
    ds_write_b128 v27, v[188:191] offset:9216
    v_mfma_f32_16x16x32_bf16 v[192:195], a[168:171], v[84:87], v[192:195]
    ds_write_b128 v27, v[204:207] offset:10240
    v_mfma_f32_16x16x32_bf16 v[208:211], a[172:175], v[84:87], v[208:211]
    ds_write_b128 v27, v[220:223] offset:11264
    v_mfma_f32_16x16x32_bf16 v[208:211], a[156:159], v[68:71], v[208:211]
    v_cndmask_b32 v236, v252, v236, s[16:17]
    v_cndmask_b32 v237, v253, v237, s[16:17]
    v_mfma_f32_16x16x32_bf16 v[224:227], a[176:179], v[68:71], v[224:227]
    v_cndmask_b32 v238, v254, v238, s[16:17]
    v_cndmask_b32 v239, v255, v239, s[16:17]
    v_mfma_f32_16x16x32_bf16 v[240:243], a[176:179], v[84:87], v[240:243]
    ds_write_b128 v27, v[236:239] offset:15360
    s_nop 7
    v_cndmask_b32 v224, v240, v224, s[16:17]
    v_cndmask_b32 v225, v241, v225, s[16:17]
    v_cndmask_b32 v226, v242, v226, s[16:17]
    v_cndmask_b32 v227, v243, v227, s[16:17]
    ds_write_b128 v27, v[224:227] offset:12288
    s_waitcnt vmcnt(0)
    ds_write_b128 v24, v[148:151]
    ds_write_b128 v24, v[152:155] offset:4096
    s_mov_b64 exec, 0xffff
    ds_write_b128 v11, v[156:159]
    s_mov_b64 exec, -1
KM_epi:
    v_add_u32 v4, v32, v12
    v_add_u32 v5, v33, v12
    v_add_u32 v6, v34, v12
    v_add_u32 v7, v35, v12
    v_pk_add_f32 v[160:161], v[160:161], v[100:101]
    v_pk_add_f32 v[162:163], v[162:163], v[102:103]
    v_pk_add_f32 v[176:177], v[176:177], v[104:105]
    v_pk_add_f32 v[178:179], v[178:179], v[106:107]
    v_pk_add_f32 v[192:193], v[192:193], v[108:109]
    v_pk_add_f32 v[194:195], v[194:195], v[110:111]
    v_pk_add_f32 v[208:209], v[208:209], v[112:113]
    v_pk_add_f32 v[210:211], v[210:211], v[114:115]
    s_waitcnt lgkmcnt(0)
    s_barrier
    ds_read_b64_tr_b16 v[84:85], v25 offset:0
    ds_read_b64_tr_b16 v[86:87], v25 offset:512
    ds_read_b64_tr_b16 v[88:89], v25 offset:4096
    ds_read_b64_tr_b16 v[90:91], v25 offset:4608
    ds_read_b64_tr_b16 v[92:93], v26 offset:8192
    ds_read_b128 v[36:39], v33 offset:0
    ds_read_b128 v[40:43], v33 offset:1024
    ds_read_b128 v[44:47], v33 offset:2048
    ds_read_b128 v[48:51], v33 offset:3072
    ds_read_b128 v[52:55], v34 offset:4096
    ds_read_b128 v[56:59], v34 offset:5120
    ds_read_b128 v[60:63], v34 offset:6144
    ds_read_b128 v[64:67], v34 offset:7168
    s_waitcnt lgkmcnt(8)
    ds_read_b128 v[68:71], v35 offset:8192
    ds_read_b128 v[72:75], v35 offset:9216
    ds_read_b128 v[76:79], v35 offset:10240
    ds_read_b128 v[80:83], v35 offset:11264
    v_lshlrev_b32 v224, 16, v84
    v_and_b32 v225, 0xffff0000, v84
    v_lshlrev_b32 v226, 16, v85
    v_and_b32 v227, 0xffff0000, v85
    v_lshlrev_b32 v228, 16, v86
    v_and_b32 v229, 0xffff0000, v86
    v_lshlrev_b32 v230, 16, v87
    v_and_b32 v231, 0xffff0000, v87
    v_lshlrev_b32 v232, 16, v88
    v_and_b32 v233, 0xffff0000, v88
    v_lshlrev_b32 v234, 16, v89
    v_and_b32 v235, 0xffff0000, v89
    v_lshlrev_b32 v236, 16, v90
    v_and_b32 v237, 0xffff0000, v90
    v_lshlrev_b32 v238, 16, v91
    v_and_b32 v239, 0xffff0000, v91
    v_lshlrev_b32 v240, 16, v92
    v_and_b32 v241, 0xffff0000, v92
    v_lshlrev_b32 v242, 16, v93
    v_and_b32 v243, 0xffff0000, v93
    s_waitcnt lgkmcnt(4)
    ds_read_b128 v[164:167], v32 offset:12288
    ds_read_b128 v[168:171], v4 offset:12288
    ds_read_b128 v[172:175], v33 offset:13312
    ds_read_b128 v[180:183], v5 offset:13312
    ds_read_b128 v[184:187], v34 offset:14336
    ds_read_b128 v[188:191], v6 offset:14336
    ds_read_b128 v[196:199], v35 offset:15360
    ds_read_b128 v[200:203], v7 offset:15360
    v_pk_fma_f32 v[160:161], v[120:121], v[224:225], v[160:161]
    v_pk_fma_f32 v[162:163], v[122:123], v[226:227], v[162:163]
    v_pk_fma_f32 v[176:177], v[124:125], v[228:229], v[176:177]
    v_pk_fma_f32 v[178:179], v[126:127], v[230:231], v[178:179]
    v_pk_fma_f32 v[192:193], v[128:129], v[232:233], v[192:193]
    v_pk_fma_f32 v[194:195], v[130:131], v[234:235], v[194:195]
    v_pk_fma_f32 v[208:209], v[132:133], v[236:237], v[208:209]
    v_pk_fma_f32 v[210:211], v[134:135], v[238:239], v[210:211]
    v_pk_fma_f32 v[116:117], v[136:137], v[240:241], v[116:117]
    v_pk_fma_f32 v[118:119], v[138:139], v[242:243], v[118:119]
    v_pk_add_f32 v[36:37], v[36:37], v[52:53]
    v_pk_add_f32 v[38:39], v[38:39], v[54:55]
    v_pk_add_f32 v[40:41], v[40:41], v[56:57]
    v_pk_add_f32 v[42:43], v[42:43], v[58:59]
    v_pk_add_f32 v[44:45], v[44:45], v[60:61]
    v_pk_add_f32 v[46:47], v[46:47], v[62:63]
    v_pk_add_f32 v[48:49], v[48:49], v[64:65]
    v_pk_add_f32 v[50:51], v[50:51], v[66:67]
    s_waitcnt lgkmcnt(8)
    v_pk_add_f32 v[160:161], v[160:161], v[68:69]
    v_pk_add_f32 v[162:163], v[162:163], v[70:71]
    v_pk_add_f32 v[176:177], v[176:177], v[72:73]
    v_pk_add_f32 v[178:179], v[178:179], v[74:75]
    v_pk_add_f32 v[192:193], v[192:193], v[76:77]
    v_pk_add_f32 v[194:195], v[194:195], v[78:79]
    v_pk_add_f32 v[208:209], v[208:209], v[80:81]
    v_pk_add_f32 v[210:211], v[210:211], v[82:83]
    v_pk_add_f32 v[160:161], v[160:161], v[36:37]
    v_pk_add_f32 v[162:163], v[162:163], v[38:39]
    v_pk_add_f32 v[176:177], v[176:177], v[40:41]
    v_pk_add_f32 v[178:179], v[178:179], v[42:43]
    v_pk_add_f32 v[192:193], v[192:193], v[44:45]
    v_pk_add_f32 v[194:195], v[194:195], v[46:47]
    v_pk_add_f32 v[208:209], v[208:209], v[48:49]
    v_pk_add_f32 v[210:211], v[210:211], v[50:51]
    v_cvt_pk_bf16_f32 v148, v160, v161
    v_cvt_pk_bf16_f32 v149, v162, v163
    v_cvt_pk_bf16_f32 v150, v176, v177
    v_cvt_pk_bf16_f32 v151, v178, v179
    v_cvt_pk_bf16_f32 v152, v192, v193
    v_cvt_pk_bf16_f32 v153, v194, v195
    v_cvt_pk_bf16_f32 v154, v208, v209
    v_cvt_pk_bf16_f32 v155, v210, v211
    s_waitcnt lgkmcnt(0)
    ds_write_b128 v20, v[148:151]
    ds_write_b128 v20, v[152:155] offset:64
    v_pk_add_f32 v[164:165], v[164:165], v[184:185]
    v_pk_add_f32 v[166:167], v[166:167], v[186:187]
    v_pk_add_f32 v[168:169], v[168:169], v[188:189]
    v_pk_add_f32 v[170:171], v[170:171], v[190:191]
    v_pk_add_f32 v[172:173], v[172:173], v[196:197]
    v_pk_add_f32 v[174:175], v[174:175], v[198:199]
    v_pk_add_f32 v[180:181], v[180:181], v[200:201]
    v_pk_add_f32 v[182:183], v[182:183], v[202:203]
    v_pk_add_f32 v[164:165], v[164:165], v[172:173]
    v_pk_add_f32 v[166:167], v[166:167], v[174:175]
    v_pk_add_f32 v[168:169], v[168:169], v[180:181]
    v_pk_add_f32 v[170:171], v[170:171], v[182:183]
    v_pk_add_f32 v[164:165], v[164:165], v[168:169]
    v_pk_add_f32 v[166:167], v[166:167], v[170:171]
    v_pk_add_f32 v[116:117], v[116:117], v[164:165]
    v_pk_add_f32 v[118:119], v[118:119], v[166:167]
    v_cvt_pk_bf16_f32 v156, v116, v117
    v_cvt_pk_bf16_f32 v157, v118, v119
    s_mov_b64 exec, s[16:17]
    ds_write_b64 v21, v[156:157] offset:128
    s_mov_b64 exec, -1
    ds_read_b128 v[36:39], v13 offset:0
    ds_read_b128 v[40:43], v13 offset:1024
    ds_read_b128 v[44:47], v13 offset:2048
    s_waitcnt lgkmcnt(2)
    buffer_store_dwordx4 v[36:39], v16, s[44:47], s85 offen nt
    s_waitcnt lgkmcnt(1)
    buffer_store_dwordx4 v[40:43], v17, s[44:47], s85 offen nt
    s_waitcnt lgkmcnt(0)
    buffer_store_dwordx4 v[44:47], v18, s[44:47], s85 offen nt
KM_end:
    s_endpgm

.section .rodata,"a"
.p2align 6
.amdhsa_kernel parallel_sum__ssm_conv_h3__mixer_gmlp__prompt_kernel
  .amdhsa_next_free_vgpr 512
  .amdhsa_next_free_sgpr 102
  .amdhsa_accum_offset 256
  .amdhsa_group_segment_fixed_size 0
  .amdhsa_kernarg_size 112
  .amdhsa_user_sgpr_count 2
  .amdhsa_user_sgpr_kernarg_segment_ptr 1
  .amdhsa_system_sgpr_workgroup_id_x 1
  .amdhsa_float_denorm_mode_32 3
  .amdhsa_float_denorm_mode_16_64 3
.end_amdhsa_kernel
```
